```python
import torch

def _softmax(x, axis=-1):
    return torch.softmax(x, dim=axis)

def _gelu(x):
    return torch.nn.functional.gelu(x, approximate='tanh')

def _silu(x):
    return torch.nn.functional.silu(x)

def _sigmoid(x):
    return torch.sigmoid(x)

def _layernorm(x, axis=-1, eps=1e-05):
    m = x.mean(dim=axis, keepdim=True)
    v = x.var(dim=axis, keepdim=True, unbiased=False)
    return (x - m) / torch.sqrt(v + eps)

def _scatter_add(tgt, idx, src, axis=0):
    return tgt.clone().index_add_(axis, idx, src)

def _segment_sum(src, seg, n):
    out = torch.zeros((n,) + src.shape[1:], dtype=src.dtype)
    return out.index_add_(0, seg, src)

def _pad(x, pw):
    flat = tuple((v for pair in reversed(pw) for v in pair))
    return torch.nn.functional.pad(x, flat)
kernel_name = 'sequential_preLN__memory_aug_recurrent_mem_tr__dense_activation_relu__prompt'

def setup_inputs():

    _w = lambda a: (lambda t: t.to(torch.bfloat16) if t.is_floating_point() else t)(torch.as_tensor(a))

    def _A_setup():
        B, S, Dm = (1, 2048, 576)
        H, Dh = (32, 128)
        M, seg = (8, 32)
        seg = min(seg, S)
        S = S // seg * seg
        return {'x': _w((lambda *s: torch.randn(*s, dtype=torch.bfloat16) * 0.05)(B, S, Dm)), 'mem0': _w((lambda *s: torch.randn(*s, dtype=torch.bfloat16) * 0.2)(B, M, Dm)), 'Wq': _w((lambda *s: torch.randn(*s, dtype=torch.bfloat16) * 1.6)(Dm, H, Dh) * Dm ** (-0.5)), 'Wk': _w((lambda *s: torch.randn(*s, dtype=torch.bfloat16) * 1.6)(Dm, H, Dh) * Dm ** (-0.5)), 'Wv': _w((lambda *s: torch.randn(*s, dtype=torch.bfloat16) * 0.2)(Dm, H, Dh) * Dm ** (-0.5)), 'Wo': _w((lambda *s: torch.randn(*s, dtype=torch.bfloat16) * 0.2)(H, Dh, Dm) * (H * Dh) ** (-0.5)), 'seg_len': seg}
    _A_in = _A_setup()

    def _B_setup():
        B, S, D, Dff = (1, 2048, 576, 4608)
        return {'x': _w((lambda *s: torch.randn(*s, dtype=torch.bfloat16) * 0.05)(B, S, D)), 'w1': _w((lambda *s: torch.randn(*s, dtype=torch.bfloat16) * 0.05)(D, Dff)), 'w2': _w((lambda *s: torch.randn(*s, dtype=torch.bfloat16) * 0.05)(Dff, D))}
    _B_in = _B_setup()
    return {'A_x': _A_in['x'], 'A_mem0': _A_in['mem0'], 'A_Wq': _A_in['Wq'], 'A_Wk': _A_in['Wk'], 'A_Wv': _A_in['Wv'], 'A_Wo': _A_in['Wo'], 'A_seg_len': _A_in['seg_len'], 'B_x': _B_in['x'], 'B_w1': _B_in['w1'], 'B_w2': _B_in['w2']}

def reference(A_x, A_mem0, A_Wq, A_Wk, A_Wv, A_Wo, A_seg_len, B_x, B_w1, B_w2):

    def _A_ref(x, mem0, Wq, Wk, Wv, Wo, seg_len):
        B, S, Dm = x.shape
        H, Dh = (Wq.shape[1], Wq.shape[2])
        M = mem0.shape[1]
        scale = Dh ** (-0.5)
        n_seg = S // seg_len
        L = M + seg_len
        idx = torch.arange(L)
        mask = (idx[:, None] < M) | (idx[:, None] >= idx[None, :])
        mem = mem0
        outs = []
        for s in range(n_seg):
            xs = x[:, s * seg_len:(s + 1) * seg_len, :].clone()
            h = torch.concatenate([mem, xs], axis=1)
            q = torch.einsum('btd,dhe->bhte', h, Wq)
            k = torch.einsum('btd,dhe->bhte', h, Wk)
            v = torch.einsum('btd,dhe->bhte', h, Wv)
            scores = torch.einsum('bhqe,bhke->bhqk', q, k) * scale
            scores = torch.where(mask[None, None], scores, -1000000000.0)
            p = _softmax(scores, axis=-1)
            o = torch.einsum('bhqk,bhke->bhqe', p, v)
            o = torch.einsum('bhte,hed->btd', o, Wo)
            mem = o[:, :M, :].clone()
            outs.append(o[:, M:, :])
        return torch.concatenate(outs, axis=1)

    def _B_ref(x, w1, w2):
        h = torch.einsum('bsd,df->bsf', x, w1)
        zero = torch.zeros_like(h)
        h = torch.maximum(h, zero)
        return torch.einsum('bsf,fd->bsd', h, w2)
    x = A_x
    h = x + _A_ref(_layernorm(x, axis=-1), A_mem0, A_Wq, A_Wk, A_Wv, A_Wo, A_seg_len)
    h2 = h + _B_ref(_layernorm(h, axis=-1), B_w1, B_w2)
    return h2
```

```asm
; @launch grid=(256,1,1) block=(256,1,1) lds=163840
.amdgcn_target "amdgcn-amd-amdhsa--gfx950"
.text
.globl sequential_preLN__memory_aug_recurrent_mem_tr__dense_activation_relu__prompt_kernel
.p2align 8
.type sequential_preLN__memory_aug_recurrent_mem_tr__dense_activation_relu__prompt_kernel,@function
sequential_preLN__memory_aug_recurrent_mem_tr__dense_activation_relu__prompt_kernel:
    s_cmp_ge_u32 s2, 256
    s_cbranch_scc1 Lexit2
    s_getreg_b32 s71, hwreg(HW_REG_XCC_ID)
    s_and_b32 s71, s71, 7
    s_load_dwordx2 s[4:5], s[0:1], 96
    s_load_dwordx2 s[12:13], s[0:1], 88
    v_lshrrev_b32 v1, 6, v0
    s_nop 0
    v_readfirstlane_b32 s17, v1
    s_waitcnt lgkmcnt(0)
    s_mov_b32 s6, 268435456
    s_mov_b32 s7, 0x20000
    s_mov_b32 s14, 256
    s_mov_b32 s15, 0x20000
    s_lshr_b32 s88, s71, 1
    s_lshl_b32 s88, s88, 6
    s_cmp_lg_u32 s17, 0
    s_cbranch_scc1 Lst1
    s_mov_b64 exec, 1
    v_mov_b32 v4, 1
    s_and_b32 s20, s71, 1
    s_lshl_b32 s20, s20, 2
    s_add_u32 s20, s20, s88
    v_mov_b32 v5, s20
    buffer_atomic_add v4, v5, s[12:15], 0 offen sc0
    s_waitcnt vmcnt(0)
    v_mov_b32 v5, 163072
    ds_write_b32 v5, v4
    s_waitcnt lgkmcnt(0)
    s_mov_b64 exec, -1
Lst1:
    s_barrier
    v_mov_b32 v5, 163072
    ds_read_b32 v4, v5
    s_waitcnt lgkmcnt(0)
    v_readfirstlane_b32 s72, v4
    s_barrier
    s_nop 1
    s_mov_b32 s16, s72
    s_cmp_lg_u32 s71, 0
    s_cbranch_scc1 Lspec
    s_cmp_lt_u32 s72, 32
    s_cbranch_scc1 Lchain
    s_branch Lresolve
Lspec:
    s_cmp_ge_u32 s72, 32
    s_cbranch_scc1 Lresolve
    s_sub_u32 s20, s71, 1
    s_lshl_b32 s20, s20, 5
    s_add_u32 s20, s20, s72
    v_and_b32 v1, 63, v0
    v_lshlrev_b32 v2, 2, v1
    v_mov_b32 v3, 0
    s_mul_i32 s21, s20, 1280
    s_add_u32 s21, s21, 1572864
    s_cmp_lg_u32 s17, 0
    s_cbranch_scc1 Lza
    buffer_store_dword v3, v2, s[4:7], s21 offen offset:0 sc1
    buffer_store_dword v3, v2, s[4:7], s21 offen offset:256 sc1
    buffer_store_dword v3, v2, s[4:7], s21 offen offset:512 sc1
    buffer_store_dword v3, v2, s[4:7], s21 offen offset:768 sc1
    buffer_store_dword v3, v2, s[4:7], s21 offen offset:1024 sc1
Lza:
    s_mul_i32 s50, s20, 9
    s_min_u32 s21, s20, 32
    s_add_u32 s50, s50, s21
    s_cmp_lt_u32 s20, 32
    s_cselect_b32 s49, 10, 9
    s_load_dwordx2 s[8:9], s[0:1], 0
    s_load_dwordx2 s[12:13], s[0:1], 80
    s_waitcnt lgkmcnt(0)
    s_mov_b32 s10, 2359296
    s_mov_b32 s11, 0x20000
    s_mov_b32 s14, 2359296
    s_mov_b32 s15, 0x20000
    v_and_b32 v1, 63, v0
    v_cmp_gt_u32 vcc, 36, v1
    v_lshlrev_b32 v2, 4, v1
    v_mov_b32 v3, 0x40000000
    v_cndmask_b32 v2, v3, v2, vcc
    v_mov_b32 v4, v2
    s_mov_b64 s[60:61], vcc
    s_add_u32 s51, s17, 0
    s_add_u32 s59, s51, s50
    s_mul_i32 s52, s59, 1152
    s_mul_i32 s55, s59, 2304
    s_cmp_lt_u32 s51, s49
    s_cselect_b32 s52, s52, 0x40000000
    s_cselect_b32 s55, s55, 0x40000000
    s_add_u32 s51, s17, 4
    s_add_u32 s59, s51, s50
    s_mul_i32 s53, s59, 1152
    s_mul_i32 s56, s59, 2304
    s_cmp_lt_u32 s51, s49
    s_cselect_b32 s53, s53, 0x40000000
    s_cselect_b32 s56, s56, 0x40000000
    s_add_u32 s51, s17, 8
    s_add_u32 s59, s51, s50
    s_mul_i32 s54, s59, 1152
    s_mul_i32 s57, s59, 2304
    s_cmp_lt_u32 s51, s49
    s_cselect_b32 s54, s54, 0x40000000
    s_cselect_b32 s57, s57, 0x40000000
    buffer_load_dwordx4 v[48:51], v2, s[8:11], s52 offen
    buffer_load_dwordx4 v[52:55], v2, s[8:11], s52 offen offset:576
    buffer_load_dwordx4 v[96:99], v2, s[8:11], s53 offen
    buffer_load_dwordx4 v[100:103], v2, s[8:11], s53 offen offset:576
    buffer_load_dwordx4 v[144:147], v2, s[8:11], s54 offen
    buffer_load_dwordx4 v[148:151], v2, s[8:11], s54 offen offset:576
    s_waitcnt vmcnt(0)
    v_lshlrev_b32 v16, 16, v48
    v_and_b32 v17, 0xffff0000, v48
    v_lshlrev_b32 v18, 16, v49
    v_and_b32 v19, 0xffff0000, v49
    v_lshlrev_b32 v20, 16, v50
    v_and_b32 v21, 0xffff0000, v50
    v_lshlrev_b32 v22, 16, v51
    v_and_b32 v23, 0xffff0000, v51
    v_lshlrev_b32 v24, 16, v52
    v_and_b32 v25, 0xffff0000, v52
    v_lshlrev_b32 v26, 16, v53
    v_and_b32 v27, 0xffff0000, v53
    v_lshlrev_b32 v28, 16, v54
    v_and_b32 v29, 0xffff0000, v54
    v_lshlrev_b32 v30, 16, v55
    v_and_b32 v31, 0xffff0000, v55
    v_add_f32 v5, v16, v17
    v_add_f32 v5, v5, v18
    v_add_f32 v5, v5, v19
    v_add_f32 v5, v5, v20
    v_add_f32 v5, v5, v21
    v_add_f32 v5, v5, v22
    v_add_f32 v5, v5, v23
    v_add_f32 v5, v5, v24
    v_add_f32 v5, v5, v25
    v_add_f32 v5, v5, v26
    v_add_f32 v5, v5, v27
    v_add_f32 v5, v5, v28
    v_add_f32 v5, v5, v29
    v_add_f32 v5, v5, v30
    v_add_f32 v5, v5, v31
    s_nop 1
    v_add_f32_dpp v5, v5, v5 row_ror:1 row_mask:0xf bank_mask:0xf
    s_nop 1
    v_add_f32_dpp v5, v5, v5 row_ror:2 row_mask:0xf bank_mask:0xf
    s_nop 1
    v_add_f32_dpp v5, v5, v5 row_ror:4 row_mask:0xf bank_mask:0xf
    s_nop 1
    v_add_f32_dpp v5, v5, v5 row_ror:8 row_mask:0xf bank_mask:0xf
    v_mov_b32 v6, v5
    s_nop 1
    v_permlane16_swap_b32 v6, v5
    v_add_f32 v5, v5, v6
    v_mov_b32 v6, v5
    s_nop 1
    v_permlane32_swap_b32 v6, v5
    v_add_f32 v5, v5, v6
    v_mul_f32 v5, 0x3ae38e39, v5
    v_sub_f32 v32, v16, v5
    v_sub_f32 v33, v17, v5
    v_sub_f32 v34, v18, v5
    v_sub_f32 v35, v19, v5
    v_sub_f32 v36, v20, v5
    v_sub_f32 v37, v21, v5
    v_sub_f32 v38, v22, v5
    v_sub_f32 v39, v23, v5
    v_sub_f32 v40, v24, v5
    v_sub_f32 v41, v25, v5
    v_sub_f32 v42, v26, v5
    v_sub_f32 v43, v27, v5
    v_sub_f32 v44, v28, v5
    v_sub_f32 v45, v29, v5
    v_sub_f32 v46, v30, v5
    v_sub_f32 v47, v31, v5
    v_mul_f32 v6, v32, v32
    v_fmac_f32 v6, v33, v33
    v_fmac_f32 v6, v34, v34
    v_fmac_f32 v6, v35, v35
    v_fmac_f32 v6, v36, v36
    v_fmac_f32 v6, v37, v37
    v_fmac_f32 v6, v38, v38
    v_fmac_f32 v6, v39, v39
    v_fmac_f32 v6, v40, v40
    v_fmac_f32 v6, v41, v41
    v_fmac_f32 v6, v42, v42
    v_fmac_f32 v6, v43, v43
    v_fmac_f32 v6, v44, v44
    v_fmac_f32 v6, v45, v45
    v_fmac_f32 v6, v46, v46
    v_fmac_f32 v6, v47, v47
    v_cndmask_b32 v6, 0, v6, s[60:61]
    s_nop 1
    v_add_f32_dpp v6, v6, v6 row_ror:1 row_mask:0xf bank_mask:0xf
    s_nop 1
    v_add_f32_dpp v6, v6, v6 row_ror:2 row_mask:0xf bank_mask:0xf
    s_nop 1
    v_add_f32_dpp v6, v6, v6 row_ror:4 row_mask:0xf bank_mask:0xf
    s_nop 1
    v_add_f32_dpp v6, v6, v6 row_ror:8 row_mask:0xf bank_mask:0xf
    v_mov_b32 v7, v6
    s_nop 1
    v_permlane16_swap_b32 v7, v6
    v_add_f32 v6, v6, v7
    v_mov_b32 v7, v6
    s_nop 1
    v_permlane32_swap_b32 v7, v6
    v_add_f32 v6, v6, v7
    v_mov_b32 v7, 0x3727c5ac
    v_fmac_f32 v7, 0x3ae38e39, v6
    v_rsq_f32 v7, v7
    s_nop 0
    v_mul_f32 v32, v32, v7
    v_mul_f32 v33, v33, v7
    v_mul_f32 v34, v34, v7
    v_mul_f32 v35, v35, v7
    v_mul_f32 v36, v36, v7
    v_mul_f32 v37, v37, v7
    v_mul_f32 v38, v38, v7
    v_mul_f32 v39, v39, v7
    v_mul_f32 v40, v40, v7
    v_mul_f32 v41, v41, v7
    v_mul_f32 v42, v42, v7
    v_mul_f32 v43, v43, v7
    v_mul_f32 v44, v44, v7
    v_mul_f32 v45, v45, v7
    v_mul_f32 v46, v46, v7
    v_mul_f32 v47, v47, v7
    v_cvt_pk_bf16_f32 v48, v32, v33
    v_cvt_pk_bf16_f32 v49, v34, v35
    v_cvt_pk_bf16_f32 v50, v36, v37
    v_cvt_pk_bf16_f32 v51, v38, v39
    v_cvt_pk_bf16_f32 v52, v40, v41
    v_cvt_pk_bf16_f32 v53, v42, v43
    v_cvt_pk_bf16_f32 v54, v44, v45
    v_cvt_pk_bf16_f32 v55, v46, v47
    s_add_u32 s58, s52, 2097152
    buffer_store_dwordx4 v[48:51], v2, s[4:7], s58 offen sc1
    buffer_store_dwordx4 v[52:55], v2, s[4:7], s58 offen offset:576 sc1
    v_lshlrev_b32 v64, 16, v96
    v_and_b32 v65, 0xffff0000, v96
    v_lshlrev_b32 v66, 16, v97
    v_and_b32 v67, 0xffff0000, v97
    v_lshlrev_b32 v68, 16, v98
    v_and_b32 v69, 0xffff0000, v98
    v_lshlrev_b32 v70, 16, v99
    v_and_b32 v71, 0xffff0000, v99
    v_lshlrev_b32 v72, 16, v100
    v_and_b32 v73, 0xffff0000, v100
    v_lshlrev_b32 v74, 16, v101
    v_and_b32 v75, 0xffff0000, v101
    v_lshlrev_b32 v76, 16, v102
    v_and_b32 v77, 0xffff0000, v102
    v_lshlrev_b32 v78, 16, v103
    v_and_b32 v79, 0xffff0000, v103
    v_add_f32 v5, v64, v65
    v_add_f32 v5, v5, v66
    v_add_f32 v5, v5, v67
    v_add_f32 v5, v5, v68
    v_add_f32 v5, v5, v69
    v_add_f32 v5, v5, v70
    v_add_f32 v5, v5, v71
    v_add_f32 v5, v5, v72
    v_add_f32 v5, v5, v73
    v_add_f32 v5, v5, v74
    v_add_f32 v5, v5, v75
    v_add_f32 v5, v5, v76
    v_add_f32 v5, v5, v77
    v_add_f32 v5, v5, v78
    v_add_f32 v5, v5, v79
    s_nop 1
    v_add_f32_dpp v5, v5, v5 row_ror:1 row_mask:0xf bank_mask:0xf
    s_nop 1
    v_add_f32_dpp v5, v5, v5 row_ror:2 row_mask:0xf bank_mask:0xf
    s_nop 1
    v_add_f32_dpp v5, v5, v5 row_ror:4 row_mask:0xf bank_mask:0xf
    s_nop 1
    v_add_f32_dpp v5, v5, v5 row_ror:8 row_mask:0xf bank_mask:0xf
    v_mov_b32 v6, v5
    s_nop 1
    v_permlane16_swap_b32 v6, v5
    v_add_f32 v5, v5, v6
    v_mov_b32 v6, v5
    s_nop 1
    v_permlane32_swap_b32 v6, v5
    v_add_f32 v5, v5, v6
    v_mul_f32 v5, 0x3ae38e39, v5
    v_sub_f32 v80, v64, v5
    v_sub_f32 v81, v65, v5
    v_sub_f32 v82, v66, v5
    v_sub_f32 v83, v67, v5
    v_sub_f32 v84, v68, v5
    v_sub_f32 v85, v69, v5
    v_sub_f32 v86, v70, v5
    v_sub_f32 v87, v71, v5
    v_sub_f32 v88, v72, v5
    v_sub_f32 v89, v73, v5
    v_sub_f32 v90, v74, v5
    v_sub_f32 v91, v75, v5
    v_sub_f32 v92, v76, v5
    v_sub_f32 v93, v77, v5
    v_sub_f32 v94, v78, v5
    v_sub_f32 v95, v79, v5
    v_mul_f32 v6, v80, v80
    v_fmac_f32 v6, v81, v81
    v_fmac_f32 v6, v82, v82
    v_fmac_f32 v6, v83, v83
    v_fmac_f32 v6, v84, v84
    v_fmac_f32 v6, v85, v85
    v_fmac_f32 v6, v86, v86
    v_fmac_f32 v6, v87, v87
    v_fmac_f32 v6, v88, v88
    v_fmac_f32 v6, v89, v89
    v_fmac_f32 v6, v90, v90
    v_fmac_f32 v6, v91, v91
    v_fmac_f32 v6, v92, v92
    v_fmac_f32 v6, v93, v93
    v_fmac_f32 v6, v94, v94
    v_fmac_f32 v6, v95, v95
    v_cndmask_b32 v6, 0, v6, s[60:61]
    s_nop 1
    v_add_f32_dpp v6, v6, v6 row_ror:1 row_mask:0xf bank_mask:0xf
    s_nop 1
    v_add_f32_dpp v6, v6, v6 row_ror:2 row_mask:0xf bank_mask:0xf
    s_nop 1
    v_add_f32_dpp v6, v6, v6 row_ror:4 row_mask:0xf bank_mask:0xf
    s_nop 1
    v_add_f32_dpp v6, v6, v6 row_ror:8 row_mask:0xf bank_mask:0xf
    v_mov_b32 v7, v6
    s_nop 1
    v_permlane16_swap_b32 v7, v6
    v_add_f32 v6, v6, v7
    v_mov_b32 v7, v6
    s_nop 1
    v_permlane32_swap_b32 v7, v6
    v_add_f32 v6, v6, v7
    v_mov_b32 v7, 0x3727c5ac
    v_fmac_f32 v7, 0x3ae38e39, v6
    v_rsq_f32 v7, v7
    s_nop 0
    v_mul_f32 v80, v80, v7
    v_mul_f32 v81, v81, v7
    v_mul_f32 v82, v82, v7
    v_mul_f32 v83, v83, v7
    v_mul_f32 v84, v84, v7
    v_mul_f32 v85, v85, v7
    v_mul_f32 v86, v86, v7
    v_mul_f32 v87, v87, v7
    v_mul_f32 v88, v88, v7
    v_mul_f32 v89, v89, v7
    v_mul_f32 v90, v90, v7
    v_mul_f32 v91, v91, v7
    v_mul_f32 v92, v92, v7
    v_mul_f32 v93, v93, v7
    v_mul_f32 v94, v94, v7
    v_mul_f32 v95, v95, v7
    v_cvt_pk_bf16_f32 v96, v80, v81
    v_cvt_pk_bf16_f32 v97, v82, v83
    v_cvt_pk_bf16_f32 v98, v84, v85
    v_cvt_pk_bf16_f32 v99, v86, v87
    v_cvt_pk_bf16_f32 v100, v88, v89
    v_cvt_pk_bf16_f32 v101, v90, v91
    v_cvt_pk_bf16_f32 v102, v92, v93
    v_cvt_pk_bf16_f32 v103, v94, v95
    s_add_u32 s58, s53, 2097152
    buffer_store_dwordx4 v[96:99], v2, s[4:7], s58 offen sc1
    buffer_store_dwordx4 v[100:103], v2, s[4:7], s58 offen offset:576 sc1
    v_lshlrev_b32 v112, 16, v144
    v_and_b32 v113, 0xffff0000, v144
    v_lshlrev_b32 v114, 16, v145
    v_and_b32 v115, 0xffff0000, v145
    v_lshlrev_b32 v116, 16, v146
    v_and_b32 v117, 0xffff0000, v146
    v_lshlrev_b32 v118, 16, v147
    v_and_b32 v119, 0xffff0000, v147
    v_lshlrev_b32 v120, 16, v148
    v_and_b32 v121, 0xffff0000, v148
    v_lshlrev_b32 v122, 16, v149
    v_and_b32 v123, 0xffff0000, v149
    v_lshlrev_b32 v124, 16, v150
    v_and_b32 v125, 0xffff0000, v150
    v_lshlrev_b32 v126, 16, v151
    v_and_b32 v127, 0xffff0000, v151
    v_add_f32 v5, v112, v113
    v_add_f32 v5, v5, v114
    v_add_f32 v5, v5, v115
    v_add_f32 v5, v5, v116
    v_add_f32 v5, v5, v117
    v_add_f32 v5, v5, v118
    v_add_f32 v5, v5, v119
    v_add_f32 v5, v5, v120
    v_add_f32 v5, v5, v121
    v_add_f32 v5, v5, v122
    v_add_f32 v5, v5, v123
    v_add_f32 v5, v5, v124
    v_add_f32 v5, v5, v125
    v_add_f32 v5, v5, v126
    v_add_f32 v5, v5, v127
    s_nop 1
    v_add_f32_dpp v5, v5, v5 row_ror:1 row_mask:0xf bank_mask:0xf
    s_nop 1
    v_add_f32_dpp v5, v5, v5 row_ror:2 row_mask:0xf bank_mask:0xf
    s_nop 1
    v_add_f32_dpp v5, v5, v5 row_ror:4 row_mask:0xf bank_mask:0xf
    s_nop 1
    v_add_f32_dpp v5, v5, v5 row_ror:8 row_mask:0xf bank_mask:0xf
    v_mov_b32 v6, v5
    s_nop 1
    v_permlane16_swap_b32 v6, v5
    v_add_f32 v5, v5, v6
    v_mov_b32 v6, v5
    s_nop 1
    v_permlane32_swap_b32 v6, v5
    v_add_f32 v5, v5, v6
    v_mul_f32 v5, 0x3ae38e39, v5
    v_sub_f32 v128, v112, v5
    v_sub_f32 v129, v113, v5
    v_sub_f32 v130, v114, v5
    v_sub_f32 v131, v115, v5
    v_sub_f32 v132, v116, v5
    v_sub_f32 v133, v117, v5
    v_sub_f32 v134, v118, v5
    v_sub_f32 v135, v119, v5
    v_sub_f32 v136, v120, v5
    v_sub_f32 v137, v121, v5
    v_sub_f32 v138, v122, v5
    v_sub_f32 v139, v123, v5
    v_sub_f32 v140, v124, v5
    v_sub_f32 v141, v125, v5
    v_sub_f32 v142, v126, v5
    v_sub_f32 v143, v127, v5
    v_mul_f32 v6, v128, v128
    v_fmac_f32 v6, v129, v129
    v_fmac_f32 v6, v130, v130
    v_fmac_f32 v6, v131, v131
    v_fmac_f32 v6, v132, v132
    v_fmac_f32 v6, v133, v133
    v_fmac_f32 v6, v134, v134
    v_fmac_f32 v6, v135, v135
    v_fmac_f32 v6, v136, v136
    v_fmac_f32 v6, v137, v137
    v_fmac_f32 v6, v138, v138
    v_fmac_f32 v6, v139, v139
    v_fmac_f32 v6, v140, v140
    v_fmac_f32 v6, v141, v141
    v_fmac_f32 v6, v142, v142
    v_fmac_f32 v6, v143, v143
    v_cndmask_b32 v6, 0, v6, s[60:61]
    s_nop 1
    v_add_f32_dpp v6, v6, v6 row_ror:1 row_mask:0xf bank_mask:0xf
    s_nop 1
    v_add_f32_dpp v6, v6, v6 row_ror:2 row_mask:0xf bank_mask:0xf
    s_nop 1
    v_add_f32_dpp v6, v6, v6 row_ror:4 row_mask:0xf bank_mask:0xf
    s_nop 1
    v_add_f32_dpp v6, v6, v6 row_ror:8 row_mask:0xf bank_mask:0xf
    v_mov_b32 v7, v6
    s_nop 1
    v_permlane16_swap_b32 v7, v6
    v_add_f32 v6, v6, v7
    v_mov_b32 v7, v6
    s_nop 1
    v_permlane32_swap_b32 v7, v6
    v_add_f32 v6, v6, v7
    v_mov_b32 v7, 0x3727c5ac
    v_fmac_f32 v7, 0x3ae38e39, v6
    v_rsq_f32 v7, v7
    s_nop 0
    v_mul_f32 v128, v128, v7
    v_mul_f32 v129, v129, v7
    v_mul_f32 v130, v130, v7
    v_mul_f32 v131, v131, v7
    v_mul_f32 v132, v132, v7
    v_mul_f32 v133, v133, v7
    v_mul_f32 v134, v134, v7
    v_mul_f32 v135, v135, v7
    v_mul_f32 v136, v136, v7
    v_mul_f32 v137, v137, v7
    v_mul_f32 v138, v138, v7
    v_mul_f32 v139, v139, v7
    v_mul_f32 v140, v140, v7
    v_mul_f32 v141, v141, v7
    v_mul_f32 v142, v142, v7
    v_mul_f32 v143, v143, v7
    v_cvt_pk_bf16_f32 v144, v128, v129
    v_cvt_pk_bf16_f32 v145, v130, v131
    v_cvt_pk_bf16_f32 v146, v132, v133
    v_cvt_pk_bf16_f32 v147, v134, v135
    v_cvt_pk_bf16_f32 v148, v136, v137
    v_cvt_pk_bf16_f32 v149, v138, v139
    v_cvt_pk_bf16_f32 v150, v140, v141
    v_cvt_pk_bf16_f32 v151, v142, v143
    s_add_u32 s58, s54, 2097152
    buffer_store_dwordx4 v[144:147], v2, s[4:7], s58 offen sc1
    buffer_store_dwordx4 v[148:151], v2, s[4:7], s58 offen offset:576 sc1
    s_load_dwordx2 s[12:13], s[0:1], 88
    s_waitcnt lgkmcnt(0)
    s_mov_b32 s14, 256
    s_mov_b32 s15, 0x20000
    s_waitcnt vmcnt(0)
    s_barrier
    s_cmp_lg_u32 s17, 0
    s_cbranch_scc1 Lzza
    s_mov_b64 exec, 1
    v_mov_b32 v4, 1
    s_add_u32 s21, s88, 8
    v_mov_b32 v5, s21
    buffer_atomic_add v4, v5, s[12:15], 0 offen
    s_mov_b64 exec, -1
Lzza:
Lresolve:
    s_mov_b32 s19, 0
    v_and_b32 v1, 63, v0
    v_lshlrev_b32 v2, 2, v1
Lrs0w:
    buffer_load_dword v3, v2, s[12:15], 0 offen sc1
    s_waitcnt vmcnt(0)
    s_mov_b32 s20, 0
    s_mov_b32 s89, 1
    v_readlane_b32 s80, v3, 0
    v_readlane_b32 s81, v3, 1
    v_readlane_b32 s82, v3, 16
    v_readlane_b32 s83, v3, 17
    v_readlane_b32 s84, v3, 32
    v_readlane_b32 s85, v3, 33
    v_readlane_b32 s86, v3, 48
    v_readlane_b32 s87, v3, 49
    s_add_u32 s20, s20, s80
    s_cmp_eq_u32 s80, 32
    s_cselect_b32 s89, s89, 0
    s_add_u32 s20, s20, s81
    s_cmp_eq_u32 s81, 32
    s_cselect_b32 s89, s89, 0
    s_add_u32 s20, s20, s82
    s_cmp_eq_u32 s82, 32
    s_cselect_b32 s89, s89, 0
    s_add_u32 s20, s20, s83
    s_cmp_eq_u32 s83, 32
    s_cselect_b32 s89, s89, 0
    s_add_u32 s20, s20, s84
    s_cmp_eq_u32 s84, 32
    s_cselect_b32 s89, s89, 0
    s_add_u32 s20, s20, s85
    s_cmp_eq_u32 s85, 32
    s_cselect_b32 s89, s89, 0
    s_add_u32 s20, s20, s86
    s_cmp_eq_u32 s86, 32
    s_cselect_b32 s89, s89, 0
    s_add_u32 s20, s20, s87
    s_cmp_eq_u32 s87, 32
    s_cselect_b32 s89, s89, 0
    s_cmp_ge_u32 s20, 256
    s_cbranch_scc1 Lrs1w
    s_sleep 4
    s_add_u32 s19, s19, 1
    s_cmp_lt_u32 s19, 524288
    s_cbranch_scc1 Lrs0w
    s_branch Lfail
Lrs1w:
    s_mov_b32 s90, 0
    s_min_u32 s20, s81, 32
    s_add_u32 s90, s90, s20
    s_min_u32 s20, s82, 32
    s_add_u32 s90, s90, s20
    s_min_u32 s20, s83, 32
    s_add_u32 s90, s90, s20
    s_min_u32 s20, s84, 32
    s_add_u32 s90, s90, s20
    s_min_u32 s20, s85, 32
    s_add_u32 s90, s90, s20
    s_min_u32 s20, s86, 32
    s_add_u32 s90, s90, s20
    s_min_u32 s20, s87, 32
    s_add_u32 s90, s90, s20
    s_mov_b32 s21, s72
    s_cmp_gt_u32 s71, 0
    s_cselect_b32 s22, s80, 0
    s_add_u32 s21, s21, s22
    s_cmp_gt_u32 s71, 1
    s_cselect_b32 s22, s81, 0
    s_add_u32 s21, s21, s22
    s_cmp_gt_u32 s71, 2
    s_cselect_b32 s22, s82, 0
    s_add_u32 s21, s21, s22
    s_cmp_gt_u32 s71, 3
    s_cselect_b32 s22, s83, 0
    s_add_u32 s21, s21, s22
    s_cmp_gt_u32 s71, 4
    s_cselect_b32 s22, s84, 0
    s_add_u32 s21, s21, s22
    s_cmp_gt_u32 s71, 5
    s_cselect_b32 s22, s85, 0
    s_add_u32 s21, s21, s22
    s_cmp_gt_u32 s71, 6
    s_cselect_b32 s22, s86, 0
    s_add_u32 s21, s21, s22
    s_cmp_lt_u32 s21, 32
    s_cbranch_scc0 Lworker
    s_mov_b32 s16, s21
    s_branch Lchain
Lchain:
    s_load_dwordx2 s[4:5], s[0:1], 96
    s_load_dwordx2 s[12:13], s[0:1], 88
    v_lshrrev_b32 v1, 6, v0
    s_nop 0
    v_readfirstlane_b32 s17, v1
    s_waitcnt lgkmcnt(0)
    s_mov_b32 s6, 268435456
    s_mov_b32 s7, 0x20000
    s_mov_b32 s14, 256
    s_mov_b32 s15, 0x20000
    v_and_b32 v0, 63, v0
    s_mul_i32 s20, s17, 38912
    s_sub_u32 s21, s17, 2
    s_mul_i32 s21, s21, 30720
    s_add_u32 s21, s21, 77824
    s_cmp_lt_u32 s17, 2
    s_cselect_b32 s55, s20, s21
    s_lshl_b32 s20, s17, 10
    s_add_u32 s63, s20, 896768
    s_add_u32 s44, s20, 151808
    s_add_u32 s45, s44, 4096
    s_mov_b32 s46, 160000
    v_and_b32 v1, 15, v0
    v_lshrrev_b32 v2, 4, v0
    v_bfe_u32 v3, v0, 3, 1
    v_and_b32 v4, 7, v0
    v_lshlrev_b32 v5, 4, v0
    v_add_u32 v56, s55, v5
    v_add_u32 v68, 151808, v5
    v_xor_b32 v5, 128, v5
    v_add_u32 v69, 151808, v5
    v_mov_b32 v5, 0x4444
    v_mov_b32 v6, 0xeeee
    v_cmp_eq_u32 vcc, 1, v3
    s_nop 1
    v_cndmask_b32 v57, v5, v6, vcc
    v_lshrrev_b32 v5, 2, v1
    v_lshlrev_b32 v5, 3, v5
    v_and_b32 v6, 3, v1
    v_add_u32 v5, v5, v6
    v_lshlrev_b32 v5, 8, v5
    v_xor_b32 v6, v2, v1
    v_lshlrev_b32 v6, 4, v6
    v_add_u32 v5, v5, v6
    v_add_u32 v58, 139264, v5
    s_lshl_b32 s20, s17, 5
    v_lshrrev_b32 v5, 1, v2
    v_lshlrev_b32 v5, 4, v5
    v_add_u32 v5, v5, v1
    v_add_u32 v7, s20, v5
    v_lshlrev_b32 v5, 3, v7
    v_and_b32 v6, 1, v2
    v_mul_u32_u24 v8, 1056, v6
    v_add_u32 v5, v5, v8
    v_add_u32 v59, 147456, v5
    v_lshlrev_b32 v6, 3, v6
    v_lshlrev_b32 v5, 4, v7
    v_add_u32 v63, v5, v6
    v_lshlrev_b32 v5, 3, v2
    v_lshrrev_b32 v6, 2, v1
    v_add_u32 v5, v5, v6
    v_lshlrev_b32 v5, 3, v5
    v_and_b32 v6, 1, v0
    v_mul_u32_u24 v6, 1056, v6
    v_add_u32 v5, v5, v6
    v_add_u32 v60, 147456, v5
    s_lshl_b32 s20, s17, 2
    v_lshlrev_b32 v5, 1, v3
    v_lshrrev_b32 v6, 1, v2
    v_add_u32 v5, v5, v6
    v_add_u32 v5, s20, v5
    v_lshlrev_b32 v6, 1, v4
    v_xor_b32 v5, v5, v6
    v_lshlrev_b32 v5, 4, v5
    v_lshlrev_b32 v6, 8, v4
    v_add_u32 v5, v5, v6
    v_and_b32 v6, 1, v2
    v_lshlrev_b32 v6, 3, v6
    v_add_u32 v5, v5, v6
    v_add_u32 v61, 161024, v5
    v_lshlrev_b32 v5, 1, v2
    v_add_u32 v5, v5, v3
    v_lshlrev_b32 v6, 1, v4
    v_xor_b32 v5, v5, v6
    v_lshlrev_b32 v5, 4, v5
    v_lshlrev_b32 v6, 8, v4
    v_add_u32 v5, v5, v6
    v_add_u32 v62, 161024, v5
    v_lshlrev_b32 v5, 1, v2
    v_add_u32 v5, v5, v3
    v_mul_u32_u24 v5, 9216, v5
    v_lshlrev_b32 v6, 4, v4
    v_add_u32 v64, v5, v6
    v_and_b32 v5, 1, v2
    v_lshlrev_b32 v5, 3, v5
    v_lshrrev_b32 v6, 1, v2
    v_lshlrev_b32 v6, 2, v6
    v_add_u32 v5, v5, v6
    v_lshlrev_b32 v6, 4, v1
    v_add_u32 v5, v5, v6
    v_mov_b32 v6, 0x80000000
    v_cmp_eq_u32 vcc, 1, v3
    s_nop 1
    v_cndmask_b32 v65, v5, v6, vcc
    s_lshl_b32 s20, s17, 3
    v_add_u32 v5, s20, v2
    v_lshlrev_b32 v5, 13, v5
    s_lshl_b32 s20, s17, 2
    v_add_u32 v6, s20, v2
    v_xor_b32 v6, v6, v1
    v_lshlrev_b32 v6, 4, v6
    v_add_u32 v66, v5, v6
    s_lshl_b32 s20, s17, 5
    v_add_u32 v5, s20, v1
    v_lshlrev_b32 v5, 6, v5
    v_lshlrev_b32 v6, 4, v2
    v_add_u32 v67, v5, v6
    v_mov_b32 v70, 0x3f803f80
    v_mov_b32 v71, 0x3f803f80
    s_mov_b32 s40, -1
    s_mov_b32 s41, 0
    s_mov_b32 s42, 0
    s_mov_b32 s43, -1
    s_mov_b32 s52, 0x3e0293ee
    s_mov_b32 s53, 0x3e0293ee
    s_mov_b32 s58, 0x42200000
    s_sub_u32 s20, s17, 2
    s_lshl_b32 s20, s20, 5
    s_add_u32 s20, s20, s16
    s_add_u32 s21, s16, 64
    s_cmp_lt_u32 s16, 8
    s_cselect_b32 s21, s21, -1
    s_cmp_eq_u32 s17, 1
    s_cselect_b32 s21, s21, -1
    s_cmp_ge_u32 s17, 2
    s_cselect_b32 s39, s20, s21
    s_lshr_b32 s20, s39, 3
    s_lshl_b32 s20, s20, 10
    s_lshr_b32 s21, s39, 1
    s_and_b32 s21, s21, 3
    s_lshl_b32 s21, s21, 8
    s_add_u32 s20, s20, s21
    s_and_b32 s21, s39, 1
    s_lshl_b32 s21, s21, 7
    s_add_u32 s35, s20, s21
    s_add_u32 s54, s35, 1048576
    s_lshl_b32 s62, s39, 7
    s_lshl_b32 s20, s17, 11
    s_add_u32 s60, s20, 139264
    s_add_u32 s61, s60, 1024
    s_mov_b32 s19, 0
    v_and_b32 v1, 63, v0
    v_lshlrev_b32 v2, 2, v1
Lrs0c:
    buffer_load_dword v3, v2, s[12:15], 0 offen sc1
    s_waitcnt vmcnt(0)
    s_mov_b32 s20, 0
    s_mov_b32 s89, 1
    v_readlane_b32 s80, v3, 0
    v_readlane_b32 s81, v3, 1
    v_readlane_b32 s82, v3, 16
    v_readlane_b32 s83, v3, 17
    v_readlane_b32 s84, v3, 32
    v_readlane_b32 s85, v3, 33
    v_readlane_b32 s86, v3, 48
    v_readlane_b32 s87, v3, 49
    s_add_u32 s20, s20, s80
    s_cmp_eq_u32 s80, 32
    s_cselect_b32 s89, s89, 0
    s_add_u32 s20, s20, s81
    s_cmp_eq_u32 s81, 32
    s_cselect_b32 s89, s89, 0
    s_add_u32 s20, s20, s82
    s_cmp_eq_u32 s82, 32
    s_cselect_b32 s89, s89, 0
    s_add_u32 s20, s20, s83
    s_cmp_eq_u32 s83, 32
    s_cselect_b32 s89, s89, 0
    s_add_u32 s20, s20, s84
    s_cmp_eq_u32 s84, 32
    s_cselect_b32 s89, s89, 0
    s_add_u32 s20, s20, s85
    s_cmp_eq_u32 s85, 32
    s_cselect_b32 s89, s89, 0
    s_add_u32 s20, s20, s86
    s_cmp_eq_u32 s86, 32
    s_cselect_b32 s89, s89, 0
    s_add_u32 s20, s20, s87
    s_cmp_eq_u32 s87, 32
    s_cselect_b32 s89, s89, 0
    s_cmp_ge_u32 s20, 256
    s_cbranch_scc1 Lrs1c
    s_sleep 4
    s_add_u32 s19, s19, 1
    s_cmp_lt_u32 s19, 524288
    s_cbranch_scc1 Lrs0c
    s_branch Lfail
Lrs1c:
    s_mov_b32 s90, 0
    s_min_u32 s20, s81, 32
    s_add_u32 s90, s90, s20
    s_min_u32 s20, s82, 32
    s_add_u32 s90, s90, s20
    s_min_u32 s20, s83, 32
    s_add_u32 s90, s90, s20
    s_min_u32 s20, s84, 32
    s_add_u32 s90, s90, s20
    s_min_u32 s20, s85, 32
    s_add_u32 s90, s90, s20
    s_min_u32 s20, s86, 32
    s_add_u32 s90, s90, s20
    s_min_u32 s20, s87, 32
    s_add_u32 s90, s90, s20
    v_and_b32 v1, 15, v0
    v_lshrrev_b32 v2, 4, v0
    v_bfe_u32 v3, v0, 3, 1
    v_and_b32 v4, 7, v0
    s_cmp_lt_u32 s80, 32
    s_cbranch_scc1 Linit_slow
    v_mov_b32 v12, -1
    v_mov_b32 v13, -1
    v_mov_b32 v14, -1
    v_mov_b32 v15, -1
    v_lshlrev_b32 v16, 4, v0
    s_cmp_ge_u32 s17, 2
    s_cbranch_scc1 Lip_1
    s_mul_i32 s20, s17, 524288
    s_mul_i32 s21, s16, 9216
    s_add_u32 s20, s20, s21
    s_add_u32 s20, s20, 0
    buffer_store_dwordx4 v[12:15], v16, s[4:7], s20 offen
    s_add_u32 s20, s20, 1024
    buffer_store_dwordx4 v[12:15], v16, s[4:7], s20 offen
    s_add_u32 s20, s20, 1024
    buffer_store_dwordx4 v[12:15], v16, s[4:7], s20 offen
    s_add_u32 s20, s20, 1024
    buffer_store_dwordx4 v[12:15], v16, s[4:7], s20 offen
    s_add_u32 s20, s20, 1024
    buffer_store_dwordx4 v[12:15], v16, s[4:7], s20 offen
    s_add_u32 s20, s20, 1024
    buffer_store_dwordx4 v[12:15], v16, s[4:7], s20 offen
    s_add_u32 s20, s20, 1024
    buffer_store_dwordx4 v[12:15], v16, s[4:7], s20 offen
    s_add_u32 s20, s20, 1024
    buffer_store_dwordx4 v[12:15], v16, s[4:7], s20 offen
    s_add_u32 s20, s20, 1024
    buffer_store_dwordx4 v[12:15], v16, s[4:7], s20 offen
    s_add_u32 s20, s20, 1024
Lip_1:
    s_cmp_lg_u32 s17, 2
    s_cbranch_scc1 Lim_2
    s_cmp_ge_u32 s16, 4
    s_cbranch_scc1 Lim_2
    s_cmp_eq_u32 s16, 0
    s_cbranch_scc1 Lim0_3
    s_mul_i32 s20, s16, 16384
    s_add_u32 s20, s20, 1048576
    buffer_store_dwordx4 v[12:15], v16, s[4:7], s20 offen
    s_add_u32 s20, s20, 1024
    buffer_store_dwordx4 v[12:15], v16, s[4:7], s20 offen
    s_add_u32 s20, s20, 1024
    buffer_store_dwordx4 v[12:15], v16, s[4:7], s20 offen
    s_add_u32 s20, s20, 1024
    buffer_store_dwordx4 v[12:15], v16, s[4:7], s20 offen
    s_add_u32 s20, s20, 1024
    buffer_store_dwordx4 v[12:15], v16, s[4:7], s20 offen
    s_add_u32 s20, s20, 1024
    buffer_store_dwordx4 v[12:15], v16, s[4:7], s20 offen
    s_add_u32 s20, s20, 1024
    buffer_store_dwordx4 v[12:15], v16, s[4:7], s20 offen
    s_add_u32 s20, s20, 1024
    buffer_store_dwordx4 v[12:15], v16, s[4:7], s20 offen
    s_add_u32 s20, s20, 1024
    buffer_store_dwordx4 v[12:15], v16, s[4:7], s20 offen
    s_add_u32 s20, s20, 1024
    s_branch Lim_2
Lim0_3:
    s_load_dwordx2 s[8:9], s[0:1], 8
    s_waitcnt lgkmcnt(0)
    s_mov_b32 s10, 9216
    s_mov_b32 s11, 0x20000
    v_mul_u32_u24 v17, 1152, v4
    v_lshlrev_b32 v18, 5, v2
    v_add_u32 v17, v17, v18
    v_lshlrev_b32 v18, 4, v3
    v_add_u32 v17, v17, v18
    s_mov_b32 s20, 1048576
    buffer_load_dwordx4 v[20:23], v17, s[8:11], 0 offen offset:0
    buffer_load_dwordx4 v[24:27], v17, s[8:11], 0 offen offset:128
    buffer_load_dwordx4 v[28:31], v17, s[8:11], 0 offen offset:256
    buffer_load_dwordx4 v[32:35], v17, s[8:11], 0 offen offset:384
    buffer_load_dwordx4 v[36:39], v17, s[8:11], 0 offen offset:512
    buffer_load_dwordx4 v[40:43], v17, s[8:11], 0 offen offset:640
    buffer_load_dwordx4 v[44:47], v17, s[8:11], 0 offen offset:768
    buffer_load_dwordx4 v[48:51], v17, s[8:11], 0 offen offset:896
    buffer_load_dwordx4 v[52:55], v17, s[8:11], 0 offen offset:1024
    s_waitcnt vmcnt(0)
    v_min_u32 v20, -2, v20
    v_min_u32 v21, -2, v21
    v_min_u32 v22, -2, v22
    v_min_u32 v23, -2, v23
    buffer_store_dwordx4 v[20:23], v16, s[4:7], s20 offen
    s_add_u32 s20, s20, 1024
    v_min_u32 v24, -2, v24
    v_min_u32 v25, -2, v25
    v_min_u32 v26, -2, v26
    v_min_u32 v27, -2, v27
    buffer_store_dwordx4 v[24:27], v16, s[4:7], s20 offen
    s_add_u32 s20, s20, 1024
    v_min_u32 v28, -2, v28
    v_min_u32 v29, -2, v29
    v_min_u32 v30, -2, v30
    v_min_u32 v31, -2, v31
    buffer_store_dwordx4 v[28:31], v16, s[4:7], s20 offen
    s_add_u32 s20, s20, 1024
    v_min_u32 v32, -2, v32
    v_min_u32 v33, -2, v33
    v_min_u32 v34, -2, v34
    v_min_u32 v35, -2, v35
    buffer_store_dwordx4 v[32:35], v16, s[4:7], s20 offen
    s_add_u32 s20, s20, 1024
    v_min_u32 v36, -2, v36
    v_min_u32 v37, -2, v37
    v_min_u32 v38, -2, v38
    v_min_u32 v39, -2, v39
    buffer_store_dwordx4 v[36:39], v16, s[4:7], s20 offen
    s_add_u32 s20, s20, 1024
    v_min_u32 v40, -2, v40
    v_min_u32 v41, -2, v41
    v_min_u32 v42, -2, v42
    v_min_u32 v43, -2, v43
    buffer_store_dwordx4 v[40:43], v16, s[4:7], s20 offen
    s_add_u32 s20, s20, 1024
    v_min_u32 v44, -2, v44
    v_min_u32 v45, -2, v45
    v_min_u32 v46, -2, v46
    v_min_u32 v47, -2, v47
    buffer_store_dwordx4 v[44:47], v16, s[4:7], s20 offen
    s_add_u32 s20, s20, 1024
    v_min_u32 v48, -2, v48
    v_min_u32 v49, -2, v49
    v_min_u32 v50, -2, v50
    v_min_u32 v51, -2, v51
    buffer_store_dwordx4 v[48:51], v16, s[4:7], s20 offen
    s_add_u32 s20, s20, 1024
    v_min_u32 v52, -2, v52
    v_min_u32 v53, -2, v53
    v_min_u32 v54, -2, v54
    v_min_u32 v55, -2, v55
    buffer_store_dwordx4 v[52:55], v16, s[4:7], s20 offen
    s_add_u32 s20, s20, 1024
Lim_2:
    s_branch Linit_done
Linit_slow:
    v_mov_b32 v12, -1
    v_mov_b32 v13, -1
    v_mov_b32 v14, -1
    v_mov_b32 v15, -1
    v_lshlrev_b32 v16, 4, v0
    s_cmp_ge_u32 s17, 2
    s_cbranch_scc1 Lip_4
    s_mul_i32 s20, s17, 524288
    s_mul_i32 s21, s16, 9216
    s_add_u32 s20, s20, s21
    s_add_u32 s20, s20, 0
    buffer_store_dwordx4 v[12:15], v16, s[4:7], s20 offen sc1
    s_add_u32 s20, s20, 1024
    buffer_store_dwordx4 v[12:15], v16, s[4:7], s20 offen sc1
    s_add_u32 s20, s20, 1024
    buffer_store_dwordx4 v[12:15], v16, s[4:7], s20 offen sc1
    s_add_u32 s20, s20, 1024
    buffer_store_dwordx4 v[12:15], v16, s[4:7], s20 offen sc1
    s_add_u32 s20, s20, 1024
    buffer_store_dwordx4 v[12:15], v16, s[4:7], s20 offen sc1
    s_add_u32 s20, s20, 1024
    buffer_store_dwordx4 v[12:15], v16, s[4:7], s20 offen sc1
    s_add_u32 s20, s20, 1024
    buffer_store_dwordx4 v[12:15], v16, s[4:7], s20 offen sc1
    s_add_u32 s20, s20, 1024
    buffer_store_dwordx4 v[12:15], v16, s[4:7], s20 offen sc1
    s_add_u32 s20, s20, 1024
    buffer_store_dwordx4 v[12:15], v16, s[4:7], s20 offen sc1
    s_add_u32 s20, s20, 1024
Lip_4:
    s_cmp_lg_u32 s17, 2
    s_cbranch_scc1 Lim_5
    s_cmp_ge_u32 s16, 4
    s_cbranch_scc1 Lim_5
    s_cmp_eq_u32 s16, 0
    s_cbranch_scc1 Lim0_6
    s_mul_i32 s20, s16, 16384
    s_add_u32 s20, s20, 1048576
    buffer_store_dwordx4 v[12:15], v16, s[4:7], s20 offen sc1
    s_add_u32 s20, s20, 1024
    buffer_store_dwordx4 v[12:15], v16, s[4:7], s20 offen sc1
    s_add_u32 s20, s20, 1024
    buffer_store_dwordx4 v[12:15], v16, s[4:7], s20 offen sc1
    s_add_u32 s20, s20, 1024
    buffer_store_dwordx4 v[12:15], v16, s[4:7], s20 offen sc1
    s_add_u32 s20, s20, 1024
    buffer_store_dwordx4 v[12:15], v16, s[4:7], s20 offen sc1
    s_add_u32 s20, s20, 1024
    buffer_store_dwordx4 v[12:15], v16, s[4:7], s20 offen sc1
    s_add_u32 s20, s20, 1024
    buffer_store_dwordx4 v[12:15], v16, s[4:7], s20 offen sc1
    s_add_u32 s20, s20, 1024
    buffer_store_dwordx4 v[12:15], v16, s[4:7], s20 offen sc1
    s_add_u32 s20, s20, 1024
    buffer_store_dwordx4 v[12:15], v16, s[4:7], s20 offen sc1
    s_add_u32 s20, s20, 1024
    s_branch Lim_5
Lim0_6:
    s_load_dwordx2 s[8:9], s[0:1], 8
    s_waitcnt lgkmcnt(0)
    s_mov_b32 s10, 9216
    s_mov_b32 s11, 0x20000
    v_mul_u32_u24 v17, 1152, v4
    v_lshlrev_b32 v18, 5, v2
    v_add_u32 v17, v17, v18
    v_lshlrev_b32 v18, 4, v3
    v_add_u32 v17, v17, v18
    s_mov_b32 s20, 1048576
    buffer_load_dwordx4 v[20:23], v17, s[8:11], 0 offen offset:0
    buffer_load_dwordx4 v[24:27], v17, s[8:11], 0 offen offset:128
    buffer_load_dwordx4 v[28:31], v17, s[8:11], 0 offen offset:256
    buffer_load_dwordx4 v[32:35], v17, s[8:11], 0 offen offset:384
    buffer_load_dwordx4 v[36:39], v17, s[8:11], 0 offen offset:512
    buffer_load_dwordx4 v[40:43], v17, s[8:11], 0 offen offset:640
    buffer_load_dwordx4 v[44:47], v17, s[8:11], 0 offen offset:768
    buffer_load_dwordx4 v[48:51], v17, s[8:11], 0 offen offset:896
    buffer_load_dwordx4 v[52:55], v17, s[8:11], 0 offen offset:1024
    s_waitcnt vmcnt(0)
    v_min_u32 v20, -2, v20
    v_min_u32 v21, -2, v21
    v_min_u32 v22, -2, v22
    v_min_u32 v23, -2, v23
    buffer_store_dwordx4 v[20:23], v16, s[4:7], s20 offen sc1
    s_add_u32 s20, s20, 1024
    v_min_u32 v24, -2, v24
    v_min_u32 v25, -2, v25
    v_min_u32 v26, -2, v26
    v_min_u32 v27, -2, v27
    buffer_store_dwordx4 v[24:27], v16, s[4:7], s20 offen sc1
    s_add_u32 s20, s20, 1024
    v_min_u32 v28, -2, v28
    v_min_u32 v29, -2, v29
    v_min_u32 v30, -2, v30
    v_min_u32 v31, -2, v31
    buffer_store_dwordx4 v[28:31], v16, s[4:7], s20 offen sc1
    s_add_u32 s20, s20, 1024
    v_min_u32 v32, -2, v32
    v_min_u32 v33, -2, v33
    v_min_u32 v34, -2, v34
    v_min_u32 v35, -2, v35
    buffer_store_dwordx4 v[32:35], v16, s[4:7], s20 offen sc1
    s_add_u32 s20, s20, 1024
    v_min_u32 v36, -2, v36
    v_min_u32 v37, -2, v37
    v_min_u32 v38, -2, v38
    v_min_u32 v39, -2, v39
    buffer_store_dwordx4 v[36:39], v16, s[4:7], s20 offen sc1
    s_add_u32 s20, s20, 1024
    v_min_u32 v40, -2, v40
    v_min_u32 v41, -2, v41
    v_min_u32 v42, -2, v42
    v_min_u32 v43, -2, v43
    buffer_store_dwordx4 v[40:43], v16, s[4:7], s20 offen sc1
    s_add_u32 s20, s20, 1024
    v_min_u32 v44, -2, v44
    v_min_u32 v45, -2, v45
    v_min_u32 v46, -2, v46
    v_min_u32 v47, -2, v47
    buffer_store_dwordx4 v[44:47], v16, s[4:7], s20 offen sc1
    s_add_u32 s20, s20, 1024
    v_min_u32 v48, -2, v48
    v_min_u32 v49, -2, v49
    v_min_u32 v50, -2, v50
    v_min_u32 v51, -2, v51
    buffer_store_dwordx4 v[48:51], v16, s[4:7], s20 offen sc1
    s_add_u32 s20, s20, 1024
    v_min_u32 v52, -2, v52
    v_min_u32 v53, -2, v53
    v_min_u32 v54, -2, v54
    v_min_u32 v55, -2, v55
    buffer_store_dwordx4 v[52:55], v16, s[4:7], s20 offen sc1
    s_add_u32 s20, s20, 1024
Lim_5:
Linit_done:
    s_mov_b32 s79, s80
    v_lshrrev_b32 v5, 2, v0
    v_lshlrev_b32 v6, 13, v5
    v_and_b32 v7, 3, v0
    v_lshlrev_b32 v7, 4, v7
    v_add_u32 v8, v6, v7
    v_mul_u32_u24 v6, 1152, v5
    v_add_u32 v9, v6, v7
    v_lshrrev_b32 v5, 1, v2
    v_lshlrev_b32 v5, 4, v5
    v_and_b32 v6, 1, v2
    v_lshlrev_b32 v6, 2, v6
    v_add_u32 v5, v5, v6
    v_bfe_u32 v6, v1, 2, 1
    v_add_u32 v5, v5, v6
    v_bfe_u32 v6, v1, 3, 1
    v_lshlrev_b32 v7, 3, v6
    v_add_u32 v5, v5, v7
    v_lshlrev_b32 v5, 6, v5
    v_lshlrev_b32 v6, 5, v6
    v_add_u32 v5, v5, v6
    v_and_b32 v6, 3, v0
    v_lshlrev_b32 v6, 3, v6
    v_add_u32 v5, v5, v6
    v_xor_b32 v7, 512, v5
    v_add_u32 v10, s55, v5
    v_add_u32 v11, s55, v7
    s_lshl_b32 s22, s17, 12
    s_add_u32 s22, s22, 139264
    v_add_u32 v28, s22, v5
    v_add_u32 v29, s22, v7
    v_lshlrev_b32 v33, 4, v0
    v_add_u32 v33, s22, v33
    s_load_dwordx2 s[8:9], s[0:1], 16
    s_waitcnt lgkmcnt(0)
    s_mov_b32 s10, 4718592
    s_mov_b32 s11, 0x20000
    s_lshl_b32 s20, s16, 8
    s_lshl_b32 s21, s17, 6
    s_add_u32 s20, s20, s21
    s_add_u32 s20, s20, 0
    buffer_load_dwordx4 v[72:75], v8, s[8:11], s20 offen
    s_add_u32 s20, s20, 131072
    buffer_load_dwordx4 v[76:79], v8, s[8:11], s20 offen
    s_add_u32 s20, s20, 131072
    buffer_load_dwordx4 v[80:83], v8, s[8:11], s20 offen
    s_add_u32 s20, s20, 131072
    buffer_load_dwordx4 v[84:87], v8, s[8:11], s20 offen
    s_lshl_b32 s20, s16, 8
    s_lshl_b32 s21, s17, 6
    s_add_u32 s20, s20, s21
    s_add_u32 s20, s20, 524288
    buffer_load_dwordx4 v[104:107], v8, s[8:11], s20 offen
    s_add_u32 s20, s20, 131072
    buffer_load_dwordx4 v[108:111], v8, s[8:11], s20 offen
    s_add_u32 s20, s20, 131072
    buffer_load_dwordx4 v[112:115], v8, s[8:11], s20 offen
    s_add_u32 s20, s20, 131072
    buffer_load_dwordx4 v[116:119], v8, s[8:11], s20 offen
    s_lshl_b32 s20, s16, 8
    s_lshl_b32 s21, s17, 6
    s_add_u32 s20, s20, s21
    s_add_u32 s20, s20, 1048576
    buffer_load_dwordx4 v[136:139], v8, s[8:11], s20 offen
    s_add_u32 s20, s20, 131072
    buffer_load_dwordx4 v[140:143], v8, s[8:11], s20 offen
    s_add_u32 s20, s20, 131072
    buffer_load_dwordx4 v[144:147], v8, s[8:11], s20 offen
    s_add_u32 s20, s20, 131072
    buffer_load_dwordx4 v[148:151], v8, s[8:11], s20 offen
    s_lshl_b32 s20, s16, 8
    s_lshl_b32 s21, s17, 6
    s_add_u32 s20, s20, s21
    s_add_u32 s20, s20, 1572864
    buffer_load_dwordx4 v[168:171], v8, s[8:11], s20 offen
    s_add_u32 s20, s20, 131072
    buffer_load_dwordx4 v[172:175], v8, s[8:11], s20 offen
    s_add_u32 s20, s20, 131072
    buffer_load_dwordx4 v[176:179], v8, s[8:11], s20 offen
    s_add_u32 s20, s20, 131072
    buffer_load_dwordx4 v[180:183], v8, s[8:11], s20 offen
    s_lshl_b32 s20, s16, 8
    s_lshl_b32 s21, s17, 6
    s_add_u32 s20, s20, s21
    s_add_u32 s20, s20, 2097152
    buffer_load_dwordx4 v[200:203], v8, s[8:11], s20 offen
    s_add_u32 s20, s20, 131072
    buffer_load_dwordx4 v[204:207], v8, s[8:11], s20 offen
    s_add_u32 s20, s20, 131072
    buffer_load_dwordx4 v[208:211], v8, s[8:11], s20 offen
    s_add_u32 s20, s20, 131072
    buffer_load_dwordx4 v[212:215], v8, s[8:11], s20 offen
    s_lshl_b32 s20, s16, 8
    s_lshl_b32 s21, s17, 6
    s_add_u32 s20, s20, s21
    s_add_u32 s20, s20, 2621440
    buffer_load_dwordx4 v[240:243], v8, s[8:11], s20 offen
    s_add_u32 s20, s20, 131072
    buffer_load_dwordx4 v[244:247], v8, s[8:11], s20 offen
    s_add_u32 s20, s20, 131072
    buffer_load_dwordx4 v[248:251], v8, s[8:11], s20 offen
    s_add_u32 s20, s20, 131072
    buffer_load_dwordx4 v[252:255], v8, s[8:11], s20 offen
    s_lshl_b32 s20, s16, 8
    s_lshl_b32 s21, s17, 6
    s_add_u32 s20, s20, s21
    s_add_u32 s20, s20, 3145728
    buffer_load_dwordx4 a[32:35], v8, s[8:11], s20 offen
    s_add_u32 s20, s20, 131072
    buffer_load_dwordx4 a[36:39], v8, s[8:11], s20 offen
    s_add_u32 s20, s20, 131072
    buffer_load_dwordx4 a[40:43], v8, s[8:11], s20 offen
    s_add_u32 s20, s20, 131072
    buffer_load_dwordx4 a[44:47], v8, s[8:11], s20 offen
    s_lshl_b32 s20, s16, 8
    s_lshl_b32 s21, s17, 6
    s_add_u32 s20, s20, s21
    s_add_u32 s20, s20, 3670016
    buffer_load_dwordx4 a[80:83], v8, s[8:11], s20 offen
    s_add_u32 s20, s20, 131072
    buffer_load_dwordx4 a[84:87], v8, s[8:11], s20 offen
    s_add_u32 s20, s20, 131072
    buffer_load_dwordx4 a[88:91], v8, s[8:11], s20 offen
    s_add_u32 s20, s20, 131072
    buffer_load_dwordx4 a[92:95], v8, s[8:11], s20 offen
    s_lshl_b32 s20, s16, 8
    s_lshl_b32 s21, s17, 6
    s_add_u32 s20, s20, s21
    s_add_u32 s20, s20, 4194304
    buffer_load_dwordx4 a[128:131], v8, s[8:11], s20 offen
    s_add_u32 s20, s20, 131072
    buffer_load_dwordx4 a[132:135], v8, s[8:11], s20 offen
    s_add_u32 s20, s20, 131072
    buffer_load_dwordx4 a[136:139], v8, s[8:11], s20 offen
    s_add_u32 s20, s20, 131072
    buffer_load_dwordx4 a[140:143], v8, s[8:11], s20 offen
    s_load_dwordx2 s[8:9], s[0:1], 24
    s_waitcnt lgkmcnt(0)
    s_mov_b32 s10, 4718592
    s_mov_b32 s11, 0x20000
    s_lshl_b32 s20, s16, 8
    s_lshl_b32 s21, s17, 6
    s_add_u32 s20, s20, s21
    s_add_u32 s20, s20, 0
    buffer_load_dwordx4 v[88:91], v8, s[8:11], s20 offen
    s_add_u32 s20, s20, 131072
    buffer_load_dwordx4 v[92:95], v8, s[8:11], s20 offen
    s_add_u32 s20, s20, 131072
    buffer_load_dwordx4 v[96:99], v8, s[8:11], s20 offen
    s_add_u32 s20, s20, 131072
    buffer_load_dwordx4 v[100:103], v8, s[8:11], s20 offen
    s_lshl_b32 s20, s16, 8
    s_lshl_b32 s21, s17, 6
    s_add_u32 s20, s20, s21
    s_add_u32 s20, s20, 524288
    buffer_load_dwordx4 v[120:123], v8, s[8:11], s20 offen
    s_add_u32 s20, s20, 131072
    buffer_load_dwordx4 v[124:127], v8, s[8:11], s20 offen
    s_add_u32 s20, s20, 131072
    buffer_load_dwordx4 v[128:131], v8, s[8:11], s20 offen
    s_add_u32 s20, s20, 131072
    buffer_load_dwordx4 v[132:135], v8, s[8:11], s20 offen
    s_lshl_b32 s20, s16, 8
    s_lshl_b32 s21, s17, 6
    s_add_u32 s20, s20, s21
    s_add_u32 s20, s20, 1048576
    buffer_load_dwordx4 v[152:155], v8, s[8:11], s20 offen
    s_add_u32 s20, s20, 131072
    buffer_load_dwordx4 v[156:159], v8, s[8:11], s20 offen
    s_add_u32 s20, s20, 131072
    buffer_load_dwordx4 v[160:163], v8, s[8:11], s20 offen
    s_add_u32 s20, s20, 131072
    buffer_load_dwordx4 v[164:167], v8, s[8:11], s20 offen
    s_lshl_b32 s20, s16, 8
    s_lshl_b32 s21, s17, 6
    s_add_u32 s20, s20, s21
    s_add_u32 s20, s20, 1572864
    buffer_load_dwordx4 v[184:187], v8, s[8:11], s20 offen
    s_add_u32 s20, s20, 131072
    buffer_load_dwordx4 v[188:191], v8, s[8:11], s20 offen
    s_add_u32 s20, s20, 131072
    buffer_load_dwordx4 v[192:195], v8, s[8:11], s20 offen
    s_add_u32 s20, s20, 131072
    buffer_load_dwordx4 v[196:199], v8, s[8:11], s20 offen
    s_lshl_b32 s20, s16, 8
    s_lshl_b32 s21, s17, 6
    s_add_u32 s20, s20, s21
    s_add_u32 s20, s20, 2097152
    buffer_load_dwordx4 v[216:219], v8, s[8:11], s20 offen
    s_add_u32 s20, s20, 131072
    buffer_load_dwordx4 v[220:223], v8, s[8:11], s20 offen
    s_add_u32 s20, s20, 131072
    buffer_load_dwordx4 v[224:227], v8, s[8:11], s20 offen
    s_add_u32 s20, s20, 131072
    buffer_load_dwordx4 v[228:231], v8, s[8:11], s20 offen
    s_lshl_b32 s20, s16, 8
    s_lshl_b32 s21, s17, 6
    s_add_u32 s20, s20, s21
    s_add_u32 s20, s20, 2621440
    buffer_load_dwordx4 a[0:3], v8, s[8:11], s20 offen
    s_add_u32 s20, s20, 131072
    buffer_load_dwordx4 a[4:7], v8, s[8:11], s20 offen
    s_add_u32 s20, s20, 131072
    buffer_load_dwordx4 a[8:11], v8, s[8:11], s20 offen
    s_add_u32 s20, s20, 131072
    buffer_load_dwordx4 a[12:15], v8, s[8:11], s20 offen
    s_waitcnt vmcnt(56)
    ds_write_b128 v33, v[72:75] offset:0
    ds_write_b128 v33, v[76:79] offset:1024
    ds_write_b128 v33, v[80:83] offset:2048
    ds_write_b128 v33, v[84:87] offset:3072
    s_waitcnt lgkmcnt(0)
    ds_read_b64_tr_b16 v[72:73], v28 offset:0
    ds_read_b64_tr_b16 v[74:75], v28 offset:128
    ds_read_b64_tr_b16 v[76:77], v28 offset:2048
    ds_read_b64_tr_b16 v[78:79], v28 offset:2176
    ds_read_b64_tr_b16 v[80:81], v29 offset:0
    ds_read_b64_tr_b16 v[82:83], v29 offset:128
    ds_read_b64_tr_b16 v[84:85], v29 offset:2048
    ds_read_b64_tr_b16 v[86:87], v29 offset:2176
    s_waitcnt lgkmcnt(0)
    s_lshl_b32 s20, s16, 8
    s_lshl_b32 s21, s17, 6
    s_add_u32 s20, s20, s21
    s_add_u32 s20, s20, 3145728
    buffer_load_dwordx4 a[48:51], v8, s[8:11], s20 offen
    s_add_u32 s20, s20, 131072
    buffer_load_dwordx4 a[52:55], v8, s[8:11], s20 offen
    s_add_u32 s20, s20, 131072
    buffer_load_dwordx4 a[56:59], v8, s[8:11], s20 offen
    s_add_u32 s20, s20, 131072
    buffer_load_dwordx4 a[60:63], v8, s[8:11], s20 offen
    s_waitcnt vmcnt(56)
    ds_write_b128 v33, v[104:107] offset:0
    ds_write_b128 v33, v[108:111] offset:1024
    ds_write_b128 v33, v[112:115] offset:2048
    ds_write_b128 v33, v[116:119] offset:3072
    s_waitcnt lgkmcnt(0)
    ds_read_b64_tr_b16 v[104:105], v28 offset:0
    ds_read_b64_tr_b16 v[106:107], v28 offset:128
    ds_read_b64_tr_b16 v[108:109], v28 offset:2048
    ds_read_b64_tr_b16 v[110:111], v28 offset:2176
    ds_read_b64_tr_b16 v[112:113], v29 offset:0
    ds_read_b64_tr_b16 v[114:115], v29 offset:128
    ds_read_b64_tr_b16 v[116:117], v29 offset:2048
    ds_read_b64_tr_b16 v[118:119], v29 offset:2176
    s_waitcnt lgkmcnt(0)
    s_lshl_b32 s20, s16, 8
    s_lshl_b32 s21, s17, 6
    s_add_u32 s20, s20, s21
    s_add_u32 s20, s20, 3670016
    buffer_load_dwordx4 a[96:99], v8, s[8:11], s20 offen
    s_add_u32 s20, s20, 131072
    buffer_load_dwordx4 a[100:103], v8, s[8:11], s20 offen
    s_add_u32 s20, s20, 131072
    buffer_load_dwordx4 a[104:107], v8, s[8:11], s20 offen
    s_add_u32 s20, s20, 131072
    buffer_load_dwordx4 a[108:111], v8, s[8:11], s20 offen
    s_waitcnt vmcnt(56)
    ds_write_b128 v33, v[136:139] offset:0
    ds_write_b128 v33, v[140:143] offset:1024
    ds_write_b128 v33, v[144:147] offset:2048
    ds_write_b128 v33, v[148:151] offset:3072
    s_waitcnt lgkmcnt(0)
    ds_read_b64_tr_b16 v[136:137], v28 offset:0
    ds_read_b64_tr_b16 v[138:139], v28 offset:128
    ds_read_b64_tr_b16 v[140:141], v28 offset:2048
    ds_read_b64_tr_b16 v[142:143], v28 offset:2176
    ds_read_b64_tr_b16 v[144:145], v29 offset:0
    ds_read_b64_tr_b16 v[146:147], v29 offset:128
    ds_read_b64_tr_b16 v[148:149], v29 offset:2048
    ds_read_b64_tr_b16 v[150:151], v29 offset:2176
    s_waitcnt lgkmcnt(0)
    s_lshl_b32 s20, s16, 8
    s_lshl_b32 s21, s17, 6
    s_add_u32 s20, s20, s21
    s_add_u32 s20, s20, 4194304
    buffer_load_dwordx4 a[144:147], v8, s[8:11], s20 offen
    s_add_u32 s20, s20, 131072
    buffer_load_dwordx4 a[148:151], v8, s[8:11], s20 offen
    s_add_u32 s20, s20, 131072
    buffer_load_dwordx4 a[152:155], v8, s[8:11], s20 offen
    s_add_u32 s20, s20, 131072
    buffer_load_dwordx4 a[156:159], v8, s[8:11], s20 offen
    s_waitcnt vmcnt(56)
    ds_write_b128 v33, v[168:171] offset:0
    ds_write_b128 v33, v[172:175] offset:1024
    ds_write_b128 v33, v[176:179] offset:2048
    ds_write_b128 v33, v[180:183] offset:3072
    s_waitcnt lgkmcnt(0)
    ds_read_b64_tr_b16 v[168:169], v28 offset:0
    ds_read_b64_tr_b16 v[170:171], v28 offset:128
    ds_read_b64_tr_b16 v[172:173], v28 offset:2048
    ds_read_b64_tr_b16 v[174:175], v28 offset:2176
    ds_read_b64_tr_b16 v[176:177], v29 offset:0
    ds_read_b64_tr_b16 v[178:179], v29 offset:128
    ds_read_b64_tr_b16 v[180:181], v29 offset:2048
    ds_read_b64_tr_b16 v[182:183], v29 offset:2176
    s_waitcnt lgkmcnt(0)
    s_load_dwordx2 s[8:9], s[0:1], 32
    s_waitcnt lgkmcnt(0)
    s_mov_b32 s10, 4718592
    s_mov_b32 s11, 0x20000
    s_lshl_b32 s20, s16, 8
    s_lshl_b32 s21, s17, 6
    s_add_u32 s20, s20, s21
    s_add_u32 s20, s20, 2621440
    buffer_load_dwordx4 a[16:19], v8, s[8:11], s20 offen
    s_add_u32 s20, s20, 131072
    buffer_load_dwordx4 a[20:23], v8, s[8:11], s20 offen
    s_add_u32 s20, s20, 131072
    buffer_load_dwordx4 a[24:27], v8, s[8:11], s20 offen
    s_add_u32 s20, s20, 131072
    buffer_load_dwordx4 a[28:31], v8, s[8:11], s20 offen
    s_waitcnt vmcnt(56)
    ds_write_b128 v33, v[200:203] offset:0
    ds_write_b128 v33, v[204:207] offset:1024
    ds_write_b128 v33, v[208:211] offset:2048
    ds_write_b128 v33, v[212:215] offset:3072
    s_waitcnt lgkmcnt(0)
    ds_read_b64_tr_b16 v[200:201], v28 offset:0
    ds_read_b64_tr_b16 v[202:203], v28 offset:128
    ds_read_b64_tr_b16 v[204:205], v28 offset:2048
    ds_read_b64_tr_b16 v[206:207], v28 offset:2176
    ds_read_b64_tr_b16 v[208:209], v29 offset:0
    ds_read_b64_tr_b16 v[210:211], v29 offset:128
    ds_read_b64_tr_b16 v[212:213], v29 offset:2048
    ds_read_b64_tr_b16 v[214:215], v29 offset:2176
    s_waitcnt lgkmcnt(0)
    s_lshl_b32 s20, s16, 8
    s_lshl_b32 s21, s17, 6
    s_add_u32 s20, s20, s21
    s_add_u32 s20, s20, 3145728
    buffer_load_dwordx4 a[64:67], v8, s[8:11], s20 offen
    s_add_u32 s20, s20, 131072
    buffer_load_dwordx4 a[68:71], v8, s[8:11], s20 offen
    s_add_u32 s20, s20, 131072
    buffer_load_dwordx4 a[72:75], v8, s[8:11], s20 offen
    s_add_u32 s20, s20, 131072
    buffer_load_dwordx4 a[76:79], v8, s[8:11], s20 offen
    s_waitcnt vmcnt(56)
    ds_write_b128 v33, v[240:243] offset:0
    ds_write_b128 v33, v[244:247] offset:1024
    ds_write_b128 v33, v[248:251] offset:2048
    ds_write_b128 v33, v[252:255] offset:3072
    s_waitcnt lgkmcnt(0)
    ds_read_b64_tr_b16 v[240:241], v28 offset:0
    ds_read_b64_tr_b16 v[242:243], v28 offset:128
    ds_read_b64_tr_b16 v[244:245], v28 offset:2048
    ds_read_b64_tr_b16 v[246:247], v28 offset:2176
    ds_read_b64_tr_b16 v[248:249], v29 offset:0
    ds_read_b64_tr_b16 v[250:251], v29 offset:128
    ds_read_b64_tr_b16 v[252:253], v29 offset:2048
    ds_read_b64_tr_b16 v[254:255], v29 offset:2176
    s_waitcnt lgkmcnt(0)
    s_lshl_b32 s20, s16, 8
    s_lshl_b32 s21, s17, 6
    s_add_u32 s20, s20, s21
    s_add_u32 s20, s20, 3670016
    buffer_load_dwordx4 a[112:115], v8, s[8:11], s20 offen
    s_add_u32 s20, s20, 131072
    buffer_load_dwordx4 a[116:119], v8, s[8:11], s20 offen
    s_add_u32 s20, s20, 131072
    buffer_load_dwordx4 a[120:123], v8, s[8:11], s20 offen
    s_add_u32 s20, s20, 131072
    buffer_load_dwordx4 a[124:127], v8, s[8:11], s20 offen
    s_waitcnt vmcnt(56)
    ds_write_b128 v33, a[32:35] offset:0
    ds_write_b128 v33, a[36:39] offset:1024
    ds_write_b128 v33, a[40:43] offset:2048
    ds_write_b128 v33, a[44:47] offset:3072
    s_waitcnt lgkmcnt(0)
    ds_read_b64_tr_b16 a[32:33], v28 offset:0
    ds_read_b64_tr_b16 a[34:35], v28 offset:128
    ds_read_b64_tr_b16 a[36:37], v28 offset:2048
    ds_read_b64_tr_b16 a[38:39], v28 offset:2176
    ds_read_b64_tr_b16 a[40:41], v29 offset:0
    ds_read_b64_tr_b16 a[42:43], v29 offset:128
    ds_read_b64_tr_b16 a[44:45], v29 offset:2048
    ds_read_b64_tr_b16 a[46:47], v29 offset:2176
    s_waitcnt lgkmcnt(0)
    s_lshl_b32 s20, s16, 8
    s_lshl_b32 s21, s17, 6
    s_add_u32 s20, s20, s21
    s_add_u32 s20, s20, 4194304
    buffer_load_dwordx4 a[160:163], v8, s[8:11], s20 offen
    s_add_u32 s20, s20, 131072
    buffer_load_dwordx4 a[164:167], v8, s[8:11], s20 offen
    s_add_u32 s20, s20, 131072
    buffer_load_dwordx4 a[168:171], v8, s[8:11], s20 offen
    s_add_u32 s20, s20, 131072
    buffer_load_dwordx4 a[172:175], v8, s[8:11], s20 offen
    s_waitcnt vmcnt(56)
    ds_write_b128 v33, a[80:83] offset:0
    ds_write_b128 v33, a[84:87] offset:1024
    ds_write_b128 v33, a[88:91] offset:2048
    ds_write_b128 v33, a[92:95] offset:3072
    s_waitcnt lgkmcnt(0)
    ds_read_b64_tr_b16 a[80:81], v28 offset:0
    ds_read_b64_tr_b16 a[82:83], v28 offset:128
    ds_read_b64_tr_b16 a[84:85], v28 offset:2048
    ds_read_b64_tr_b16 a[86:87], v28 offset:2176
    ds_read_b64_tr_b16 a[88:89], v29 offset:0
    ds_read_b64_tr_b16 a[90:91], v29 offset:128
    ds_read_b64_tr_b16 a[92:93], v29 offset:2048
    ds_read_b64_tr_b16 a[94:95], v29 offset:2176
    s_waitcnt lgkmcnt(0)
    s_load_dwordx2 s[8:9], s[0:1], 40
    s_waitcnt lgkmcnt(0)
    s_mov_b32 s10, 4718592
    s_mov_b32 s11, 0x20000
    s_mul_i32 s20, s16, 147456
    s_lshl_b32 s21, s17, 6
    s_add_u32 s20, s20, s21
    s_add_u32 s20, s20, 0
    buffer_load_dwordx4 a[176:179], v9, s[8:11], s20 offen
    s_add_u32 s20, s20, 18432
    buffer_load_dwordx4 a[180:183], v9, s[8:11], s20 offen
    s_add_u32 s20, s20, 18432
    buffer_load_dwordx4 a[184:187], v9, s[8:11], s20 offen
    s_add_u32 s20, s20, 18432
    buffer_load_dwordx4 a[188:191], v9, s[8:11], s20 offen
    s_waitcnt vmcnt(56)
    ds_write_b128 v33, a[128:131] offset:0
    ds_write_b128 v33, a[132:135] offset:1024
    ds_write_b128 v33, a[136:139] offset:2048
    ds_write_b128 v33, a[140:143] offset:3072
    s_waitcnt lgkmcnt(0)
    ds_read_b64_tr_b16 a[128:129], v28 offset:0
    ds_read_b64_tr_b16 a[130:131], v28 offset:128
    ds_read_b64_tr_b16 a[132:133], v28 offset:2048
    ds_read_b64_tr_b16 a[134:135], v28 offset:2176
    ds_read_b64_tr_b16 a[136:137], v29 offset:0
    ds_read_b64_tr_b16 a[138:139], v29 offset:128
    ds_read_b64_tr_b16 a[140:141], v29 offset:2048
    ds_read_b64_tr_b16 a[142:143], v29 offset:2176
    s_waitcnt lgkmcnt(0)
    s_mul_i32 s20, s16, 147456
    s_lshl_b32 s21, s17, 6
    s_add_u32 s20, s20, s21
    s_add_u32 s20, s20, 73728
    buffer_load_dwordx4 a[192:195], v9, s[8:11], s20 offen
    s_add_u32 s20, s20, 18432
    buffer_load_dwordx4 a[196:199], v9, s[8:11], s20 offen
    s_add_u32 s20, s20, 18432
    buffer_load_dwordx4 a[200:203], v9, s[8:11], s20 offen
    s_add_u32 s20, s20, 18432
    buffer_load_dwordx4 a[204:207], v9, s[8:11], s20 offen
    s_waitcnt vmcnt(56)
    ds_write_b128 v33, v[88:91] offset:0
    ds_write_b128 v33, v[92:95] offset:1024
    ds_write_b128 v33, v[96:99] offset:2048
    ds_write_b128 v33, v[100:103] offset:3072
    s_waitcnt lgkmcnt(0)
    ds_read_b64_tr_b16 v[88:89], v28 offset:0
    ds_read_b64_tr_b16 v[90:91], v28 offset:128
    ds_read_b64_tr_b16 v[92:93], v28 offset:2048
    ds_read_b64_tr_b16 v[94:95], v28 offset:2176
    ds_read_b64_tr_b16 v[96:97], v29 offset:0
    ds_read_b64_tr_b16 v[98:99], v29 offset:128
    ds_read_b64_tr_b16 v[100:101], v29 offset:2048
    ds_read_b64_tr_b16 v[102:103], v29 offset:2176
    s_waitcnt lgkmcnt(0)
    s_mul_i32 s20, s16, 147456
    s_lshl_b32 s21, s17, 6
    s_add_u32 s20, s20, s21
    s_add_u32 s20, s20, 256
    buffer_load_dwordx4 a[208:211], v9, s[8:11], s20 offen
    s_add_u32 s20, s20, 18432
    buffer_load_dwordx4 a[212:215], v9, s[8:11], s20 offen
    s_add_u32 s20, s20, 18432
    buffer_load_dwordx4 a[216:219], v9, s[8:11], s20 offen
    s_add_u32 s20, s20, 18432
    buffer_load_dwordx4 a[220:223], v9, s[8:11], s20 offen
    s_waitcnt vmcnt(56)
    ds_write_b128 v33, v[120:123] offset:0
    ds_write_b128 v33, v[124:127] offset:1024
    ds_write_b128 v33, v[128:131] offset:2048
    ds_write_b128 v33, v[132:135] offset:3072
    s_waitcnt lgkmcnt(0)
    ds_read_b64_tr_b16 v[120:121], v28 offset:0
    ds_read_b64_tr_b16 v[122:123], v28 offset:128
    ds_read_b64_tr_b16 v[124:125], v28 offset:2048
    ds_read_b64_tr_b16 v[126:127], v28 offset:2176
    ds_read_b64_tr_b16 v[128:129], v29 offset:0
    ds_read_b64_tr_b16 v[130:131], v29 offset:128
    ds_read_b64_tr_b16 v[132:133], v29 offset:2048
    ds_read_b64_tr_b16 v[134:135], v29 offset:2176
    s_waitcnt lgkmcnt(0)
    s_mul_i32 s20, s16, 147456
    s_lshl_b32 s21, s17, 6
    s_add_u32 s20, s20, s21
    s_add_u32 s20, s20, 73984
    buffer_load_dwordx4 a[224:227], v9, s[8:11], s20 offen
    s_add_u32 s20, s20, 18432
    buffer_load_dwordx4 a[228:231], v9, s[8:11], s20 offen
    s_add_u32 s20, s20, 18432
    buffer_load_dwordx4 a[232:235], v9, s[8:11], s20 offen
    s_add_u32 s20, s20, 18432
    buffer_load_dwordx4 a[236:239], v9, s[8:11], s20 offen
    s_waitcnt vmcnt(56)
    ds_write_b128 v33, v[152:155] offset:0
    ds_write_b128 v33, v[156:159] offset:1024
    ds_write_b128 v33, v[160:163] offset:2048
    ds_write_b128 v33, v[164:167] offset:3072
    s_waitcnt lgkmcnt(0)
    ds_read_b64_tr_b16 v[152:153], v28 offset:0
    ds_read_b64_tr_b16 v[154:155], v28 offset:128
    ds_read_b64_tr_b16 v[156:157], v28 offset:2048
    ds_read_b64_tr_b16 v[158:159], v28 offset:2176
    ds_read_b64_tr_b16 v[160:161], v29 offset:0
    ds_read_b64_tr_b16 v[162:163], v29 offset:128
    ds_read_b64_tr_b16 v[164:165], v29 offset:2048
    ds_read_b64_tr_b16 v[166:167], v29 offset:2176
    s_waitcnt lgkmcnt(0)
    s_mul_i32 s20, s16, 147456
    s_lshl_b32 s21, s17, 6
    s_add_u32 s20, s20, s21
    s_add_u32 s20, s20, 512
    buffer_load_dwordx4 a[240:243], v9, s[8:11], s20 offen
    s_add_u32 s20, s20, 18432
    buffer_load_dwordx4 a[244:247], v9, s[8:11], s20 offen
    s_add_u32 s20, s20, 18432
    buffer_load_dwordx4 a[248:251], v9, s[8:11], s20 offen
    s_add_u32 s20, s20, 18432
    buffer_load_dwordx4 a[252:255], v9, s[8:11], s20 offen
    s_waitcnt vmcnt(56)
    ds_write_b128 v33, v[184:187] offset:0
    ds_write_b128 v33, v[188:191] offset:1024
    ds_write_b128 v33, v[192:195] offset:2048
    ds_write_b128 v33, v[196:199] offset:3072
    s_waitcnt lgkmcnt(0)
    ds_read_b64_tr_b16 v[184:185], v28 offset:0
    ds_read_b64_tr_b16 v[186:187], v28 offset:128
    ds_read_b64_tr_b16 v[188:189], v28 offset:2048
    ds_read_b64_tr_b16 v[190:191], v28 offset:2176
    ds_read_b64_tr_b16 v[192:193], v29 offset:0
    ds_read_b64_tr_b16 v[194:195], v29 offset:128
    ds_read_b64_tr_b16 v[196:197], v29 offset:2048
    ds_read_b64_tr_b16 v[198:199], v29 offset:2176
    s_waitcnt lgkmcnt(0)
    s_load_dwordx2 s[8:9], s[0:1], 32
    s_waitcnt lgkmcnt(0)
    s_mov_b32 s10, 4718592
    s_mov_b32 s11, 0x20000
    s_lshl_b32 s20, s16, 8
    s_lshl_b32 s21, s17, 6
    s_add_u32 s20, s20, s21
    s_add_u32 s20, s20, 2097152
    buffer_load_dwordx4 v[40:43], v8, s[8:11], s20 offen
    s_add_u32 s20, s20, 131072
    buffer_load_dwordx4 v[44:47], v8, s[8:11], s20 offen
    s_add_u32 s20, s20, 131072
    buffer_load_dwordx4 v[48:51], v8, s[8:11], s20 offen
    s_add_u32 s20, s20, 131072
    buffer_load_dwordx4 v[52:55], v8, s[8:11], s20 offen
    s_waitcnt vmcnt(56)
    ds_write_b128 v33, v[216:219] offset:0
    ds_write_b128 v33, v[220:223] offset:1024
    ds_write_b128 v33, v[224:227] offset:2048
    ds_write_b128 v33, v[228:231] offset:3072
    s_waitcnt lgkmcnt(0)
    ds_read_b64_tr_b16 v[216:217], v28 offset:0
    ds_read_b64_tr_b16 v[218:219], v28 offset:128
    ds_read_b64_tr_b16 v[220:221], v28 offset:2048
    ds_read_b64_tr_b16 v[222:223], v28 offset:2176
    ds_read_b64_tr_b16 v[224:225], v29 offset:0
    ds_read_b64_tr_b16 v[226:227], v29 offset:128
    ds_read_b64_tr_b16 v[228:229], v29 offset:2048
    ds_read_b64_tr_b16 v[230:231], v29 offset:2176
    s_waitcnt lgkmcnt(0)
    s_lshl_b32 s20, s16, 8
    s_lshl_b32 s21, s17, 6
    s_add_u32 s20, s20, s21
    s_add_u32 s20, s20, 0
    s_add_u32 s21, s55, 0
    s_mov_b32 m0, s21
    s_nop 0
    buffer_load_dwordx4 v8, s[8:11], s20 offen lds
    s_add_u32 s20, s20, 131072
    s_add_u32 s21, s21, 1024
    s_mov_b32 m0, s21
    s_nop 0
    buffer_load_dwordx4 v8, s[8:11], s20 offen lds
    s_add_u32 s20, s20, 131072
    s_add_u32 s21, s21, 1024
    s_mov_b32 m0, s21
    s_nop 0
    buffer_load_dwordx4 v8, s[8:11], s20 offen lds
    s_add_u32 s20, s20, 131072
    s_add_u32 s21, s21, 1024
    s_mov_b32 m0, s21
    s_nop 0
    buffer_load_dwordx4 v8, s[8:11], s20 offen lds
    s_waitcnt vmcnt(56)
    ds_write_b128 v33, a[0:3] offset:0
    ds_write_b128 v33, a[4:7] offset:1024
    ds_write_b128 v33, a[8:11] offset:2048
    ds_write_b128 v33, a[12:15] offset:3072
    s_waitcnt lgkmcnt(0)
    ds_read_b64_tr_b16 a[0:1], v28 offset:0
    ds_read_b64_tr_b16 a[2:3], v28 offset:128
    ds_read_b64_tr_b16 a[4:5], v28 offset:2048
    ds_read_b64_tr_b16 a[6:7], v28 offset:2176
    ds_read_b64_tr_b16 a[8:9], v29 offset:0
    ds_read_b64_tr_b16 a[10:11], v29 offset:128
    ds_read_b64_tr_b16 a[12:13], v29 offset:2048
    ds_read_b64_tr_b16 a[14:15], v29 offset:2176
    s_waitcnt lgkmcnt(0)
    s_lshl_b32 s20, s16, 8
    s_lshl_b32 s21, s17, 6
    s_add_u32 s20, s20, s21
    s_add_u32 s20, s20, 524288
    s_add_u32 s21, s55, 4096
    s_mov_b32 m0, s21
    s_nop 0
    buffer_load_dwordx4 v8, s[8:11], s20 offen lds
    s_add_u32 s20, s20, 131072
    s_add_u32 s21, s21, 1024
    s_mov_b32 m0, s21
    s_nop 0
    buffer_load_dwordx4 v8, s[8:11], s20 offen lds
    s_add_u32 s20, s20, 131072
    s_add_u32 s21, s21, 1024
    s_mov_b32 m0, s21
    s_nop 0
    buffer_load_dwordx4 v8, s[8:11], s20 offen lds
    s_add_u32 s20, s20, 131072
    s_add_u32 s21, s21, 1024
    s_mov_b32 m0, s21
    s_nop 0
    buffer_load_dwordx4 v8, s[8:11], s20 offen lds
    s_waitcnt vmcnt(56)
    ds_write_b128 v33, a[48:51] offset:0
    ds_write_b128 v33, a[52:55] offset:1024
    ds_write_b128 v33, a[56:59] offset:2048
    ds_write_b128 v33, a[60:63] offset:3072
    s_waitcnt lgkmcnt(0)
    ds_read_b64_tr_b16 a[48:49], v28 offset:0
    ds_read_b64_tr_b16 a[50:51], v28 offset:128
    ds_read_b64_tr_b16 a[52:53], v28 offset:2048
    ds_read_b64_tr_b16 a[54:55], v28 offset:2176
    ds_read_b64_tr_b16 a[56:57], v29 offset:0
    ds_read_b64_tr_b16 a[58:59], v29 offset:128
    ds_read_b64_tr_b16 a[60:61], v29 offset:2048
    ds_read_b64_tr_b16 a[62:63], v29 offset:2176
    s_waitcnt lgkmcnt(0)
    s_lshl_b32 s20, s16, 8
    s_lshl_b32 s21, s17, 6
    s_add_u32 s20, s20, s21
    s_add_u32 s20, s20, 1048576
    s_add_u32 s21, s55, 8192
    s_mov_b32 m0, s21
    s_nop 0
    buffer_load_dwordx4 v8, s[8:11], s20 offen lds
    s_add_u32 s20, s20, 131072
    s_add_u32 s21, s21, 1024
    s_mov_b32 m0, s21
    s_nop 0
    buffer_load_dwordx4 v8, s[8:11], s20 offen lds
    s_add_u32 s20, s20, 131072
    s_add_u32 s21, s21, 1024
    s_mov_b32 m0, s21
    s_nop 0
    buffer_load_dwordx4 v8, s[8:11], s20 offen lds
    s_add_u32 s20, s20, 131072
    s_add_u32 s21, s21, 1024
    s_mov_b32 m0, s21
    s_nop 0
    buffer_load_dwordx4 v8, s[8:11], s20 offen lds
    s_waitcnt vmcnt(56)
    ds_write_b128 v33, a[96:99] offset:0
    ds_write_b128 v33, a[100:103] offset:1024
    ds_write_b128 v33, a[104:107] offset:2048
    ds_write_b128 v33, a[108:111] offset:3072
    s_waitcnt lgkmcnt(0)
    ds_read_b64_tr_b16 a[96:97], v28 offset:0
    ds_read_b64_tr_b16 a[98:99], v28 offset:128
    ds_read_b64_tr_b16 a[100:101], v28 offset:2048
    ds_read_b64_tr_b16 a[102:103], v28 offset:2176
    ds_read_b64_tr_b16 a[104:105], v29 offset:0
    ds_read_b64_tr_b16 a[106:107], v29 offset:128
    ds_read_b64_tr_b16 a[108:109], v29 offset:2048
    ds_read_b64_tr_b16 a[110:111], v29 offset:2176
    s_waitcnt lgkmcnt(0)
    s_lshl_b32 s20, s16, 8
    s_lshl_b32 s21, s17, 6
    s_add_u32 s20, s20, s21
    s_add_u32 s20, s20, 1572864
    s_add_u32 s21, s55, 12288
    s_mov_b32 m0, s21
    s_nop 0
    buffer_load_dwordx4 v8, s[8:11], s20 offen lds
    s_add_u32 s20, s20, 131072
    s_add_u32 s21, s21, 1024
    s_mov_b32 m0, s21
    s_nop 0
    buffer_load_dwordx4 v8, s[8:11], s20 offen lds
    s_add_u32 s20, s20, 131072
    s_add_u32 s21, s21, 1024
    s_mov_b32 m0, s21
    s_nop 0
    buffer_load_dwordx4 v8, s[8:11], s20 offen lds
    s_add_u32 s20, s20, 131072
    s_add_u32 s21, s21, 1024
    s_mov_b32 m0, s21
    s_nop 0
    buffer_load_dwordx4 v8, s[8:11], s20 offen lds
    s_waitcnt vmcnt(56)
    ds_write_b128 v33, a[144:147] offset:0
    ds_write_b128 v33, a[148:151] offset:1024
    ds_write_b128 v33, a[152:155] offset:2048
    ds_write_b128 v33, a[156:159] offset:3072
    s_waitcnt lgkmcnt(0)
    ds_read_b64_tr_b16 a[144:145], v28 offset:0
    ds_read_b64_tr_b16 a[146:147], v28 offset:128
    ds_read_b64_tr_b16 a[148:149], v28 offset:2048
    ds_read_b64_tr_b16 a[150:151], v28 offset:2176
    ds_read_b64_tr_b16 a[152:153], v29 offset:0
    ds_read_b64_tr_b16 a[154:155], v29 offset:128
    ds_read_b64_tr_b16 a[156:157], v29 offset:2048
    ds_read_b64_tr_b16 a[158:159], v29 offset:2176
    s_waitcnt lgkmcnt(0)
    s_load_dwordx2 s[8:9], s[0:1], 40
    s_waitcnt lgkmcnt(0)
    s_mov_b32 s10, 4718592
    s_mov_b32 s11, 0x20000
    s_mul_i32 s20, s16, 147456
    s_lshl_b32 s21, s17, 6
    s_add_u32 s20, s20, s21
    s_add_u32 s20, s20, 74240
    s_add_u32 s21, s55, 18432
    s_mov_b32 m0, s21
    s_nop 0
    buffer_load_dwordx4 v9, s[8:11], s20 offen lds
    s_add_u32 s20, s20, 18432
    s_add_u32 s21, s21, 1024
    s_mov_b32 m0, s21
    s_nop 0
    buffer_load_dwordx4 v9, s[8:11], s20 offen lds
    s_add_u32 s20, s20, 18432
    s_add_u32 s21, s21, 1024
    s_mov_b32 m0, s21
    s_nop 0
    buffer_load_dwordx4 v9, s[8:11], s20 offen lds
    s_add_u32 s20, s20, 18432
    s_add_u32 s21, s21, 1024
    s_mov_b32 m0, s21
    s_nop 0
    buffer_load_dwordx4 v9, s[8:11], s20 offen lds
    s_waitcnt vmcnt(56)
    ds_write_b128 v33, a[16:19] offset:0
    ds_write_b128 v33, a[20:23] offset:1024
    ds_write_b128 v33, a[24:27] offset:2048
    ds_write_b128 v33, a[28:31] offset:3072
    s_waitcnt lgkmcnt(0)
    ds_read_b64_tr_b16 a[16:17], v28 offset:0
    ds_read_b64_tr_b16 a[18:19], v28 offset:128
    ds_read_b64_tr_b16 a[20:21], v28 offset:2048
    ds_read_b64_tr_b16 a[22:23], v28 offset:2176
    ds_read_b64_tr_b16 a[24:25], v29 offset:0
    ds_read_b64_tr_b16 a[26:27], v29 offset:128
    ds_read_b64_tr_b16 a[28:29], v29 offset:2048
    ds_read_b64_tr_b16 a[30:31], v29 offset:2176
    s_waitcnt lgkmcnt(0)
    s_mul_i32 s20, s16, 147456
    s_lshl_b32 s21, s17, 6
    s_add_u32 s20, s20, s21
    s_add_u32 s20, s20, 768
    s_add_u32 s21, s55, 22528
    s_mov_b32 m0, s21
    s_nop 0
    buffer_load_dwordx4 v9, s[8:11], s20 offen lds
    s_add_u32 s20, s20, 18432
    s_add_u32 s21, s21, 1024
    s_mov_b32 m0, s21
    s_nop 0
    buffer_load_dwordx4 v9, s[8:11], s20 offen lds
    s_add_u32 s20, s20, 18432
    s_add_u32 s21, s21, 1024
    s_mov_b32 m0, s21
    s_nop 0
    buffer_load_dwordx4 v9, s[8:11], s20 offen lds
    s_add_u32 s20, s20, 18432
    s_add_u32 s21, s21, 1024
    s_mov_b32 m0, s21
    s_nop 0
    buffer_load_dwordx4 v9, s[8:11], s20 offen lds
    s_waitcnt vmcnt(56)
    ds_write_b128 v33, a[64:67] offset:0
    ds_write_b128 v33, a[68:71] offset:1024
    ds_write_b128 v33, a[72:75] offset:2048
    ds_write_b128 v33, a[76:79] offset:3072
    s_waitcnt lgkmcnt(0)
    ds_read_b64_tr_b16 a[64:65], v28 offset:0
    ds_read_b64_tr_b16 a[66:67], v28 offset:128
    ds_read_b64_tr_b16 a[68:69], v28 offset:2048
    ds_read_b64_tr_b16 a[70:71], v28 offset:2176
    ds_read_b64_tr_b16 a[72:73], v29 offset:0
    ds_read_b64_tr_b16 a[74:75], v29 offset:128
    ds_read_b64_tr_b16 a[76:77], v29 offset:2048
    ds_read_b64_tr_b16 a[78:79], v29 offset:2176
    s_waitcnt lgkmcnt(0)
    s_mul_i32 s20, s16, 147456
    s_lshl_b32 s21, s17, 6
    s_add_u32 s20, s20, s21
    s_add_u32 s20, s20, 74496
    s_add_u32 s21, s55, 26624
    s_mov_b32 m0, s21
    s_nop 0
    buffer_load_dwordx4 v9, s[8:11], s20 offen lds
    s_add_u32 s20, s20, 18432
    s_add_u32 s21, s21, 1024
    s_mov_b32 m0, s21
    s_nop 0
    buffer_load_dwordx4 v9, s[8:11], s20 offen lds
    s_add_u32 s20, s20, 18432
    s_add_u32 s21, s21, 1024
    s_mov_b32 m0, s21
    s_nop 0
    buffer_load_dwordx4 v9, s[8:11], s20 offen lds
    s_add_u32 s20, s20, 18432
    s_add_u32 s21, s21, 1024
    s_mov_b32 m0, s21
    s_nop 0
    buffer_load_dwordx4 v9, s[8:11], s20 offen lds
    s_waitcnt vmcnt(56)
    ds_write_b128 v33, a[112:115] offset:0
    ds_write_b128 v33, a[116:119] offset:1024
    ds_write_b128 v33, a[120:123] offset:2048
    ds_write_b128 v33, a[124:127] offset:3072
    s_waitcnt lgkmcnt(0)
    ds_read_b64_tr_b16 a[112:113], v28 offset:0
    ds_read_b64_tr_b16 a[114:115], v28 offset:128
    ds_read_b64_tr_b16 a[116:117], v28 offset:2048
    ds_read_b64_tr_b16 a[118:119], v28 offset:2176
    ds_read_b64_tr_b16 a[120:121], v29 offset:0
    ds_read_b64_tr_b16 a[122:123], v29 offset:128
    ds_read_b64_tr_b16 a[124:125], v29 offset:2048
    ds_read_b64_tr_b16 a[126:127], v29 offset:2176
    s_waitcnt lgkmcnt(0)
    s_cmp_ge_u32 s17, 2
    s_cbranch_scc1 Lsk4a_7
    s_mul_i32 s20, s16, 147456
    s_lshl_b32 s21, s17, 6
    s_add_u32 s20, s20, s21
    s_add_u32 s20, s20, 1024
    s_add_u32 s21, s55, 30720
    s_mov_b32 m0, s21
    s_nop 0
    buffer_load_dwordx4 v9, s[8:11], s20 offen lds
    s_add_u32 s20, s20, 18432
    s_add_u32 s21, s21, 1024
    s_mov_b32 m0, s21
    s_nop 0
    buffer_load_dwordx4 v9, s[8:11], s20 offen lds
    s_add_u32 s20, s20, 18432
    s_add_u32 s21, s21, 1024
    s_mov_b32 m0, s21
    s_nop 0
    buffer_load_dwordx4 v9, s[8:11], s20 offen lds
    s_add_u32 s20, s20, 18432
    s_add_u32 s21, s21, 1024
    s_mov_b32 m0, s21
    s_nop 0
    buffer_load_dwordx4 v9, s[8:11], s20 offen lds
    s_mul_i32 s20, s16, 147456
    s_lshl_b32 s21, s17, 6
    s_add_u32 s20, s20, s21
    s_add_u32 s20, s20, 74752
    s_add_u32 s21, s55, 34816
    s_mov_b32 m0, s21
    s_nop 0
    buffer_load_dwordx4 v9, s[8:11], s20 offen lds
    s_add_u32 s20, s20, 18432
    s_add_u32 s21, s21, 1024
    s_mov_b32 m0, s21
    s_nop 0
    buffer_load_dwordx4 v9, s[8:11], s20 offen lds
    s_add_u32 s20, s20, 18432
    s_add_u32 s21, s21, 1024
    s_mov_b32 m0, s21
    s_nop 0
    buffer_load_dwordx4 v9, s[8:11], s20 offen lds
    s_add_u32 s20, s20, 18432
    s_add_u32 s21, s21, 1024
    s_mov_b32 m0, s21
    s_nop 0
    buffer_load_dwordx4 v9, s[8:11], s20 offen lds
Lsk4a_7:
    s_waitcnt vmcnt(52)
    ds_write_b128 v33, a[160:163] offset:0
    ds_write_b128 v33, a[164:167] offset:1024
    ds_write_b128 v33, a[168:171] offset:2048
    ds_write_b128 v33, a[172:175] offset:3072
    s_waitcnt lgkmcnt(0)
    ds_read_b64_tr_b16 a[160:161], v28 offset:0
    ds_read_b64_tr_b16 a[162:163], v28 offset:128
    ds_read_b64_tr_b16 a[164:165], v28 offset:2048
    ds_read_b64_tr_b16 a[166:167], v28 offset:2176
    ds_read_b64_tr_b16 a[168:169], v29 offset:0
    ds_read_b64_tr_b16 a[170:171], v29 offset:128
    ds_read_b64_tr_b16 a[172:173], v29 offset:2048
    ds_read_b64_tr_b16 a[174:175], v29 offset:2176
    s_waitcnt lgkmcnt(0)
    s_waitcnt vmcnt(48)
    ds_write_b128 v33, a[176:179] offset:0
    ds_write_b128 v33, a[180:183] offset:1024
    ds_write_b128 v33, a[184:187] offset:2048
    ds_write_b128 v33, a[188:191] offset:3072
    s_waitcnt lgkmcnt(0)
    ds_read_b64_tr_b16 a[176:177], v28 offset:0
    ds_read_b64_tr_b16 a[178:179], v28 offset:128
    ds_read_b64_tr_b16 a[180:181], v28 offset:2048
    ds_read_b64_tr_b16 a[182:183], v28 offset:2176
    ds_read_b64_tr_b16 a[184:185], v29 offset:0
    ds_read_b64_tr_b16 a[186:187], v29 offset:128
    ds_read_b64_tr_b16 a[188:189], v29 offset:2048
    ds_read_b64_tr_b16 a[190:191], v29 offset:2176
    s_waitcnt lgkmcnt(0)
    s_waitcnt vmcnt(44)
    ds_write_b128 v33, a[192:195] offset:0
    ds_write_b128 v33, a[196:199] offset:1024
    ds_write_b128 v33, a[200:203] offset:2048
    ds_write_b128 v33, a[204:207] offset:3072
    s_waitcnt lgkmcnt(0)
    ds_read_b64_tr_b16 a[192:193], v28 offset:0
    ds_read_b64_tr_b16 a[194:195], v28 offset:128
    ds_read_b64_tr_b16 a[196:197], v28 offset:2048
    ds_read_b64_tr_b16 a[198:199], v28 offset:2176
    ds_read_b64_tr_b16 a[200:201], v29 offset:0
    ds_read_b64_tr_b16 a[202:203], v29 offset:128
    ds_read_b64_tr_b16 a[204:205], v29 offset:2048
    ds_read_b64_tr_b16 a[206:207], v29 offset:2176
    s_waitcnt lgkmcnt(0)
    s_waitcnt vmcnt(40)
    ds_write_b128 v33, a[208:211] offset:0
    ds_write_b128 v33, a[212:215] offset:1024
    ds_write_b128 v33, a[216:219] offset:2048
    ds_write_b128 v33, a[220:223] offset:3072
    s_waitcnt lgkmcnt(0)
    ds_read_b64_tr_b16 a[208:209], v28 offset:0
    ds_read_b64_tr_b16 a[210:211], v28 offset:128
    ds_read_b64_tr_b16 a[212:213], v28 offset:2048
    ds_read_b64_tr_b16 a[214:215], v28 offset:2176
    ds_read_b64_tr_b16 a[216:217], v29 offset:0
    ds_read_b64_tr_b16 a[218:219], v29 offset:128
    ds_read_b64_tr_b16 a[220:221], v29 offset:2048
    ds_read_b64_tr_b16 a[222:223], v29 offset:2176
    s_waitcnt lgkmcnt(0)
    s_waitcnt vmcnt(36)
    ds_write_b128 v33, a[224:227] offset:0
    ds_write_b128 v33, a[228:231] offset:1024
    ds_write_b128 v33, a[232:235] offset:2048
    ds_write_b128 v33, a[236:239] offset:3072
    s_waitcnt lgkmcnt(0)
    ds_read_b64_tr_b16 a[224:225], v28 offset:0
    ds_read_b64_tr_b16 a[226:227], v28 offset:128
    ds_read_b64_tr_b16 a[228:229], v28 offset:2048
    ds_read_b64_tr_b16 a[230:231], v28 offset:2176
    ds_read_b64_tr_b16 a[232:233], v29 offset:0
    ds_read_b64_tr_b16 a[234:235], v29 offset:128
    ds_read_b64_tr_b16 a[236:237], v29 offset:2048
    ds_read_b64_tr_b16 a[238:239], v29 offset:2176
    s_waitcnt lgkmcnt(0)
    s_waitcnt vmcnt(32)
    ds_write_b128 v33, a[240:243] offset:0
    ds_write_b128 v33, a[244:247] offset:1024
    ds_write_b128 v33, a[248:251] offset:2048
    ds_write_b128 v33, a[252:255] offset:3072
    s_waitcnt lgkmcnt(0)
    ds_read_b64_tr_b16 a[240:241], v28 offset:0
    ds_read_b64_tr_b16 a[242:243], v28 offset:128
    ds_read_b64_tr_b16 a[244:245], v28 offset:2048
    ds_read_b64_tr_b16 a[246:247], v28 offset:2176
    ds_read_b64_tr_b16 a[248:249], v29 offset:0
    ds_read_b64_tr_b16 a[250:251], v29 offset:128
    ds_read_b64_tr_b16 a[252:253], v29 offset:2048
    ds_read_b64_tr_b16 a[254:255], v29 offset:2176
    s_waitcnt lgkmcnt(0)
    s_waitcnt vmcnt(28)
    ds_write_b128 v33, v[40:43] offset:0
    ds_write_b128 v33, v[44:47] offset:1024
    ds_write_b128 v33, v[48:51] offset:2048
    ds_write_b128 v33, v[52:55] offset:3072
    s_waitcnt lgkmcnt(0)
    ds_read_b64_tr_b16 v[232:233], v28 offset:0
    ds_read_b64_tr_b16 v[234:235], v28 offset:128
    ds_read_b64_tr_b16 v[236:237], v28 offset:2048
    ds_read_b64_tr_b16 v[238:239], v28 offset:2176
    ds_read_b64_tr_b16 v[20:21], v29 offset:0
    ds_read_b64_tr_b16 v[22:23], v29 offset:128
    ds_read_b64_tr_b16 v[24:25], v29 offset:2048
    ds_read_b64_tr_b16 v[26:27], v29 offset:2176
    s_waitcnt lgkmcnt(0)
    ds_write_b128 v56, v[20:23] offset:16384
    ds_write_b128 v56, v[24:27] offset:17408
    s_waitcnt lgkmcnt(0)
    s_waitcnt vmcnt(24)
    ds_read_b64_tr_b16 v[12:13], v10 offset:0
    ds_read_b64_tr_b16 v[14:15], v10 offset:128
    ds_read_b64_tr_b16 v[16:17], v10 offset:2048
    ds_read_b64_tr_b16 v[18:19], v10 offset:2176
    ds_read_b64_tr_b16 v[20:21], v11 offset:0
    ds_read_b64_tr_b16 v[22:23], v11 offset:128
    ds_read_b64_tr_b16 v[24:25], v11 offset:2048
    ds_read_b64_tr_b16 v[26:27], v11 offset:2176
    s_waitcnt lgkmcnt(0)
    ds_write_b128 v56, v[12:15] offset:0
    ds_write_b128 v56, v[16:19] offset:1024
    ds_write_b128 v56, v[20:23] offset:2048
    ds_write_b128 v56, v[24:27] offset:3072
    s_waitcnt lgkmcnt(0)
    s_waitcnt vmcnt(20)
    ds_read_b64_tr_b16 v[12:13], v10 offset:4096
    ds_read_b64_tr_b16 v[14:15], v10 offset:4224
    ds_read_b64_tr_b16 v[16:17], v10 offset:6144
    ds_read_b64_tr_b16 v[18:19], v10 offset:6272
    ds_read_b64_tr_b16 v[20:21], v11 offset:4096
    ds_read_b64_tr_b16 v[22:23], v11 offset:4224
    ds_read_b64_tr_b16 v[24:25], v11 offset:6144
    ds_read_b64_tr_b16 v[26:27], v11 offset:6272
    s_waitcnt lgkmcnt(0)
    ds_write_b128 v56, v[12:15] offset:4096
    ds_write_b128 v56, v[16:19] offset:5120
    ds_write_b128 v56, v[20:23] offset:6144
    ds_write_b128 v56, v[24:27] offset:7168
    s_waitcnt lgkmcnt(0)
    s_waitcnt vmcnt(16)
    ds_read_b64_tr_b16 v[12:13], v10 offset:8192
    ds_read_b64_tr_b16 v[14:15], v10 offset:8320
    ds_read_b64_tr_b16 v[16:17], v10 offset:10240
    ds_read_b64_tr_b16 v[18:19], v10 offset:10368
    ds_read_b64_tr_b16 v[20:21], v11 offset:8192
    ds_read_b64_tr_b16 v[22:23], v11 offset:8320
    ds_read_b64_tr_b16 v[24:25], v11 offset:10240
    ds_read_b64_tr_b16 v[26:27], v11 offset:10368
    s_waitcnt lgkmcnt(0)
    ds_write_b128 v56, v[12:15] offset:8192
    ds_write_b128 v56, v[16:19] offset:9216
    ds_write_b128 v56, v[20:23] offset:10240
    ds_write_b128 v56, v[24:27] offset:11264
    s_waitcnt lgkmcnt(0)
    s_waitcnt vmcnt(12)
    ds_read_b64_tr_b16 v[12:13], v10 offset:12288
    ds_read_b64_tr_b16 v[14:15], v10 offset:12416
    ds_read_b64_tr_b16 v[16:17], v10 offset:14336
    ds_read_b64_tr_b16 v[18:19], v10 offset:14464
    ds_read_b64_tr_b16 v[20:21], v11 offset:12288
    ds_read_b64_tr_b16 v[22:23], v11 offset:12416
    ds_read_b64_tr_b16 v[24:25], v11 offset:14336
    ds_read_b64_tr_b16 v[26:27], v11 offset:14464
    s_waitcnt lgkmcnt(0)
    ds_write_b128 v56, v[12:15] offset:12288
    ds_write_b128 v56, v[16:19] offset:13312
    ds_write_b128 v56, v[20:23] offset:14336
    ds_write_b128 v56, v[24:27] offset:15360
    s_waitcnt lgkmcnt(0)
    s_waitcnt vmcnt(8)
    ds_read_b64_tr_b16 v[12:13], v10 offset:18432
    ds_read_b64_tr_b16 v[14:15], v10 offset:18560
    ds_read_b64_tr_b16 v[16:17], v10 offset:20480
    ds_read_b64_tr_b16 v[18:19], v10 offset:20608
    ds_read_b64_tr_b16 v[20:21], v11 offset:18432
    ds_read_b64_tr_b16 v[22:23], v11 offset:18560
    ds_read_b64_tr_b16 v[24:25], v11 offset:20480
    ds_read_b64_tr_b16 v[26:27], v11 offset:20608
    s_waitcnt lgkmcnt(0)
    ds_write_b128 v56, v[12:15] offset:18432
    ds_write_b128 v56, v[16:19] offset:19456
    ds_write_b128 v56, v[20:23] offset:20480
    ds_write_b128 v56, v[24:27] offset:21504
    s_waitcnt lgkmcnt(0)
    s_waitcnt vmcnt(4)
    ds_read_b64_tr_b16 v[12:13], v10 offset:22528
    ds_read_b64_tr_b16 v[14:15], v10 offset:22656
    ds_read_b64_tr_b16 v[16:17], v10 offset:24576
    ds_read_b64_tr_b16 v[18:19], v10 offset:24704
    ds_read_b64_tr_b16 v[20:21], v11 offset:22528
    ds_read_b64_tr_b16 v[22:23], v11 offset:22656
    ds_read_b64_tr_b16 v[24:25], v11 offset:24576
    ds_read_b64_tr_b16 v[26:27], v11 offset:24704
    s_waitcnt lgkmcnt(0)
    ds_write_b128 v56, v[12:15] offset:22528
    ds_write_b128 v56, v[16:19] offset:23552
    ds_write_b128 v56, v[20:23] offset:24576
    ds_write_b128 v56, v[24:27] offset:25600
    s_waitcnt lgkmcnt(0)
    s_waitcnt vmcnt(0)
    ds_read_b64_tr_b16 v[12:13], v10 offset:26624
    ds_read_b64_tr_b16 v[14:15], v10 offset:26752
    ds_read_b64_tr_b16 v[16:17], v10 offset:28672
    ds_read_b64_tr_b16 v[18:19], v10 offset:28800
    ds_read_b64_tr_b16 v[20:21], v11 offset:26624
    ds_read_b64_tr_b16 v[22:23], v11 offset:26752
    ds_read_b64_tr_b16 v[24:25], v11 offset:28672
    ds_read_b64_tr_b16 v[26:27], v11 offset:28800
    s_waitcnt lgkmcnt(0)
    ds_write_b128 v56, v[12:15] offset:26624
    ds_write_b128 v56, v[16:19] offset:27648
    ds_write_b128 v56, v[20:23] offset:28672
    ds_write_b128 v56, v[24:27] offset:29696
    s_waitcnt lgkmcnt(0)
    s_waitcnt vmcnt(0)
    s_cmp_ge_u32 s17, 2
    s_cbranch_scc1 Lsk4_8
    ds_read_b64_tr_b16 v[12:13], v10 offset:30720
    ds_read_b64_tr_b16 v[14:15], v10 offset:30848
    ds_read_b64_tr_b16 v[16:17], v10 offset:32768
    ds_read_b64_tr_b16 v[18:19], v10 offset:32896
    ds_read_b64_tr_b16 v[20:21], v11 offset:30720
    ds_read_b64_tr_b16 v[22:23], v11 offset:30848
    ds_read_b64_tr_b16 v[24:25], v11 offset:32768
    ds_read_b64_tr_b16 v[26:27], v11 offset:32896
    s_waitcnt lgkmcnt(0)
    ds_write_b128 v56, v[12:15] offset:30720
    ds_write_b128 v56, v[16:19] offset:31744
    ds_write_b128 v56, v[20:23] offset:32768
    ds_write_b128 v56, v[24:27] offset:33792
    s_waitcnt lgkmcnt(0)
    ds_read_b64_tr_b16 v[12:13], v10 offset:34816
    ds_read_b64_tr_b16 v[14:15], v10 offset:34944
    ds_read_b64_tr_b16 v[16:17], v10 offset:36864
    ds_read_b64_tr_b16 v[18:19], v10 offset:36992
    ds_read_b64_tr_b16 v[20:21], v11 offset:34816
    ds_read_b64_tr_b16 v[22:23], v11 offset:34944
    ds_read_b64_tr_b16 v[24:25], v11 offset:36864
    ds_read_b64_tr_b16 v[26:27], v11 offset:36992
    s_waitcnt lgkmcnt(0)
    ds_write_b128 v56, v[12:15] offset:34816
    ds_write_b128 v56, v[16:19] offset:35840
    ds_write_b128 v56, v[20:23] offset:36864
    ds_write_b128 v56, v[24:27] offset:37888
    s_waitcnt lgkmcnt(0)
Lsk4_8:
    s_cmp_lg_u32 s17, 0
    s_cbranch_scc1 Llw1c
    s_mov_b32 s19, 0
    v_and_b32 v1, 63, v0
    v_lshlrev_b32 v2, 2, v1
Llw0c:
    buffer_load_dword v3, v2, s[12:15], 0 offen sc1
    s_waitcnt vmcnt(0)
    s_mov_b32 s20, 0
    s_mov_b32 s21, 0
    v_readlane_b32 s22, v3, 2
    s_nop 2
    s_add_u32 s20, s20, s22
    v_readlane_b32 s22, v3, 3
    s_nop 2
    s_add_u32 s21, s21, s22
    v_readlane_b32 s22, v3, 18
    s_nop 2
    s_add_u32 s20, s20, s22
    v_readlane_b32 s22, v3, 19
    s_nop 2
    s_add_u32 s21, s21, s22
    v_readlane_b32 s22, v3, 34
    s_nop 2
    s_add_u32 s20, s20, s22
    v_readlane_b32 s22, v3, 35
    s_nop 2
    s_add_u32 s21, s21, s22
    v_readlane_b32 s22, v3, 50
    s_nop 2
    s_add_u32 s20, s20, s22
    v_readlane_b32 s22, v3, 51
    s_nop 2
    s_add_u32 s21, s21, s22
    s_cmp_ge_u32 s20, s90
    s_cselect_b32 s22, s21, 0
    s_cmp_eq_u32 s89, 1
    s_cselect_b32 s20, s20, s22
    s_cmp_ge_u32 s20, 224
    s_cbranch_scc1 Llw1c
    s_sleep 12
    s_add_u32 s19, s19, 1
    s_cmp_lt_u32 s19, 524288
    s_cbranch_scc1 Llw0c
    s_branch Lfail
Llw1c:
    s_barrier
    s_cmp_lt_u32 s79, 32
    s_cbranch_scc1 Lchain_slow
    s_waitcnt vmcnt(0)
    s_barrier
    s_cmp_lg_u32 s17, 0
    s_cbranch_scc1 Ltb2f
    s_mov_b64 exec, 1
    v_mov_b32 v2, 1
    v_mov_b32 v3, 16
    buffer_atomic_add v2, v3, s[12:15], 0 offen
    s_mov_b32 s19, 0
Ltb1f:
    buffer_load_dword v2, v3, s[12:15], 0 offen sc1
    s_waitcnt vmcnt(0)
    v_cmp_le_u32 vcc, 32, v2
    s_cbranch_vccnz Ltb3f
    s_add_u32 s19, s19, 1
    s_cmp_lt_u32 s19, 524288
    s_cbranch_scc1 Ltb1f
    s_branch Lfail
Ltb3f:
    s_mov_b64 exec, -1
Ltb2f:
    s_barrier
    s_mov_b32 s21, 0
    s_lshl_b32 s20, s21, 8
    s_lshl_b32 s21, s16, 2
    s_add_u32 s20, s20, s21
    s_add_u32 s20, s20, 1581056
    s_mov_b32 s19, 0
    v_subrev_u32 v54, 151808, v68
    v_lshlrev_b32 v54, 4, v54
    s_mov_b64 exec, 3
Lkv0f0:
    buffer_load_dword v55, v54, s[4:7], s20 offen sc1
    s_waitcnt vmcnt(0)
    v_and_b32 v55, 0xff, v55
    v_cmp_gt_u32 vcc, 2, v55
    s_cbranch_vccz Lkv1f0
    s_add_u32 s19, s19, 1
    s_cmp_lt_u32 s19, 524288
    s_cbranch_scc1 Lkv0f0
    s_branch Lfail
Lkv1f0:
    s_mov_b64 exec, -1
    s_mov_b32 s18, 0
    s_mov_b32 s24, s63
    s_add_u32 s25, s24, 4096
    s_add_u32 s26, 904960, 0
    s_add_u32 s32, s54, 16384
    s_add_u32 s33, s54, 49152
    s_lshl_b32 s20, s16, 11
    s_add_u32 s34, s20, 58720256
    s_add_u32 s47, s20, 62914560
    s_mul_i32 s21, s16, 9216
    s_add_u32 s27, s21, 0
    s_add_u32 s56, s27, 4096
    s_add_u32 s57, s27, 8192
    s_add_u32 s28, s62, 0
    s_add_u32 s29, s28, 73728
    s_add_u32 s30, s29, 73728
    s_add_u32 s31, s30, 73728
    s_lshl_b32 s21, s16, 8
    s_add_u32 s36, s21, 25165824
    s_add_u32 s37, s36, 32768
    s_lshl_b32 s20, s16, 13
    s_add_u32 s38, s20, 41943040
    s_lshl_b32 s59, s16, 8
    s_add_u32 s59, s59, 1572864
    s_cmp_eq_u32 s17, 0
    s_cselect_b32 s59, s59, 0x40000000
    s_mov_b32 s48, 0x40000000
    s_mov_b32 s49, 0x40000000
    s_mov_b32 s50, 0x40000000
    s_mov_b32 s51, 0x40000000
    s_mov_b32 s8, 0xaaaaaaaa
    s_mov_b32 s9, 0xaaaaaaaa
    s_mov_b32 s90, 0x30003
    s_mov_b32 s91, 0x30003
    s_mov_b32 s92, 0xc000c
    s_mov_b32 s93, 0xc000c
    s_mov_b32 s94, 0x300030
    s_mov_b32 s95, 0x300030
    s_mov_b32 s96, 0xc000c0
    s_mov_b32 s97, 0xc000c0
    s_mov_b32 m0, s60
    s_nop 0
    buffer_load_dwordx4 v66, s[4:7], s36 offen lds
    s_mov_b32 m0, s61
    s_nop 0
    buffer_load_dwordx4 v66, s[4:7], s37 offen lds
    s_add_u32 s36, s36, 262144
    s_add_u32 s37, s37, 262144
Lstepf_9:
    s_cmp_lg_u32 s17, 0
    s_cbranch_scc1 Lpwnf_19
    s_mov_b32 m0, s44
    s_nop 0
    buffer_load_dwordx4 v68, s[4:7], s24 offen sc1 lds
    s_mov_b32 m0, s45
    s_nop 0
    buffer_load_dwordx4 v68, s[4:7], s25 offen sc1 lds
    s_mov_b32 m0, s46
    s_nop 0
    buffer_load_dwordx4 v68, s[4:7], s26 offen sc1 lds
    ds_read_b128 v[28:31], v56 offset:0
    ds_read_b128 v[32:35], v56 offset:1024
    ds_read_b128 v[36:39], v56 offset:2048
    ds_read_b128 v[40:43], v56 offset:3072
    v_mov_b64 v[16:17], 0
    v_mov_b64 v[18:19], 0
    v_mov_b64 v[20:21], 0
    v_mov_b64 v[22:23], 0
    v_mov_b64 v[24:25], 0
    v_mov_b64 v[26:27], 0
    v_mov_b32 v44, -1
    v_mov_b32 v45, -1
    v_mov_b32 v46, -1
    v_mov_b32 v47, -1
    s_lshl_b32 s20, s17, 10
    v_add_u32 v52, s20, v68
    s_mov_b32 s19, 0
Lpw0f_18l:
    s_mov_b32 m0, s44
    s_nop 0
    buffer_load_dwordx4 v68, s[4:7], s24 offen sc1 lds
    s_mov_b32 m0, s45
    s_nop 0
    buffer_load_dwordx4 v68, s[4:7], s25 offen sc1 lds
    s_mov_b32 m0, s46
    s_nop 0
    buffer_load_dwordx4 v68, s[4:7], s26 offen sc1 lds
    s_waitcnt vmcnt(3)
    ds_read_b32 v55, v52
    ds_read_b32 v51, v52 offset:4096
    ds_read_b32 v53, v68 offset:8192
    s_waitcnt lgkmcnt(0)
    v_max3_u32 v53, v53, v55, v51
    v_cmp_eq_u32 vcc, -1, v53
    s_cbranch_vccz Lokf_10
    s_add_u32 s19, s19, 1
    s_cmp_lt_u32 s19, 262144
    s_cbranch_scc1 Lpw0f_18l
    s_branch Lchain_fail
Lpwnf_19:
    s_mov_b32 m0, s44
    s_nop 0
    buffer_load_dwordx4 v68, s[4:7], s24 offen sc1 lds
    s_mov_b32 m0, s45
    s_nop 0
    buffer_load_dwordx4 v68, s[4:7], s25 offen sc1 lds
    ds_read_b128 v[28:31], v56 offset:0
    ds_read_b128 v[32:35], v56 offset:1024
    ds_read_b128 v[36:39], v56 offset:2048
    ds_read_b128 v[40:43], v56 offset:3072
    v_mov_b64 v[16:17], 0
    v_mov_b64 v[18:19], 0
    v_mov_b64 v[20:21], 0
    v_mov_b64 v[22:23], 0
    v_mov_b64 v[24:25], 0
    v_mov_b64 v[26:27], 0
    v_mov_b32 v44, -1
    v_mov_b32 v45, -1
    v_mov_b32 v46, -1
    v_mov_b32 v47, -1
    s_lshl_b32 s20, s17, 10
    v_add_u32 v52, s20, v68
    s_mov_b32 s19, 0
Lpwnf_19l:
    s_mov_b32 m0, s44
    s_nop 0
    buffer_load_dwordx4 v68, s[4:7], s24 offen sc1 lds
    s_mov_b32 m0, s45
    s_nop 0
    buffer_load_dwordx4 v68, s[4:7], s25 offen sc1 lds
    s_waitcnt vmcnt(2)
    ds_read_b32 v55, v52
    ds_read_b32 v51, v52 offset:4096
    s_waitcnt lgkmcnt(0)
    v_max_u32 v53, v55, v51
    v_cmp_eq_u32 vcc, -1, v53
    s_cbranch_vccz Lokf_10
    s_add_u32 s19, s19, 1
    s_cmp_lt_u32 s19, 262144
    s_cbranch_scc1 Lpwnf_19l
    s_branch Lchain_fail
Lokf_10:
    s_barrier
    ds_read_b128 v[0:3], v68 offset:0
    ds_read_b128 v[4:7], v69 offset:0
    ds_read_b128 v[8:11], v68 offset:1024
    ds_read_b128 v[12:15], v69 offset:1024
    s_cmp_lg_u32 s18, 2
    s_cbranch_scc1 Lh_21
    s_mov_b32 s21, 2
    s_lshl_b32 s20, s21, 8
    s_lshl_b32 s21, s16, 2
    s_add_u32 s20, s20, s21
    s_add_u32 s20, s20, 1581056
    s_mov_b32 s19, 0
    v_subrev_u32 v54, 151808, v68
    v_lshlrev_b32 v54, 4, v54
    s_mov_b64 exec, 3
Lkv0f2:
    buffer_load_dword v55, v54, s[4:7], s20 offen sc1
    s_waitcnt vmcnt(0)
    v_and_b32 v55, 0xff, v55
    v_cmp_gt_u32 vcc, 2, v55
    s_cbranch_vccz Lkv1f2
    s_add_u32 s19, s19, 1
    s_cmp_lt_u32 s19, 524288
    s_cbranch_scc1 Lkv0f2
    s_branch Lfail
Lkv1f2:
    s_mov_b64 exec, -1
Lh_21:
    s_and_b32 s20, s18, 7
    s_cmp_lg_u32 s20, 6
    s_cbranch_scc1 Lh_20
    s_cmp_gt_u32 s18, 56
    s_cbranch_scc1 Lh_20
    s_add_u32 s21, s18, 2
    s_lshr_b32 s21, s21, 1
    s_lshl_b32 s20, s21, 8
    s_lshl_b32 s21, s16, 2
    s_add_u32 s20, s20, s21
    s_add_u32 s20, s20, 1581056
    s_mov_b32 s19, 0
    v_subrev_u32 v54, 151808, v68
    v_lshlrev_b32 v54, 4, v54
    s_mov_b64 exec, 15
Lkv0f1:
    buffer_load_dword v55, v54, s[4:7], s20 offen sc1
    s_waitcnt vmcnt(0)
    v_and_b32 v55, 0xff, v55
    v_cmp_gt_u32 vcc, 2, v55
    s_cbranch_vccz Lkv1f1
    s_add_u32 s19, s19, 1
    s_cmp_lt_u32 s19, 524288
    s_cbranch_scc1 Lkv0f1
    s_branch Lfail
Lkv1f1:
    s_mov_b64 exec, -1
Lh_20:
    s_waitcnt lgkmcnt(3)
    v_smfmac_f32_16x16x64_bf16 v[16:19], v[0:3], v[72:79], v57
    v_smfmac_f32_16x16x64_bf16 v[20:23], v[0:3], v[88:95], v57
    v_smfmac_f32_16x16x64_bf16 v[24:27], v[0:3], v[28:35], v57
    ds_read_b128 v[28:31], v56 offset:4096
    buffer_store_dwordx4 v[44:47], v64, s[4:7], s48 offen
    s_waitcnt lgkmcnt(3)
    v_smfmac_f32_16x16x64_bf16 v[16:19], v[4:7], v[80:87], v57
    ds_read_b128 v[32:35], v56 offset:5120
    v_smfmac_f32_16x16x64_bf16 v[20:23], v[4:7], v[96:103], v57
    ds_read_b128 v[0:3], v68 offset:2048
    v_smfmac_f32_16x16x64_bf16 v[24:27], v[4:7], v[36:43], v57
    ds_read_b128 v[36:39], v56 offset:6144
    buffer_store_dwordx4 v[44:47], v64, s[4:7], s49 offen
    s_waitcnt lgkmcnt(5)
    v_smfmac_f32_16x16x64_bf16 v[16:19], v[8:11], v[104:111], v57
    ds_read_b128 v[40:43], v56 offset:7168
    v_smfmac_f32_16x16x64_bf16 v[20:23], v[8:11], v[120:127], v57
    ds_read_b128 v[4:7], v69 offset:2048
    buffer_store_dwordx4 v[44:47], v64, s[4:7], s50 offen
    s_waitcnt lgkmcnt(4)
    v_smfmac_f32_16x16x64_bf16 v[24:27], v[8:11], v[28:35], v57
    ds_read_b128 v[28:31], v56 offset:8192
    v_smfmac_f32_16x16x64_bf16 v[16:19], v[12:15], v[112:119], v57
    ds_read_b128 v[32:35], v56 offset:9216
    v_smfmac_f32_16x16x64_bf16 v[20:23], v[12:15], v[128:135], v57
    ds_read_b128 v[8:11], v68 offset:3072
    buffer_store_dwordx4 v[44:47], v64, s[4:7], s51 offen
    s_waitcnt lgkmcnt(4)
    v_smfmac_f32_16x16x64_bf16 v[24:27], v[12:15], v[36:43], v57
    ds_read_b128 v[36:39], v56 offset:10240
    v_smfmac_f32_16x16x64_bf16 v[16:19], v[0:3], v[136:143], v57
    ds_read_b128 v[40:43], v56 offset:11264
    v_smfmac_f32_16x16x64_bf16 v[20:23], v[0:3], v[152:159], v57
    ds_read_b128 v[12:15], v69 offset:3072
    buffer_load_dwordx4 v[44:47], v67, s[4:7], s38 offen offset:0
    s_waitcnt lgkmcnt(4)
    v_smfmac_f32_16x16x64_bf16 v[24:27], v[0:3], v[28:35], v57
    ds_read_b128 v[28:31], v56 offset:12288
    v_smfmac_f32_16x16x64_bf16 v[16:19], v[4:7], v[144:151], v57
    ds_read_b128 v[32:35], v56 offset:13312
    v_smfmac_f32_16x16x64_bf16 v[20:23], v[4:7], v[160:167], v57
    ds_read_b128 v[0:3], v68 offset:4096
    buffer_load_dwordx4 v[48:51], v67, s[4:7], s38 offen offset:1024
    s_waitcnt lgkmcnt(4)
    v_smfmac_f32_16x16x64_bf16 v[24:27], v[4:7], v[36:43], v57
    ds_read_b128 v[36:39], v56 offset:14336
    v_mov_b32 v54, s18
    v_smfmac_f32_16x16x64_bf16 v[16:19], v[8:11], v[168:175], v57
    ds_read_b128 v[40:43], v56 offset:15360
    v_smfmac_f32_16x16x64_bf16 v[20:23], v[8:11], v[184:191], v57
    ds_read_b128 v[4:7], v69 offset:4096
    buffer_store_dword v54, v65, s[4:7], s59 offen sc1
    s_waitcnt lgkmcnt(4)
    v_smfmac_f32_16x16x64_bf16 v[24:27], v[8:11], v[28:35], v57
    v_smfmac_f32_16x16x64_bf16 v[16:19], v[12:15], v[176:183], v57
    v_smfmac_f32_16x16x64_bf16 v[20:23], v[12:15], v[192:199], v57
    ds_read_b128 v[8:11], v68 offset:5120
    s_waitcnt lgkmcnt(2)
    v_smfmac_f32_16x16x64_bf16 v[24:27], v[12:15], v[36:43], v57
    ds_read_b128 v[36:39], v56 offset:16384
    v_smfmac_f32_16x16x64_bf16 v[16:19], v[0:3], v[200:207], v57
    ds_read_b128 v[40:43], v56 offset:17408
    v_smfmac_f32_16x16x64_bf16 v[20:23], v[0:3], v[216:223], v57
    ds_read_b128 v[12:15], v69 offset:5120
    v_smfmac_f32_16x16x64_bf16 v[24:27], v[0:3], v[232:239], v57
    ds_read_b128 v[28:31], v58 offset:0
    s_waitcnt lgkmcnt(5)
    v_smfmac_f32_16x16x64_bf16 v[16:19], v[4:7], v[208:215], v57
    ds_read_b128 v[32:35], v58 offset:1024
    v_smfmac_f32_16x16x64_bf16 v[20:23], v[4:7], v[224:231], v57
    ds_read_b128 v[0:3], v68 offset:6144
    s_waitcnt lgkmcnt(4)
    v_smfmac_f32_16x16x64_bf16 v[24:27], v[4:7], v[36:43], v57
    v_smfmac_f32_16x16x64_bf16 v[16:19], v[8:11], v[240:247], v57
    v_smfmac_f32_16x16x64_bf16 v[20:23], v[8:11], a[0:7], v57
    ds_read_b128 v[4:7], v69 offset:6144
    v_smfmac_f32_16x16x64_bf16 v[24:27], v[8:11], a[16:23], v57
    s_waitcnt lgkmcnt(4)
    v_smfmac_f32_16x16x64_bf16 v[16:19], v[12:15], v[248:255], v57
    v_smfmac_f32_16x16x64_bf16 v[20:23], v[12:15], a[8:15], v57
    ds_read_b128 v[8:11], v68 offset:7168
    v_smfmac_f32_16x16x64_bf16 v[24:27], v[12:15], a[24:31], v57
    s_waitcnt lgkmcnt(2)
    v_smfmac_f32_16x16x64_bf16 v[16:19], v[0:3], a[32:39], v57
    v_smfmac_f32_16x16x64_bf16 v[20:23], v[0:3], a[48:55], v57
    ds_read_b128 v[12:15], v69 offset:7168
    v_smfmac_f32_16x16x64_bf16 v[24:27], v[0:3], a[64:71], v57
    v_xor_b32 v53, 64, v58
    s_waitcnt lgkmcnt(2)
    v_smfmac_f32_16x16x64_bf16 v[16:19], v[4:7], a[40:47], v57
    ds_read_b128 v[36:39], v53 offset:0
    v_smfmac_f32_16x16x64_bf16 v[20:23], v[4:7], a[56:63], v57
    ds_read_b128 v[0:3], v68 offset:8192
    v_smfmac_f32_16x16x64_bf16 v[24:27], v[4:7], a[72:79], v57
    s_waitcnt lgkmcnt(3)
    v_smfmac_f32_16x16x64_bf16 v[16:19], v[8:11], a[80:87], v57
    v_smfmac_f32_16x16x64_bf16 v[20:23], v[8:11], a[96:103], v57
    ds_read_b128 v[4:7], v69 offset:8192
    v_smfmac_f32_16x16x64_bf16 v[24:27], v[8:11], a[112:119], v57
    ds_read_b128 v[40:43], v53 offset:1024
    s_waitcnt lgkmcnt(4)
    v_smfmac_f32_16x16x64_bf16 v[16:19], v[12:15], a[88:95], v57
    v_xor_b32 v52, 128, v58
    v_smfmac_f32_16x16x64_bf16 v[20:23], v[12:15], a[104:111], v57
    v_smfmac_f32_16x16x64_bf16 v[24:27], v[12:15], a[120:127], v57
    s_waitcnt lgkmcnt(2)
    v_smfmac_f32_16x16x64_bf16 v[16:19], v[0:3], a[128:135], v57
    v_smfmac_f32_16x16x64_bf16 v[20:23], v[0:3], a[144:151], v57
    v_smfmac_f32_16x16x64_bf16 v[24:27], v[0:3], a[160:167], v57
    v_xor_b32 v53, 192, v58
    s_waitcnt lgkmcnt(1)
    v_smfmac_f32_16x16x64_bf16 v[16:19], v[4:7], a[136:143], v57
    v_smfmac_f32_16x16x64_bf16 v[20:23], v[4:7], a[152:159], v57
    v_smfmac_f32_16x16x64_bf16 v[24:27], v[4:7], a[168:175], v57
    s_nop 6
    v_cvt_pk_bf16_f32 v54, v20, v21
    v_cvt_pk_bf16_f32 v55, v22, v23
    v_pk_mul_f32 v[16:17], v[16:17], s[52:53]
    v_pk_mul_f32 v[18:19], v[18:19], s[52:53]
    ds_write_b64 v59, v[54:55] offset:2112
    v_cvt_pk_bf16_f32 v20, v16, v17
    v_cvt_pk_bf16_f32 v21, v18, v19
    ds_write_b64 v59, v[20:21]
    v_cvt_pk_bf16_f32 v24, v24, v25
    v_cvt_pk_bf16_f32 v25, v26, v27
    v_mov_b32 v26, v52
    v_mov_b32 v27, v53
    buffer_store_dwordx2 v[54:55], v63, s[4:7], s34 offen sc1
    buffer_store_dwordx2 v[24:25], v63, s[4:7], s47 offen sc1
    s_cmp_eq_u32 s18, 63
    s_cbranch_scc1 Ldonef_11
    s_waitcnt lgkmcnt(0)
    s_barrier
    ds_read_b64_tr_b16 v[0:1], v60 offset:0
    ds_read_b64_tr_b16 v[2:3], v60 offset:32
    ds_read_b64_tr_b16 v[4:5], v60 offset:2112
    ds_read_b64_tr_b16 v[6:7], v60 offset:2144
    ds_read_b64_tr_b16 v[8:9], v60 offset:256
    ds_read_b64_tr_b16 v[10:11], v60 offset:288
    ds_read_b64_tr_b16 v[12:13], v60 offset:2368
    ds_read_b64_tr_b16 v[14:15], v60 offset:2400
    s_waitcnt lgkmcnt(6)
    v_mfma_f32_16x16x32_bf16 v[16:19], v[28:31], v[0:3], 0
    ds_read_b128 v[28:31], v26 offset:0
    v_mfma_f32_16x16x32_bf16 v[20:23], v[32:35], v[0:3], 0
    ds_read_b128 v[32:35], v26 offset:1024
    s_waitcnt lgkmcnt(6)
    v_mfma_f32_16x16x32_bf16 v[52:55], v[4:7], v[0:3], 0
    ds_read_b64_tr_b16 v[0:1], v60 offset:512
    ds_read_b64_tr_b16 v[2:3], v60 offset:544
    ds_read_b64_tr_b16 v[4:5], v60 offset:2624
    ds_read_b64_tr_b16 v[6:7], v60 offset:2656
    s_waitcnt lgkmcnt(8)
    v_mfma_f32_16x16x32_bf16 v[16:19], v[36:39], v[8:11], v[16:19]
    ds_read_b128 v[36:39], v27 offset:0
    v_mfma_f32_16x16x32_bf16 v[20:23], v[40:43], v[8:11], v[20:23]
    ds_read_b128 v[40:43], v27 offset:1024
    s_waitcnt lgkmcnt(8)
    v_mfma_f32_16x16x32_bf16 v[52:55], v[12:15], v[8:11], v[52:55]
    ds_read_b64_tr_b16 v[8:9], v60 offset:768
    ds_read_b64_tr_b16 v[10:11], v60 offset:800
    ds_read_b64_tr_b16 v[12:13], v60 offset:2880
    ds_read_b64_tr_b16 v[14:15], v60 offset:2912
    s_waitcnt lgkmcnt(8)
    v_mfma_f32_16x16x32_bf16 v[16:19], v[28:31], v[0:3], v[16:19]
    v_mfma_f32_16x16x32_bf16 v[20:23], v[32:35], v[0:3], v[20:23]
    s_waitcnt lgkmcnt(6)
    v_mfma_f32_16x16x32_bf16 v[52:55], v[4:7], v[0:3], v[52:55]
    s_waitcnt lgkmcnt(2)
    v_mfma_f32_16x16x32_bf16 v[16:19], v[36:39], v[8:11], v[16:19]
    v_mfma_f32_16x16x32_bf16 v[20:23], v[40:43], v[8:11], v[20:23]
    s_waitcnt lgkmcnt(0)
    v_mfma_f32_16x16x32_bf16 v[52:55], v[12:15], v[8:11], v[52:55]
    s_mov_b32 m0, s60
    s_nop 0
    buffer_load_dwordx4 v66, s[4:7], s36 offen lds
    s_mov_b32 m0, s61
    s_nop 0
    buffer_load_dwordx4 v66, s[4:7], s37 offen lds
    v_mov_b32_dpp v16, v20 quad_perm:[0,1,2,3] row_mask:0xf bank_mask:0xc
    v_mov_b32_dpp v17, v21 quad_perm:[0,1,2,3] row_mask:0xf bank_mask:0xc
    v_mov_b32_dpp v18, v22 quad_perm:[0,1,2,3] row_mask:0xf bank_mask:0xc
    v_mov_b32_dpp v19, v23 quad_perm:[0,1,2,3] row_mask:0xf bank_mask:0xc
    v_max3_f32 v26, |v16|, |v17|, |v18|
    v_max3_f32 v27, |v19|, |v52|, |v53|
    v_max3_f32 v26, v26, |v54|, |v55|
    v_max_f32 v26, v26, v27
    v_cmp_nge_f32 vcc, s58, v26
    s_cbranch_vccnz Lfbf_15
Lexpf_16:
    v_exp_f32 v16, v16
    v_exp_f32 v17, v17
    v_exp_f32 v18, v18
    v_exp_f32 v19, v19
    v_exp_f32 v52, v52
    v_exp_f32 v53, v53
    v_exp_f32 v54, v54
    v_exp_f32 v55, v55
    v_cvt_pk_bf16_f32 v0, v16, v17
    v_cvt_pk_bf16_f32 v1, v18, v19
    v_cvt_pk_bf16_f32 v4, v52, v53
    v_cvt_pk_bf16_f32 v5, v54, v55
    v_mov_b32_dpp v2, v0 row_ror:8 row_mask:0xf bank_mask:0xf
    v_mov_b32_dpp v3, v1 row_ror:8 row_mask:0xf bank_mask:0xf
    v_cndmask_b32 v6, 0, v4, s[40:41]
    v_cndmask_b32 v7, 0, v5, s[40:41]
    v_cndmask_b32 v8, 0, v4, s[42:43]
    v_cndmask_b32 v9, 0, v5, s[42:43]
    s_waitcnt vmcnt(5)
    v_mfma_f32_16x16x32_bf16 v[28:31], v[44:47], v[0:3], 0
    ds_read_b128 v[36:39], v56 offset:18432
    v_mfma_f32_16x16x32_bf16 v[32:35], v[48:51], v[0:3], 0
    ds_read_b128 v[40:43], v56 offset:19456
    v_mfma_f32_16x16x16_bf16 v[12:15], v[70:71], v[0:1], 0
    v_xor_b32 v52, 16, v62
    v_mfma_f32_16x16x16_bf16 v[28:31], v[24:25], v[6:7], v[28:31]
    v_xor_b32 v53, 128, v62
    v_mfma_f32_16x16x16_bf16 v[12:15], v[70:71], v[2:3], v[12:15]
    v_xor_b32 v54, 144, v62
    v_mfma_f32_16x16x16_bf16 v[32:35], v[24:25], v[8:9], v[32:35]
    ds_read_b128 v[44:47], v56 offset:20480
    v_mfma_f32_16x16x16_bf16 v[12:15], v[70:71], v[6:7], v[12:15]
    ds_read_b128 v[48:51], v56 offset:21504
    s_add_u32 s36, s36, 262144
    s_add_u32 s37, s37, 262144
    s_nop 2
    v_mov_b32_dpp v28, v32 row_ror:8 row_mask:0xf bank_mask:0xc
    v_mov_b32_dpp v29, v33 row_ror:8 row_mask:0xf bank_mask:0xc
    v_mov_b32_dpp v30, v34 row_ror:8 row_mask:0xf bank_mask:0xc
    v_mov_b32_dpp v31, v35 row_ror:8 row_mask:0xf bank_mask:0xc
    v_rcp_f32 v26, v12
    s_nop 0
    v_pk_mul_f32 v[28:29], v[28:29], v[26:27] op_sel_hi:[1,0]
    v_pk_mul_f32 v[30:31], v[30:31], v[26:27] op_sel_hi:[1,0]
    v_cvt_pk_bf16_f32 v26, v28, v29
    v_cvt_pk_bf16_f32 v27, v30, v31
    ds_write_b64 v61, v[26:27]
    v_mov_b64 v[28:29], 0
    v_mov_b64 v[30:31], 0
    v_mov_b64 v[32:33], 0
    v_mov_b64 v[34:35], 0
    s_waitcnt lgkmcnt(0)
    s_barrier
    ds_read_b128 v[0:3], v62 offset:0
    ds_read_b128 v[4:7], v52 offset:0
    ds_read_b128 v[8:11], v53 offset:0
    ds_read_b128 v[12:15], v54 offset:0
    ds_read_b128 v[16:19], v56 offset:22528
    ds_read_b128 v[20:23], v56 offset:23552
    s_waitcnt lgkmcnt(5)
    v_smfmac_f32_16x16x64_bf16 v[28:31], v[0:3], a[176:183], v57
    s_waitcnt lgkmcnt(4)
    v_smfmac_f32_16x16x64_bf16 v[28:31], v[4:7], a[184:191], v57
    s_waitcnt lgkmcnt(3)
    v_smfmac_f32_16x16x64_bf16 v[28:31], v[8:11], a[192:199], v57
    s_waitcnt lgkmcnt(2)
    v_smfmac_f32_16x16x64_bf16 v[28:31], v[12:15], a[200:207], v57
    v_smfmac_f32_16x16x64_bf16 v[32:35], v[0:3], a[208:215], v57
    v_smfmac_f32_16x16x64_bf16 v[32:35], v[4:7], a[216:223], v57
    s_nop 5
    v_cvt_pk_bf16_f32 v24, v28, v29
    v_cvt_pk_bf16_f32 v25, v30, v31
    v_smfmac_f32_16x16x64_bf16 v[32:35], v[8:11], a[224:231], v57
    buffer_store_dwordx2 v[24:25], v63, s[4:7], s27 offen offset:0
    v_smfmac_f32_16x16x64_bf16 v[32:35], v[12:15], a[232:239], v57
    v_mov_b64 v[28:29], 0
    v_mov_b64 v[30:31], 0
    s_nop 1
    v_smfmac_f32_16x16x64_bf16 v[28:31], v[0:3], a[240:247], v57
    v_smfmac_f32_16x16x64_bf16 v[28:31], v[4:7], a[248:255], v57
    s_nop 1
    v_cvt_pk_bf16_f32 v24, v32, v33
    v_cvt_pk_bf16_f32 v25, v34, v35
    v_smfmac_f32_16x16x64_bf16 v[28:31], v[8:11], v[36:43], v57
    ds_read_b128 v[36:39], v56 offset:24576
    ds_read_b128 v[40:43], v56 offset:25600
    buffer_store_dwordx2 v[24:25], v63, s[4:7], s27 offen offset:2048
    v_smfmac_f32_16x16x64_bf16 v[28:31], v[12:15], v[44:51], v57
    ds_read_b128 v[44:47], v56 offset:26624
    ds_read_b128 v[48:51], v56 offset:27648
    v_mov_b64 v[32:33], 0
    v_mov_b64 v[34:35], 0
    s_waitcnt lgkmcnt(4)
    s_nop 0
    v_smfmac_f32_16x16x64_bf16 v[32:35], v[0:3], v[16:23], v57
    ds_read_b128 v[16:19], v56 offset:28672
    ds_read_b128 v[20:23], v56 offset:29696
    s_waitcnt lgkmcnt(4)
    v_smfmac_f32_16x16x64_bf16 v[32:35], v[4:7], v[36:43], v57
    ds_read_b128 v[36:39], v56 offset:30720
    ds_read_b128 v[40:43], v56 offset:31744
    v_cvt_pk_bf16_f32 v24, v28, v29
    v_cvt_pk_bf16_f32 v25, v30, v31
    s_waitcnt lgkmcnt(4)
    v_smfmac_f32_16x16x64_bf16 v[32:35], v[8:11], v[44:51], v57
    ds_read_b128 v[44:47], v56 offset:32768
    ds_read_b128 v[48:51], v56 offset:33792
    buffer_store_dwordx2 v[24:25], v63, s[4:7], s56 offen offset:0
    s_waitcnt lgkmcnt(4)
    v_smfmac_f32_16x16x64_bf16 v[32:35], v[12:15], v[16:23], v57
    ds_read_b128 v[16:19], v56 offset:34816
    ds_read_b128 v[20:23], v56 offset:35840
    v_mov_b64 v[28:29], 0
    v_mov_b64 v[30:31], 0
    s_cmp_ge_u32 s17, 2
    s_cbranch_scc1 Lno4f_17
    s_waitcnt lgkmcnt(4)
    v_smfmac_f32_16x16x64_bf16 v[28:31], v[0:3], v[36:43], v57
    ds_read_b128 v[36:39], v56 offset:36864
    ds_read_b128 v[40:43], v56 offset:37888
    s_waitcnt lgkmcnt(4)
    v_smfmac_f32_16x16x64_bf16 v[28:31], v[4:7], v[44:51], v57
    v_cvt_pk_bf16_f32 v24, v32, v33
    v_cvt_pk_bf16_f32 v25, v34, v35
    s_waitcnt lgkmcnt(2)
    v_smfmac_f32_16x16x64_bf16 v[28:31], v[8:11], v[16:23], v57
    buffer_store_dwordx2 v[24:25], v63, s[4:7], s56 offen offset:2048
    s_waitcnt lgkmcnt(0)
    v_smfmac_f32_16x16x64_bf16 v[28:31], v[12:15], v[36:43], v57
    s_nop 7
    v_cvt_pk_bf16_f32 v24, v28, v29
    v_cvt_pk_bf16_f32 v25, v30, v31
    buffer_store_dwordx2 v[24:25], v63, s[4:7], s57 offen offset:0
    s_branch Lno4f_17x
Lno4f_17:
    s_nop 7
    v_cvt_pk_bf16_f32 v24, v32, v33
    v_cvt_pk_bf16_f32 v25, v34, v35
    buffer_store_dwordx2 v[24:25], v63, s[4:7], s56 offen offset:2048
    s_waitcnt lgkmcnt(0)
    v_lshrrev_b32 v53, 16, v70
    v_cndmask_b32 v53, v53, 1.0, s[8:9]
    v_cndmask_b32 v20, 0, v53, s[90:91]
    v_cndmask_b32 v21, 0, v53, s[92:93]
    v_cndmask_b32 v22, 0, v53, s[94:95]
    v_cndmask_b32 v23, 0, v53, s[96:97]
Lno4f_17x:
    s_waitcnt lgkmcnt(0)
    s_mov_b32 s22, s32
    s_mov_b32 s23, s33
    s_barrier
    s_add_u32 s18, s18, 1
    s_and_b32 s20, s18, 3
    s_lshl_b32 s20, s20, 14
    s_add_u32 s24, s63, s20
    s_add_u32 s25, s24, 4096
    s_add_u32 s26, s20, 904960
    s_add_u32 s20, s20, 16384
    s_and_b32 s21, s20, 49152
    s_add_u32 s32, s54, s21
    s_add_u32 s20, s20, 32768
    s_and_b32 s21, s20, 49152
    s_add_u32 s33, s54, s21
    s_xor_b32 s27, s27, 524288
    s_xor_b32 s56, s56, 524288
    s_xor_b32 s57, s57, 524288
    s_add_u32 s38, s38, 262144
    s_add_u32 s34, s34, 65536
    s_add_u32 s47, s47, 65536
    s_cmp_eq_u32 s39, -1
    s_cbranch_scc1 Lntf_22
    s_mov_b32 s48, s28
    s_mov_b32 s49, s29
    s_mov_b32 s50, s30
    s_mov_b32 s51, s31
    s_cmp_lg_u32 s17, 1
    s_cbranch_scc1 Ls1f_23
    v_lshrrev_b32 v53, 16, v70
    v_cndmask_b32 v53, v53, 1.0, s[8:9]
    v_cndmask_b32 v20, 0, v53, s[90:91]
    v_cndmask_b32 v21, 0, v53, s[92:93]
    v_cndmask_b32 v22, 0, v53, s[94:95]
    v_cndmask_b32 v23, 0, v53, s[96:97]
Ls1f_23:
    s_mov_b32 s19, 0
Lrpf_13:
    buffer_load_dwordx4 v[0:3], v64, s[4:7], s28 offen sc1
    buffer_load_dwordx4 v[4:7], v64, s[4:7], s29 offen sc1
    buffer_load_dwordx4 v[8:11], v64, s[4:7], s30 offen sc1
    buffer_load_dwordx4 v[12:15], v64, s[4:7], s31 offen sc1
    s_waitcnt vmcnt(3)
    v_mfma_f32_16x16x32_bf16 v[16:19], v[0:3], v[20:23], 0
    s_waitcnt vmcnt(2)
    v_mfma_f32_16x16x32_bf16 v[16:19], v[4:7], v[20:23], v[16:19]
    s_waitcnt vmcnt(1)
    v_mfma_f32_16x16x32_bf16 v[16:19], v[8:11], v[20:23], v[16:19]
    v_max3_u32 v52, v0, v4, v8
    s_waitcnt vmcnt(0)
    v_mfma_f32_16x16x32_bf16 v[16:19], v[12:15], v[20:23], v[16:19]
    v_max_u32 v52, v52, v12
    v_cmp_eq_u32 vcc, -1, v52
    s_cbranch_vccz Lrokf_14
    s_add_u32 s19, s19, 1
    s_cmp_lt_u32 s19, 262144
    s_cbranch_scc1 Lrpf_13
    s_branch Lchain_fail
Lrokf_14:
    v_mov_b32 v52, -1
    v_permlane32_swap_b32 v16, v18
    v_permlane32_swap_b32 v17, v19
    v_add_f32 v16, v16, v18
    v_add_f32 v17, v17, v19
    v_cvt_pk_bf16_f32 v16, v16, v17
    buffer_store_dword v16, v65, s[4:7], s22 offen
    buffer_store_dword v52, v65, s[4:7], s23 offen
    s_xor_b32 s28, s28, 524288
    s_xor_b32 s29, s29, 524288
    s_xor_b32 s30, s30, 524288
    s_xor_b32 s31, s31, 524288
    s_branch Lnoredf_12
Lntf_22:
Lnoredf_12:
    s_barrier
    s_branch Lstepf_9
Lfbf_15:
    v_max3_f32 v26, v16, v17, v18
    v_max3_f32 v26, v26, v19, v52
    v_max3_f32 v26, v26, v53, v54
    v_max_f32 v26, v26, v55
    s_nop 1
    v_max_f32_dpp v26, v26, v26 row_ror:8 row_mask:0xf bank_mask:0xf
    v_mov_b32 v27, v26
    s_nop 1
    v_permlane16_swap_b32 v27, v26
    v_max_f32 v26, v26, v27
    v_mov_b32 v27, v26
    s_nop 1
    v_permlane32_swap_b32 v27, v26
    v_max_f32 v26, v26, v27
    v_sub_f32 v16, v16, v26
    v_sub_f32 v52, v52, v26
    v_sub_f32 v17, v17, v26
    v_sub_f32 v53, v53, v26
    v_sub_f32 v18, v18, v26
    v_sub_f32 v54, v54, v26
    v_sub_f32 v19, v19, v26
    v_sub_f32 v55, v55, v26
    s_nop 1
    s_branch Lexpf_16
Ldonef_11:
    s_waitcnt vmcnt(0) lgkmcnt(0)
    s_barrier
    v_mov_b32 v54, 64
    buffer_store_dword v54, v65, s[4:7], s59 offen sc1
    s_waitcnt vmcnt(0)
    s_branch Lexit
Lchain_slow:
    s_waitcnt vmcnt(0)
    s_barrier
    s_cmp_lg_u32 s17, 0
    s_cbranch_scc1 Ltb2s
    s_mov_b64 exec, 1
    v_mov_b32 v2, 1
    v_mov_b32 v3, 16
    buffer_atomic_add v2, v3, s[12:15], 0 offen
    s_mov_b32 s19, 0
Ltb1s:
    buffer_load_dword v2, v3, s[12:15], 0 offen sc1
    s_waitcnt vmcnt(0)
    v_cmp_le_u32 vcc, 32, v2
    s_cbranch_vccnz Ltb3s
    s_add_u32 s19, s19, 1
    s_cmp_lt_u32 s19, 524288
    s_cbranch_scc1 Ltb1s
    s_branch Lfail
Ltb3s:
    s_mov_b64 exec, -1
Ltb2s:
    s_barrier
    s_mov_b32 s21, 0
    s_lshl_b32 s20, s21, 8
    s_lshl_b32 s21, s16, 2
    s_add_u32 s20, s20, s21
    s_add_u32 s20, s20, 1581056
    s_mov_b32 s19, 0
    v_subrev_u32 v54, 151808, v68
    v_lshlrev_b32 v54, 4, v54
    s_mov_b64 exec, 3
Lkv0s0:
    buffer_load_dword v55, v54, s[4:7], s20 offen sc1
    s_waitcnt vmcnt(0)
    v_and_b32 v55, 0xff, v55
    v_cmp_gt_u32 vcc, 2, v55
    s_cbranch_vccz Lkv1s0
    s_add_u32 s19, s19, 1
    s_cmp_lt_u32 s19, 524288
    s_cbranch_scc1 Lkv0s0
    s_branch Lfail
Lkv1s0:
    s_mov_b64 exec, -1
    s_mov_b32 s18, 0
    s_mov_b32 s24, s63
    s_add_u32 s25, s24, 4096
    s_add_u32 s26, 904960, 0
    s_add_u32 s32, s54, 16384
    s_add_u32 s33, s54, 49152
    s_lshl_b32 s20, s16, 11
    s_add_u32 s34, s20, 58720256
    s_add_u32 s47, s20, 62914560
    s_mul_i32 s21, s16, 9216
    s_add_u32 s27, s21, 0
    s_add_u32 s56, s27, 4096
    s_add_u32 s57, s27, 8192
    s_add_u32 s28, s62, 0
    s_add_u32 s29, s28, 73728
    s_add_u32 s30, s29, 73728
    s_add_u32 s31, s30, 73728
    s_lshl_b32 s21, s16, 8
    s_add_u32 s36, s21, 25165824
    s_add_u32 s37, s36, 32768
    s_lshl_b32 s20, s16, 13
    s_add_u32 s38, s20, 41943040
    s_lshl_b32 s59, s16, 8
    s_add_u32 s59, s59, 1572864
    s_cmp_eq_u32 s17, 0
    s_cselect_b32 s59, s59, 0x40000000
    s_mov_b32 s48, 0x40000000
    s_mov_b32 s49, 0x40000000
    s_mov_b32 s50, 0x40000000
    s_mov_b32 s51, 0x40000000
    s_mov_b32 s8, 0xaaaaaaaa
    s_mov_b32 s9, 0xaaaaaaaa
    s_mov_b32 s90, 0x30003
    s_mov_b32 s91, 0x30003
    s_mov_b32 s92, 0xc000c
    s_mov_b32 s93, 0xc000c
    s_mov_b32 s94, 0x300030
    s_mov_b32 s95, 0x300030
    s_mov_b32 s96, 0xc000c0
    s_mov_b32 s97, 0xc000c0
    s_mov_b32 m0, s60
    s_nop 0
    buffer_load_dwordx4 v66, s[4:7], s36 offen lds
    s_mov_b32 m0, s61
    s_nop 0
    buffer_load_dwordx4 v66, s[4:7], s37 offen lds
    s_add_u32 s36, s36, 262144
    s_add_u32 s37, s37, 262144
Lsteps_24:
    s_cmp_lg_u32 s17, 0
    s_cbranch_scc1 Lpwns_34
    s_mov_b32 m0, s44
    s_nop 0
    buffer_load_dwordx4 v68, s[4:7], s24 offen sc1 lds
    s_mov_b32 m0, s45
    s_nop 0
    buffer_load_dwordx4 v68, s[4:7], s25 offen sc1 lds
    s_mov_b32 m0, s46
    s_nop 0
    buffer_load_dwordx4 v68, s[4:7], s26 offen sc1 lds
    ds_read_b128 v[28:31], v56 offset:0
    ds_read_b128 v[32:35], v56 offset:1024
    ds_read_b128 v[36:39], v56 offset:2048
    ds_read_b128 v[40:43], v56 offset:3072
    v_mov_b64 v[16:17], 0
    v_mov_b64 v[18:19], 0
    v_mov_b64 v[20:21], 0
    v_mov_b64 v[22:23], 0
    v_mov_b64 v[24:25], 0
    v_mov_b64 v[26:27], 0
    v_mov_b32 v44, -1
    v_mov_b32 v45, -1
    v_mov_b32 v46, -1
    v_mov_b32 v47, -1
    s_lshl_b32 s20, s17, 10
    v_add_u32 v52, s20, v68
    s_mov_b32 s19, 0
Lpw0s_33l:
    s_mov_b32 m0, s44
    s_nop 0
    buffer_load_dwordx4 v68, s[4:7], s24 offen sc1 lds
    s_mov_b32 m0, s45
    s_nop 0
    buffer_load_dwordx4 v68, s[4:7], s25 offen sc1 lds
    s_mov_b32 m0, s46
    s_nop 0
    buffer_load_dwordx4 v68, s[4:7], s26 offen sc1 lds
    s_waitcnt vmcnt(3)
    ds_read_b32 v55, v52
    ds_read_b32 v51, v52 offset:4096
    ds_read_b32 v53, v68 offset:8192
    s_waitcnt lgkmcnt(0)
    v_max3_u32 v53, v53, v55, v51
    v_cmp_eq_u32 vcc, -1, v53
    s_cbranch_vccz Loks_25
    s_add_u32 s19, s19, 1
    s_cmp_lt_u32 s19, 262144
    s_cbranch_scc1 Lpw0s_33l
    s_branch Lchain_fail
Lpwns_34:
    s_mov_b32 m0, s44
    s_nop 0
    buffer_load_dwordx4 v68, s[4:7], s24 offen sc1 lds
    s_mov_b32 m0, s45
    s_nop 0
    buffer_load_dwordx4 v68, s[4:7], s25 offen sc1 lds
    ds_read_b128 v[28:31], v56 offset:0
    ds_read_b128 v[32:35], v56 offset:1024
    ds_read_b128 v[36:39], v56 offset:2048
    ds_read_b128 v[40:43], v56 offset:3072
    v_mov_b64 v[16:17], 0
    v_mov_b64 v[18:19], 0
    v_mov_b64 v[20:21], 0
    v_mov_b64 v[22:23], 0
    v_mov_b64 v[24:25], 0
    v_mov_b64 v[26:27], 0
    v_mov_b32 v44, -1
    v_mov_b32 v45, -1
    v_mov_b32 v46, -1
    v_mov_b32 v47, -1
    s_lshl_b32 s20, s17, 10
    v_add_u32 v52, s20, v68
    s_mov_b32 s19, 0
Lpwns_34l:
    s_mov_b32 m0, s44
    s_nop 0
    buffer_load_dwordx4 v68, s[4:7], s24 offen sc1 lds
    s_mov_b32 m0, s45
    s_nop 0
    buffer_load_dwordx4 v68, s[4:7], s25 offen sc1 lds
    s_waitcnt vmcnt(2)
    ds_read_b32 v55, v52
    ds_read_b32 v51, v52 offset:4096
    s_waitcnt lgkmcnt(0)
    v_max_u32 v53, v55, v51
    v_cmp_eq_u32 vcc, -1, v53
    s_cbranch_vccz Loks_25
    s_add_u32 s19, s19, 1
    s_cmp_lt_u32 s19, 262144
    s_cbranch_scc1 Lpwns_34l
    s_branch Lchain_fail
Loks_25:
    s_barrier
    ds_read_b128 v[0:3], v68 offset:0
    ds_read_b128 v[4:7], v69 offset:0
    ds_read_b128 v[8:11], v68 offset:1024
    ds_read_b128 v[12:15], v69 offset:1024
    s_cmp_lg_u32 s18, 2
    s_cbranch_scc1 Lh_36
    s_mov_b32 s21, 2
    s_lshl_b32 s20, s21, 8
    s_lshl_b32 s21, s16, 2
    s_add_u32 s20, s20, s21
    s_add_u32 s20, s20, 1581056
    s_mov_b32 s19, 0
    v_subrev_u32 v54, 151808, v68
    v_lshlrev_b32 v54, 4, v54
    s_mov_b64 exec, 3
Lkv0s2:
    buffer_load_dword v55, v54, s[4:7], s20 offen sc1
    s_waitcnt vmcnt(0)
    v_and_b32 v55, 0xff, v55
    v_cmp_gt_u32 vcc, 2, v55
    s_cbranch_vccz Lkv1s2
    s_add_u32 s19, s19, 1
    s_cmp_lt_u32 s19, 524288
    s_cbranch_scc1 Lkv0s2
    s_branch Lfail
Lkv1s2:
    s_mov_b64 exec, -1
Lh_36:
    s_and_b32 s20, s18, 7
    s_cmp_lg_u32 s20, 6
    s_cbranch_scc1 Lh_35
    s_cmp_gt_u32 s18, 56
    s_cbranch_scc1 Lh_35
    s_add_u32 s21, s18, 2
    s_lshr_b32 s21, s21, 1
    s_lshl_b32 s20, s21, 8
    s_lshl_b32 s21, s16, 2
    s_add_u32 s20, s20, s21
    s_add_u32 s20, s20, 1581056
    s_mov_b32 s19, 0
    v_subrev_u32 v54, 151808, v68
    v_lshlrev_b32 v54, 4, v54
    s_mov_b64 exec, 15
Lkv0s1:
    buffer_load_dword v55, v54, s[4:7], s20 offen sc1
    s_waitcnt vmcnt(0)
    v_and_b32 v55, 0xff, v55
    v_cmp_gt_u32 vcc, 2, v55
    s_cbranch_vccz Lkv1s1
    s_add_u32 s19, s19, 1
    s_cmp_lt_u32 s19, 524288
    s_cbranch_scc1 Lkv0s1
    s_branch Lfail
Lkv1s1:
    s_mov_b64 exec, -1
Lh_35:
    s_waitcnt lgkmcnt(3)
    v_smfmac_f32_16x16x64_bf16 v[16:19], v[0:3], v[72:79], v57
    v_smfmac_f32_16x16x64_bf16 v[20:23], v[0:3], v[88:95], v57
    v_smfmac_f32_16x16x64_bf16 v[24:27], v[0:3], v[28:35], v57
    ds_read_b128 v[28:31], v56 offset:4096
    buffer_store_dwordx4 v[44:47], v64, s[4:7], s48 offen sc1
    s_waitcnt lgkmcnt(3)
    v_smfmac_f32_16x16x64_bf16 v[16:19], v[4:7], v[80:87], v57
    ds_read_b128 v[32:35], v56 offset:5120
    v_smfmac_f32_16x16x64_bf16 v[20:23], v[4:7], v[96:103], v57
    ds_read_b128 v[0:3], v68 offset:2048
    v_smfmac_f32_16x16x64_bf16 v[24:27], v[4:7], v[36:43], v57
    ds_read_b128 v[36:39], v56 offset:6144
    buffer_store_dwordx4 v[44:47], v64, s[4:7], s49 offen sc1
    s_waitcnt lgkmcnt(5)
    v_smfmac_f32_16x16x64_bf16 v[16:19], v[8:11], v[104:111], v57
    ds_read_b128 v[40:43], v56 offset:7168
    v_smfmac_f32_16x16x64_bf16 v[20:23], v[8:11], v[120:127], v57
    ds_read_b128 v[4:7], v69 offset:2048
    buffer_store_dwordx4 v[44:47], v64, s[4:7], s50 offen sc1
    s_waitcnt lgkmcnt(4)
    v_smfmac_f32_16x16x64_bf16 v[24:27], v[8:11], v[28:35], v57
    ds_read_b128 v[28:31], v56 offset:8192
    v_smfmac_f32_16x16x64_bf16 v[16:19], v[12:15], v[112:119], v57
    ds_read_b128 v[32:35], v56 offset:9216
    v_smfmac_f32_16x16x64_bf16 v[20:23], v[12:15], v[128:135], v57
    ds_read_b128 v[8:11], v68 offset:3072
    buffer_store_dwordx4 v[44:47], v64, s[4:7], s51 offen sc1
    s_waitcnt lgkmcnt(4)
    v_smfmac_f32_16x16x64_bf16 v[24:27], v[12:15], v[36:43], v57
    ds_read_b128 v[36:39], v56 offset:10240
    v_smfmac_f32_16x16x64_bf16 v[16:19], v[0:3], v[136:143], v57
    ds_read_b128 v[40:43], v56 offset:11264
    v_smfmac_f32_16x16x64_bf16 v[20:23], v[0:3], v[152:159], v57
    ds_read_b128 v[12:15], v69 offset:3072
    buffer_load_dwordx4 v[44:47], v67, s[4:7], s38 offen offset:0
    s_waitcnt lgkmcnt(4)
    v_smfmac_f32_16x16x64_bf16 v[24:27], v[0:3], v[28:35], v57
    ds_read_b128 v[28:31], v56 offset:12288
    v_smfmac_f32_16x16x64_bf16 v[16:19], v[4:7], v[144:151], v57
    ds_read_b128 v[32:35], v56 offset:13312
    v_smfmac_f32_16x16x64_bf16 v[20:23], v[4:7], v[160:167], v57
    ds_read_b128 v[0:3], v68 offset:4096
    buffer_load_dwordx4 v[48:51], v67, s[4:7], s38 offen offset:1024
    s_waitcnt lgkmcnt(4)
    v_smfmac_f32_16x16x64_bf16 v[24:27], v[4:7], v[36:43], v57
    ds_read_b128 v[36:39], v56 offset:14336
    v_mov_b32 v54, s18
    v_smfmac_f32_16x16x64_bf16 v[16:19], v[8:11], v[168:175], v57
    ds_read_b128 v[40:43], v56 offset:15360
    v_smfmac_f32_16x16x64_bf16 v[20:23], v[8:11], v[184:191], v57
    ds_read_b128 v[4:7], v69 offset:4096
    buffer_store_dword v54, v65, s[4:7], s59 offen sc1
    s_waitcnt lgkmcnt(4)
    v_smfmac_f32_16x16x64_bf16 v[24:27], v[8:11], v[28:35], v57
    v_smfmac_f32_16x16x64_bf16 v[16:19], v[12:15], v[176:183], v57
    v_smfmac_f32_16x16x64_bf16 v[20:23], v[12:15], v[192:199], v57
    ds_read_b128 v[8:11], v68 offset:5120
    s_waitcnt lgkmcnt(2)
    v_smfmac_f32_16x16x64_bf16 v[24:27], v[12:15], v[36:43], v57
    ds_read_b128 v[36:39], v56 offset:16384
    v_smfmac_f32_16x16x64_bf16 v[16:19], v[0:3], v[200:207], v57
    ds_read_b128 v[40:43], v56 offset:17408
    v_smfmac_f32_16x16x64_bf16 v[20:23], v[0:3], v[216:223], v57
    ds_read_b128 v[12:15], v69 offset:5120
    v_smfmac_f32_16x16x64_bf16 v[24:27], v[0:3], v[232:239], v57
    ds_read_b128 v[28:31], v58 offset:0
    s_waitcnt lgkmcnt(5)
    v_smfmac_f32_16x16x64_bf16 v[16:19], v[4:7], v[208:215], v57
    ds_read_b128 v[32:35], v58 offset:1024
    v_smfmac_f32_16x16x64_bf16 v[20:23], v[4:7], v[224:231], v57
    ds_read_b128 v[0:3], v68 offset:6144
    s_waitcnt lgkmcnt(4)
    v_smfmac_f32_16x16x64_bf16 v[24:27], v[4:7], v[36:43], v57
    v_smfmac_f32_16x16x64_bf16 v[16:19], v[8:11], v[240:247], v57
    v_smfmac_f32_16x16x64_bf16 v[20:23], v[8:11], a[0:7], v57
    ds_read_b128 v[4:7], v69 offset:6144
    v_smfmac_f32_16x16x64_bf16 v[24:27], v[8:11], a[16:23], v57
    s_waitcnt lgkmcnt(4)
    v_smfmac_f32_16x16x64_bf16 v[16:19], v[12:15], v[248:255], v57
    v_smfmac_f32_16x16x64_bf16 v[20:23], v[12:15], a[8:15], v57
    ds_read_b128 v[8:11], v68 offset:7168
    v_smfmac_f32_16x16x64_bf16 v[24:27], v[12:15], a[24:31], v57
    s_waitcnt lgkmcnt(2)
    v_smfmac_f32_16x16x64_bf16 v[16:19], v[0:3], a[32:39], v57
    v_smfmac_f32_16x16x64_bf16 v[20:23], v[0:3], a[48:55], v57
    ds_read_b128 v[12:15], v69 offset:7168
    v_smfmac_f32_16x16x64_bf16 v[24:27], v[0:3], a[64:71], v57
    v_xor_b32 v53, 64, v58
    s_waitcnt lgkmcnt(2)
    v_smfmac_f32_16x16x64_bf16 v[16:19], v[4:7], a[40:47], v57
    ds_read_b128 v[36:39], v53 offset:0
    v_smfmac_f32_16x16x64_bf16 v[20:23], v[4:7], a[56:63], v57
    ds_read_b128 v[0:3], v68 offset:8192
    v_smfmac_f32_16x16x64_bf16 v[24:27], v[4:7], a[72:79], v57
    s_waitcnt lgkmcnt(3)
    v_smfmac_f32_16x16x64_bf16 v[16:19], v[8:11], a[80:87], v57
    v_smfmac_f32_16x16x64_bf16 v[20:23], v[8:11], a[96:103], v57
    ds_read_b128 v[4:7], v69 offset:8192
    v_smfmac_f32_16x16x64_bf16 v[24:27], v[8:11], a[112:119], v57
    ds_read_b128 v[40:43], v53 offset:1024
    s_waitcnt lgkmcnt(4)
    v_smfmac_f32_16x16x64_bf16 v[16:19], v[12:15], a[88:95], v57
    v_xor_b32 v52, 128, v58
    v_smfmac_f32_16x16x64_bf16 v[20:23], v[12:15], a[104:111], v57
    v_smfmac_f32_16x16x64_bf16 v[24:27], v[12:15], a[120:127], v57
    s_waitcnt lgkmcnt(2)
    v_smfmac_f32_16x16x64_bf16 v[16:19], v[0:3], a[128:135], v57
    v_smfmac_f32_16x16x64_bf16 v[20:23], v[0:3], a[144:151], v57
    v_smfmac_f32_16x16x64_bf16 v[24:27], v[0:3], a[160:167], v57
    v_xor_b32 v53, 192, v58
    s_waitcnt lgkmcnt(1)
    v_smfmac_f32_16x16x64_bf16 v[16:19], v[4:7], a[136:143], v57
    v_smfmac_f32_16x16x64_bf16 v[20:23], v[4:7], a[152:159], v57
    v_smfmac_f32_16x16x64_bf16 v[24:27], v[4:7], a[168:175], v57
    s_nop 6
    v_cvt_pk_bf16_f32 v54, v20, v21
    v_cvt_pk_bf16_f32 v55, v22, v23
    v_pk_mul_f32 v[16:17], v[16:17], s[52:53]
    v_pk_mul_f32 v[18:19], v[18:19], s[52:53]
    ds_write_b64 v59, v[54:55] offset:2112
    v_cvt_pk_bf16_f32 v20, v16, v17
    v_cvt_pk_bf16_f32 v21, v18, v19
    ds_write_b64 v59, v[20:21]
    v_cvt_pk_bf16_f32 v24, v24, v25
    v_cvt_pk_bf16_f32 v25, v26, v27
    v_mov_b32 v26, v52
    v_mov_b32 v27, v53
    buffer_store_dwordx2 v[54:55], v63, s[4:7], s34 offen sc1
    buffer_store_dwordx2 v[24:25], v63, s[4:7], s47 offen sc1
    s_cmp_eq_u32 s18, 63
    s_cbranch_scc1 Ldones_26
    s_waitcnt lgkmcnt(0)
    s_barrier
    ds_read_b64_tr_b16 v[0:1], v60 offset:0
    ds_read_b64_tr_b16 v[2:3], v60 offset:32
    ds_read_b64_tr_b16 v[4:5], v60 offset:2112
    ds_read_b64_tr_b16 v[6:7], v60 offset:2144
    ds_read_b64_tr_b16 v[8:9], v60 offset:256
    ds_read_b64_tr_b16 v[10:11], v60 offset:288
    ds_read_b64_tr_b16 v[12:13], v60 offset:2368
    ds_read_b64_tr_b16 v[14:15], v60 offset:2400
    s_waitcnt lgkmcnt(6)
    v_mfma_f32_16x16x32_bf16 v[16:19], v[28:31], v[0:3], 0
    ds_read_b128 v[28:31], v26 offset:0
    v_mfma_f32_16x16x32_bf16 v[20:23], v[32:35], v[0:3], 0
    ds_read_b128 v[32:35], v26 offset:1024
    s_waitcnt lgkmcnt(6)
    v_mfma_f32_16x16x32_bf16 v[52:55], v[4:7], v[0:3], 0
    ds_read_b64_tr_b16 v[0:1], v60 offset:512
    ds_read_b64_tr_b16 v[2:3], v60 offset:544
    ds_read_b64_tr_b16 v[4:5], v60 offset:2624
    ds_read_b64_tr_b16 v[6:7], v60 offset:2656
    s_waitcnt lgkmcnt(8)
    v_mfma_f32_16x16x32_bf16 v[16:19], v[36:39], v[8:11], v[16:19]
    ds_read_b128 v[36:39], v27 offset:0
    v_mfma_f32_16x16x32_bf16 v[20:23], v[40:43], v[8:11], v[20:23]
    ds_read_b128 v[40:43], v27 offset:1024
    s_waitcnt lgkmcnt(8)
    v_mfma_f32_16x16x32_bf16 v[52:55], v[12:15], v[8:11], v[52:55]
    ds_read_b64_tr_b16 v[8:9], v60 offset:768
    ds_read_b64_tr_b16 v[10:11], v60 offset:800
    ds_read_b64_tr_b16 v[12:13], v60 offset:2880
    ds_read_b64_tr_b16 v[14:15], v60 offset:2912
    s_waitcnt lgkmcnt(8)
    v_mfma_f32_16x16x32_bf16 v[16:19], v[28:31], v[0:3], v[16:19]
    v_mfma_f32_16x16x32_bf16 v[20:23], v[32:35], v[0:3], v[20:23]
    s_waitcnt lgkmcnt(6)
    v_mfma_f32_16x16x32_bf16 v[52:55], v[4:7], v[0:3], v[52:55]
    s_waitcnt lgkmcnt(2)
    v_mfma_f32_16x16x32_bf16 v[16:19], v[36:39], v[8:11], v[16:19]
    v_mfma_f32_16x16x32_bf16 v[20:23], v[40:43], v[8:11], v[20:23]
    s_waitcnt lgkmcnt(0)
    v_mfma_f32_16x16x32_bf16 v[52:55], v[12:15], v[8:11], v[52:55]
    s_mov_b32 m0, s60
    s_nop 0
    buffer_load_dwordx4 v66, s[4:7], s36 offen lds
    s_mov_b32 m0, s61
    s_nop 0
    buffer_load_dwordx4 v66, s[4:7], s37 offen lds
    v_mov_b32_dpp v16, v20 quad_perm:[0,1,2,3] row_mask:0xf bank_mask:0xc
    v_mov_b32_dpp v17, v21 quad_perm:[0,1,2,3] row_mask:0xf bank_mask:0xc
    v_mov_b32_dpp v18, v22 quad_perm:[0,1,2,3] row_mask:0xf bank_mask:0xc
    v_mov_b32_dpp v19, v23 quad_perm:[0,1,2,3] row_mask:0xf bank_mask:0xc
    v_max3_f32 v26, |v16|, |v17|, |v18|
    v_max3_f32 v27, |v19|, |v52|, |v53|
    v_max3_f32 v26, v26, |v54|, |v55|
    v_max_f32 v26, v26, v27
    v_cmp_nge_f32 vcc, s58, v26
    s_cbranch_vccnz Lfbs_30
Lexps_31:
    v_exp_f32 v16, v16
    v_exp_f32 v17, v17
    v_exp_f32 v18, v18
    v_exp_f32 v19, v19
    v_exp_f32 v52, v52
    v_exp_f32 v53, v53
    v_exp_f32 v54, v54
    v_exp_f32 v55, v55
    v_cvt_pk_bf16_f32 v0, v16, v17
    v_cvt_pk_bf16_f32 v1, v18, v19
    v_cvt_pk_bf16_f32 v4, v52, v53
    v_cvt_pk_bf16_f32 v5, v54, v55
    v_mov_b32_dpp v2, v0 row_ror:8 row_mask:0xf bank_mask:0xf
    v_mov_b32_dpp v3, v1 row_ror:8 row_mask:0xf bank_mask:0xf
    v_cndmask_b32 v6, 0, v4, s[40:41]
    v_cndmask_b32 v7, 0, v5, s[40:41]
    v_cndmask_b32 v8, 0, v4, s[42:43]
    v_cndmask_b32 v9, 0, v5, s[42:43]
    s_waitcnt vmcnt(5)
    v_mfma_f32_16x16x32_bf16 v[28:31], v[44:47], v[0:3], 0
    ds_read_b128 v[36:39], v56 offset:18432
    v_mfma_f32_16x16x32_bf16 v[32:35], v[48:51], v[0:3], 0
    ds_read_b128 v[40:43], v56 offset:19456
    v_mfma_f32_16x16x16_bf16 v[12:15], v[70:71], v[0:1], 0
    v_xor_b32 v52, 16, v62
    v_mfma_f32_16x16x16_bf16 v[28:31], v[24:25], v[6:7], v[28:31]
    v_xor_b32 v53, 128, v62
    v_mfma_f32_16x16x16_bf16 v[12:15], v[70:71], v[2:3], v[12:15]
    v_xor_b32 v54, 144, v62
    v_mfma_f32_16x16x16_bf16 v[32:35], v[24:25], v[8:9], v[32:35]
    ds_read_b128 v[44:47], v56 offset:20480
    v_mfma_f32_16x16x16_bf16 v[12:15], v[70:71], v[6:7], v[12:15]
    ds_read_b128 v[48:51], v56 offset:21504
    s_add_u32 s36, s36, 262144
    s_add_u32 s37, s37, 262144
    s_nop 2
    v_mov_b32_dpp v28, v32 row_ror:8 row_mask:0xf bank_mask:0xc
    v_mov_b32_dpp v29, v33 row_ror:8 row_mask:0xf bank_mask:0xc
    v_mov_b32_dpp v30, v34 row_ror:8 row_mask:0xf bank_mask:0xc
    v_mov_b32_dpp v31, v35 row_ror:8 row_mask:0xf bank_mask:0xc
    v_rcp_f32 v26, v12
    s_nop 0
    v_pk_mul_f32 v[28:29], v[28:29], v[26:27] op_sel_hi:[1,0]
    v_pk_mul_f32 v[30:31], v[30:31], v[26:27] op_sel_hi:[1,0]
    v_cvt_pk_bf16_f32 v26, v28, v29
    v_cvt_pk_bf16_f32 v27, v30, v31
    ds_write_b64 v61, v[26:27]
    v_mov_b64 v[28:29], 0
    v_mov_b64 v[30:31], 0
    v_mov_b64 v[32:33], 0
    v_mov_b64 v[34:35], 0
    s_waitcnt lgkmcnt(0)
    s_barrier
    ds_read_b128 v[0:3], v62 offset:0
    ds_read_b128 v[4:7], v52 offset:0
    ds_read_b128 v[8:11], v53 offset:0
    ds_read_b128 v[12:15], v54 offset:0
    ds_read_b128 v[16:19], v56 offset:22528
    ds_read_b128 v[20:23], v56 offset:23552
    s_waitcnt lgkmcnt(5)
    v_smfmac_f32_16x16x64_bf16 v[28:31], v[0:3], a[176:183], v57
    s_waitcnt lgkmcnt(4)
    v_smfmac_f32_16x16x64_bf16 v[28:31], v[4:7], a[184:191], v57
    s_waitcnt lgkmcnt(3)
    v_smfmac_f32_16x16x64_bf16 v[28:31], v[8:11], a[192:199], v57
    s_waitcnt lgkmcnt(2)
    v_smfmac_f32_16x16x64_bf16 v[28:31], v[12:15], a[200:207], v57
    v_smfmac_f32_16x16x64_bf16 v[32:35], v[0:3], a[208:215], v57
    v_smfmac_f32_16x16x64_bf16 v[32:35], v[4:7], a[216:223], v57
    s_nop 5
    v_cvt_pk_bf16_f32 v24, v28, v29
    v_cvt_pk_bf16_f32 v25, v30, v31
    v_smfmac_f32_16x16x64_bf16 v[32:35], v[8:11], a[224:231], v57
    buffer_store_dwordx2 v[24:25], v63, s[4:7], s27 offen offset:0 sc1
    v_smfmac_f32_16x16x64_bf16 v[32:35], v[12:15], a[232:239], v57
    v_mov_b64 v[28:29], 0
    v_mov_b64 v[30:31], 0
    s_nop 1
    v_smfmac_f32_16x16x64_bf16 v[28:31], v[0:3], a[240:247], v57
    v_smfmac_f32_16x16x64_bf16 v[28:31], v[4:7], a[248:255], v57
    s_nop 1
    v_cvt_pk_bf16_f32 v24, v32, v33
    v_cvt_pk_bf16_f32 v25, v34, v35
    v_smfmac_f32_16x16x64_bf16 v[28:31], v[8:11], v[36:43], v57
    ds_read_b128 v[36:39], v56 offset:24576
    ds_read_b128 v[40:43], v56 offset:25600
    buffer_store_dwordx2 v[24:25], v63, s[4:7], s27 offen offset:2048 sc1
    v_smfmac_f32_16x16x64_bf16 v[28:31], v[12:15], v[44:51], v57
    ds_read_b128 v[44:47], v56 offset:26624
    ds_read_b128 v[48:51], v56 offset:27648
    v_mov_b64 v[32:33], 0
    v_mov_b64 v[34:35], 0
    s_waitcnt lgkmcnt(4)
    s_nop 0
    v_smfmac_f32_16x16x64_bf16 v[32:35], v[0:3], v[16:23], v57
    ds_read_b128 v[16:19], v56 offset:28672
    ds_read_b128 v[20:23], v56 offset:29696
    s_waitcnt lgkmcnt(4)
    v_smfmac_f32_16x16x64_bf16 v[32:35], v[4:7], v[36:43], v57
    ds_read_b128 v[36:39], v56 offset:30720
    ds_read_b128 v[40:43], v56 offset:31744
    v_cvt_pk_bf16_f32 v24, v28, v29
    v_cvt_pk_bf16_f32 v25, v30, v31
    s_waitcnt lgkmcnt(4)
    v_smfmac_f32_16x16x64_bf16 v[32:35], v[8:11], v[44:51], v57
    ds_read_b128 v[44:47], v56 offset:32768
    ds_read_b128 v[48:51], v56 offset:33792
    buffer_store_dwordx2 v[24:25], v63, s[4:7], s56 offen offset:0 sc1
    s_waitcnt lgkmcnt(4)
    v_smfmac_f32_16x16x64_bf16 v[32:35], v[12:15], v[16:23], v57
    ds_read_b128 v[16:19], v56 offset:34816
    ds_read_b128 v[20:23], v56 offset:35840
    v_mov_b64 v[28:29], 0
    v_mov_b64 v[30:31], 0
    s_cmp_ge_u32 s17, 2
    s_cbranch_scc1 Lno4s_32
    s_waitcnt lgkmcnt(4)
    v_smfmac_f32_16x16x64_bf16 v[28:31], v[0:3], v[36:43], v57
    ds_read_b128 v[36:39], v56 offset:36864
    ds_read_b128 v[40:43], v56 offset:37888
    s_waitcnt lgkmcnt(4)
    v_smfmac_f32_16x16x64_bf16 v[28:31], v[4:7], v[44:51], v57
    v_cvt_pk_bf16_f32 v24, v32, v33
    v_cvt_pk_bf16_f32 v25, v34, v35
    s_waitcnt lgkmcnt(2)
    v_smfmac_f32_16x16x64_bf16 v[28:31], v[8:11], v[16:23], v57
    buffer_store_dwordx2 v[24:25], v63, s[4:7], s56 offen offset:2048 sc1
    s_waitcnt lgkmcnt(0)
    v_smfmac_f32_16x16x64_bf16 v[28:31], v[12:15], v[36:43], v57
    s_nop 7
    v_cvt_pk_bf16_f32 v24, v28, v29
    v_cvt_pk_bf16_f32 v25, v30, v31
    buffer_store_dwordx2 v[24:25], v63, s[4:7], s57 offen offset:0 sc1
    s_branch Lno4s_32x
Lno4s_32:
    s_nop 7
    v_cvt_pk_bf16_f32 v24, v32, v33
    v_cvt_pk_bf16_f32 v25, v34, v35
    buffer_store_dwordx2 v[24:25], v63, s[4:7], s56 offen offset:2048 sc1
    s_waitcnt lgkmcnt(0)
    v_lshrrev_b32 v53, 16, v70
    v_cndmask_b32 v53, v53, 1.0, s[8:9]
    v_cndmask_b32 v20, 0, v53, s[90:91]
    v_cndmask_b32 v21, 0, v53, s[92:93]
    v_cndmask_b32 v22, 0, v53, s[94:95]
    v_cndmask_b32 v23, 0, v53, s[96:97]
Lno4s_32x:
    s_waitcnt lgkmcnt(0)
    s_mov_b32 s22, s32
    s_mov_b32 s23, s33
    s_barrier
    s_add_u32 s18, s18, 1
    s_and_b32 s20, s18, 3
    s_lshl_b32 s20, s20, 14
    s_add_u32 s24, s63, s20
    s_add_u32 s25, s24, 4096
    s_add_u32 s26, s20, 904960
    s_add_u32 s20, s20, 16384
    s_and_b32 s21, s20, 49152
    s_add_u32 s32, s54, s21
    s_add_u32 s20, s20, 32768
    s_and_b32 s21, s20, 49152
    s_add_u32 s33, s54, s21
    s_xor_b32 s27, s27, 524288
    s_xor_b32 s56, s56, 524288
    s_xor_b32 s57, s57, 524288
    s_add_u32 s38, s38, 262144
    s_add_u32 s34, s34, 65536
    s_add_u32 s47, s47, 65536
    s_cmp_eq_u32 s39, -1
    s_cbranch_scc1 Lnts_37
    s_mov_b32 s48, s28
    s_mov_b32 s49, s29
    s_mov_b32 s50, s30
    s_mov_b32 s51, s31
    s_cmp_lg_u32 s17, 1
    s_cbranch_scc1 Ls1s_38
    v_lshrrev_b32 v53, 16, v70
    v_cndmask_b32 v53, v53, 1.0, s[8:9]
    v_cndmask_b32 v20, 0, v53, s[90:91]
    v_cndmask_b32 v21, 0, v53, s[92:93]
    v_cndmask_b32 v22, 0, v53, s[94:95]
    v_cndmask_b32 v23, 0, v53, s[96:97]
Ls1s_38:
    s_mov_b32 s19, 0
Lrps_28:
    buffer_load_dwordx4 v[0:3], v64, s[4:7], s28 offen sc1
    buffer_load_dwordx4 v[4:7], v64, s[4:7], s29 offen sc1
    buffer_load_dwordx4 v[8:11], v64, s[4:7], s30 offen sc1
    buffer_load_dwordx4 v[12:15], v64, s[4:7], s31 offen sc1
    s_waitcnt vmcnt(3)
    v_mfma_f32_16x16x32_bf16 v[16:19], v[0:3], v[20:23], 0
    s_waitcnt vmcnt(2)
    v_mfma_f32_16x16x32_bf16 v[16:19], v[4:7], v[20:23], v[16:19]
    s_waitcnt vmcnt(1)
    v_mfma_f32_16x16x32_bf16 v[16:19], v[8:11], v[20:23], v[16:19]
    v_max3_u32 v52, v0, v4, v8
    s_waitcnt vmcnt(0)
    v_mfma_f32_16x16x32_bf16 v[16:19], v[12:15], v[20:23], v[16:19]
    v_max_u32 v52, v52, v12
    v_cmp_eq_u32 vcc, -1, v52
    s_cbranch_vccz Lroks_29
    s_add_u32 s19, s19, 1
    s_cmp_lt_u32 s19, 262144
    s_cbranch_scc1 Lrps_28
    s_branch Lchain_fail
Lroks_29:
    v_mov_b32 v52, -1
    v_permlane32_swap_b32 v16, v18
    v_permlane32_swap_b32 v17, v19
    v_add_f32 v16, v16, v18
    v_add_f32 v17, v17, v19
    v_cvt_pk_bf16_f32 v16, v16, v17
    buffer_store_dword v16, v65, s[4:7], s22 offen sc1
    buffer_store_dword v52, v65, s[4:7], s23 offen sc1
    s_xor_b32 s28, s28, 524288
    s_xor_b32 s29, s29, 524288
    s_xor_b32 s30, s30, 524288
    s_xor_b32 s31, s31, 524288
    s_branch Lnoreds_27
Lnts_37:
Lnoreds_27:
    s_barrier
    s_branch Lsteps_24
Lfbs_30:
    v_max3_f32 v26, v16, v17, v18
    v_max3_f32 v26, v26, v19, v52
    v_max3_f32 v26, v26, v53, v54
    v_max_f32 v26, v26, v55
    s_nop 1
    v_max_f32_dpp v26, v26, v26 row_ror:8 row_mask:0xf bank_mask:0xf
    v_mov_b32 v27, v26
    s_nop 1
    v_permlane16_swap_b32 v27, v26
    v_max_f32 v26, v26, v27
    v_mov_b32 v27, v26
    s_nop 1
    v_permlane32_swap_b32 v27, v26
    v_max_f32 v26, v26, v27
    v_sub_f32 v16, v16, v26
    v_sub_f32 v52, v52, v26
    v_sub_f32 v17, v17, v26
    v_sub_f32 v53, v53, v26
    v_sub_f32 v18, v18, v26
    v_sub_f32 v54, v54, v26
    v_sub_f32 v19, v19, v26
    v_sub_f32 v55, v55, v26
    s_nop 1
    s_branch Lexps_31
Ldones_26:
    s_waitcnt vmcnt(0) lgkmcnt(0)
    s_barrier
    v_mov_b32 v54, 64
    buffer_store_dword v54, v65, s[4:7], s59 offen sc1
    s_waitcnt vmcnt(0)
    s_branch Lexit
Lworker:
    s_sub_u32 s64, s21, 32
    s_mov_b32 s63, 1431655766
    s_cmp_eq_u32 s89, 1
    s_cbranch_scc1 Lnorm
    s_mov_b32 s20, s64
    v_and_b32 v1, 63, v0
    v_lshlrev_b32 v2, 2, v1
    v_mov_b32 v3, 0
    s_mul_i32 s21, s20, 1280
    s_add_u32 s21, s21, 1572864
    s_cmp_lg_u32 s17, 0
    s_cbranch_scc1 Lzb
    buffer_store_dword v3, v2, s[4:7], s21 offen offset:0 sc1
    buffer_store_dword v3, v2, s[4:7], s21 offen offset:256 sc1
    buffer_store_dword v3, v2, s[4:7], s21 offen offset:512 sc1
    buffer_store_dword v3, v2, s[4:7], s21 offen offset:768 sc1
    buffer_store_dword v3, v2, s[4:7], s21 offen offset:1024 sc1
Lzb:
    s_mul_i32 s50, s20, 9
    s_min_u32 s21, s20, 32
    s_add_u32 s50, s50, s21
    s_cmp_lt_u32 s20, 32
    s_cselect_b32 s49, 10, 9
    s_load_dwordx2 s[8:9], s[0:1], 0
    s_load_dwordx2 s[12:13], s[0:1], 80
    s_waitcnt lgkmcnt(0)
    s_mov_b32 s10, 2359296
    s_mov_b32 s11, 0x20000
    s_mov_b32 s14, 2359296
    s_mov_b32 s15, 0x20000
    v_and_b32 v1, 63, v0
    v_cmp_gt_u32 vcc, 36, v1
    v_lshlrev_b32 v2, 4, v1
    v_mov_b32 v3, 0x40000000
    v_cndmask_b32 v2, v3, v2, vcc
    v_mov_b32 v4, v2
    s_mov_b64 s[60:61], vcc
    s_add_u32 s51, s17, 0
    s_add_u32 s59, s51, s50
    s_mul_i32 s52, s59, 1152
    s_mul_i32 s55, s59, 2304
    s_cmp_lt_u32 s51, s49
    s_cselect_b32 s52, s52, 0x40000000
    s_cselect_b32 s55, s55, 0x40000000
    s_add_u32 s51, s17, 4
    s_add_u32 s59, s51, s50
    s_mul_i32 s53, s59, 1152
    s_mul_i32 s56, s59, 2304
    s_cmp_lt_u32 s51, s49
    s_cselect_b32 s53, s53, 0x40000000
    s_cselect_b32 s56, s56, 0x40000000
    s_add_u32 s51, s17, 8
    s_add_u32 s59, s51, s50
    s_mul_i32 s54, s59, 1152
    s_mul_i32 s57, s59, 2304
    s_cmp_lt_u32 s51, s49
    s_cselect_b32 s54, s54, 0x40000000
    s_cselect_b32 s57, s57, 0x40000000
    buffer_load_dwordx4 v[48:51], v2, s[8:11], s52 offen
    buffer_load_dwordx4 v[52:55], v2, s[8:11], s52 offen offset:576
    buffer_load_dwordx4 v[96:99], v2, s[8:11], s53 offen
    buffer_load_dwordx4 v[100:103], v2, s[8:11], s53 offen offset:576
    buffer_load_dwordx4 v[144:147], v2, s[8:11], s54 offen
    buffer_load_dwordx4 v[148:151], v2, s[8:11], s54 offen offset:576
    s_waitcnt vmcnt(0)
    v_lshlrev_b32 v16, 16, v48
    v_and_b32 v17, 0xffff0000, v48
    v_lshlrev_b32 v18, 16, v49
    v_and_b32 v19, 0xffff0000, v49
    v_lshlrev_b32 v20, 16, v50
    v_and_b32 v21, 0xffff0000, v50
    v_lshlrev_b32 v22, 16, v51
    v_and_b32 v23, 0xffff0000, v51
    v_lshlrev_b32 v24, 16, v52
    v_and_b32 v25, 0xffff0000, v52
    v_lshlrev_b32 v26, 16, v53
    v_and_b32 v27, 0xffff0000, v53
    v_lshlrev_b32 v28, 16, v54
    v_and_b32 v29, 0xffff0000, v54
    v_lshlrev_b32 v30, 16, v55
    v_and_b32 v31, 0xffff0000, v55
    v_add_f32 v5, v16, v17
    v_add_f32 v5, v5, v18
    v_add_f32 v5, v5, v19
    v_add_f32 v5, v5, v20
    v_add_f32 v5, v5, v21
    v_add_f32 v5, v5, v22
    v_add_f32 v5, v5, v23
    v_add_f32 v5, v5, v24
    v_add_f32 v5, v5, v25
    v_add_f32 v5, v5, v26
    v_add_f32 v5, v5, v27
    v_add_f32 v5, v5, v28
    v_add_f32 v5, v5, v29
    v_add_f32 v5, v5, v30
    v_add_f32 v5, v5, v31
    s_nop 1
    v_add_f32_dpp v5, v5, v5 row_ror:1 row_mask:0xf bank_mask:0xf
    s_nop 1
    v_add_f32_dpp v5, v5, v5 row_ror:2 row_mask:0xf bank_mask:0xf
    s_nop 1
    v_add_f32_dpp v5, v5, v5 row_ror:4 row_mask:0xf bank_mask:0xf
    s_nop 1
    v_add_f32_dpp v5, v5, v5 row_ror:8 row_mask:0xf bank_mask:0xf
    v_mov_b32 v6, v5
    s_nop 1
    v_permlane16_swap_b32 v6, v5
    v_add_f32 v5, v5, v6
    v_mov_b32 v6, v5
    s_nop 1
    v_permlane32_swap_b32 v6, v5
    v_add_f32 v5, v5, v6
    v_mul_f32 v5, 0x3ae38e39, v5
    v_sub_f32 v32, v16, v5
    v_sub_f32 v33, v17, v5
    v_sub_f32 v34, v18, v5
    v_sub_f32 v35, v19, v5
    v_sub_f32 v36, v20, v5
    v_sub_f32 v37, v21, v5
    v_sub_f32 v38, v22, v5
    v_sub_f32 v39, v23, v5
    v_sub_f32 v40, v24, v5
    v_sub_f32 v41, v25, v5
    v_sub_f32 v42, v26, v5
    v_sub_f32 v43, v27, v5
    v_sub_f32 v44, v28, v5
    v_sub_f32 v45, v29, v5
    v_sub_f32 v46, v30, v5
    v_sub_f32 v47, v31, v5
    v_mul_f32 v6, v32, v32
    v_fmac_f32 v6, v33, v33
    v_fmac_f32 v6, v34, v34
    v_fmac_f32 v6, v35, v35
    v_fmac_f32 v6, v36, v36
    v_fmac_f32 v6, v37, v37
    v_fmac_f32 v6, v38, v38
    v_fmac_f32 v6, v39, v39
    v_fmac_f32 v6, v40, v40
    v_fmac_f32 v6, v41, v41
    v_fmac_f32 v6, v42, v42
    v_fmac_f32 v6, v43, v43
    v_fmac_f32 v6, v44, v44
    v_fmac_f32 v6, v45, v45
    v_fmac_f32 v6, v46, v46
    v_fmac_f32 v6, v47, v47
    v_cndmask_b32 v6, 0, v6, s[60:61]
    s_nop 1
    v_add_f32_dpp v6, v6, v6 row_ror:1 row_mask:0xf bank_mask:0xf
    s_nop 1
    v_add_f32_dpp v6, v6, v6 row_ror:2 row_mask:0xf bank_mask:0xf
    s_nop 1
    v_add_f32_dpp v6, v6, v6 row_ror:4 row_mask:0xf bank_mask:0xf
    s_nop 1
    v_add_f32_dpp v6, v6, v6 row_ror:8 row_mask:0xf bank_mask:0xf
    v_mov_b32 v7, v6
    s_nop 1
    v_permlane16_swap_b32 v7, v6
    v_add_f32 v6, v6, v7
    v_mov_b32 v7, v6
    s_nop 1
    v_permlane32_swap_b32 v7, v6
    v_add_f32 v6, v6, v7
    v_mov_b32 v7, 0x3727c5ac
    v_fmac_f32 v7, 0x3ae38e39, v6
    v_rsq_f32 v7, v7
    s_nop 0
    v_mul_f32 v32, v32, v7
    v_mul_f32 v33, v33, v7
    v_mul_f32 v34, v34, v7
    v_mul_f32 v35, v35, v7
    v_mul_f32 v36, v36, v7
    v_mul_f32 v37, v37, v7
    v_mul_f32 v38, v38, v7
    v_mul_f32 v39, v39, v7
    v_mul_f32 v40, v40, v7
    v_mul_f32 v41, v41, v7
    v_mul_f32 v42, v42, v7
    v_mul_f32 v43, v43, v7
    v_mul_f32 v44, v44, v7
    v_mul_f32 v45, v45, v7
    v_mul_f32 v46, v46, v7
    v_mul_f32 v47, v47, v7
    v_cvt_pk_bf16_f32 v48, v32, v33
    v_cvt_pk_bf16_f32 v49, v34, v35
    v_cvt_pk_bf16_f32 v50, v36, v37
    v_cvt_pk_bf16_f32 v51, v38, v39
    v_cvt_pk_bf16_f32 v52, v40, v41
    v_cvt_pk_bf16_f32 v53, v42, v43
    v_cvt_pk_bf16_f32 v54, v44, v45
    v_cvt_pk_bf16_f32 v55, v46, v47
    s_add_u32 s58, s52, 2097152
    buffer_store_dwordx4 v[48:51], v2, s[4:7], s58 offen sc1
    buffer_store_dwordx4 v[52:55], v2, s[4:7], s58 offen offset:576 sc1
    v_lshlrev_b32 v64, 16, v96
    v_and_b32 v65, 0xffff0000, v96
    v_lshlrev_b32 v66, 16, v97
    v_and_b32 v67, 0xffff0000, v97
    v_lshlrev_b32 v68, 16, v98
    v_and_b32 v69, 0xffff0000, v98
    v_lshlrev_b32 v70, 16, v99
    v_and_b32 v71, 0xffff0000, v99
    v_lshlrev_b32 v72, 16, v100
    v_and_b32 v73, 0xffff0000, v100
    v_lshlrev_b32 v74, 16, v101
    v_and_b32 v75, 0xffff0000, v101
    v_lshlrev_b32 v76, 16, v102
    v_and_b32 v77, 0xffff0000, v102
    v_lshlrev_b32 v78, 16, v103
    v_and_b32 v79, 0xffff0000, v103
    v_add_f32 v5, v64, v65
    v_add_f32 v5, v5, v66
    v_add_f32 v5, v5, v67
    v_add_f32 v5, v5, v68
    v_add_f32 v5, v5, v69
    v_add_f32 v5, v5, v70
    v_add_f32 v5, v5, v71
    v_add_f32 v5, v5, v72
    v_add_f32 v5, v5, v73
    v_add_f32 v5, v5, v74
    v_add_f32 v5, v5, v75
    v_add_f32 v5, v5, v76
    v_add_f32 v5, v5, v77
    v_add_f32 v5, v5, v78
    v_add_f32 v5, v5, v79
    s_nop 1
    v_add_f32_dpp v5, v5, v5 row_ror:1 row_mask:0xf bank_mask:0xf
    s_nop 1
    v_add_f32_dpp v5, v5, v5 row_ror:2 row_mask:0xf bank_mask:0xf
    s_nop 1
    v_add_f32_dpp v5, v5, v5 row_ror:4 row_mask:0xf bank_mask:0xf
    s_nop 1
    v_add_f32_dpp v5, v5, v5 row_ror:8 row_mask:0xf bank_mask:0xf
    v_mov_b32 v6, v5
    s_nop 1
    v_permlane16_swap_b32 v6, v5
    v_add_f32 v5, v5, v6
    v_mov_b32 v6, v5
    s_nop 1
    v_permlane32_swap_b32 v6, v5
    v_add_f32 v5, v5, v6
    v_mul_f32 v5, 0x3ae38e39, v5
    v_sub_f32 v80, v64, v5
    v_sub_f32 v81, v65, v5
    v_sub_f32 v82, v66, v5
    v_sub_f32 v83, v67, v5
    v_sub_f32 v84, v68, v5
    v_sub_f32 v85, v69, v5
    v_sub_f32 v86, v70, v5
    v_sub_f32 v87, v71, v5
    v_sub_f32 v88, v72, v5
    v_sub_f32 v89, v73, v5
    v_sub_f32 v90, v74, v5
    v_sub_f32 v91, v75, v5
    v_sub_f32 v92, v76, v5
    v_sub_f32 v93, v77, v5
    v_sub_f32 v94, v78, v5
    v_sub_f32 v95, v79, v5
    v_mul_f32 v6, v80, v80
    v_fmac_f32 v6, v81, v81
    v_fmac_f32 v6, v82, v82
    v_fmac_f32 v6, v83, v83
    v_fmac_f32 v6, v84, v84
    v_fmac_f32 v6, v85, v85
    v_fmac_f32 v6, v86, v86
    v_fmac_f32 v6, v87, v87
    v_fmac_f32 v6, v88, v88
    v_fmac_f32 v6, v89, v89
    v_fmac_f32 v6, v90, v90
    v_fmac_f32 v6, v91, v91
    v_fmac_f32 v6, v92, v92
    v_fmac_f32 v6, v93, v93
    v_fmac_f32 v6, v94, v94
    v_fmac_f32 v6, v95, v95
    v_cndmask_b32 v6, 0, v6, s[60:61]
    s_nop 1
    v_add_f32_dpp v6, v6, v6 row_ror:1 row_mask:0xf bank_mask:0xf
    s_nop 1
    v_add_f32_dpp v6, v6, v6 row_ror:2 row_mask:0xf bank_mask:0xf
    s_nop 1
    v_add_f32_dpp v6, v6, v6 row_ror:4 row_mask:0xf bank_mask:0xf
    s_nop 1
    v_add_f32_dpp v6, v6, v6 row_ror:8 row_mask:0xf bank_mask:0xf
    v_mov_b32 v7, v6
    s_nop 1
    v_permlane16_swap_b32 v7, v6
    v_add_f32 v6, v6, v7
    v_mov_b32 v7, v6
    s_nop 1
    v_permlane32_swap_b32 v7, v6
    v_add_f32 v6, v6, v7
    v_mov_b32 v7, 0x3727c5ac
    v_fmac_f32 v7, 0x3ae38e39, v6
    v_rsq_f32 v7, v7
    s_nop 0
    v_mul_f32 v80, v80, v7
    v_mul_f32 v81, v81, v7
    v_mul_f32 v82, v82, v7
    v_mul_f32 v83, v83, v7
    v_mul_f32 v84, v84, v7
    v_mul_f32 v85, v85, v7
    v_mul_f32 v86, v86, v7
    v_mul_f32 v87, v87, v7
    v_mul_f32 v88, v88, v7
    v_mul_f32 v89, v89, v7
    v_mul_f32 v90, v90, v7
    v_mul_f32 v91, v91, v7
    v_mul_f32 v92, v92, v7
    v_mul_f32 v93, v93, v7
    v_mul_f32 v94, v94, v7
    v_mul_f32 v95, v95, v7
    v_cvt_pk_bf16_f32 v96, v80, v81
    v_cvt_pk_bf16_f32 v97, v82, v83
    v_cvt_pk_bf16_f32 v98, v84, v85
    v_cvt_pk_bf16_f32 v99, v86, v87
    v_cvt_pk_bf16_f32 v100, v88, v89
    v_cvt_pk_bf16_f32 v101, v90, v91
    v_cvt_pk_bf16_f32 v102, v92, v93
    v_cvt_pk_bf16_f32 v103, v94, v95
    s_add_u32 s58, s53, 2097152
    buffer_store_dwordx4 v[96:99], v2, s[4:7], s58 offen sc1
    buffer_store_dwordx4 v[100:103], v2, s[4:7], s58 offen offset:576 sc1
    v_lshlrev_b32 v112, 16, v144
    v_and_b32 v113, 0xffff0000, v144
    v_lshlrev_b32 v114, 16, v145
    v_and_b32 v115, 0xffff0000, v145
    v_lshlrev_b32 v116, 16, v146
    v_and_b32 v117, 0xffff0000, v146
    v_lshlrev_b32 v118, 16, v147
    v_and_b32 v119, 0xffff0000, v147
    v_lshlrev_b32 v120, 16, v148
    v_and_b32 v121, 0xffff0000, v148
    v_lshlrev_b32 v122, 16, v149
    v_and_b32 v123, 0xffff0000, v149
    v_lshlrev_b32 v124, 16, v150
    v_and_b32 v125, 0xffff0000, v150
    v_lshlrev_b32 v126, 16, v151
    v_and_b32 v127, 0xffff0000, v151
    v_add_f32 v5, v112, v113
    v_add_f32 v5, v5, v114
    v_add_f32 v5, v5, v115
    v_add_f32 v5, v5, v116
    v_add_f32 v5, v5, v117
    v_add_f32 v5, v5, v118
    v_add_f32 v5, v5, v119
    v_add_f32 v5, v5, v120
    v_add_f32 v5, v5, v121
    v_add_f32 v5, v5, v122
    v_add_f32 v5, v5, v123
    v_add_f32 v5, v5, v124
    v_add_f32 v5, v5, v125
    v_add_f32 v5, v5, v126
    v_add_f32 v5, v5, v127
    s_nop 1
    v_add_f32_dpp v5, v5, v5 row_ror:1 row_mask:0xf bank_mask:0xf
    s_nop 1
    v_add_f32_dpp v5, v5, v5 row_ror:2 row_mask:0xf bank_mask:0xf
    s_nop 1
    v_add_f32_dpp v5, v5, v5 row_ror:4 row_mask:0xf bank_mask:0xf
    s_nop 1
    v_add_f32_dpp v5, v5, v5 row_ror:8 row_mask:0xf bank_mask:0xf
    v_mov_b32 v6, v5
    s_nop 1
    v_permlane16_swap_b32 v6, v5
    v_add_f32 v5, v5, v6
    v_mov_b32 v6, v5
    s_nop 1
    v_permlane32_swap_b32 v6, v5
    v_add_f32 v5, v5, v6
    v_mul_f32 v5, 0x3ae38e39, v5
    v_sub_f32 v128, v112, v5
    v_sub_f32 v129, v113, v5
    v_sub_f32 v130, v114, v5
    v_sub_f32 v131, v115, v5
    v_sub_f32 v132, v116, v5
    v_sub_f32 v133, v117, v5
    v_sub_f32 v134, v118, v5
    v_sub_f32 v135, v119, v5
    v_sub_f32 v136, v120, v5
    v_sub_f32 v137, v121, v5
    v_sub_f32 v138, v122, v5
    v_sub_f32 v139, v123, v5
    v_sub_f32 v140, v124, v5
    v_sub_f32 v141, v125, v5
    v_sub_f32 v142, v126, v5
    v_sub_f32 v143, v127, v5
    v_mul_f32 v6, v128, v128
    v_fmac_f32 v6, v129, v129
    v_fmac_f32 v6, v130, v130
    v_fmac_f32 v6, v131, v131
    v_fmac_f32 v6, v132, v132
    v_fmac_f32 v6, v133, v133
    v_fmac_f32 v6, v134, v134
    v_fmac_f32 v6, v135, v135
    v_fmac_f32 v6, v136, v136
    v_fmac_f32 v6, v137, v137
    v_fmac_f32 v6, v138, v138
    v_fmac_f32 v6, v139, v139
    v_fmac_f32 v6, v140, v140
    v_fmac_f32 v6, v141, v141
    v_fmac_f32 v6, v142, v142
    v_fmac_f32 v6, v143, v143
    v_cndmask_b32 v6, 0, v6, s[60:61]
    s_nop 1
    v_add_f32_dpp v6, v6, v6 row_ror:1 row_mask:0xf bank_mask:0xf
    s_nop 1
    v_add_f32_dpp v6, v6, v6 row_ror:2 row_mask:0xf bank_mask:0xf
    s_nop 1
    v_add_f32_dpp v6, v6, v6 row_ror:4 row_mask:0xf bank_mask:0xf
    s_nop 1
    v_add_f32_dpp v6, v6, v6 row_ror:8 row_mask:0xf bank_mask:0xf
    v_mov_b32 v7, v6
    s_nop 1
    v_permlane16_swap_b32 v7, v6
    v_add_f32 v6, v6, v7
    v_mov_b32 v7, v6
    s_nop 1
    v_permlane32_swap_b32 v7, v6
    v_add_f32 v6, v6, v7
    v_mov_b32 v7, 0x3727c5ac
    v_fmac_f32 v7, 0x3ae38e39, v6
    v_rsq_f32 v7, v7
    s_nop 0
    v_mul_f32 v128, v128, v7
    v_mul_f32 v129, v129, v7
    v_mul_f32 v130, v130, v7
    v_mul_f32 v131, v131, v7
    v_mul_f32 v132, v132, v7
    v_mul_f32 v133, v133, v7
    v_mul_f32 v134, v134, v7
    v_mul_f32 v135, v135, v7
    v_mul_f32 v136, v136, v7
    v_mul_f32 v137, v137, v7
    v_mul_f32 v138, v138, v7
    v_mul_f32 v139, v139, v7
    v_mul_f32 v140, v140, v7
    v_mul_f32 v141, v141, v7
    v_mul_f32 v142, v142, v7
    v_mul_f32 v143, v143, v7
    v_cvt_pk_bf16_f32 v144, v128, v129
    v_cvt_pk_bf16_f32 v145, v130, v131
    v_cvt_pk_bf16_f32 v146, v132, v133
    v_cvt_pk_bf16_f32 v147, v134, v135
    v_cvt_pk_bf16_f32 v148, v136, v137
    v_cvt_pk_bf16_f32 v149, v138, v139
    v_cvt_pk_bf16_f32 v150, v140, v141
    v_cvt_pk_bf16_f32 v151, v142, v143
    s_add_u32 s58, s54, 2097152
    buffer_store_dwordx4 v[144:147], v2, s[4:7], s58 offen sc1
    buffer_store_dwordx4 v[148:151], v2, s[4:7], s58 offen offset:576 sc1
    s_load_dwordx2 s[12:13], s[0:1], 88
    s_waitcnt lgkmcnt(0)
    s_mov_b32 s14, 256
    s_mov_b32 s15, 0x20000
    s_waitcnt vmcnt(0)
    s_barrier
    s_cmp_lg_u32 s17, 0
    s_cbranch_scc1 Lzzb
    s_mov_b64 exec, 1
    v_mov_b32 v4, 1
    s_add_u32 s21, s88, 12
    v_mov_b32 v5, s21
    buffer_atomic_add v4, v5, s[12:15], 0 offen
    s_mov_b64 exec, -1
Lzzb:
Lnorm:
    s_cmp_ge_u32 s64, 192
    s_cbranch_scc1 Lqkv_done
    s_cmp_ge_u32 s64, 96
    s_cselect_b32 s65, 4, 0
    s_cselect_b32 s20, 96, 0
    s_sub_u32 s20, s64, s20
    s_lshr_b32 s78, s20, 5
    s_and_b32 s79, s20, 31
    s_cmp_lg_u32 s78, 0
    s_cbranch_scc1 Lqs1e
    s_load_dwordx2 s[12:13], s[0:1], 24
    s_waitcnt lgkmcnt(0)
    s_mov_b32 s14, 4718592
    s_mov_b32 s15, 0x20000
    s_lshl_b32 s26, s79, 8
    s_mov_b32 s27, 8192
    s_cmp_eq_u32 s65, 0
    s_cbranch_scc1 Ldl_39
    s_load_dwordx2 s[12:13], s[0:1], 88
    s_waitcnt lgkmcnt(0)
    s_mov_b32 s14, 256
    s_mov_b32 s15, 0x20000
    s_cmp_lg_u32 s17, 0
    s_cbranch_scc1 Llw1p0
    s_mov_b32 s19, 0
    v_and_b32 v1, 63, v0
    v_lshlrev_b32 v2, 2, v1
Llw0p0:
    buffer_load_dword v3, v2, s[12:15], 0 offen sc1
    s_waitcnt vmcnt(0)
    s_mov_b32 s20, 0
    s_mov_b32 s21, 0
    v_readlane_b32 s22, v3, 2
    s_nop 2
    s_add_u32 s20, s20, s22
    v_readlane_b32 s22, v3, 3
    s_nop 2
    s_add_u32 s21, s21, s22
    v_readlane_b32 s22, v3, 18
    s_nop 2
    s_add_u32 s20, s20, s22
    v_readlane_b32 s22, v3, 19
    s_nop 2
    s_add_u32 s21, s21, s22
    v_readlane_b32 s22, v3, 34
    s_nop 2
    s_add_u32 s20, s20, s22
    v_readlane_b32 s22, v3, 35
    s_nop 2
    s_add_u32 s21, s21, s22
    v_readlane_b32 s22, v3, 50
    s_nop 2
    s_add_u32 s20, s20, s22
    v_readlane_b32 s22, v3, 51
    s_nop 2
    s_add_u32 s21, s21, s22
    s_cmp_ge_u32 s20, s90
    s_cselect_b32 s22, s21, 0
    s_cmp_eq_u32 s89, 1
    s_cselect_b32 s20, s20, s22
    s_cmp_ge_u32 s20, 224
    s_cbranch_scc1 Llw1p0
    s_sleep 12
    s_add_u32 s19, s19, 1
    s_cmp_lt_u32 s19, 524288
    s_cbranch_scc1 Llw0p0
    s_branch Lfail
Llw1p0:
    s_barrier
    s_lshl_b32 s67, s79, 2
    s_add_u32 s67, s67, 1581056
    s_cmp_lg_u32 s17, 0
    s_cbranch_scc1 Lw_42
    s_mov_b64 exec, 1
    v_mov_b32 v2, 0
    s_mov_b32 s70, 0
Lw_40:
    buffer_load_dword v3, v2, s[4:7], s67 offen sc1
    s_waitcnt vmcnt(0)
    v_readfirstlane_b32 s69, v3
    s_nop 2
    s_and_b32 s69, s69, 255
    s_cmp_ge_u32 s69, 2
    s_cbranch_scc1 Lw_41
    s_sleep 40
    s_add_u32 s70, s70, 1
    s_cmp_lt_u32 s70, 524288
    s_cbranch_scc1 Lw_40
    s_branch Lfail
Lw_41:
    s_mov_b64 exec, -1
Lw_42:
    s_barrier
    s_load_dwordx2 s[12:13], s[0:1], 24
    s_waitcnt lgkmcnt(0)
    s_mov_b32 s14, 4718592
    s_mov_b32 s15, 0x20000
Ldl_39:
    v_and_b32 v1, 63, v0
    v_lshrrev_b32 v2, 3, v1
    v_mul_lo_u32 v2, v2, s27
    v_and_b32 v3, 7, v1
    v_bfe_u32 v4, v1, 4, 1
    v_lshlrev_b32 v4, 2, v4
    v_xor_b32 v3, v3, v4
    v_lshlrev_b32 v3, 4, v3
    v_add_u32 v19, v2, v3
    v_lshrrev_b32 v2, 4, v1
    v_lshlrev_b32 v2, 3, v2
    v_bfe_u32 v3, v1, 2, 2
    v_add_u32 v2, v2, v3
    v_lshlrev_b32 v2, 7, v2
    v_and_b32 v4, 3, v1
    v_lshlrev_b32 v4, 3, v4
    v_add_u32 v2, v2, v4
    v_bfe_u32 v3, v1, 3, 1
    v_lshlrev_b32 v3, 6, v3
    s_mul_i32 s36, s17, 32
    s_add_u32 s36, s36, 0
    s_lshr_b32 s37, s36, 5
    s_and_b32 s37, s37, 1
    s_lshl_b32 s37, s37, 6
    v_xor_b32 v4, s37, v3
    v_add_u32 v4, v4, v2
    s_lshr_b32 s37, s36, 6
    s_lshl_b32 s37, s37, 13
    s_and_b32 s34, s36, 16
    s_lshl_b32 s34, s34, 1
    s_add_u32 s37, s37, s34
    v_add_u32 v16, s37, v4
    s_mul_i32 s36, s17, 32
    s_add_u32 s36, s36, 16
    s_lshr_b32 s37, s36, 5
    s_and_b32 s37, s37, 1
    s_lshl_b32 s37, s37, 6
    v_xor_b32 v4, s37, v3
    v_add_u32 v4, v4, v2
    s_lshr_b32 s37, s36, 6
    s_lshl_b32 s37, s37, 13
    s_and_b32 s34, s36, 16
    s_lshl_b32 s34, s34, 1
    s_add_u32 s37, s37, s34
    v_add_u32 v17, s37, v4
    s_lshl_b32 s36, s17, 3
    s_add_u32 s36, s36, 0
    s_mul_i32 s39, s36, s27
    s_add_u32 s39, s39, s26
    s_lshl_b32 s34, s17, 10
    s_add_u32 s34, s34, 0
    s_lshl_b32 s37, s27, 5
    s_mov_b32 m0, s34
    s_nop 0
    buffer_load_dwordx4 v19, s[12:15], s39 offen lds
    s_add_u32 s34, s34, 4096
    s_add_u32 s39, s39, s37
    s_mov_b32 m0, s34
    s_nop 0
    buffer_load_dwordx4 v19, s[12:15], s39 offen lds
    s_add_u32 s34, s34, 4096
    s_sub_u32 s39, s39, s37
    s_add_u32 s39, s39, 128
    s_mov_b32 m0, s34
    s_nop 0
    buffer_load_dwordx4 v19, s[12:15], s39 offen lds
    s_add_u32 s34, s34, 4096
    s_add_u32 s39, s39, s37
    s_mov_b32 m0, s34
    s_nop 0
    buffer_load_dwordx4 v19, s[12:15], s39 offen lds
    s_lshl_b32 s36, s17, 3
    s_add_u32 s36, s36, 64
    s_mul_i32 s39, s36, s27
    s_add_u32 s39, s39, s26
    s_lshl_b32 s34, s17, 10
    s_add_u32 s34, s34, 16384
    s_lshl_b32 s37, s27, 5
    s_mov_b32 m0, s34
    s_nop 0
    buffer_load_dwordx4 v19, s[12:15], s39 offen lds
    s_add_u32 s34, s34, 4096
    s_add_u32 s39, s39, s37
    s_mov_b32 m0, s34
    s_nop 0
    buffer_load_dwordx4 v19, s[12:15], s39 offen lds
    s_add_u32 s34, s34, 4096
    s_sub_u32 s39, s39, s37
    s_add_u32 s39, s39, 128
    s_mov_b32 m0, s34
    s_nop 0
    buffer_load_dwordx4 v19, s[12:15], s39 offen lds
    s_add_u32 s34, s34, 4096
    s_add_u32 s39, s39, s37
    s_mov_b32 m0, s34
    s_nop 0
    buffer_load_dwordx4 v19, s[12:15], s39 offen lds
    s_lshl_b32 s36, s17, 3
    s_add_u32 s36, s36, 128
    s_mul_i32 s39, s36, s27
    s_add_u32 s39, s39, s26
    s_lshl_b32 s34, s17, 10
    s_add_u32 s34, s34, 32768
    s_lshl_b32 s37, s27, 5
    s_mov_b32 m0, s34
    s_nop 0
    buffer_load_dwordx4 v19, s[12:15], s39 offen lds
    s_add_u32 s34, s34, 4096
    s_add_u32 s39, s39, s37
    s_mov_b32 m0, s34
    s_nop 0
    buffer_load_dwordx4 v19, s[12:15], s39 offen lds
    s_add_u32 s34, s34, 4096
    s_sub_u32 s39, s39, s37
    s_add_u32 s39, s39, 128
    s_mov_b32 m0, s34
    s_nop 0
    buffer_load_dwordx4 v19, s[12:15], s39 offen lds
    s_add_u32 s34, s34, 4096
    s_add_u32 s39, s39, s37
    s_mov_b32 m0, s34
    s_nop 0
    buffer_load_dwordx4 v19, s[12:15], s39 offen lds
    s_lshl_b32 s36, s17, 3
    s_add_u32 s36, s36, 192
    s_mul_i32 s39, s36, s27
    s_add_u32 s39, s39, s26
    s_lshl_b32 s34, s17, 10
    s_add_u32 s34, s34, 49152
    s_lshl_b32 s37, s27, 5
    s_mov_b32 m0, s34
    s_nop 0
    buffer_load_dwordx4 v19, s[12:15], s39 offen lds
    s_add_u32 s34, s34, 4096
    s_add_u32 s39, s39, s37
    s_mov_b32 m0, s34
    s_nop 0
    buffer_load_dwordx4 v19, s[12:15], s39 offen lds
    s_add_u32 s34, s34, 4096
    s_sub_u32 s39, s39, s37
    s_add_u32 s39, s39, 128
    s_mov_b32 m0, s34
    s_nop 0
    buffer_load_dwordx4 v19, s[12:15], s39 offen lds
    s_add_u32 s34, s34, 4096
    s_add_u32 s39, s39, s37
    s_mov_b32 m0, s34
    s_nop 0
    buffer_load_dwordx4 v19, s[12:15], s39 offen lds
    s_lshl_b32 s36, s17, 3
    s_add_u32 s36, s36, 256
    s_mul_i32 s39, s36, s27
    s_add_u32 s39, s39, s26
    s_lshl_b32 s34, s17, 10
    s_add_u32 s34, s34, 65536
    s_lshl_b32 s37, s27, 5
    s_mov_b32 m0, s34
    s_nop 0
    buffer_load_dwordx4 v19, s[12:15], s39 offen lds
    s_add_u32 s34, s34, 4096
    s_add_u32 s39, s39, s37
    s_mov_b32 m0, s34
    s_nop 0
    buffer_load_dwordx4 v19, s[12:15], s39 offen lds
    s_add_u32 s34, s34, 4096
    s_sub_u32 s39, s39, s37
    s_add_u32 s39, s39, 128
    s_mov_b32 m0, s34
    s_nop 0
    buffer_load_dwordx4 v19, s[12:15], s39 offen lds
    s_add_u32 s34, s34, 4096
    s_add_u32 s39, s39, s37
    s_mov_b32 m0, s34
    s_nop 0
    buffer_load_dwordx4 v19, s[12:15], s39 offen lds
    s_lshl_b32 s36, s17, 3
    s_add_u32 s36, s36, 320
    s_mul_i32 s39, s36, s27
    s_add_u32 s39, s39, s26
    s_lshl_b32 s34, s17, 10
    s_add_u32 s34, s34, 81920
    s_lshl_b32 s37, s27, 5
    s_mov_b32 m0, s34
    s_nop 0
    buffer_load_dwordx4 v19, s[12:15], s39 offen lds
    s_add_u32 s34, s34, 4096
    s_add_u32 s39, s39, s37
    s_mov_b32 m0, s34
    s_nop 0
    buffer_load_dwordx4 v19, s[12:15], s39 offen lds
    s_add_u32 s34, s34, 4096
    s_sub_u32 s39, s39, s37
    s_add_u32 s39, s39, 128
    s_mov_b32 m0, s34
    s_nop 0
    buffer_load_dwordx4 v19, s[12:15], s39 offen lds
    s_add_u32 s34, s34, 4096
    s_add_u32 s39, s39, s37
    s_mov_b32 m0, s34
    s_nop 0
    buffer_load_dwordx4 v19, s[12:15], s39 offen lds
    s_lshl_b32 s36, s17, 3
    s_add_u32 s36, s36, 384
    s_mul_i32 s39, s36, s27
    s_add_u32 s39, s39, s26
    s_lshl_b32 s34, s17, 10
    s_add_u32 s34, s34, 98304
    s_lshl_b32 s37, s27, 5
    s_mov_b32 m0, s34
    s_nop 0
    buffer_load_dwordx4 v19, s[12:15], s39 offen lds
    s_add_u32 s34, s34, 4096
    s_add_u32 s39, s39, s37
    s_mov_b32 m0, s34
    s_nop 0
    buffer_load_dwordx4 v19, s[12:15], s39 offen lds
    s_add_u32 s34, s34, 4096
    s_sub_u32 s39, s39, s37
    s_add_u32 s39, s39, 128
    s_mov_b32 m0, s34
    s_nop 0
    buffer_load_dwordx4 v19, s[12:15], s39 offen lds
    s_add_u32 s34, s34, 4096
    s_add_u32 s39, s39, s37
    s_mov_b32 m0, s34
    s_nop 0
    buffer_load_dwordx4 v19, s[12:15], s39 offen lds
    s_lshl_b32 s36, s17, 3
    s_add_u32 s36, s36, 448
    s_mul_i32 s39, s36, s27
    s_add_u32 s39, s39, s26
    s_lshl_b32 s34, s17, 10
    s_add_u32 s34, s34, 114688
    s_lshl_b32 s37, s27, 5
    s_mov_b32 m0, s34
    s_nop 0
    buffer_load_dwordx4 v19, s[12:15], s39 offen lds
    s_add_u32 s34, s34, 4096
    s_add_u32 s39, s39, s37
    s_mov_b32 m0, s34
    s_nop 0
    buffer_load_dwordx4 v19, s[12:15], s39 offen lds
    s_add_u32 s34, s34, 4096
    s_sub_u32 s39, s39, s37
    s_add_u32 s39, s39, 128
    s_mov_b32 m0, s34
    s_nop 0
    buffer_load_dwordx4 v19, s[12:15], s39 offen lds
    s_add_u32 s34, s34, 4096
    s_add_u32 s39, s39, s37
    s_mov_b32 m0, s34
    s_nop 0
    buffer_load_dwordx4 v19, s[12:15], s39 offen lds
    s_lshl_b32 s36, s17, 3
    s_add_u32 s36, s36, 512
    s_mul_i32 s39, s36, s27
    s_add_u32 s39, s39, s26
    s_lshl_b32 s34, s17, 10
    s_add_u32 s34, s34, 131072
    s_lshl_b32 s37, s27, 5
    s_mov_b32 m0, s34
    s_nop 0
    buffer_load_dwordx4 v19, s[12:15], s39 offen lds
    s_add_u32 s34, s34, 4096
    s_add_u32 s39, s39, s37
    s_mov_b32 m0, s34
    s_nop 0
    buffer_load_dwordx4 v19, s[12:15], s39 offen lds
    s_add_u32 s34, s34, 4096
    s_sub_u32 s39, s39, s37
    s_add_u32 s39, s39, 128
    s_mov_b32 m0, s34
    s_nop 0
    buffer_load_dwordx4 v19, s[12:15], s39 offen lds
    s_add_u32 s34, s34, 4096
    s_add_u32 s39, s39, s37
    s_mov_b32 m0, s34
    s_nop 0
    buffer_load_dwordx4 v19, s[12:15], s39 offen lds
    s_waitcnt vmcnt(0)
    s_barrier
    ds_read_b64_tr_b16 a[0:1], v16 offset:0
    ds_read_b64_tr_b16 a[2:3], v16 offset:512
    ds_read_b64_tr_b16 a[72:73], v17 offset:0
    ds_read_b64_tr_b16 a[74:75], v17 offset:512
    ds_read_b64_tr_b16 a[4:5], v16 offset:4096
    ds_read_b64_tr_b16 a[6:7], v16 offset:4608
    ds_read_b64_tr_b16 a[76:77], v17 offset:4096
    ds_read_b64_tr_b16 a[78:79], v17 offset:4608
    s_waitcnt lgkmcnt(0)
    ds_read_b64_tr_b16 a[8:9], v16 offset:16384
    ds_read_b64_tr_b16 a[10:11], v16 offset:16896
    ds_read_b64_tr_b16 a[80:81], v17 offset:16384
    ds_read_b64_tr_b16 a[82:83], v17 offset:16896
    ds_read_b64_tr_b16 a[12:13], v16 offset:20480
    ds_read_b64_tr_b16 a[14:15], v16 offset:20992
    ds_read_b64_tr_b16 a[84:85], v17 offset:20480
    ds_read_b64_tr_b16 a[86:87], v17 offset:20992
    s_waitcnt lgkmcnt(0)
    ds_read_b64_tr_b16 a[16:17], v16 offset:32768
    ds_read_b64_tr_b16 a[18:19], v16 offset:33280
    ds_read_b64_tr_b16 a[88:89], v17 offset:32768
    ds_read_b64_tr_b16 a[90:91], v17 offset:33280
    ds_read_b64_tr_b16 a[20:21], v16 offset:36864
    ds_read_b64_tr_b16 a[22:23], v16 offset:37376
    ds_read_b64_tr_b16 a[92:93], v17 offset:36864
    ds_read_b64_tr_b16 a[94:95], v17 offset:37376
    s_waitcnt lgkmcnt(0)
    ds_read_b64_tr_b16 a[24:25], v16 offset:49152
    ds_read_b64_tr_b16 a[26:27], v16 offset:49664
    ds_read_b64_tr_b16 a[96:97], v17 offset:49152
    ds_read_b64_tr_b16 a[98:99], v17 offset:49664
    ds_read_b64_tr_b16 a[28:29], v16 offset:53248
    ds_read_b64_tr_b16 a[30:31], v16 offset:53760
    ds_read_b64_tr_b16 a[100:101], v17 offset:53248
    ds_read_b64_tr_b16 a[102:103], v17 offset:53760
    s_waitcnt lgkmcnt(0)
    v_add_u32 v5, 65536, v16
    ds_read_b64_tr_b16 a[32:33], v5 offset:0
    v_add_u32 v5, 65536, v16
    ds_read_b64_tr_b16 a[34:35], v5 offset:512
    v_add_u32 v5, 65536, v17
    ds_read_b64_tr_b16 a[104:105], v5 offset:0
    v_add_u32 v5, 65536, v17
    ds_read_b64_tr_b16 a[106:107], v5 offset:512
    v_add_u32 v5, 65536, v16
    ds_read_b64_tr_b16 a[36:37], v5 offset:4096
    v_add_u32 v5, 65536, v16
    ds_read_b64_tr_b16 a[38:39], v5 offset:4608
    v_add_u32 v5, 65536, v17
    ds_read_b64_tr_b16 a[108:109], v5 offset:4096
    v_add_u32 v5, 65536, v17
    ds_read_b64_tr_b16 a[110:111], v5 offset:4608
    s_waitcnt lgkmcnt(0)
    v_add_u32 v5, 65536, v16
    ds_read_b64_tr_b16 a[40:41], v5 offset:16384
    v_add_u32 v5, 65536, v16
    ds_read_b64_tr_b16 a[42:43], v5 offset:16896
    v_add_u32 v5, 65536, v17
    ds_read_b64_tr_b16 a[112:113], v5 offset:16384
    v_add_u32 v5, 65536, v17
    ds_read_b64_tr_b16 a[114:115], v5 offset:16896
    v_add_u32 v5, 65536, v16
    ds_read_b64_tr_b16 a[44:45], v5 offset:20480
    v_add_u32 v5, 65536, v16
    ds_read_b64_tr_b16 a[46:47], v5 offset:20992
    v_add_u32 v5, 65536, v17
    ds_read_b64_tr_b16 a[116:117], v5 offset:20480
    v_add_u32 v5, 65536, v17
    ds_read_b64_tr_b16 a[118:119], v5 offset:20992
    s_waitcnt lgkmcnt(0)
    v_add_u32 v5, 65536, v16
    ds_read_b64_tr_b16 a[48:49], v5 offset:32768
    v_add_u32 v5, 65536, v16
    ds_read_b64_tr_b16 a[50:51], v5 offset:33280
    v_add_u32 v5, 65536, v17
    ds_read_b64_tr_b16 a[120:121], v5 offset:32768
    v_add_u32 v5, 65536, v17
    ds_read_b64_tr_b16 a[122:123], v5 offset:33280
    v_add_u32 v5, 65536, v16
    ds_read_b64_tr_b16 a[52:53], v5 offset:36864
    v_add_u32 v5, 65536, v16
    ds_read_b64_tr_b16 a[54:55], v5 offset:37376
    v_add_u32 v5, 65536, v17
    ds_read_b64_tr_b16 a[124:125], v5 offset:36864
    v_add_u32 v5, 65536, v17
    ds_read_b64_tr_b16 a[126:127], v5 offset:37376
    s_waitcnt lgkmcnt(0)
    v_add_u32 v5, 65536, v16
    ds_read_b64_tr_b16 a[56:57], v5 offset:49152
    v_add_u32 v5, 65536, v16
    ds_read_b64_tr_b16 a[58:59], v5 offset:49664
    v_add_u32 v5, 65536, v17
    ds_read_b64_tr_b16 a[128:129], v5 offset:49152
    v_add_u32 v5, 65536, v17
    ds_read_b64_tr_b16 a[130:131], v5 offset:49664
    v_add_u32 v5, 65536, v16
    ds_read_b64_tr_b16 a[60:61], v5 offset:53248
    v_add_u32 v5, 65536, v16
    ds_read_b64_tr_b16 a[62:63], v5 offset:53760
    v_add_u32 v5, 65536, v17
    ds_read_b64_tr_b16 a[132:133], v5 offset:53248
    v_add_u32 v5, 65536, v17
    ds_read_b64_tr_b16 a[134:135], v5 offset:53760
    s_waitcnt lgkmcnt(0)
    v_add_u32 v5, 131072, v16
    ds_read_b64_tr_b16 a[64:65], v5 offset:0
    v_add_u32 v5, 131072, v16
    ds_read_b64_tr_b16 a[66:67], v5 offset:512
    v_add_u32 v5, 131072, v17
    ds_read_b64_tr_b16 a[136:137], v5 offset:0
    v_add_u32 v5, 131072, v17
    ds_read_b64_tr_b16 a[138:139], v5 offset:512
    v_add_u32 v5, 131072, v16
    ds_read_b64_tr_b16 a[68:69], v5 offset:4096
    v_add_u32 v5, 131072, v16
    ds_read_b64_tr_b16 a[70:71], v5 offset:4608
    v_add_u32 v5, 131072, v17
    ds_read_b64_tr_b16 a[140:141], v5 offset:4096
    v_add_u32 v5, 131072, v17
    ds_read_b64_tr_b16 a[142:143], v5 offset:4608
    s_waitcnt lgkmcnt(0)
    s_barrier
    s_mov_b32 s25, 1152
    v_and_b32 v1, 63, v0
    v_and_b32 v2, 15, v1
    v_lshrrev_b32 v3, 4, v1
    v_bfe_u32 v4, v2, 1, 3
    v_xor_b32 v3, v3, v4
    v_lshlrev_b32 v3, 4, v3
    v_lshlrev_b32 v2, 7, v2
    v_add_u32 v8, v2, v3
    v_xor_b32 v9, 64, v8
    v_lshrrev_b32 v2, 3, v1
    v_mul_lo_u32 v2, v2, s25
    v_and_b32 v3, 7, v1
    v_lshrrev_b32 v4, 4, v1
    v_xor_b32 v3, v3, v4
    s_and_b32 s37, s17, 1
    s_lshl_b32 s34, s37, 2
    v_xor_b32 v3, s34, v3
    v_lshlrev_b32 v3, 4, v3
    v_add_u32 v12, v2, v3
    s_load_dwordx2 s[12:13], s[0:1], 88
    s_waitcnt lgkmcnt(0)
    s_mov_b32 s14, 256
    s_mov_b32 s15, 0x20000
    s_cmp_lg_u32 s17, 0
    s_cbranch_scc1 Llw1q0
    s_mov_b32 s19, 0
    v_and_b32 v1, 63, v0
    v_lshlrev_b32 v2, 2, v1
Llw0q0:
    buffer_load_dword v3, v2, s[12:15], 0 offen sc1
    s_waitcnt vmcnt(0)
    s_mov_b32 s20, 0
    s_mov_b32 s21, 0
    v_readlane_b32 s22, v3, 2
    s_nop 2
    s_add_u32 s20, s20, s22
    v_readlane_b32 s22, v3, 3
    s_nop 2
    s_add_u32 s21, s21, s22
    v_readlane_b32 s22, v3, 18
    s_nop 2
    s_add_u32 s20, s20, s22
    v_readlane_b32 s22, v3, 19
    s_nop 2
    s_add_u32 s21, s21, s22
    v_readlane_b32 s22, v3, 34
    s_nop 2
    s_add_u32 s20, s20, s22
    v_readlane_b32 s22, v3, 35
    s_nop 2
    s_add_u32 s21, s21, s22
    v_readlane_b32 s22, v3, 50
    s_nop 2
    s_add_u32 s20, s20, s22
    v_readlane_b32 s22, v3, 51
    s_nop 2
    s_add_u32 s21, s21, s22
    s_cmp_ge_u32 s20, s90
    s_cselect_b32 s22, s21, 0
    s_cmp_eq_u32 s89, 1
    s_cselect_b32 s20, s20, s22
    s_cmp_ge_u32 s20, 224
    s_cbranch_scc1 Llw1q0
    s_sleep 12
    s_add_u32 s19, s19, 1
    s_cmp_lt_u32 s19, 524288
    s_cbranch_scc1 Llw0q0
    s_branch Lfail
Llw1q0:
    s_barrier
    s_cmp_lg_u32 s17, 0
    s_cbranch_scc1 Linv_43
    buffer_inv sc1
    s_waitcnt vmcnt(0)
Linv_43:
    s_barrier
    s_mov_b32 s8, s4
    s_mov_b32 s9, s5
    s_mov_b32 s10, s6
    s_mov_b32 s11, s7
    s_and_b32 s53, s64, 31
    s_mov_b32 s40, 0
    s_mov_b32 s42, -1
    s_mul_i32 s24, s65, 73728
    s_add_u32 s24, s24, 2097152
    s_lshl_b32 s36, s17, 3
    s_mul_i32 s36, s36, s25
    s_add_u32 s36, s36, s24
    s_lshl_b32 s37, s25, 5
    s_lshl_b32 s39, s17, 10
    s_add_u32 s39, s39, s40
    s_add_u32 s38, s36, 0
    s_add_u32 s34, s39, 0
    s_mov_b32 m0, s34
    s_nop 0
    buffer_load_dwordx4 v12, s[8:11], s38 offen lds
    s_add_u32 s38, s38, s37
    s_add_u32 s34, s34, 4096
    s_mov_b32 m0, s34
    s_nop 0
    buffer_load_dwordx4 v12, s[8:11], s38 offen lds
    s_add_u32 s38, s36, 128
    s_add_u32 s34, s39, 8192
    s_mov_b32 m0, s34
    s_nop 0
    buffer_load_dwordx4 v12, s[8:11], s38 offen lds
    s_add_u32 s38, s38, s37
    s_add_u32 s34, s34, 4096
    s_mov_b32 m0, s34
    s_nop 0
    buffer_load_dwordx4 v12, s[8:11], s38 offen lds
    s_add_u32 s38, s36, 256
    s_add_u32 s34, s39, 16384
    s_mov_b32 m0, s34
    s_nop 0
    buffer_load_dwordx4 v12, s[8:11], s38 offen lds
    s_add_u32 s38, s38, s37
    s_add_u32 s34, s34, 4096
    s_mov_b32 m0, s34
    s_nop 0
    buffer_load_dwordx4 v12, s[8:11], s38 offen lds
    s_add_u32 s38, s36, 384
    s_add_u32 s34, s39, 24576
    s_mov_b32 m0, s34
    s_nop 0
    buffer_load_dwordx4 v12, s[8:11], s38 offen lds
    s_add_u32 s38, s38, s37
    s_add_u32 s34, s34, 4096
    s_mov_b32 m0, s34
    s_nop 0
    buffer_load_dwordx4 v12, s[8:11], s38 offen lds
    s_add_u32 s38, s36, 512
    s_add_u32 s34, s39, 32768
    s_mov_b32 m0, s34
    s_nop 0
    buffer_load_dwordx4 v12, s[8:11], s38 offen lds
    s_add_u32 s38, s38, s37
    s_add_u32 s34, s34, 4096
    s_mov_b32 m0, s34
    s_nop 0
    buffer_load_dwordx4 v12, s[8:11], s38 offen lds
    s_add_u32 s38, s36, 640
    s_add_u32 s34, s39, 40960
    s_mov_b32 m0, s34
    s_nop 0
    buffer_load_dwordx4 v12, s[8:11], s38 offen lds
    s_add_u32 s38, s38, s37
    s_add_u32 s34, s34, 4096
    s_mov_b32 m0, s34
    s_nop 0
    buffer_load_dwordx4 v12, s[8:11], s38 offen lds
    s_add_u32 s38, s36, 768
    s_add_u32 s34, s39, 49152
    s_mov_b32 m0, s34
    s_nop 0
    buffer_load_dwordx4 v12, s[8:11], s38 offen lds
    s_add_u32 s38, s38, s37
    s_add_u32 s34, s34, 4096
    s_mov_b32 m0, s34
    s_nop 0
    buffer_load_dwordx4 v12, s[8:11], s38 offen lds
    s_add_u32 s38, s36, 896
    s_add_u32 s34, s39, 57344
    s_mov_b32 m0, s34
    s_nop 0
    buffer_load_dwordx4 v12, s[8:11], s38 offen lds
    s_add_u32 s38, s38, s37
    s_add_u32 s34, s34, 4096
    s_mov_b32 m0, s34
    s_nop 0
    buffer_load_dwordx4 v12, s[8:11], s38 offen lds
    s_add_u32 s38, s36, 1024
    s_add_u32 s34, s39, 65536
    s_mov_b32 m0, s34
    s_nop 0
    buffer_load_dwordx4 v12, s[8:11], s38 offen lds
    s_add_u32 s38, s38, s37
    s_add_u32 s34, s34, 4096
    s_mov_b32 m0, s34
    s_nop 0
    buffer_load_dwordx4 v12, s[8:11], s38 offen lds
Lql_m0:
    s_add_u32 s41, s65, 2
    s_add_u32 s20, s65, 1
    s_cmp_lt_u32 s65, 7
    s_cselect_b32 s41, s20, s41
    s_cmp_eq_u32 s65, 3
    s_cselect_b32 s41, 8, s41
    s_xor_b32 s43, s40, 73728
    s_mul_i32 s24, s41, 73728
    s_add_u32 s24, s24, 2097152
    s_cmp_ge_u32 s41, 32
    s_cselect_b32 s24, 0x40000000, s24
    s_cmp_eq_u32 s42, -1
    s_cbranch_scc1 Lqw2_m0
    s_waitcnt vmcnt(5)
    s_branch Lqw1_m0x
Lqw2_m0:
    s_waitcnt vmcnt(0)
Lqw1_m0x:
    s_barrier
    v_add_u32 v10, s40, v8
    v_add_u32 v11, s40, v9
    v_add_u32 v13, 65536, v10
    v_add_u32 v14, 65536, v11
    ds_read_b128 v[32:35], v10 offset:0
    ds_read_b128 v[36:39], v10 offset:2048
    ds_read_b128 v[40:43], v10 offset:4096
    ds_read_b128 v[44:47], v10 offset:6144
    v_mov_b64 v[128:129], 0
    v_mov_b64 v[130:131], 0
    v_mov_b64 v[132:133], 0
    v_mov_b64 v[134:135], 0
    v_mov_b64 v[136:137], 0
    v_mov_b64 v[138:139], 0
    v_mov_b64 v[140:141], 0
    v_mov_b64 v[142:143], 0
    v_mov_b64 v[144:145], 0
    v_mov_b64 v[146:147], 0
    v_mov_b64 v[148:149], 0
    v_mov_b64 v[150:151], 0
    v_mov_b64 v[152:153], 0
    v_mov_b64 v[154:155], 0
    v_mov_b64 v[156:157], 0
    v_mov_b64 v[158:159], 0
    s_waitcnt lgkmcnt(0)
    v_mfma_f32_16x16x32_bf16 v[128:131], a[0:3], v[32:35], v[128:131]
    ds_read_b128 v[64:67], v11 offset:0
    v_mfma_f32_16x16x32_bf16 v[132:135], a[72:75], v[32:35], v[132:135]
    ds_read_b128 v[68:71], v11 offset:2048
    v_mfma_f32_16x16x32_bf16 v[136:139], a[0:3], v[36:39], v[136:139]
    ds_read_b128 v[72:75], v11 offset:4096
    v_mfma_f32_16x16x32_bf16 v[140:143], a[72:75], v[36:39], v[140:143]
    ds_read_b128 v[76:79], v11 offset:6144
    v_mfma_f32_16x16x32_bf16 v[144:147], a[0:3], v[40:43], v[144:147]
    v_mfma_f32_16x16x32_bf16 v[148:151], a[72:75], v[40:43], v[148:151]
    s_lshl_b32 s36, s17, 3
    s_mul_i32 s36, s36, s25
    s_add_u32 s36, s36, s24
    s_lshl_b32 s37, s25, 5
    s_lshl_b32 s39, s17, 10
    s_add_u32 s39, s39, s43
    s_add_u32 s38, s36, 0
    s_add_u32 s34, s39, 0
    s_mov_b32 m0, s34
    s_nop 0
    buffer_load_dwordx4 v12, s[8:11], s38 offen lds
    v_mfma_f32_16x16x32_bf16 v[152:155], a[0:3], v[44:47], v[152:155]
    v_mfma_f32_16x16x32_bf16 v[156:159], a[72:75], v[44:47], v[156:159]
    s_add_u32 s38, s38, s37
    s_add_u32 s34, s34, 4096
    s_mov_b32 m0, s34
    s_nop 0
    buffer_load_dwordx4 v12, s[8:11], s38 offen lds
    s_waitcnt lgkmcnt(0)
    v_mfma_f32_16x16x32_bf16 v[128:131], a[4:7], v[64:67], v[128:131]
    ds_read_b128 v[32:35], v10 offset:8192
    v_mfma_f32_16x16x32_bf16 v[132:135], a[76:79], v[64:67], v[132:135]
    ds_read_b128 v[36:39], v10 offset:10240
    v_mfma_f32_16x16x32_bf16 v[136:139], a[4:7], v[68:71], v[136:139]
    ds_read_b128 v[40:43], v10 offset:12288
    v_mfma_f32_16x16x32_bf16 v[140:143], a[76:79], v[68:71], v[140:143]
    ds_read_b128 v[44:47], v10 offset:14336
    v_mfma_f32_16x16x32_bf16 v[144:147], a[4:7], v[72:75], v[144:147]
    v_mfma_f32_16x16x32_bf16 v[148:151], a[76:79], v[72:75], v[148:151]
    s_add_u32 s38, s36, 128
    s_add_u32 s34, s39, 8192
    s_mov_b32 m0, s34
    s_nop 0
    buffer_load_dwordx4 v12, s[8:11], s38 offen lds
    v_mfma_f32_16x16x32_bf16 v[152:155], a[4:7], v[76:79], v[152:155]
    v_mfma_f32_16x16x32_bf16 v[156:159], a[76:79], v[76:79], v[156:159]
    s_add_u32 s38, s38, s37
    s_add_u32 s34, s34, 4096
    s_mov_b32 m0, s34
    s_nop 0
    buffer_load_dwordx4 v12, s[8:11], s38 offen lds
    s_waitcnt lgkmcnt(0)
    v_mfma_f32_16x16x32_bf16 v[128:131], a[8:11], v[32:35], v[128:131]
    ds_read_b128 v[64:67], v11 offset:8192
    v_mfma_f32_16x16x32_bf16 v[132:135], a[80:83], v[32:35], v[132:135]
    ds_read_b128 v[68:71], v11 offset:10240
    v_mfma_f32_16x16x32_bf16 v[136:139], a[8:11], v[36:39], v[136:139]
    ds_read_b128 v[72:75], v11 offset:12288
    v_mfma_f32_16x16x32_bf16 v[140:143], a[80:83], v[36:39], v[140:143]
    ds_read_b128 v[76:79], v11 offset:14336
    v_mfma_f32_16x16x32_bf16 v[144:147], a[8:11], v[40:43], v[144:147]
    v_mfma_f32_16x16x32_bf16 v[148:151], a[80:83], v[40:43], v[148:151]
    s_add_u32 s38, s36, 256
    s_add_u32 s34, s39, 16384
    s_mov_b32 m0, s34
    s_nop 0
    buffer_load_dwordx4 v12, s[8:11], s38 offen lds
    v_mfma_f32_16x16x32_bf16 v[152:155], a[8:11], v[44:47], v[152:155]
    v_mfma_f32_16x16x32_bf16 v[156:159], a[80:83], v[44:47], v[156:159]
    s_add_u32 s38, s38, s37
    s_add_u32 s34, s34, 4096
    s_mov_b32 m0, s34
    s_nop 0
    buffer_load_dwordx4 v12, s[8:11], s38 offen lds
    s_waitcnt lgkmcnt(0)
    v_mfma_f32_16x16x32_bf16 v[128:131], a[12:15], v[64:67], v[128:131]
    ds_read_b128 v[32:35], v10 offset:16384
    v_mfma_f32_16x16x32_bf16 v[132:135], a[84:87], v[64:67], v[132:135]
    ds_read_b128 v[36:39], v10 offset:18432
    v_mfma_f32_16x16x32_bf16 v[136:139], a[12:15], v[68:71], v[136:139]
    ds_read_b128 v[40:43], v10 offset:20480
    v_mfma_f32_16x16x32_bf16 v[140:143], a[84:87], v[68:71], v[140:143]
    ds_read_b128 v[44:47], v10 offset:22528
    v_mfma_f32_16x16x32_bf16 v[144:147], a[12:15], v[72:75], v[144:147]
    v_mfma_f32_16x16x32_bf16 v[148:151], a[84:87], v[72:75], v[148:151]
    s_add_u32 s38, s36, 384
    s_add_u32 s34, s39, 24576
    s_mov_b32 m0, s34
    s_nop 0
    buffer_load_dwordx4 v12, s[8:11], s38 offen lds
    v_mfma_f32_16x16x32_bf16 v[152:155], a[12:15], v[76:79], v[152:155]
    v_mfma_f32_16x16x32_bf16 v[156:159], a[84:87], v[76:79], v[156:159]
    s_add_u32 s38, s38, s37
    s_add_u32 s34, s34, 4096
    s_mov_b32 m0, s34
    s_nop 0
    buffer_load_dwordx4 v12, s[8:11], s38 offen lds
    s_waitcnt lgkmcnt(0)
    v_mfma_f32_16x16x32_bf16 v[128:131], a[16:19], v[32:35], v[128:131]
    ds_read_b128 v[64:67], v11 offset:16384
    v_mfma_f32_16x16x32_bf16 v[132:135], a[88:91], v[32:35], v[132:135]
    ds_read_b128 v[68:71], v11 offset:18432
    v_mfma_f32_16x16x32_bf16 v[136:139], a[16:19], v[36:39], v[136:139]
    ds_read_b128 v[72:75], v11 offset:20480
    v_mfma_f32_16x16x32_bf16 v[140:143], a[88:91], v[36:39], v[140:143]
    ds_read_b128 v[76:79], v11 offset:22528
    v_mfma_f32_16x16x32_bf16 v[144:147], a[16:19], v[40:43], v[144:147]
    v_mfma_f32_16x16x32_bf16 v[148:151], a[88:91], v[40:43], v[148:151]
    s_add_u32 s38, s36, 512
    s_add_u32 s34, s39, 32768
    s_mov_b32 m0, s34
    s_nop 0
    buffer_load_dwordx4 v12, s[8:11], s38 offen lds
    v_mfma_f32_16x16x32_bf16 v[152:155], a[16:19], v[44:47], v[152:155]
    v_mfma_f32_16x16x32_bf16 v[156:159], a[88:91], v[44:47], v[156:159]
    s_add_u32 s38, s38, s37
    s_add_u32 s34, s34, 4096
    s_mov_b32 m0, s34
    s_nop 0
    buffer_load_dwordx4 v12, s[8:11], s38 offen lds
    s_waitcnt lgkmcnt(0)
    v_mfma_f32_16x16x32_bf16 v[128:131], a[20:23], v[64:67], v[128:131]
    ds_read_b128 v[32:35], v10 offset:24576
    v_mfma_f32_16x16x32_bf16 v[132:135], a[92:95], v[64:67], v[132:135]
    ds_read_b128 v[36:39], v10 offset:26624
    v_mfma_f32_16x16x32_bf16 v[136:139], a[20:23], v[68:71], v[136:139]
    ds_read_b128 v[40:43], v10 offset:28672
    v_mfma_f32_16x16x32_bf16 v[140:143], a[92:95], v[68:71], v[140:143]
    ds_read_b128 v[44:47], v10 offset:30720
    v_mfma_f32_16x16x32_bf16 v[144:147], a[20:23], v[72:75], v[144:147]
    v_mfma_f32_16x16x32_bf16 v[148:151], a[92:95], v[72:75], v[148:151]
    s_add_u32 s38, s36, 640
    s_add_u32 s34, s39, 40960
    s_mov_b32 m0, s34
    s_nop 0
    buffer_load_dwordx4 v12, s[8:11], s38 offen lds
    v_mfma_f32_16x16x32_bf16 v[152:155], a[20:23], v[76:79], v[152:155]
    v_mfma_f32_16x16x32_bf16 v[156:159], a[92:95], v[76:79], v[156:159]
    s_add_u32 s38, s38, s37
    s_add_u32 s34, s34, 4096
    s_mov_b32 m0, s34
    s_nop 0
    buffer_load_dwordx4 v12, s[8:11], s38 offen lds
    s_waitcnt lgkmcnt(0)
    v_mfma_f32_16x16x32_bf16 v[128:131], a[24:27], v[32:35], v[128:131]
    ds_read_b128 v[64:67], v11 offset:24576
    v_mfma_f32_16x16x32_bf16 v[132:135], a[96:99], v[32:35], v[132:135]
    ds_read_b128 v[68:71], v11 offset:26624
    v_mfma_f32_16x16x32_bf16 v[136:139], a[24:27], v[36:39], v[136:139]
    ds_read_b128 v[72:75], v11 offset:28672
    v_mfma_f32_16x16x32_bf16 v[140:143], a[96:99], v[36:39], v[140:143]
    ds_read_b128 v[76:79], v11 offset:30720
    v_mfma_f32_16x16x32_bf16 v[144:147], a[24:27], v[40:43], v[144:147]
    v_mfma_f32_16x16x32_bf16 v[148:151], a[96:99], v[40:43], v[148:151]
    s_add_u32 s38, s36, 768
    s_add_u32 s34, s39, 49152
    s_mov_b32 m0, s34
    s_nop 0
    buffer_load_dwordx4 v12, s[8:11], s38 offen lds
    v_mfma_f32_16x16x32_bf16 v[152:155], a[24:27], v[44:47], v[152:155]
    v_mfma_f32_16x16x32_bf16 v[156:159], a[96:99], v[44:47], v[156:159]
    s_add_u32 s38, s38, s37
    s_add_u32 s34, s34, 4096
    s_mov_b32 m0, s34
    s_nop 0
    buffer_load_dwordx4 v12, s[8:11], s38 offen lds
    s_waitcnt lgkmcnt(0)
    v_mfma_f32_16x16x32_bf16 v[128:131], a[28:31], v[64:67], v[128:131]
    ds_read_b128 v[32:35], v10 offset:32768
    v_mfma_f32_16x16x32_bf16 v[132:135], a[100:103], v[64:67], v[132:135]
    ds_read_b128 v[36:39], v10 offset:34816
    v_mfma_f32_16x16x32_bf16 v[136:139], a[28:31], v[68:71], v[136:139]
    ds_read_b128 v[40:43], v10 offset:36864
    v_mfma_f32_16x16x32_bf16 v[140:143], a[100:103], v[68:71], v[140:143]
    ds_read_b128 v[44:47], v10 offset:38912
    v_mfma_f32_16x16x32_bf16 v[144:147], a[28:31], v[72:75], v[144:147]
    v_mfma_f32_16x16x32_bf16 v[148:151], a[100:103], v[72:75], v[148:151]
    s_add_u32 s38, s36, 896
    s_add_u32 s34, s39, 57344
    s_mov_b32 m0, s34
    s_nop 0
    buffer_load_dwordx4 v12, s[8:11], s38 offen lds
    v_mfma_f32_16x16x32_bf16 v[152:155], a[28:31], v[76:79], v[152:155]
    v_mfma_f32_16x16x32_bf16 v[156:159], a[100:103], v[76:79], v[156:159]
    s_add_u32 s38, s38, s37
    s_add_u32 s34, s34, 4096
    s_mov_b32 m0, s34
    s_nop 0
    buffer_load_dwordx4 v12, s[8:11], s38 offen lds
    s_waitcnt lgkmcnt(0)
    v_mfma_f32_16x16x32_bf16 v[128:131], a[32:35], v[32:35], v[128:131]
    ds_read_b128 v[64:67], v11 offset:32768
    v_mfma_f32_16x16x32_bf16 v[132:135], a[104:107], v[32:35], v[132:135]
    ds_read_b128 v[68:71], v11 offset:34816
    v_mfma_f32_16x16x32_bf16 v[136:139], a[32:35], v[36:39], v[136:139]
    ds_read_b128 v[72:75], v11 offset:36864
    v_mfma_f32_16x16x32_bf16 v[140:143], a[104:107], v[36:39], v[140:143]
    ds_read_b128 v[76:79], v11 offset:38912
    v_mfma_f32_16x16x32_bf16 v[144:147], a[32:35], v[40:43], v[144:147]
    v_mfma_f32_16x16x32_bf16 v[148:151], a[104:107], v[40:43], v[148:151]
    s_add_u32 s38, s36, 1024
    s_add_u32 s34, s39, 65536
    s_mov_b32 m0, s34
    s_nop 0
    buffer_load_dwordx4 v12, s[8:11], s38 offen lds
    v_mfma_f32_16x16x32_bf16 v[152:155], a[32:35], v[44:47], v[152:155]
    v_mfma_f32_16x16x32_bf16 v[156:159], a[104:107], v[44:47], v[156:159]
    s_add_u32 s38, s38, s37
    s_add_u32 s34, s34, 4096
    s_mov_b32 m0, s34
    s_nop 0
    buffer_load_dwordx4 v12, s[8:11], s38 offen lds
    s_waitcnt lgkmcnt(0)
    v_mfma_f32_16x16x32_bf16 v[128:131], a[36:39], v[64:67], v[128:131]
    ds_read_b128 v[32:35], v10 offset:40960
    v_mfma_f32_16x16x32_bf16 v[132:135], a[108:111], v[64:67], v[132:135]
    ds_read_b128 v[36:39], v10 offset:43008
    v_mfma_f32_16x16x32_bf16 v[136:139], a[36:39], v[68:71], v[136:139]
    ds_read_b128 v[40:43], v10 offset:45056
    v_mfma_f32_16x16x32_bf16 v[140:143], a[108:111], v[68:71], v[140:143]
    ds_read_b128 v[44:47], v10 offset:47104
    v_mfma_f32_16x16x32_bf16 v[144:147], a[36:39], v[72:75], v[144:147]
    v_mfma_f32_16x16x32_bf16 v[148:151], a[108:111], v[72:75], v[148:151]
    v_mfma_f32_16x16x32_bf16 v[152:155], a[36:39], v[76:79], v[152:155]
    v_mfma_f32_16x16x32_bf16 v[156:159], a[108:111], v[76:79], v[156:159]
    s_waitcnt lgkmcnt(0)
    v_mfma_f32_16x16x32_bf16 v[128:131], a[40:43], v[32:35], v[128:131]
    ds_read_b128 v[64:67], v11 offset:40960
    v_mfma_f32_16x16x32_bf16 v[132:135], a[112:115], v[32:35], v[132:135]
    ds_read_b128 v[68:71], v11 offset:43008
    v_mfma_f32_16x16x32_bf16 v[136:139], a[40:43], v[36:39], v[136:139]
    ds_read_b128 v[72:75], v11 offset:45056
    v_mfma_f32_16x16x32_bf16 v[140:143], a[112:115], v[36:39], v[140:143]
    ds_read_b128 v[76:79], v11 offset:47104
    v_mfma_f32_16x16x32_bf16 v[144:147], a[40:43], v[40:43], v[144:147]
    v_mfma_f32_16x16x32_bf16 v[148:151], a[112:115], v[40:43], v[148:151]
    v_mfma_f32_16x16x32_bf16 v[152:155], a[40:43], v[44:47], v[152:155]
    v_mfma_f32_16x16x32_bf16 v[156:159], a[112:115], v[44:47], v[156:159]
    s_waitcnt lgkmcnt(0)
    v_mfma_f32_16x16x32_bf16 v[128:131], a[44:47], v[64:67], v[128:131]
    ds_read_b128 v[32:35], v10 offset:49152
    v_mfma_f32_16x16x32_bf16 v[132:135], a[116:119], v[64:67], v[132:135]
    ds_read_b128 v[36:39], v10 offset:51200
    v_mfma_f32_16x16x32_bf16 v[136:139], a[44:47], v[68:71], v[136:139]
    ds_read_b128 v[40:43], v10 offset:53248
    v_mfma_f32_16x16x32_bf16 v[140:143], a[116:119], v[68:71], v[140:143]
    ds_read_b128 v[44:47], v10 offset:55296
    v_mfma_f32_16x16x32_bf16 v[144:147], a[44:47], v[72:75], v[144:147]
    v_mfma_f32_16x16x32_bf16 v[148:151], a[116:119], v[72:75], v[148:151]
    v_mfma_f32_16x16x32_bf16 v[152:155], a[44:47], v[76:79], v[152:155]
    v_mfma_f32_16x16x32_bf16 v[156:159], a[116:119], v[76:79], v[156:159]
    s_waitcnt lgkmcnt(0)
    v_mfma_f32_16x16x32_bf16 v[128:131], a[48:51], v[32:35], v[128:131]
    ds_read_b128 v[64:67], v11 offset:49152
    v_mfma_f32_16x16x32_bf16 v[132:135], a[120:123], v[32:35], v[132:135]
    ds_read_b128 v[68:71], v11 offset:51200
    v_mfma_f32_16x16x32_bf16 v[136:139], a[48:51], v[36:39], v[136:139]
    ds_read_b128 v[72:75], v11 offset:53248
    v_mfma_f32_16x16x32_bf16 v[140:143], a[120:123], v[36:39], v[140:143]
    ds_read_b128 v[76:79], v11 offset:55296
    v_mfma_f32_16x16x32_bf16 v[144:147], a[48:51], v[40:43], v[144:147]
    v_mfma_f32_16x16x32_bf16 v[148:151], a[120:123], v[40:43], v[148:151]
    v_mfma_f32_16x16x32_bf16 v[152:155], a[48:51], v[44:47], v[152:155]
    v_mfma_f32_16x16x32_bf16 v[156:159], a[120:123], v[44:47], v[156:159]
    s_waitcnt lgkmcnt(0)
    v_mfma_f32_16x16x32_bf16 v[128:131], a[52:55], v[64:67], v[128:131]
    ds_read_b128 v[32:35], v10 offset:57344
    v_mfma_f32_16x16x32_bf16 v[132:135], a[124:127], v[64:67], v[132:135]
    ds_read_b128 v[36:39], v10 offset:59392
    v_mfma_f32_16x16x32_bf16 v[136:139], a[52:55], v[68:71], v[136:139]
    ds_read_b128 v[40:43], v10 offset:61440
    v_mfma_f32_16x16x32_bf16 v[140:143], a[124:127], v[68:71], v[140:143]
    ds_read_b128 v[44:47], v10 offset:63488
    v_mfma_f32_16x16x32_bf16 v[144:147], a[52:55], v[72:75], v[144:147]
    v_mfma_f32_16x16x32_bf16 v[148:151], a[124:127], v[72:75], v[148:151]
    v_mfma_f32_16x16x32_bf16 v[152:155], a[52:55], v[76:79], v[152:155]
    v_mfma_f32_16x16x32_bf16 v[156:159], a[124:127], v[76:79], v[156:159]
    s_waitcnt lgkmcnt(0)
    v_mfma_f32_16x16x32_bf16 v[128:131], a[56:59], v[32:35], v[128:131]
    ds_read_b128 v[64:67], v11 offset:57344
    v_mfma_f32_16x16x32_bf16 v[132:135], a[128:131], v[32:35], v[132:135]
    ds_read_b128 v[68:71], v11 offset:59392
    v_mfma_f32_16x16x32_bf16 v[136:139], a[56:59], v[36:39], v[136:139]
    ds_read_b128 v[72:75], v11 offset:61440
    v_mfma_f32_16x16x32_bf16 v[140:143], a[128:131], v[36:39], v[140:143]
    ds_read_b128 v[76:79], v11 offset:63488
    v_mfma_f32_16x16x32_bf16 v[144:147], a[56:59], v[40:43], v[144:147]
    v_mfma_f32_16x16x32_bf16 v[148:151], a[128:131], v[40:43], v[148:151]
    v_mfma_f32_16x16x32_bf16 v[152:155], a[56:59], v[44:47], v[152:155]
    v_mfma_f32_16x16x32_bf16 v[156:159], a[128:131], v[44:47], v[156:159]
    s_waitcnt lgkmcnt(0)
    v_mfma_f32_16x16x32_bf16 v[128:131], a[60:63], v[64:67], v[128:131]
    ds_read_b128 v[32:35], v13 offset:0
    v_mfma_f32_16x16x32_bf16 v[132:135], a[132:135], v[64:67], v[132:135]
    ds_read_b128 v[36:39], v13 offset:2048
    v_mfma_f32_16x16x32_bf16 v[136:139], a[60:63], v[68:71], v[136:139]
    ds_read_b128 v[40:43], v13 offset:4096
    v_mfma_f32_16x16x32_bf16 v[140:143], a[132:135], v[68:71], v[140:143]
    ds_read_b128 v[44:47], v13 offset:6144
    v_mfma_f32_16x16x32_bf16 v[144:147], a[60:63], v[72:75], v[144:147]
    v_mfma_f32_16x16x32_bf16 v[148:151], a[132:135], v[72:75], v[148:151]
    v_mfma_f32_16x16x32_bf16 v[152:155], a[60:63], v[76:79], v[152:155]
    v_mfma_f32_16x16x32_bf16 v[156:159], a[132:135], v[76:79], v[156:159]
    s_waitcnt lgkmcnt(0)
    v_mfma_f32_16x16x32_bf16 v[128:131], a[64:67], v[32:35], v[128:131]
    ds_read_b128 v[64:67], v14 offset:0
    v_mfma_f32_16x16x32_bf16 v[132:135], a[136:139], v[32:35], v[132:135]
    ds_read_b128 v[68:71], v14 offset:2048
    v_mfma_f32_16x16x32_bf16 v[136:139], a[64:67], v[36:39], v[136:139]
    ds_read_b128 v[72:75], v14 offset:4096
    v_mfma_f32_16x16x32_bf16 v[140:143], a[136:139], v[36:39], v[140:143]
    ds_read_b128 v[76:79], v14 offset:6144
    v_mfma_f32_16x16x32_bf16 v[144:147], a[64:67], v[40:43], v[144:147]
    v_mfma_f32_16x16x32_bf16 v[148:151], a[136:139], v[40:43], v[148:151]
    v_mfma_f32_16x16x32_bf16 v[152:155], a[64:67], v[44:47], v[152:155]
    v_mfma_f32_16x16x32_bf16 v[156:159], a[136:139], v[44:47], v[156:159]
    s_waitcnt lgkmcnt(0)
    v_mfma_f32_16x16x32_bf16 v[128:131], a[68:71], v[64:67], v[128:131]
    v_mfma_f32_16x16x32_bf16 v[132:135], a[140:143], v[64:67], v[132:135]
    v_mfma_f32_16x16x32_bf16 v[136:139], a[68:71], v[68:71], v[136:139]
    v_mfma_f32_16x16x32_bf16 v[140:143], a[140:143], v[68:71], v[140:143]
    v_mfma_f32_16x16x32_bf16 v[144:147], a[68:71], v[72:75], v[144:147]
    v_mfma_f32_16x16x32_bf16 v[148:151], a[140:143], v[72:75], v[148:151]
    v_mfma_f32_16x16x32_bf16 v[152:155], a[68:71], v[76:79], v[152:155]
    v_mfma_f32_16x16x32_bf16 v[156:159], a[140:143], v[76:79], v[156:159]
    s_waitcnt vmcnt(18)
    s_barrier
    s_mov_b32 s53, 147456
    s_mov_b32 s56, 8192
    s_mul_i32 s57, s65, 524288
    s_lshl_b32 s54, s79, 8
    s_add_u32 s57, s57, s54
    s_add_u32 s57, s57, 25165824
    v_and_b32 v1, 63, v0
    v_and_b32 v2, 31, v1
    v_mul_u32_u24 v2, 256, v2
    v_add_u32 v2, s53, v2
    v_lshrrev_b32 v3, 5, v1
    s_mul_i32 s36, s17, 4
    v_add_u32 v3, s36, v3
    v_and_b32 v4, 7, v1
    v_add_u32 v5, 0, v3
    v_xor_b32 v5, v5, v4
    v_lshlrev_b32 v5, 4, v5
    v_add_u32 v16, v2, v5
    v_add_u32 v5, 2, v3
    v_xor_b32 v5, v5, v4
    v_lshlrev_b32 v5, 4, v5
    v_add_u32 v17, v2, v5
    v_cvt_pk_bf16_f32 v32, v128, v129
    v_cvt_pk_bf16_f32 v33, v130, v131
    v_cvt_pk_bf16_f32 v34, v136, v137
    v_cvt_pk_bf16_f32 v35, v138, v139
    s_nop 0
    v_permlane16_swap_b32 v32, v34
    v_permlane16_swap_b32 v33, v35
    ds_write_b128 v16, v[32:35] offset:0
    v_cvt_pk_bf16_f32 v36, v132, v133
    v_cvt_pk_bf16_f32 v37, v134, v135
    v_cvt_pk_bf16_f32 v38, v140, v141
    v_cvt_pk_bf16_f32 v39, v142, v143
    s_nop 0
    v_permlane16_swap_b32 v36, v38
    v_permlane16_swap_b32 v37, v39
    ds_write_b128 v17, v[36:39] offset:0
    v_cvt_pk_bf16_f32 v40, v144, v145
    v_cvt_pk_bf16_f32 v41, v146, v147
    v_cvt_pk_bf16_f32 v42, v152, v153
    v_cvt_pk_bf16_f32 v43, v154, v155
    s_nop 0
    v_permlane16_swap_b32 v40, v42
    v_permlane16_swap_b32 v41, v43
    ds_write_b128 v16, v[40:43] offset:8192
    v_cvt_pk_bf16_f32 v44, v148, v149
    v_cvt_pk_bf16_f32 v45, v150, v151
    v_cvt_pk_bf16_f32 v46, v156, v157
    v_cvt_pk_bf16_f32 v47, v158, v159
    s_nop 0
    v_permlane16_swap_b32 v44, v46
    v_permlane16_swap_b32 v45, v47
    ds_write_b128 v17, v[44:47] offset:8192
    v_lshrrev_b32 v2, 4, v1
    s_mul_i32 s36, s17, 16
    v_add_u32 v2, s36, v2
    v_and_b32 v3, 15, v1
    v_lshrrev_b32 v4, 4, v1
    v_xor_b32 v4, v4, v3
    v_lshlrev_b32 v4, 4, v4
    v_mul_u32_u24 v5, 256, v2
    v_add_u32 v5, v5, v4
    v_add_u32 v16, s53, v5
    v_xor_b32 v5, 64, v5
    v_add_u32 v17, s53, v5
    v_mul_lo_u32 v2, v2, s56
    v_lshlrev_b32 v3, 4, v3
    v_add_u32 v18, v2, v3
    s_lshl_b32 s37, s56, 2
    s_mov_b32 s39, s57
    s_waitcnt lgkmcnt(0)
    s_barrier
    ds_read_b128 v[32:35], v16 offset:0
    ds_read_b128 v[36:39], v17 offset:1024
    ds_read_b128 v[40:43], v16 offset:2048
    ds_read_b128 v[44:47], v17 offset:3072
    s_waitcnt lgkmcnt(3)
    buffer_store_dwordx4 v[32:35], v18, s[4:7], s39 offen sc1
    s_add_u32 s39, s39, s37
    s_waitcnt lgkmcnt(2)
    buffer_store_dwordx4 v[36:39], v18, s[4:7], s39 offen sc1
    s_add_u32 s39, s39, s37
    s_waitcnt lgkmcnt(1)
    buffer_store_dwordx4 v[40:43], v18, s[4:7], s39 offen sc1
    s_add_u32 s39, s39, s37
    s_waitcnt lgkmcnt(0)
    buffer_store_dwordx4 v[44:47], v18, s[4:7], s39 offen sc1
    s_lshl_b32 s67, s42, 8
    s_lshl_b32 s54, s79, 2
    s_add_u32 s67, s67, s54
    s_add_u32 s67, s67, 1581056
    s_cmp_eq_u32 s42, -1
    s_cselect_b32 s67, 0x40000000, s67
    s_cmp_lg_u32 s17, 0
    s_cselect_b32 s67, 0x40000000, s67
    s_mov_b64 exec, 1
    v_mov_b32 v4, 0
    v_mov_b32 v5, 1
    buffer_atomic_add v5, v4, s[4:7], s67 offen
    s_mov_b64 exec, -1
    s_cmp_ge_u32 s65, 8
    s_cbranch_scc1 Lqeg_m0
    s_waitcnt vmcnt(0)
    s_barrier
    s_lshl_b32 s67, s65, 8
    s_lshl_b32 s54, s79, 2
    s_add_u32 s67, s67, s54
    s_add_u32 s67, s67, 1581056
    s_cmp_eq_u32 s65, -1
    s_cselect_b32 s67, 0x40000000, s67
    s_cmp_lg_u32 s17, 0
    s_cselect_b32 s67, 0x40000000, s67
    s_mov_b64 exec, 1
    v_mov_b32 v4, 0
    v_mov_b32 v5, 1
    buffer_atomic_add v5, v4, s[4:7], s67 offen
    s_mov_b64 exec, -1
    s_mov_b32 s44, 1
    s_mov_b32 s42, -1
    s_mov_b32 s65, s41
    s_mov_b32 s40, s43
    s_branch Lql_m0
Lqeg_m0:
    s_mov_b32 s42, s65
    s_mov_b32 s65, s41
    s_mov_b32 s40, s43
    s_cmp_lt_u32 s65, 32
    s_cbranch_scc1 Lql_m0
    s_waitcnt vmcnt(0)
    s_barrier
    s_lshl_b32 s67, s42, 8
    s_lshl_b32 s54, s79, 2
    s_add_u32 s67, s67, s54
    s_add_u32 s67, s67, 1581056
    s_cmp_eq_u32 s42, -1
    s_cselect_b32 s67, 0x40000000, s67
    s_cmp_lg_u32 s17, 0
    s_cselect_b32 s67, 0x40000000, s67
    s_mov_b64 exec, 1
    v_mov_b32 v4, 0
    v_mov_b32 v5, 1
    buffer_atomic_add v5, v4, s[4:7], s67 offen
    s_mov_b64 exec, -1
    s_branch Lqkv_fin
Lqs1e:
    s_cmp_lg_u32 s78, 1
    s_cbranch_scc1 Lqs2e
    s_load_dwordx2 s[12:13], s[0:1], 32
    s_waitcnt lgkmcnt(0)
    s_mov_b32 s14, 4718592
    s_mov_b32 s15, 0x20000
    s_lshl_b32 s26, s79, 8
    s_mov_b32 s27, 8192
    s_cmp_eq_u32 s65, 0
    s_cbranch_scc1 Ldl_44
    s_load_dwordx2 s[12:13], s[0:1], 88
    s_waitcnt lgkmcnt(0)
    s_mov_b32 s14, 256
    s_mov_b32 s15, 0x20000
    s_cmp_lg_u32 s17, 0
    s_cbranch_scc1 Llw1p1
    s_mov_b32 s19, 0
    v_and_b32 v1, 63, v0
    v_lshlrev_b32 v2, 2, v1
Llw0p1:
    buffer_load_dword v3, v2, s[12:15], 0 offen sc1
    s_waitcnt vmcnt(0)
    s_mov_b32 s20, 0
    s_mov_b32 s21, 0
    v_readlane_b32 s22, v3, 2
    s_nop 2
    s_add_u32 s20, s20, s22
    v_readlane_b32 s22, v3, 3
    s_nop 2
    s_add_u32 s21, s21, s22
    v_readlane_b32 s22, v3, 18
    s_nop 2
    s_add_u32 s20, s20, s22
    v_readlane_b32 s22, v3, 19
    s_nop 2
    s_add_u32 s21, s21, s22
    v_readlane_b32 s22, v3, 34
    s_nop 2
    s_add_u32 s20, s20, s22
    v_readlane_b32 s22, v3, 35
    s_nop 2
    s_add_u32 s21, s21, s22
    v_readlane_b32 s22, v3, 50
    s_nop 2
    s_add_u32 s20, s20, s22
    v_readlane_b32 s22, v3, 51
    s_nop 2
    s_add_u32 s21, s21, s22
    s_cmp_ge_u32 s20, s90
    s_cselect_b32 s22, s21, 0
    s_cmp_eq_u32 s89, 1
    s_cselect_b32 s20, s20, s22
    s_cmp_ge_u32 s20, 224
    s_cbranch_scc1 Llw1p1
    s_sleep 12
    s_add_u32 s19, s19, 1
    s_cmp_lt_u32 s19, 524288
    s_cbranch_scc1 Llw0p1
    s_branch Lfail
Llw1p1:
    s_barrier
    s_lshl_b32 s67, s79, 2
    s_add_u32 s67, s67, 1581056
    s_cmp_lg_u32 s17, 0
    s_cbranch_scc1 Lw_47
    s_mov_b64 exec, 1
    v_mov_b32 v2, 0
    s_mov_b32 s70, 0
Lw_45:
    buffer_load_dword v3, v2, s[4:7], s67 offen sc1
    s_waitcnt vmcnt(0)
    v_readfirstlane_b32 s69, v3
    s_nop 2
    s_and_b32 s69, s69, 255
    s_cmp_ge_u32 s69, 2
    s_cbranch_scc1 Lw_46
    s_sleep 40
    s_add_u32 s70, s70, 1
    s_cmp_lt_u32 s70, 524288
    s_cbranch_scc1 Lw_45
    s_branch Lfail
Lw_46:
    s_mov_b64 exec, -1
Lw_47:
    s_barrier
    s_load_dwordx2 s[12:13], s[0:1], 32
    s_waitcnt lgkmcnt(0)
    s_mov_b32 s14, 4718592
    s_mov_b32 s15, 0x20000
Ldl_44:
    v_and_b32 v1, 63, v0
    v_lshrrev_b32 v2, 3, v1
    v_mul_lo_u32 v2, v2, s27
    v_and_b32 v3, 7, v1
    v_bfe_u32 v4, v1, 4, 1
    v_lshlrev_b32 v4, 2, v4
    v_xor_b32 v3, v3, v4
    v_lshlrev_b32 v3, 4, v3
    v_add_u32 v19, v2, v3
    v_lshrrev_b32 v2, 4, v1
    v_lshlrev_b32 v2, 3, v2
    v_bfe_u32 v3, v1, 2, 2
    v_add_u32 v2, v2, v3
    v_lshlrev_b32 v2, 7, v2
    v_and_b32 v4, 3, v1
    v_lshlrev_b32 v4, 3, v4
    v_add_u32 v2, v2, v4
    v_bfe_u32 v3, v1, 3, 1
    v_lshlrev_b32 v3, 6, v3
    s_mul_i32 s36, s17, 32
    s_add_u32 s36, s36, 0
    s_lshr_b32 s37, s36, 5
    s_and_b32 s37, s37, 1
    s_lshl_b32 s37, s37, 6
    v_xor_b32 v4, s37, v3
    v_add_u32 v4, v4, v2
    s_lshr_b32 s37, s36, 6
    s_lshl_b32 s37, s37, 13
    s_and_b32 s34, s36, 16
    s_lshl_b32 s34, s34, 1
    s_add_u32 s37, s37, s34
    v_add_u32 v16, s37, v4
    s_mul_i32 s36, s17, 32
    s_add_u32 s36, s36, 16
    s_lshr_b32 s37, s36, 5
    s_and_b32 s37, s37, 1
    s_lshl_b32 s37, s37, 6
    v_xor_b32 v4, s37, v3
    v_add_u32 v4, v4, v2
    s_lshr_b32 s37, s36, 6
    s_lshl_b32 s37, s37, 13
    s_and_b32 s34, s36, 16
    s_lshl_b32 s34, s34, 1
    s_add_u32 s37, s37, s34
    v_add_u32 v17, s37, v4
    s_lshl_b32 s36, s17, 3
    s_add_u32 s36, s36, 0
    s_mul_i32 s39, s36, s27
    s_add_u32 s39, s39, s26
    s_lshl_b32 s34, s17, 10
    s_add_u32 s34, s34, 0
    s_lshl_b32 s37, s27, 5
    s_mov_b32 m0, s34
    s_nop 0
    buffer_load_dwordx4 v19, s[12:15], s39 offen lds
    s_add_u32 s34, s34, 4096
    s_add_u32 s39, s39, s37
    s_mov_b32 m0, s34
    s_nop 0
    buffer_load_dwordx4 v19, s[12:15], s39 offen lds
    s_add_u32 s34, s34, 4096
    s_sub_u32 s39, s39, s37
    s_add_u32 s39, s39, 128
    s_mov_b32 m0, s34
    s_nop 0
    buffer_load_dwordx4 v19, s[12:15], s39 offen lds
    s_add_u32 s34, s34, 4096
    s_add_u32 s39, s39, s37
    s_mov_b32 m0, s34
    s_nop 0
    buffer_load_dwordx4 v19, s[12:15], s39 offen lds
    s_lshl_b32 s36, s17, 3
    s_add_u32 s36, s36, 64
    s_mul_i32 s39, s36, s27
    s_add_u32 s39, s39, s26
    s_lshl_b32 s34, s17, 10
    s_add_u32 s34, s34, 16384
    s_lshl_b32 s37, s27, 5
    s_mov_b32 m0, s34
    s_nop 0
    buffer_load_dwordx4 v19, s[12:15], s39 offen lds
    s_add_u32 s34, s34, 4096
    s_add_u32 s39, s39, s37
    s_mov_b32 m0, s34
    s_nop 0
    buffer_load_dwordx4 v19, s[12:15], s39 offen lds
    s_add_u32 s34, s34, 4096
    s_sub_u32 s39, s39, s37
    s_add_u32 s39, s39, 128
    s_mov_b32 m0, s34
    s_nop 0
    buffer_load_dwordx4 v19, s[12:15], s39 offen lds
    s_add_u32 s34, s34, 4096
    s_add_u32 s39, s39, s37
    s_mov_b32 m0, s34
    s_nop 0
    buffer_load_dwordx4 v19, s[12:15], s39 offen lds
    s_lshl_b32 s36, s17, 3
    s_add_u32 s36, s36, 128
    s_mul_i32 s39, s36, s27
    s_add_u32 s39, s39, s26
    s_lshl_b32 s34, s17, 10
    s_add_u32 s34, s34, 32768
    s_lshl_b32 s37, s27, 5
    s_mov_b32 m0, s34
    s_nop 0
    buffer_load_dwordx4 v19, s[12:15], s39 offen lds
    s_add_u32 s34, s34, 4096
    s_add_u32 s39, s39, s37
    s_mov_b32 m0, s34
    s_nop 0
    buffer_load_dwordx4 v19, s[12:15], s39 offen lds
    s_add_u32 s34, s34, 4096
    s_sub_u32 s39, s39, s37
    s_add_u32 s39, s39, 128
    s_mov_b32 m0, s34
    s_nop 0
    buffer_load_dwordx4 v19, s[12:15], s39 offen lds
    s_add_u32 s34, s34, 4096
    s_add_u32 s39, s39, s37
    s_mov_b32 m0, s34
    s_nop 0
    buffer_load_dwordx4 v19, s[12:15], s39 offen lds
    s_lshl_b32 s36, s17, 3
    s_add_u32 s36, s36, 192
    s_mul_i32 s39, s36, s27
    s_add_u32 s39, s39, s26
    s_lshl_b32 s34, s17, 10
    s_add_u32 s34, s34, 49152
    s_lshl_b32 s37, s27, 5
    s_mov_b32 m0, s34
    s_nop 0
    buffer_load_dwordx4 v19, s[12:15], s39 offen lds
    s_add_u32 s34, s34, 4096
    s_add_u32 s39, s39, s37
    s_mov_b32 m0, s34
    s_nop 0
    buffer_load_dwordx4 v19, s[12:15], s39 offen lds
    s_add_u32 s34, s34, 4096
    s_sub_u32 s39, s39, s37
    s_add_u32 s39, s39, 128
    s_mov_b32 m0, s34
    s_nop 0
    buffer_load_dwordx4 v19, s[12:15], s39 offen lds
    s_add_u32 s34, s34, 4096
    s_add_u32 s39, s39, s37
    s_mov_b32 m0, s34
    s_nop 0
    buffer_load_dwordx4 v19, s[12:15], s39 offen lds
    s_lshl_b32 s36, s17, 3
    s_add_u32 s36, s36, 256
    s_mul_i32 s39, s36, s27
    s_add_u32 s39, s39, s26
    s_lshl_b32 s34, s17, 10
    s_add_u32 s34, s34, 65536
    s_lshl_b32 s37, s27, 5
    s_mov_b32 m0, s34
    s_nop 0
    buffer_load_dwordx4 v19, s[12:15], s39 offen lds
    s_add_u32 s34, s34, 4096
    s_add_u32 s39, s39, s37
    s_mov_b32 m0, s34
    s_nop 0
    buffer_load_dwordx4 v19, s[12:15], s39 offen lds
    s_add_u32 s34, s34, 4096
    s_sub_u32 s39, s39, s37
    s_add_u32 s39, s39, 128
    s_mov_b32 m0, s34
    s_nop 0
    buffer_load_dwordx4 v19, s[12:15], s39 offen lds
    s_add_u32 s34, s34, 4096
    s_add_u32 s39, s39, s37
    s_mov_b32 m0, s34
    s_nop 0
    buffer_load_dwordx4 v19, s[12:15], s39 offen lds
    s_lshl_b32 s36, s17, 3
    s_add_u32 s36, s36, 320
    s_mul_i32 s39, s36, s27
    s_add_u32 s39, s39, s26
    s_lshl_b32 s34, s17, 10
    s_add_u32 s34, s34, 81920
    s_lshl_b32 s37, s27, 5
    s_mov_b32 m0, s34
    s_nop 0
    buffer_load_dwordx4 v19, s[12:15], s39 offen lds
    s_add_u32 s34, s34, 4096
    s_add_u32 s39, s39, s37
    s_mov_b32 m0, s34
    s_nop 0
    buffer_load_dwordx4 v19, s[12:15], s39 offen lds
    s_add_u32 s34, s34, 4096
    s_sub_u32 s39, s39, s37
    s_add_u32 s39, s39, 128
    s_mov_b32 m0, s34
    s_nop 0
    buffer_load_dwordx4 v19, s[12:15], s39 offen lds
    s_add_u32 s34, s34, 4096
    s_add_u32 s39, s39, s37
    s_mov_b32 m0, s34
    s_nop 0
    buffer_load_dwordx4 v19, s[12:15], s39 offen lds
    s_lshl_b32 s36, s17, 3
    s_add_u32 s36, s36, 384
    s_mul_i32 s39, s36, s27
    s_add_u32 s39, s39, s26
    s_lshl_b32 s34, s17, 10
    s_add_u32 s34, s34, 98304
    s_lshl_b32 s37, s27, 5
    s_mov_b32 m0, s34
    s_nop 0
    buffer_load_dwordx4 v19, s[12:15], s39 offen lds
    s_add_u32 s34, s34, 4096
    s_add_u32 s39, s39, s37
    s_mov_b32 m0, s34
    s_nop 0
    buffer_load_dwordx4 v19, s[12:15], s39 offen lds
    s_add_u32 s34, s34, 4096
    s_sub_u32 s39, s39, s37
    s_add_u32 s39, s39, 128
    s_mov_b32 m0, s34
    s_nop 0
    buffer_load_dwordx4 v19, s[12:15], s39 offen lds
    s_add_u32 s34, s34, 4096
    s_add_u32 s39, s39, s37
    s_mov_b32 m0, s34
    s_nop 0
    buffer_load_dwordx4 v19, s[12:15], s39 offen lds
    s_lshl_b32 s36, s17, 3
    s_add_u32 s36, s36, 448
    s_mul_i32 s39, s36, s27
    s_add_u32 s39, s39, s26
    s_lshl_b32 s34, s17, 10
    s_add_u32 s34, s34, 114688
    s_lshl_b32 s37, s27, 5
    s_mov_b32 m0, s34
    s_nop 0
    buffer_load_dwordx4 v19, s[12:15], s39 offen lds
    s_add_u32 s34, s34, 4096
    s_add_u32 s39, s39, s37
    s_mov_b32 m0, s34
    s_nop 0
    buffer_load_dwordx4 v19, s[12:15], s39 offen lds
    s_add_u32 s34, s34, 4096
    s_sub_u32 s39, s39, s37
    s_add_u32 s39, s39, 128
    s_mov_b32 m0, s34
    s_nop 0
    buffer_load_dwordx4 v19, s[12:15], s39 offen lds
    s_add_u32 s34, s34, 4096
    s_add_u32 s39, s39, s37
    s_mov_b32 m0, s34
    s_nop 0
    buffer_load_dwordx4 v19, s[12:15], s39 offen lds
    s_lshl_b32 s36, s17, 3
    s_add_u32 s36, s36, 512
    s_mul_i32 s39, s36, s27
    s_add_u32 s39, s39, s26
    s_lshl_b32 s34, s17, 10
    s_add_u32 s34, s34, 131072
    s_lshl_b32 s37, s27, 5
    s_mov_b32 m0, s34
    s_nop 0
    buffer_load_dwordx4 v19, s[12:15], s39 offen lds
    s_add_u32 s34, s34, 4096
    s_add_u32 s39, s39, s37
    s_mov_b32 m0, s34
    s_nop 0
    buffer_load_dwordx4 v19, s[12:15], s39 offen lds
    s_add_u32 s34, s34, 4096
    s_sub_u32 s39, s39, s37
    s_add_u32 s39, s39, 128
    s_mov_b32 m0, s34
    s_nop 0
    buffer_load_dwordx4 v19, s[12:15], s39 offen lds
    s_add_u32 s34, s34, 4096
    s_add_u32 s39, s39, s37
    s_mov_b32 m0, s34
    s_nop 0
    buffer_load_dwordx4 v19, s[12:15], s39 offen lds
    s_waitcnt vmcnt(0)
    s_barrier
    ds_read_b64_tr_b16 a[0:1], v16 offset:0
    ds_read_b64_tr_b16 a[2:3], v16 offset:512
    ds_read_b64_tr_b16 a[72:73], v17 offset:0
    ds_read_b64_tr_b16 a[74:75], v17 offset:512
    ds_read_b64_tr_b16 a[4:5], v16 offset:4096
    ds_read_b64_tr_b16 a[6:7], v16 offset:4608
    ds_read_b64_tr_b16 a[76:77], v17 offset:4096
    ds_read_b64_tr_b16 a[78:79], v17 offset:4608
    s_waitcnt lgkmcnt(0)
    ds_read_b64_tr_b16 a[8:9], v16 offset:16384
    ds_read_b64_tr_b16 a[10:11], v16 offset:16896
    ds_read_b64_tr_b16 a[80:81], v17 offset:16384
    ds_read_b64_tr_b16 a[82:83], v17 offset:16896
    ds_read_b64_tr_b16 a[12:13], v16 offset:20480
    ds_read_b64_tr_b16 a[14:15], v16 offset:20992
    ds_read_b64_tr_b16 a[84:85], v17 offset:20480
    ds_read_b64_tr_b16 a[86:87], v17 offset:20992
    s_waitcnt lgkmcnt(0)
    ds_read_b64_tr_b16 a[16:17], v16 offset:32768
    ds_read_b64_tr_b16 a[18:19], v16 offset:33280
    ds_read_b64_tr_b16 a[88:89], v17 offset:32768
    ds_read_b64_tr_b16 a[90:91], v17 offset:33280
    ds_read_b64_tr_b16 a[20:21], v16 offset:36864
    ds_read_b64_tr_b16 a[22:23], v16 offset:37376
    ds_read_b64_tr_b16 a[92:93], v17 offset:36864
    ds_read_b64_tr_b16 a[94:95], v17 offset:37376
    s_waitcnt lgkmcnt(0)
    ds_read_b64_tr_b16 a[24:25], v16 offset:49152
    ds_read_b64_tr_b16 a[26:27], v16 offset:49664
    ds_read_b64_tr_b16 a[96:97], v17 offset:49152
    ds_read_b64_tr_b16 a[98:99], v17 offset:49664
    ds_read_b64_tr_b16 a[28:29], v16 offset:53248
    ds_read_b64_tr_b16 a[30:31], v16 offset:53760
    ds_read_b64_tr_b16 a[100:101], v17 offset:53248
    ds_read_b64_tr_b16 a[102:103], v17 offset:53760
    s_waitcnt lgkmcnt(0)
    v_add_u32 v5, 65536, v16
    ds_read_b64_tr_b16 a[32:33], v5 offset:0
    v_add_u32 v5, 65536, v16
    ds_read_b64_tr_b16 a[34:35], v5 offset:512
    v_add_u32 v5, 65536, v17
    ds_read_b64_tr_b16 a[104:105], v5 offset:0
    v_add_u32 v5, 65536, v17
    ds_read_b64_tr_b16 a[106:107], v5 offset:512
    v_add_u32 v5, 65536, v16
    ds_read_b64_tr_b16 a[36:37], v5 offset:4096
    v_add_u32 v5, 65536, v16
    ds_read_b64_tr_b16 a[38:39], v5 offset:4608
    v_add_u32 v5, 65536, v17
    ds_read_b64_tr_b16 a[108:109], v5 offset:4096
    v_add_u32 v5, 65536, v17
    ds_read_b64_tr_b16 a[110:111], v5 offset:4608
    s_waitcnt lgkmcnt(0)
    v_add_u32 v5, 65536, v16
    ds_read_b64_tr_b16 a[40:41], v5 offset:16384
    v_add_u32 v5, 65536, v16
    ds_read_b64_tr_b16 a[42:43], v5 offset:16896
    v_add_u32 v5, 65536, v17
    ds_read_b64_tr_b16 a[112:113], v5 offset:16384
    v_add_u32 v5, 65536, v17
    ds_read_b64_tr_b16 a[114:115], v5 offset:16896
    v_add_u32 v5, 65536, v16
    ds_read_b64_tr_b16 a[44:45], v5 offset:20480
    v_add_u32 v5, 65536, v16
    ds_read_b64_tr_b16 a[46:47], v5 offset:20992
    v_add_u32 v5, 65536, v17
    ds_read_b64_tr_b16 a[116:117], v5 offset:20480
    v_add_u32 v5, 65536, v17
    ds_read_b64_tr_b16 a[118:119], v5 offset:20992
    s_waitcnt lgkmcnt(0)
    v_add_u32 v5, 65536, v16
    ds_read_b64_tr_b16 a[48:49], v5 offset:32768
    v_add_u32 v5, 65536, v16
    ds_read_b64_tr_b16 a[50:51], v5 offset:33280
    v_add_u32 v5, 65536, v17
    ds_read_b64_tr_b16 a[120:121], v5 offset:32768
    v_add_u32 v5, 65536, v17
    ds_read_b64_tr_b16 a[122:123], v5 offset:33280
    v_add_u32 v5, 65536, v16
    ds_read_b64_tr_b16 a[52:53], v5 offset:36864
    v_add_u32 v5, 65536, v16
    ds_read_b64_tr_b16 a[54:55], v5 offset:37376
    v_add_u32 v5, 65536, v17
    ds_read_b64_tr_b16 a[124:125], v5 offset:36864
    v_add_u32 v5, 65536, v17
    ds_read_b64_tr_b16 a[126:127], v5 offset:37376
    s_waitcnt lgkmcnt(0)
    v_add_u32 v5, 65536, v16
    ds_read_b64_tr_b16 a[56:57], v5 offset:49152
    v_add_u32 v5, 65536, v16
    ds_read_b64_tr_b16 a[58:59], v5 offset:49664
    v_add_u32 v5, 65536, v17
    ds_read_b64_tr_b16 a[128:129], v5 offset:49152
    v_add_u32 v5, 65536, v17
    ds_read_b64_tr_b16 a[130:131], v5 offset:49664
    v_add_u32 v5, 65536, v16
    ds_read_b64_tr_b16 a[60:61], v5 offset:53248
    v_add_u32 v5, 65536, v16
    ds_read_b64_tr_b16 a[62:63], v5 offset:53760
    v_add_u32 v5, 65536, v17
    ds_read_b64_tr_b16 a[132:133], v5 offset:53248
    v_add_u32 v5, 65536, v17
    ds_read_b64_tr_b16 a[134:135], v5 offset:53760
    s_waitcnt lgkmcnt(0)
    v_add_u32 v5, 131072, v16
    ds_read_b64_tr_b16 a[64:65], v5 offset:0
    v_add_u32 v5, 131072, v16
    ds_read_b64_tr_b16 a[66:67], v5 offset:512
    v_add_u32 v5, 131072, v17
    ds_read_b64_tr_b16 a[136:137], v5 offset:0
    v_add_u32 v5, 131072, v17
    ds_read_b64_tr_b16 a[138:139], v5 offset:512
    v_add_u32 v5, 131072, v16
    ds_read_b64_tr_b16 a[68:69], v5 offset:4096
    v_add_u32 v5, 131072, v16
    ds_read_b64_tr_b16 a[70:71], v5 offset:4608
    v_add_u32 v5, 131072, v17
    ds_read_b64_tr_b16 a[140:141], v5 offset:4096
    v_add_u32 v5, 131072, v17
    ds_read_b64_tr_b16 a[142:143], v5 offset:4608
    s_waitcnt lgkmcnt(0)
    s_barrier
    s_mov_b32 s25, 1152
    v_and_b32 v1, 63, v0
    v_and_b32 v2, 15, v1
    v_lshrrev_b32 v3, 4, v1
    v_bfe_u32 v4, v2, 1, 3
    v_xor_b32 v3, v3, v4
    v_lshlrev_b32 v3, 4, v3
    v_lshlrev_b32 v2, 7, v2
    v_add_u32 v8, v2, v3
    v_xor_b32 v9, 64, v8
    v_lshrrev_b32 v2, 3, v1
    v_mul_lo_u32 v2, v2, s25
    v_and_b32 v3, 7, v1
    v_lshrrev_b32 v4, 4, v1
    v_xor_b32 v3, v3, v4
    s_and_b32 s37, s17, 1
    s_lshl_b32 s34, s37, 2
    v_xor_b32 v3, s34, v3
    v_lshlrev_b32 v3, 4, v3
    v_add_u32 v12, v2, v3
    s_load_dwordx2 s[12:13], s[0:1], 88
    s_waitcnt lgkmcnt(0)
    s_mov_b32 s14, 256
    s_mov_b32 s15, 0x20000
    s_cmp_lg_u32 s17, 0
    s_cbranch_scc1 Llw1q1
    s_mov_b32 s19, 0
    v_and_b32 v1, 63, v0
    v_lshlrev_b32 v2, 2, v1
Llw0q1:
    buffer_load_dword v3, v2, s[12:15], 0 offen sc1
    s_waitcnt vmcnt(0)
    s_mov_b32 s20, 0
    s_mov_b32 s21, 0
    v_readlane_b32 s22, v3, 2
    s_nop 2
    s_add_u32 s20, s20, s22
    v_readlane_b32 s22, v3, 3
    s_nop 2
    s_add_u32 s21, s21, s22
    v_readlane_b32 s22, v3, 18
    s_nop 2
    s_add_u32 s20, s20, s22
    v_readlane_b32 s22, v3, 19
    s_nop 2
    s_add_u32 s21, s21, s22
    v_readlane_b32 s22, v3, 34
    s_nop 2
    s_add_u32 s20, s20, s22
    v_readlane_b32 s22, v3, 35
    s_nop 2
    s_add_u32 s21, s21, s22
    v_readlane_b32 s22, v3, 50
    s_nop 2
    s_add_u32 s20, s20, s22
    v_readlane_b32 s22, v3, 51
    s_nop 2
    s_add_u32 s21, s21, s22
    s_cmp_ge_u32 s20, s90
    s_cselect_b32 s22, s21, 0
    s_cmp_eq_u32 s89, 1
    s_cselect_b32 s20, s20, s22
    s_cmp_ge_u32 s20, 224
    s_cbranch_scc1 Llw1q1
    s_sleep 12
    s_add_u32 s19, s19, 1
    s_cmp_lt_u32 s19, 524288
    s_cbranch_scc1 Llw0q1
    s_branch Lfail
Llw1q1:
    s_barrier
    s_cmp_lg_u32 s17, 0
    s_cbranch_scc1 Linv_48
    buffer_inv sc1
    s_waitcnt vmcnt(0)
Linv_48:
    s_barrier
    s_mov_b32 s8, s4
    s_mov_b32 s9, s5
    s_mov_b32 s10, s6
    s_mov_b32 s11, s7
    s_and_b32 s53, s64, 31
    s_mov_b32 s40, 0
    s_mov_b32 s42, -1
    s_mul_i32 s24, s65, 73728
    s_add_u32 s24, s24, 2097152
    s_lshl_b32 s36, s17, 3
    s_mul_i32 s36, s36, s25
    s_add_u32 s36, s36, s24
    s_lshl_b32 s37, s25, 5
    s_lshl_b32 s39, s17, 10
    s_add_u32 s39, s39, s40
    s_add_u32 s38, s36, 0
    s_add_u32 s34, s39, 0
    s_mov_b32 m0, s34
    s_nop 0
    buffer_load_dwordx4 v12, s[8:11], s38 offen lds
    s_add_u32 s38, s38, s37
    s_add_u32 s34, s34, 4096
    s_mov_b32 m0, s34
    s_nop 0
    buffer_load_dwordx4 v12, s[8:11], s38 offen lds
    s_add_u32 s38, s36, 128
    s_add_u32 s34, s39, 8192
    s_mov_b32 m0, s34
    s_nop 0
    buffer_load_dwordx4 v12, s[8:11], s38 offen lds
    s_add_u32 s38, s38, s37
    s_add_u32 s34, s34, 4096
    s_mov_b32 m0, s34
    s_nop 0
    buffer_load_dwordx4 v12, s[8:11], s38 offen lds
    s_add_u32 s38, s36, 256
    s_add_u32 s34, s39, 16384
    s_mov_b32 m0, s34
    s_nop 0
    buffer_load_dwordx4 v12, s[8:11], s38 offen lds
    s_add_u32 s38, s38, s37
    s_add_u32 s34, s34, 4096
    s_mov_b32 m0, s34
    s_nop 0
    buffer_load_dwordx4 v12, s[8:11], s38 offen lds
    s_add_u32 s38, s36, 384
    s_add_u32 s34, s39, 24576
    s_mov_b32 m0, s34
    s_nop 0
    buffer_load_dwordx4 v12, s[8:11], s38 offen lds
    s_add_u32 s38, s38, s37
    s_add_u32 s34, s34, 4096
    s_mov_b32 m0, s34
    s_nop 0
    buffer_load_dwordx4 v12, s[8:11], s38 offen lds
    s_add_u32 s38, s36, 512
    s_add_u32 s34, s39, 32768
    s_mov_b32 m0, s34
    s_nop 0
    buffer_load_dwordx4 v12, s[8:11], s38 offen lds
    s_add_u32 s38, s38, s37
    s_add_u32 s34, s34, 4096
    s_mov_b32 m0, s34
    s_nop 0
    buffer_load_dwordx4 v12, s[8:11], s38 offen lds
    s_add_u32 s38, s36, 640
    s_add_u32 s34, s39, 40960
    s_mov_b32 m0, s34
    s_nop 0
    buffer_load_dwordx4 v12, s[8:11], s38 offen lds
    s_add_u32 s38, s38, s37
    s_add_u32 s34, s34, 4096
    s_mov_b32 m0, s34
    s_nop 0
    buffer_load_dwordx4 v12, s[8:11], s38 offen lds
    s_add_u32 s38, s36, 768
    s_add_u32 s34, s39, 49152
    s_mov_b32 m0, s34
    s_nop 0
    buffer_load_dwordx4 v12, s[8:11], s38 offen lds
    s_add_u32 s38, s38, s37
    s_add_u32 s34, s34, 4096
    s_mov_b32 m0, s34
    s_nop 0
    buffer_load_dwordx4 v12, s[8:11], s38 offen lds
    s_add_u32 s38, s36, 896
    s_add_u32 s34, s39, 57344
    s_mov_b32 m0, s34
    s_nop 0
    buffer_load_dwordx4 v12, s[8:11], s38 offen lds
    s_add_u32 s38, s38, s37
    s_add_u32 s34, s34, 4096
    s_mov_b32 m0, s34
    s_nop 0
    buffer_load_dwordx4 v12, s[8:11], s38 offen lds
    s_add_u32 s38, s36, 1024
    s_add_u32 s34, s39, 65536
    s_mov_b32 m0, s34
    s_nop 0
    buffer_load_dwordx4 v12, s[8:11], s38 offen lds
    s_add_u32 s38, s38, s37
    s_add_u32 s34, s34, 4096
    s_mov_b32 m0, s34
    s_nop 0
    buffer_load_dwordx4 v12, s[8:11], s38 offen lds
Lql_m1:
    s_add_u32 s41, s65, 2
    s_add_u32 s20, s65, 1
    s_cmp_lt_u32 s65, 7
    s_cselect_b32 s41, s20, s41
    s_cmp_eq_u32 s65, 3
    s_cselect_b32 s41, 8, s41
    s_xor_b32 s43, s40, 73728
    s_mul_i32 s24, s41, 73728
    s_add_u32 s24, s24, 2097152
    s_cmp_ge_u32 s41, 32
    s_cselect_b32 s24, 0x40000000, s24
    s_cmp_eq_u32 s42, -1
    s_cbranch_scc1 Lqw2_m1
    s_waitcnt vmcnt(5)
    s_branch Lqw1_m1x
Lqw2_m1:
    s_waitcnt vmcnt(0)
Lqw1_m1x:
    s_barrier
    v_add_u32 v10, s40, v8
    v_add_u32 v11, s40, v9
    v_add_u32 v13, 65536, v10
    v_add_u32 v14, 65536, v11
    ds_read_b128 v[32:35], v10 offset:0
    ds_read_b128 v[36:39], v10 offset:2048
    ds_read_b128 v[40:43], v10 offset:4096
    ds_read_b128 v[44:47], v10 offset:6144
    v_mov_b64 v[128:129], 0
    v_mov_b64 v[130:131], 0
    v_mov_b64 v[132:133], 0
    v_mov_b64 v[134:135], 0
    v_mov_b64 v[136:137], 0
    v_mov_b64 v[138:139], 0
    v_mov_b64 v[140:141], 0
    v_mov_b64 v[142:143], 0
    v_mov_b64 v[144:145], 0
    v_mov_b64 v[146:147], 0
    v_mov_b64 v[148:149], 0
    v_mov_b64 v[150:151], 0
    v_mov_b64 v[152:153], 0
    v_mov_b64 v[154:155], 0
    v_mov_b64 v[156:157], 0
    v_mov_b64 v[158:159], 0
    s_waitcnt lgkmcnt(0)
    v_mfma_f32_16x16x32_bf16 v[128:131], v[32:35], a[0:3], v[128:131]
    ds_read_b128 v[64:67], v11 offset:0
    v_mfma_f32_16x16x32_bf16 v[132:135], v[32:35], a[72:75], v[132:135]
    ds_read_b128 v[68:71], v11 offset:2048
    v_mfma_f32_16x16x32_bf16 v[136:139], v[36:39], a[0:3], v[136:139]
    ds_read_b128 v[72:75], v11 offset:4096
    v_mfma_f32_16x16x32_bf16 v[140:143], v[36:39], a[72:75], v[140:143]
    ds_read_b128 v[76:79], v11 offset:6144
    v_mfma_f32_16x16x32_bf16 v[144:147], v[40:43], a[0:3], v[144:147]
    v_mfma_f32_16x16x32_bf16 v[148:151], v[40:43], a[72:75], v[148:151]
    s_lshl_b32 s36, s17, 3
    s_mul_i32 s36, s36, s25
    s_add_u32 s36, s36, s24
    s_lshl_b32 s37, s25, 5
    s_lshl_b32 s39, s17, 10
    s_add_u32 s39, s39, s43
    s_add_u32 s38, s36, 0
    s_add_u32 s34, s39, 0
    s_mov_b32 m0, s34
    s_nop 0
    buffer_load_dwordx4 v12, s[8:11], s38 offen lds
    v_mfma_f32_16x16x32_bf16 v[152:155], v[44:47], a[0:3], v[152:155]
    v_mfma_f32_16x16x32_bf16 v[156:159], v[44:47], a[72:75], v[156:159]
    s_add_u32 s38, s38, s37
    s_add_u32 s34, s34, 4096
    s_mov_b32 m0, s34
    s_nop 0
    buffer_load_dwordx4 v12, s[8:11], s38 offen lds
    s_waitcnt lgkmcnt(0)
    v_mfma_f32_16x16x32_bf16 v[128:131], v[64:67], a[4:7], v[128:131]
    ds_read_b128 v[32:35], v10 offset:8192
    v_mfma_f32_16x16x32_bf16 v[132:135], v[64:67], a[76:79], v[132:135]
    ds_read_b128 v[36:39], v10 offset:10240
    v_mfma_f32_16x16x32_bf16 v[136:139], v[68:71], a[4:7], v[136:139]
    ds_read_b128 v[40:43], v10 offset:12288
    v_mfma_f32_16x16x32_bf16 v[140:143], v[68:71], a[76:79], v[140:143]
    ds_read_b128 v[44:47], v10 offset:14336
    v_mfma_f32_16x16x32_bf16 v[144:147], v[72:75], a[4:7], v[144:147]
    v_mfma_f32_16x16x32_bf16 v[148:151], v[72:75], a[76:79], v[148:151]
    s_add_u32 s38, s36, 128
    s_add_u32 s34, s39, 8192
    s_mov_b32 m0, s34
    s_nop 0
    buffer_load_dwordx4 v12, s[8:11], s38 offen lds
    v_mfma_f32_16x16x32_bf16 v[152:155], v[76:79], a[4:7], v[152:155]
    v_mfma_f32_16x16x32_bf16 v[156:159], v[76:79], a[76:79], v[156:159]
    s_add_u32 s38, s38, s37
    s_add_u32 s34, s34, 4096
    s_mov_b32 m0, s34
    s_nop 0
    buffer_load_dwordx4 v12, s[8:11], s38 offen lds
    s_waitcnt lgkmcnt(0)
    v_mfma_f32_16x16x32_bf16 v[128:131], v[32:35], a[8:11], v[128:131]
    ds_read_b128 v[64:67], v11 offset:8192
    v_mfma_f32_16x16x32_bf16 v[132:135], v[32:35], a[80:83], v[132:135]
    ds_read_b128 v[68:71], v11 offset:10240
    v_mfma_f32_16x16x32_bf16 v[136:139], v[36:39], a[8:11], v[136:139]
    ds_read_b128 v[72:75], v11 offset:12288
    v_mfma_f32_16x16x32_bf16 v[140:143], v[36:39], a[80:83], v[140:143]
    ds_read_b128 v[76:79], v11 offset:14336
    v_mfma_f32_16x16x32_bf16 v[144:147], v[40:43], a[8:11], v[144:147]
    v_mfma_f32_16x16x32_bf16 v[148:151], v[40:43], a[80:83], v[148:151]
    s_add_u32 s38, s36, 256
    s_add_u32 s34, s39, 16384
    s_mov_b32 m0, s34
    s_nop 0
    buffer_load_dwordx4 v12, s[8:11], s38 offen lds
    v_mfma_f32_16x16x32_bf16 v[152:155], v[44:47], a[8:11], v[152:155]
    v_mfma_f32_16x16x32_bf16 v[156:159], v[44:47], a[80:83], v[156:159]
    s_add_u32 s38, s38, s37
    s_add_u32 s34, s34, 4096
    s_mov_b32 m0, s34
    s_nop 0
    buffer_load_dwordx4 v12, s[8:11], s38 offen lds
    s_waitcnt lgkmcnt(0)
    v_mfma_f32_16x16x32_bf16 v[128:131], v[64:67], a[12:15], v[128:131]
    ds_read_b128 v[32:35], v10 offset:16384
    v_mfma_f32_16x16x32_bf16 v[132:135], v[64:67], a[84:87], v[132:135]
    ds_read_b128 v[36:39], v10 offset:18432
    v_mfma_f32_16x16x32_bf16 v[136:139], v[68:71], a[12:15], v[136:139]
    ds_read_b128 v[40:43], v10 offset:20480
    v_mfma_f32_16x16x32_bf16 v[140:143], v[68:71], a[84:87], v[140:143]
    ds_read_b128 v[44:47], v10 offset:22528
    v_mfma_f32_16x16x32_bf16 v[144:147], v[72:75], a[12:15], v[144:147]
    v_mfma_f32_16x16x32_bf16 v[148:151], v[72:75], a[84:87], v[148:151]
    s_add_u32 s38, s36, 384
    s_add_u32 s34, s39, 24576
    s_mov_b32 m0, s34
    s_nop 0
    buffer_load_dwordx4 v12, s[8:11], s38 offen lds
    v_mfma_f32_16x16x32_bf16 v[152:155], v[76:79], a[12:15], v[152:155]
    v_mfma_f32_16x16x32_bf16 v[156:159], v[76:79], a[84:87], v[156:159]
    s_add_u32 s38, s38, s37
    s_add_u32 s34, s34, 4096
    s_mov_b32 m0, s34
    s_nop 0
    buffer_load_dwordx4 v12, s[8:11], s38 offen lds
    s_waitcnt lgkmcnt(0)
    v_mfma_f32_16x16x32_bf16 v[128:131], v[32:35], a[16:19], v[128:131]
    ds_read_b128 v[64:67], v11 offset:16384
    v_mfma_f32_16x16x32_bf16 v[132:135], v[32:35], a[88:91], v[132:135]
    ds_read_b128 v[68:71], v11 offset:18432
    v_mfma_f32_16x16x32_bf16 v[136:139], v[36:39], a[16:19], v[136:139]
    ds_read_b128 v[72:75], v11 offset:20480
    v_mfma_f32_16x16x32_bf16 v[140:143], v[36:39], a[88:91], v[140:143]
    ds_read_b128 v[76:79], v11 offset:22528
    v_mfma_f32_16x16x32_bf16 v[144:147], v[40:43], a[16:19], v[144:147]
    v_mfma_f32_16x16x32_bf16 v[148:151], v[40:43], a[88:91], v[148:151]
    s_add_u32 s38, s36, 512
    s_add_u32 s34, s39, 32768
    s_mov_b32 m0, s34
    s_nop 0
    buffer_load_dwordx4 v12, s[8:11], s38 offen lds
    v_mfma_f32_16x16x32_bf16 v[152:155], v[44:47], a[16:19], v[152:155]
    v_mfma_f32_16x16x32_bf16 v[156:159], v[44:47], a[88:91], v[156:159]
    s_add_u32 s38, s38, s37
    s_add_u32 s34, s34, 4096
    s_mov_b32 m0, s34
    s_nop 0
    buffer_load_dwordx4 v12, s[8:11], s38 offen lds
    s_waitcnt lgkmcnt(0)
    v_mfma_f32_16x16x32_bf16 v[128:131], v[64:67], a[20:23], v[128:131]
    ds_read_b128 v[32:35], v10 offset:24576
    v_mfma_f32_16x16x32_bf16 v[132:135], v[64:67], a[92:95], v[132:135]
    ds_read_b128 v[36:39], v10 offset:26624
    v_mfma_f32_16x16x32_bf16 v[136:139], v[68:71], a[20:23], v[136:139]
    ds_read_b128 v[40:43], v10 offset:28672
    v_mfma_f32_16x16x32_bf16 v[140:143], v[68:71], a[92:95], v[140:143]
    ds_read_b128 v[44:47], v10 offset:30720
    v_mfma_f32_16x16x32_bf16 v[144:147], v[72:75], a[20:23], v[144:147]
    v_mfma_f32_16x16x32_bf16 v[148:151], v[72:75], a[92:95], v[148:151]
    s_add_u32 s38, s36, 640
    s_add_u32 s34, s39, 40960
    s_mov_b32 m0, s34
    s_nop 0
    buffer_load_dwordx4 v12, s[8:11], s38 offen lds
    v_mfma_f32_16x16x32_bf16 v[152:155], v[76:79], a[20:23], v[152:155]
    v_mfma_f32_16x16x32_bf16 v[156:159], v[76:79], a[92:95], v[156:159]
    s_add_u32 s38, s38, s37
    s_add_u32 s34, s34, 4096
    s_mov_b32 m0, s34
    s_nop 0
    buffer_load_dwordx4 v12, s[8:11], s38 offen lds
    s_waitcnt lgkmcnt(0)
    v_mfma_f32_16x16x32_bf16 v[128:131], v[32:35], a[24:27], v[128:131]
    ds_read_b128 v[64:67], v11 offset:24576
    v_mfma_f32_16x16x32_bf16 v[132:135], v[32:35], a[96:99], v[132:135]
    ds_read_b128 v[68:71], v11 offset:26624
    v_mfma_f32_16x16x32_bf16 v[136:139], v[36:39], a[24:27], v[136:139]
    ds_read_b128 v[72:75], v11 offset:28672
    v_mfma_f32_16x16x32_bf16 v[140:143], v[36:39], a[96:99], v[140:143]
    ds_read_b128 v[76:79], v11 offset:30720
    v_mfma_f32_16x16x32_bf16 v[144:147], v[40:43], a[24:27], v[144:147]
    v_mfma_f32_16x16x32_bf16 v[148:151], v[40:43], a[96:99], v[148:151]
    s_add_u32 s38, s36, 768
    s_add_u32 s34, s39, 49152
    s_mov_b32 m0, s34
    s_nop 0
    buffer_load_dwordx4 v12, s[8:11], s38 offen lds
    v_mfma_f32_16x16x32_bf16 v[152:155], v[44:47], a[24:27], v[152:155]
    v_mfma_f32_16x16x32_bf16 v[156:159], v[44:47], a[96:99], v[156:159]
    s_add_u32 s38, s38, s37
    s_add_u32 s34, s34, 4096
    s_mov_b32 m0, s34
    s_nop 0
    buffer_load_dwordx4 v12, s[8:11], s38 offen lds
    s_waitcnt lgkmcnt(0)
    v_mfma_f32_16x16x32_bf16 v[128:131], v[64:67], a[28:31], v[128:131]
    ds_read_b128 v[32:35], v10 offset:32768
    v_mfma_f32_16x16x32_bf16 v[132:135], v[64:67], a[100:103], v[132:135]
    ds_read_b128 v[36:39], v10 offset:34816
    v_mfma_f32_16x16x32_bf16 v[136:139], v[68:71], a[28:31], v[136:139]
    ds_read_b128 v[40:43], v10 offset:36864
    v_mfma_f32_16x16x32_bf16 v[140:143], v[68:71], a[100:103], v[140:143]
    ds_read_b128 v[44:47], v10 offset:38912
    v_mfma_f32_16x16x32_bf16 v[144:147], v[72:75], a[28:31], v[144:147]
    v_mfma_f32_16x16x32_bf16 v[148:151], v[72:75], a[100:103], v[148:151]
    s_add_u32 s38, s36, 896
    s_add_u32 s34, s39, 57344
    s_mov_b32 m0, s34
    s_nop 0
    buffer_load_dwordx4 v12, s[8:11], s38 offen lds
    v_mfma_f32_16x16x32_bf16 v[152:155], v[76:79], a[28:31], v[152:155]
    v_mfma_f32_16x16x32_bf16 v[156:159], v[76:79], a[100:103], v[156:159]
    s_add_u32 s38, s38, s37
    s_add_u32 s34, s34, 4096
    s_mov_b32 m0, s34
    s_nop 0
    buffer_load_dwordx4 v12, s[8:11], s38 offen lds
    s_waitcnt lgkmcnt(0)
    v_mfma_f32_16x16x32_bf16 v[128:131], v[32:35], a[32:35], v[128:131]
    ds_read_b128 v[64:67], v11 offset:32768
    v_mfma_f32_16x16x32_bf16 v[132:135], v[32:35], a[104:107], v[132:135]
    ds_read_b128 v[68:71], v11 offset:34816
    v_mfma_f32_16x16x32_bf16 v[136:139], v[36:39], a[32:35], v[136:139]
    ds_read_b128 v[72:75], v11 offset:36864
    v_mfma_f32_16x16x32_bf16 v[140:143], v[36:39], a[104:107], v[140:143]
    ds_read_b128 v[76:79], v11 offset:38912
    v_mfma_f32_16x16x32_bf16 v[144:147], v[40:43], a[32:35], v[144:147]
    v_mfma_f32_16x16x32_bf16 v[148:151], v[40:43], a[104:107], v[148:151]
    s_add_u32 s38, s36, 1024
    s_add_u32 s34, s39, 65536
    s_mov_b32 m0, s34
    s_nop 0
    buffer_load_dwordx4 v12, s[8:11], s38 offen lds
    v_mfma_f32_16x16x32_bf16 v[152:155], v[44:47], a[32:35], v[152:155]
    v_mfma_f32_16x16x32_bf16 v[156:159], v[44:47], a[104:107], v[156:159]
    s_add_u32 s38, s38, s37
    s_add_u32 s34, s34, 4096
    s_mov_b32 m0, s34
    s_nop 0
    buffer_load_dwordx4 v12, s[8:11], s38 offen lds
    s_waitcnt lgkmcnt(0)
    v_mfma_f32_16x16x32_bf16 v[128:131], v[64:67], a[36:39], v[128:131]
    ds_read_b128 v[32:35], v10 offset:40960
    v_mfma_f32_16x16x32_bf16 v[132:135], v[64:67], a[108:111], v[132:135]
    ds_read_b128 v[36:39], v10 offset:43008
    v_mfma_f32_16x16x32_bf16 v[136:139], v[68:71], a[36:39], v[136:139]
    ds_read_b128 v[40:43], v10 offset:45056
    v_mfma_f32_16x16x32_bf16 v[140:143], v[68:71], a[108:111], v[140:143]
    ds_read_b128 v[44:47], v10 offset:47104
    v_mfma_f32_16x16x32_bf16 v[144:147], v[72:75], a[36:39], v[144:147]
    v_mfma_f32_16x16x32_bf16 v[148:151], v[72:75], a[108:111], v[148:151]
    v_mfma_f32_16x16x32_bf16 v[152:155], v[76:79], a[36:39], v[152:155]
    v_mfma_f32_16x16x32_bf16 v[156:159], v[76:79], a[108:111], v[156:159]
    s_waitcnt lgkmcnt(0)
    v_mfma_f32_16x16x32_bf16 v[128:131], v[32:35], a[40:43], v[128:131]
    ds_read_b128 v[64:67], v11 offset:40960
    v_mfma_f32_16x16x32_bf16 v[132:135], v[32:35], a[112:115], v[132:135]
    ds_read_b128 v[68:71], v11 offset:43008
    v_mfma_f32_16x16x32_bf16 v[136:139], v[36:39], a[40:43], v[136:139]
    ds_read_b128 v[72:75], v11 offset:45056
    v_mfma_f32_16x16x32_bf16 v[140:143], v[36:39], a[112:115], v[140:143]
    ds_read_b128 v[76:79], v11 offset:47104
    v_mfma_f32_16x16x32_bf16 v[144:147], v[40:43], a[40:43], v[144:147]
    v_mfma_f32_16x16x32_bf16 v[148:151], v[40:43], a[112:115], v[148:151]
    v_mfma_f32_16x16x32_bf16 v[152:155], v[44:47], a[40:43], v[152:155]
    v_mfma_f32_16x16x32_bf16 v[156:159], v[44:47], a[112:115], v[156:159]
    s_waitcnt lgkmcnt(0)
    v_mfma_f32_16x16x32_bf16 v[128:131], v[64:67], a[44:47], v[128:131]
    ds_read_b128 v[32:35], v10 offset:49152
    v_mfma_f32_16x16x32_bf16 v[132:135], v[64:67], a[116:119], v[132:135]
    ds_read_b128 v[36:39], v10 offset:51200
    v_mfma_f32_16x16x32_bf16 v[136:139], v[68:71], a[44:47], v[136:139]
    ds_read_b128 v[40:43], v10 offset:53248
    v_mfma_f32_16x16x32_bf16 v[140:143], v[68:71], a[116:119], v[140:143]
    ds_read_b128 v[44:47], v10 offset:55296
    v_mfma_f32_16x16x32_bf16 v[144:147], v[72:75], a[44:47], v[144:147]
    v_mfma_f32_16x16x32_bf16 v[148:151], v[72:75], a[116:119], v[148:151]
    v_mfma_f32_16x16x32_bf16 v[152:155], v[76:79], a[44:47], v[152:155]
    v_mfma_f32_16x16x32_bf16 v[156:159], v[76:79], a[116:119], v[156:159]
    s_waitcnt lgkmcnt(0)
    v_mfma_f32_16x16x32_bf16 v[128:131], v[32:35], a[48:51], v[128:131]
    ds_read_b128 v[64:67], v11 offset:49152
    v_mfma_f32_16x16x32_bf16 v[132:135], v[32:35], a[120:123], v[132:135]
    ds_read_b128 v[68:71], v11 offset:51200
    v_mfma_f32_16x16x32_bf16 v[136:139], v[36:39], a[48:51], v[136:139]
    ds_read_b128 v[72:75], v11 offset:53248
    v_mfma_f32_16x16x32_bf16 v[140:143], v[36:39], a[120:123], v[140:143]
    ds_read_b128 v[76:79], v11 offset:55296
    v_mfma_f32_16x16x32_bf16 v[144:147], v[40:43], a[48:51], v[144:147]
    v_mfma_f32_16x16x32_bf16 v[148:151], v[40:43], a[120:123], v[148:151]
    v_mfma_f32_16x16x32_bf16 v[152:155], v[44:47], a[48:51], v[152:155]
    v_mfma_f32_16x16x32_bf16 v[156:159], v[44:47], a[120:123], v[156:159]
    s_waitcnt lgkmcnt(0)
    v_mfma_f32_16x16x32_bf16 v[128:131], v[64:67], a[52:55], v[128:131]
    ds_read_b128 v[32:35], v10 offset:57344
    v_mfma_f32_16x16x32_bf16 v[132:135], v[64:67], a[124:127], v[132:135]
    ds_read_b128 v[36:39], v10 offset:59392
    v_mfma_f32_16x16x32_bf16 v[136:139], v[68:71], a[52:55], v[136:139]
    ds_read_b128 v[40:43], v10 offset:61440
    v_mfma_f32_16x16x32_bf16 v[140:143], v[68:71], a[124:127], v[140:143]
    ds_read_b128 v[44:47], v10 offset:63488
    v_mfma_f32_16x16x32_bf16 v[144:147], v[72:75], a[52:55], v[144:147]
    v_mfma_f32_16x16x32_bf16 v[148:151], v[72:75], a[124:127], v[148:151]
    v_mfma_f32_16x16x32_bf16 v[152:155], v[76:79], a[52:55], v[152:155]
    v_mfma_f32_16x16x32_bf16 v[156:159], v[76:79], a[124:127], v[156:159]
    s_waitcnt lgkmcnt(0)
    v_mfma_f32_16x16x32_bf16 v[128:131], v[32:35], a[56:59], v[128:131]
    ds_read_b128 v[64:67], v11 offset:57344
    v_mfma_f32_16x16x32_bf16 v[132:135], v[32:35], a[128:131], v[132:135]
    ds_read_b128 v[68:71], v11 offset:59392
    v_mfma_f32_16x16x32_bf16 v[136:139], v[36:39], a[56:59], v[136:139]
    ds_read_b128 v[72:75], v11 offset:61440
    v_mfma_f32_16x16x32_bf16 v[140:143], v[36:39], a[128:131], v[140:143]
    ds_read_b128 v[76:79], v11 offset:63488
    v_mfma_f32_16x16x32_bf16 v[144:147], v[40:43], a[56:59], v[144:147]
    v_mfma_f32_16x16x32_bf16 v[148:151], v[40:43], a[128:131], v[148:151]
    v_mfma_f32_16x16x32_bf16 v[152:155], v[44:47], a[56:59], v[152:155]
    v_mfma_f32_16x16x32_bf16 v[156:159], v[44:47], a[128:131], v[156:159]
    s_waitcnt lgkmcnt(0)
    v_mfma_f32_16x16x32_bf16 v[128:131], v[64:67], a[60:63], v[128:131]
    ds_read_b128 v[32:35], v13 offset:0
    v_mfma_f32_16x16x32_bf16 v[132:135], v[64:67], a[132:135], v[132:135]
    ds_read_b128 v[36:39], v13 offset:2048
    v_mfma_f32_16x16x32_bf16 v[136:139], v[68:71], a[60:63], v[136:139]
    ds_read_b128 v[40:43], v13 offset:4096
    v_mfma_f32_16x16x32_bf16 v[140:143], v[68:71], a[132:135], v[140:143]
    ds_read_b128 v[44:47], v13 offset:6144
    v_mfma_f32_16x16x32_bf16 v[144:147], v[72:75], a[60:63], v[144:147]
    v_mfma_f32_16x16x32_bf16 v[148:151], v[72:75], a[132:135], v[148:151]
    v_mfma_f32_16x16x32_bf16 v[152:155], v[76:79], a[60:63], v[152:155]
    v_mfma_f32_16x16x32_bf16 v[156:159], v[76:79], a[132:135], v[156:159]
    s_waitcnt lgkmcnt(0)
    v_mfma_f32_16x16x32_bf16 v[128:131], v[32:35], a[64:67], v[128:131]
    ds_read_b128 v[64:67], v14 offset:0
    v_mfma_f32_16x16x32_bf16 v[132:135], v[32:35], a[136:139], v[132:135]
    ds_read_b128 v[68:71], v14 offset:2048
    v_mfma_f32_16x16x32_bf16 v[136:139], v[36:39], a[64:67], v[136:139]
    ds_read_b128 v[72:75], v14 offset:4096
    v_mfma_f32_16x16x32_bf16 v[140:143], v[36:39], a[136:139], v[140:143]
    ds_read_b128 v[76:79], v14 offset:6144
    v_mfma_f32_16x16x32_bf16 v[144:147], v[40:43], a[64:67], v[144:147]
    v_mfma_f32_16x16x32_bf16 v[148:151], v[40:43], a[136:139], v[148:151]
    v_mfma_f32_16x16x32_bf16 v[152:155], v[44:47], a[64:67], v[152:155]
    v_mfma_f32_16x16x32_bf16 v[156:159], v[44:47], a[136:139], v[156:159]
    s_waitcnt lgkmcnt(0)
    v_mfma_f32_16x16x32_bf16 v[128:131], v[64:67], a[68:71], v[128:131]
    v_mfma_f32_16x16x32_bf16 v[132:135], v[64:67], a[140:143], v[132:135]
    v_mfma_f32_16x16x32_bf16 v[136:139], v[68:71], a[68:71], v[136:139]
    v_mfma_f32_16x16x32_bf16 v[140:143], v[68:71], a[140:143], v[140:143]
    v_mfma_f32_16x16x32_bf16 v[144:147], v[72:75], a[68:71], v[144:147]
    v_mfma_f32_16x16x32_bf16 v[148:151], v[72:75], a[140:143], v[148:151]
    v_mfma_f32_16x16x32_bf16 v[152:155], v[76:79], a[68:71], v[152:155]
    v_mfma_f32_16x16x32_bf16 v[156:159], v[76:79], a[140:143], v[156:159]
    s_waitcnt vmcnt(18)
    s_barrier
    s_mov_b32 s53, 147456
    s_mul_i32 s57, s65, 524288
    s_lshl_b32 s54, s79, 13
    s_add_u32 s57, s57, s54
    s_add_u32 s57, s57, 41943040
    v_and_b32 v1, 63, v0
    v_and_b32 v2, 15, v1
    v_bfe_u32 v3, v1, 4, 1
    v_lshlrev_b32 v3, 1, v3
    v_lshrrev_b32 v4, 5, v1
    v_or_b32 v3, v3, v4
    v_bfe_u32 v4, v2, 1, 2
    v_xor_b32 v3, v3, v4
    v_lshlrev_b32 v3, 4, v3
    v_lshlrev_b32 v2, 6, v2
    v_add_u32 v2, v2, v3
    s_mul_i32 s36, s17, 2048
    s_add_u32 s36, s36, s53
    v_add_u32 v16, s36, v2
    v_cvt_pk_bf16_f32 v32, v128, v129
    v_cvt_pk_bf16_f32 v33, v130, v131
    v_cvt_pk_bf16_f32 v34, v136, v137
    v_cvt_pk_bf16_f32 v35, v138, v139
    s_nop 0
    v_permlane16_swap_b32 v32, v34
    v_permlane16_swap_b32 v33, v35
    ds_write_b128 v16, v[32:35] offset:0
    v_cvt_pk_bf16_f32 v36, v132, v133
    v_cvt_pk_bf16_f32 v37, v134, v135
    v_cvt_pk_bf16_f32 v38, v140, v141
    v_cvt_pk_bf16_f32 v39, v142, v143
    s_nop 0
    v_permlane16_swap_b32 v36, v38
    v_permlane16_swap_b32 v37, v39
    ds_write_b128 v16, v[36:39] offset:1024
    v_cvt_pk_bf16_f32 v40, v144, v145
    v_cvt_pk_bf16_f32 v41, v146, v147
    v_cvt_pk_bf16_f32 v42, v152, v153
    v_cvt_pk_bf16_f32 v43, v154, v155
    s_nop 0
    v_permlane16_swap_b32 v40, v42
    v_permlane16_swap_b32 v41, v43
    ds_write_b128 v16, v[40:43] offset:8192
    v_cvt_pk_bf16_f32 v44, v148, v149
    v_cvt_pk_bf16_f32 v45, v150, v151
    v_cvt_pk_bf16_f32 v46, v156, v157
    v_cvt_pk_bf16_f32 v47, v158, v159
    s_nop 0
    v_permlane16_swap_b32 v44, v46
    v_permlane16_swap_b32 v45, v47
    ds_write_b128 v16, v[44:47] offset:9216
    v_lshlrev_b32 v2, 4, v1
    s_lshl_b32 s36, s17, 10
    s_add_u32 s37, s36, s53
    v_add_u32 v17, s37, v2
    v_lshrrev_b32 v3, 2, v1
    v_lshlrev_b32 v3, 6, v3
    v_and_b32 v4, 3, v1
    v_bfe_u32 v5, v1, 3, 2
    v_xor_b32 v4, v4, v5
    v_lshlrev_b32 v4, 4, v4
    v_add_u32 v3, v3, v4
    v_add_u32 v18, s36, v3
    s_mov_b32 s39, s57
    s_waitcnt lgkmcnt(0)
    s_barrier
    ds_read_b128 v[32:35], v17 offset:0
    ds_read_b128 v[36:39], v17 offset:4096
    ds_read_b128 v[40:43], v17 offset:8192
    ds_read_b128 v[44:47], v17 offset:12288
    s_waitcnt lgkmcnt(3)
    buffer_store_dwordx4 v[32:35], v18, s[4:7], s39 offen sc1
    s_waitcnt lgkmcnt(2)
    s_add_u32 s36, s39, 4096
    buffer_store_dwordx4 v[36:39], v18, s[4:7], s36 offen sc1
    s_add_u32 s39, s39, 262144
    s_waitcnt lgkmcnt(1)
    buffer_store_dwordx4 v[40:43], v18, s[4:7], s39 offen sc1
    s_waitcnt lgkmcnt(0)
    s_add_u32 s36, s39, 4096
    buffer_store_dwordx4 v[44:47], v18, s[4:7], s36 offen sc1
    s_lshl_b32 s67, s42, 8
    s_lshl_b32 s54, s79, 2
    s_add_u32 s67, s67, s54
    s_add_u32 s67, s67, 1581056
    s_cmp_eq_u32 s42, -1
    s_cselect_b32 s67, 0x40000000, s67
    s_cmp_lg_u32 s17, 0
    s_cselect_b32 s67, 0x40000000, s67
    s_mov_b64 exec, 1
    v_mov_b32 v4, 0
    v_mov_b32 v5, 1
    buffer_atomic_add v5, v4, s[4:7], s67 offen
    s_mov_b64 exec, -1
    s_cmp_ge_u32 s65, 8
    s_cbranch_scc1 Lqeg_m1
    s_waitcnt vmcnt(0)
    s_barrier
    s_lshl_b32 s67, s65, 8
    s_lshl_b32 s54, s79, 2
    s_add_u32 s67, s67, s54
    s_add_u32 s67, s67, 1581056
    s_cmp_eq_u32 s65, -1
    s_cselect_b32 s67, 0x40000000, s67
    s_cmp_lg_u32 s17, 0
    s_cselect_b32 s67, 0x40000000, s67
    s_mov_b64 exec, 1
    v_mov_b32 v4, 0
    v_mov_b32 v5, 1
    buffer_atomic_add v5, v4, s[4:7], s67 offen
    s_mov_b64 exec, -1
    s_mov_b32 s44, 1
    s_mov_b32 s42, -1
    s_mov_b32 s65, s41
    s_mov_b32 s40, s43
    s_branch Lql_m1
Lqeg_m1:
    s_mov_b32 s42, s65
    s_mov_b32 s65, s41
    s_mov_b32 s40, s43
    s_cmp_lt_u32 s65, 32
    s_cbranch_scc1 Lql_m1
    s_waitcnt vmcnt(0)
    s_barrier
    s_lshl_b32 s67, s42, 8
    s_lshl_b32 s54, s79, 2
    s_add_u32 s67, s67, s54
    s_add_u32 s67, s67, 1581056
    s_cmp_eq_u32 s42, -1
    s_cselect_b32 s67, 0x40000000, s67
    s_cmp_lg_u32 s17, 0
    s_cselect_b32 s67, 0x40000000, s67
    s_mov_b64 exec, 1
    v_mov_b32 v4, 0
    v_mov_b32 v5, 1
    buffer_atomic_add v5, v4, s[4:7], s67 offen
    s_mov_b64 exec, -1
    s_branch Lqkv_fin
Lqs2e:
    s_load_dwordx2 s[12:13], s[0:1], 16
    s_waitcnt lgkmcnt(0)
    s_mov_b32 s14, 4718592
    s_mov_b32 s15, 0x20000
    s_lshl_b32 s26, s79, 8
    s_mov_b32 s27, 8192
    s_load_dwordx2 s[12:13], s[0:1], 88
    s_waitcnt lgkmcnt(0)
    s_mov_b32 s14, 256
    s_mov_b32 s15, 0x20000
    s_cmp_lg_u32 s17, 0
    s_cbranch_scc1 Llw1p2
    s_mov_b32 s19, 0
    v_and_b32 v1, 63, v0
    v_lshlrev_b32 v2, 2, v1
Llw0p2:
    buffer_load_dword v3, v2, s[12:15], 0 offen sc1
    s_waitcnt vmcnt(0)
    s_mov_b32 s20, 0
    s_mov_b32 s21, 0
    v_readlane_b32 s22, v3, 2
    s_nop 2
    s_add_u32 s20, s20, s22
    v_readlane_b32 s22, v3, 3
    s_nop 2
    s_add_u32 s21, s21, s22
    v_readlane_b32 s22, v3, 18
    s_nop 2
    s_add_u32 s20, s20, s22
    v_readlane_b32 s22, v3, 19
    s_nop 2
    s_add_u32 s21, s21, s22
    v_readlane_b32 s22, v3, 34
    s_nop 2
    s_add_u32 s20, s20, s22
    v_readlane_b32 s22, v3, 35
    s_nop 2
    s_add_u32 s21, s21, s22
    v_readlane_b32 s22, v3, 50
    s_nop 2
    s_add_u32 s20, s20, s22
    v_readlane_b32 s22, v3, 51
    s_nop 2
    s_add_u32 s21, s21, s22
    s_cmp_ge_u32 s20, s90
    s_cselect_b32 s22, s21, 0
    s_cmp_eq_u32 s89, 1
    s_cselect_b32 s20, s20, s22
    s_cmp_ge_u32 s20, 224
    s_cbranch_scc1 Llw1p2
    s_sleep 12
    s_add_u32 s19, s19, 1
    s_cmp_lt_u32 s19, 524288
    s_cbranch_scc1 Llw0p2
    s_branch Lfail
Llw1p2:
    s_barrier
    s_lshl_b32 s67, s79, 2
    s_add_u32 s67, s67, 1581056
    s_cmp_lg_u32 s17, 0
    s_cbranch_scc1 Lw_52
    s_mov_b64 exec, 1
    v_mov_b32 v2, 0
    s_mov_b32 s70, 0
Lw_50:
    buffer_load_dword v3, v2, s[4:7], s67 offen sc1
    s_waitcnt vmcnt(0)
    v_readfirstlane_b32 s69, v3
    s_nop 2
    s_and_b32 s69, s69, 255
    s_cmp_ge_u32 s69, 2
    s_cbranch_scc1 Lw_51
    s_sleep 40
    s_add_u32 s70, s70, 1
    s_cmp_lt_u32 s70, 524288
    s_cbranch_scc1 Lw_50
    s_branch Lfail
Lw_51:
    s_mov_b64 exec, -1
Lw_52:
    s_barrier
    s_load_dwordx2 s[12:13], s[0:1], 16
    s_waitcnt lgkmcnt(0)
    s_mov_b32 s14, 4718592
    s_mov_b32 s15, 0x20000
Ldl_49:
    v_and_b32 v1, 63, v0
    v_lshrrev_b32 v2, 3, v1
    v_mul_lo_u32 v2, v2, s27
    v_and_b32 v3, 7, v1
    v_bfe_u32 v4, v1, 4, 1
    v_lshlrev_b32 v4, 2, v4
    v_xor_b32 v3, v3, v4
    v_lshlrev_b32 v3, 4, v3
    v_add_u32 v19, v2, v3
    v_lshrrev_b32 v2, 4, v1
    v_lshlrev_b32 v2, 3, v2
    v_bfe_u32 v3, v1, 2, 2
    v_add_u32 v2, v2, v3
    v_lshlrev_b32 v2, 7, v2
    v_and_b32 v4, 3, v1
    v_lshlrev_b32 v4, 3, v4
    v_add_u32 v2, v2, v4
    v_bfe_u32 v3, v1, 3, 1
    v_lshlrev_b32 v3, 6, v3
    s_mul_i32 s36, s17, 32
    s_add_u32 s36, s36, 0
    s_lshr_b32 s37, s36, 5
    s_and_b32 s37, s37, 1
    s_lshl_b32 s37, s37, 6
    v_xor_b32 v4, s37, v3
    v_add_u32 v4, v4, v2
    s_lshr_b32 s37, s36, 6
    s_lshl_b32 s37, s37, 13
    s_and_b32 s34, s36, 16
    s_lshl_b32 s34, s34, 1
    s_add_u32 s37, s37, s34
    v_add_u32 v16, s37, v4
    s_mul_i32 s36, s17, 32
    s_add_u32 s36, s36, 16
    s_lshr_b32 s37, s36, 5
    s_and_b32 s37, s37, 1
    s_lshl_b32 s37, s37, 6
    v_xor_b32 v4, s37, v3
    v_add_u32 v4, v4, v2
    s_lshr_b32 s37, s36, 6
    s_lshl_b32 s37, s37, 13
    s_and_b32 s34, s36, 16
    s_lshl_b32 s34, s34, 1
    s_add_u32 s37, s37, s34
    v_add_u32 v17, s37, v4
    s_lshl_b32 s36, s17, 3
    s_add_u32 s36, s36, 0
    s_mul_i32 s39, s36, s27
    s_add_u32 s39, s39, s26
    s_lshl_b32 s34, s17, 10
    s_add_u32 s34, s34, 0
    s_lshl_b32 s37, s27, 5
    s_mov_b32 m0, s34
    s_nop 0
    buffer_load_dwordx4 v19, s[12:15], s39 offen lds
    s_add_u32 s34, s34, 4096
    s_add_u32 s39, s39, s37
    s_mov_b32 m0, s34
    s_nop 0
    buffer_load_dwordx4 v19, s[12:15], s39 offen lds
    s_add_u32 s34, s34, 4096
    s_sub_u32 s39, s39, s37
    s_add_u32 s39, s39, 128
    s_mov_b32 m0, s34
    s_nop 0
    buffer_load_dwordx4 v19, s[12:15], s39 offen lds
    s_add_u32 s34, s34, 4096
    s_add_u32 s39, s39, s37
    s_mov_b32 m0, s34
    s_nop 0
    buffer_load_dwordx4 v19, s[12:15], s39 offen lds
    s_lshl_b32 s36, s17, 3
    s_add_u32 s36, s36, 64
    s_mul_i32 s39, s36, s27
    s_add_u32 s39, s39, s26
    s_lshl_b32 s34, s17, 10
    s_add_u32 s34, s34, 16384
    s_lshl_b32 s37, s27, 5
    s_mov_b32 m0, s34
    s_nop 0
    buffer_load_dwordx4 v19, s[12:15], s39 offen lds
    s_add_u32 s34, s34, 4096
    s_add_u32 s39, s39, s37
    s_mov_b32 m0, s34
    s_nop 0
    buffer_load_dwordx4 v19, s[12:15], s39 offen lds
    s_add_u32 s34, s34, 4096
    s_sub_u32 s39, s39, s37
    s_add_u32 s39, s39, 128
    s_mov_b32 m0, s34
    s_nop 0
    buffer_load_dwordx4 v19, s[12:15], s39 offen lds
    s_add_u32 s34, s34, 4096
    s_add_u32 s39, s39, s37
    s_mov_b32 m0, s34
    s_nop 0
    buffer_load_dwordx4 v19, s[12:15], s39 offen lds
    s_lshl_b32 s36, s17, 3
    s_add_u32 s36, s36, 128
    s_mul_i32 s39, s36, s27
    s_add_u32 s39, s39, s26
    s_lshl_b32 s34, s17, 10
    s_add_u32 s34, s34, 32768
    s_lshl_b32 s37, s27, 5
    s_mov_b32 m0, s34
    s_nop 0
    buffer_load_dwordx4 v19, s[12:15], s39 offen lds
    s_add_u32 s34, s34, 4096
    s_add_u32 s39, s39, s37
    s_mov_b32 m0, s34
    s_nop 0
    buffer_load_dwordx4 v19, s[12:15], s39 offen lds
    s_add_u32 s34, s34, 4096
    s_sub_u32 s39, s39, s37
    s_add_u32 s39, s39, 128
    s_mov_b32 m0, s34
    s_nop 0
    buffer_load_dwordx4 v19, s[12:15], s39 offen lds
    s_add_u32 s34, s34, 4096
    s_add_u32 s39, s39, s37
    s_mov_b32 m0, s34
    s_nop 0
    buffer_load_dwordx4 v19, s[12:15], s39 offen lds
    s_lshl_b32 s36, s17, 3
    s_add_u32 s36, s36, 192
    s_mul_i32 s39, s36, s27
    s_add_u32 s39, s39, s26
    s_lshl_b32 s34, s17, 10
    s_add_u32 s34, s34, 49152
    s_lshl_b32 s37, s27, 5
    s_mov_b32 m0, s34
    s_nop 0
    buffer_load_dwordx4 v19, s[12:15], s39 offen lds
    s_add_u32 s34, s34, 4096
    s_add_u32 s39, s39, s37
    s_mov_b32 m0, s34
    s_nop 0
    buffer_load_dwordx4 v19, s[12:15], s39 offen lds
    s_add_u32 s34, s34, 4096
    s_sub_u32 s39, s39, s37
    s_add_u32 s39, s39, 128
    s_mov_b32 m0, s34
    s_nop 0
    buffer_load_dwordx4 v19, s[12:15], s39 offen lds
    s_add_u32 s34, s34, 4096
    s_add_u32 s39, s39, s37
    s_mov_b32 m0, s34
    s_nop 0
    buffer_load_dwordx4 v19, s[12:15], s39 offen lds
    s_lshl_b32 s36, s17, 3
    s_add_u32 s36, s36, 256
    s_mul_i32 s39, s36, s27
    s_add_u32 s39, s39, s26
    s_lshl_b32 s34, s17, 10
    s_add_u32 s34, s34, 65536
    s_lshl_b32 s37, s27, 5
    s_mov_b32 m0, s34
    s_nop 0
    buffer_load_dwordx4 v19, s[12:15], s39 offen lds
    s_add_u32 s34, s34, 4096
    s_add_u32 s39, s39, s37
    s_mov_b32 m0, s34
    s_nop 0
    buffer_load_dwordx4 v19, s[12:15], s39 offen lds
    s_add_u32 s34, s34, 4096
    s_sub_u32 s39, s39, s37
    s_add_u32 s39, s39, 128
    s_mov_b32 m0, s34
    s_nop 0
    buffer_load_dwordx4 v19, s[12:15], s39 offen lds
    s_add_u32 s34, s34, 4096
    s_add_u32 s39, s39, s37
    s_mov_b32 m0, s34
    s_nop 0
    buffer_load_dwordx4 v19, s[12:15], s39 offen lds
    s_lshl_b32 s36, s17, 3
    s_add_u32 s36, s36, 320
    s_mul_i32 s39, s36, s27
    s_add_u32 s39, s39, s26
    s_lshl_b32 s34, s17, 10
    s_add_u32 s34, s34, 81920
    s_lshl_b32 s37, s27, 5
    s_mov_b32 m0, s34
    s_nop 0
    buffer_load_dwordx4 v19, s[12:15], s39 offen lds
    s_add_u32 s34, s34, 4096
    s_add_u32 s39, s39, s37
    s_mov_b32 m0, s34
    s_nop 0
    buffer_load_dwordx4 v19, s[12:15], s39 offen lds
    s_add_u32 s34, s34, 4096
    s_sub_u32 s39, s39, s37
    s_add_u32 s39, s39, 128
    s_mov_b32 m0, s34
    s_nop 0
    buffer_load_dwordx4 v19, s[12:15], s39 offen lds
    s_add_u32 s34, s34, 4096
    s_add_u32 s39, s39, s37
    s_mov_b32 m0, s34
    s_nop 0
    buffer_load_dwordx4 v19, s[12:15], s39 offen lds
    s_lshl_b32 s36, s17, 3
    s_add_u32 s36, s36, 384
    s_mul_i32 s39, s36, s27
    s_add_u32 s39, s39, s26
    s_lshl_b32 s34, s17, 10
    s_add_u32 s34, s34, 98304
    s_lshl_b32 s37, s27, 5
    s_mov_b32 m0, s34
    s_nop 0
    buffer_load_dwordx4 v19, s[12:15], s39 offen lds
    s_add_u32 s34, s34, 4096
    s_add_u32 s39, s39, s37
    s_mov_b32 m0, s34
    s_nop 0
    buffer_load_dwordx4 v19, s[12:15], s39 offen lds
    s_add_u32 s34, s34, 4096
    s_sub_u32 s39, s39, s37
    s_add_u32 s39, s39, 128
    s_mov_b32 m0, s34
    s_nop 0
    buffer_load_dwordx4 v19, s[12:15], s39 offen lds
    s_add_u32 s34, s34, 4096
    s_add_u32 s39, s39, s37
    s_mov_b32 m0, s34
    s_nop 0
    buffer_load_dwordx4 v19, s[12:15], s39 offen lds
    s_lshl_b32 s36, s17, 3
    s_add_u32 s36, s36, 448
    s_mul_i32 s39, s36, s27
    s_add_u32 s39, s39, s26
    s_lshl_b32 s34, s17, 10
    s_add_u32 s34, s34, 114688
    s_lshl_b32 s37, s27, 5
    s_mov_b32 m0, s34
    s_nop 0
    buffer_load_dwordx4 v19, s[12:15], s39 offen lds
    s_add_u32 s34, s34, 4096
    s_add_u32 s39, s39, s37
    s_mov_b32 m0, s34
    s_nop 0
    buffer_load_dwordx4 v19, s[12:15], s39 offen lds
    s_add_u32 s34, s34, 4096
    s_sub_u32 s39, s39, s37
    s_add_u32 s39, s39, 128
    s_mov_b32 m0, s34
    s_nop 0
    buffer_load_dwordx4 v19, s[12:15], s39 offen lds
    s_add_u32 s34, s34, 4096
    s_add_u32 s39, s39, s37
    s_mov_b32 m0, s34
    s_nop 0
    buffer_load_dwordx4 v19, s[12:15], s39 offen lds
    s_lshl_b32 s36, s17, 3
    s_add_u32 s36, s36, 512
    s_mul_i32 s39, s36, s27
    s_add_u32 s39, s39, s26
    s_lshl_b32 s34, s17, 10
    s_add_u32 s34, s34, 131072
    s_lshl_b32 s37, s27, 5
    s_mov_b32 m0, s34
    s_nop 0
    buffer_load_dwordx4 v19, s[12:15], s39 offen lds
    s_add_u32 s34, s34, 4096
    s_add_u32 s39, s39, s37
    s_mov_b32 m0, s34
    s_nop 0
    buffer_load_dwordx4 v19, s[12:15], s39 offen lds
    s_add_u32 s34, s34, 4096
    s_sub_u32 s39, s39, s37
    s_add_u32 s39, s39, 128
    s_mov_b32 m0, s34
    s_nop 0
    buffer_load_dwordx4 v19, s[12:15], s39 offen lds
    s_add_u32 s34, s34, 4096
    s_add_u32 s39, s39, s37
    s_mov_b32 m0, s34
    s_nop 0
    buffer_load_dwordx4 v19, s[12:15], s39 offen lds
    s_waitcnt vmcnt(0)
    s_barrier
    ds_read_b64_tr_b16 a[0:1], v16 offset:0
    ds_read_b64_tr_b16 a[2:3], v16 offset:512
    ds_read_b64_tr_b16 a[72:73], v17 offset:0
    ds_read_b64_tr_b16 a[74:75], v17 offset:512
    ds_read_b64_tr_b16 a[4:5], v16 offset:4096
    ds_read_b64_tr_b16 a[6:7], v16 offset:4608
    ds_read_b64_tr_b16 a[76:77], v17 offset:4096
    ds_read_b64_tr_b16 a[78:79], v17 offset:4608
    s_waitcnt lgkmcnt(0)
    ds_read_b64_tr_b16 a[8:9], v16 offset:16384
    ds_read_b64_tr_b16 a[10:11], v16 offset:16896
    ds_read_b64_tr_b16 a[80:81], v17 offset:16384
    ds_read_b64_tr_b16 a[82:83], v17 offset:16896
    ds_read_b64_tr_b16 a[12:13], v16 offset:20480
    ds_read_b64_tr_b16 a[14:15], v16 offset:20992
    ds_read_b64_tr_b16 a[84:85], v17 offset:20480
    ds_read_b64_tr_b16 a[86:87], v17 offset:20992
    s_waitcnt lgkmcnt(0)
    ds_read_b64_tr_b16 a[16:17], v16 offset:32768
    ds_read_b64_tr_b16 a[18:19], v16 offset:33280
    ds_read_b64_tr_b16 a[88:89], v17 offset:32768
    ds_read_b64_tr_b16 a[90:91], v17 offset:33280
    ds_read_b64_tr_b16 a[20:21], v16 offset:36864
    ds_read_b64_tr_b16 a[22:23], v16 offset:37376
    ds_read_b64_tr_b16 a[92:93], v17 offset:36864
    ds_read_b64_tr_b16 a[94:95], v17 offset:37376
    s_waitcnt lgkmcnt(0)
    ds_read_b64_tr_b16 a[24:25], v16 offset:49152
    ds_read_b64_tr_b16 a[26:27], v16 offset:49664
    ds_read_b64_tr_b16 a[96:97], v17 offset:49152
    ds_read_b64_tr_b16 a[98:99], v17 offset:49664
    ds_read_b64_tr_b16 a[28:29], v16 offset:53248
    ds_read_b64_tr_b16 a[30:31], v16 offset:53760
    ds_read_b64_tr_b16 a[100:101], v17 offset:53248
    ds_read_b64_tr_b16 a[102:103], v17 offset:53760
    s_waitcnt lgkmcnt(0)
    v_add_u32 v5, 65536, v16
    ds_read_b64_tr_b16 a[32:33], v5 offset:0
    v_add_u32 v5, 65536, v16
    ds_read_b64_tr_b16 a[34:35], v5 offset:512
    v_add_u32 v5, 65536, v17
    ds_read_b64_tr_b16 a[104:105], v5 offset:0
    v_add_u32 v5, 65536, v17
    ds_read_b64_tr_b16 a[106:107], v5 offset:512
    v_add_u32 v5, 65536, v16
    ds_read_b64_tr_b16 a[36:37], v5 offset:4096
    v_add_u32 v5, 65536, v16
    ds_read_b64_tr_b16 a[38:39], v5 offset:4608
    v_add_u32 v5, 65536, v17
    ds_read_b64_tr_b16 a[108:109], v5 offset:4096
    v_add_u32 v5, 65536, v17
    ds_read_b64_tr_b16 a[110:111], v5 offset:4608
    s_waitcnt lgkmcnt(0)
    v_add_u32 v5, 65536, v16
    ds_read_b64_tr_b16 a[40:41], v5 offset:16384
    v_add_u32 v5, 65536, v16
    ds_read_b64_tr_b16 a[42:43], v5 offset:16896
    v_add_u32 v5, 65536, v17
    ds_read_b64_tr_b16 a[112:113], v5 offset:16384
    v_add_u32 v5, 65536, v17
    ds_read_b64_tr_b16 a[114:115], v5 offset:16896
    v_add_u32 v5, 65536, v16
    ds_read_b64_tr_b16 a[44:45], v5 offset:20480
    v_add_u32 v5, 65536, v16
    ds_read_b64_tr_b16 a[46:47], v5 offset:20992
    v_add_u32 v5, 65536, v17
    ds_read_b64_tr_b16 a[116:117], v5 offset:20480
    v_add_u32 v5, 65536, v17
    ds_read_b64_tr_b16 a[118:119], v5 offset:20992
    s_waitcnt lgkmcnt(0)
    v_add_u32 v5, 65536, v16
    ds_read_b64_tr_b16 a[48:49], v5 offset:32768
    v_add_u32 v5, 65536, v16
    ds_read_b64_tr_b16 a[50:51], v5 offset:33280
    v_add_u32 v5, 65536, v17
    ds_read_b64_tr_b16 a[120:121], v5 offset:32768
    v_add_u32 v5, 65536, v17
    ds_read_b64_tr_b16 a[122:123], v5 offset:33280
    v_add_u32 v5, 65536, v16
    ds_read_b64_tr_b16 a[52:53], v5 offset:36864
    v_add_u32 v5, 65536, v16
    ds_read_b64_tr_b16 a[54:55], v5 offset:37376
    v_add_u32 v5, 65536, v17
    ds_read_b64_tr_b16 a[124:125], v5 offset:36864
    v_add_u32 v5, 65536, v17
    ds_read_b64_tr_b16 a[126:127], v5 offset:37376
    s_waitcnt lgkmcnt(0)
    v_add_u32 v5, 65536, v16
    ds_read_b64_tr_b16 a[56:57], v5 offset:49152
    v_add_u32 v5, 65536, v16
    ds_read_b64_tr_b16 a[58:59], v5 offset:49664
    v_add_u32 v5, 65536, v17
    ds_read_b64_tr_b16 a[128:129], v5 offset:49152
    v_add_u32 v5, 65536, v17
    ds_read_b64_tr_b16 a[130:131], v5 offset:49664
    v_add_u32 v5, 65536, v16
    ds_read_b64_tr_b16 a[60:61], v5 offset:53248
    v_add_u32 v5, 65536, v16
    ds_read_b64_tr_b16 a[62:63], v5 offset:53760
    v_add_u32 v5, 65536, v17
    ds_read_b64_tr_b16 a[132:133], v5 offset:53248
    v_add_u32 v5, 65536, v17
    ds_read_b64_tr_b16 a[134:135], v5 offset:53760
    s_waitcnt lgkmcnt(0)
    v_add_u32 v5, 131072, v16
    ds_read_b64_tr_b16 a[64:65], v5 offset:0
    v_add_u32 v5, 131072, v16
    ds_read_b64_tr_b16 a[66:67], v5 offset:512
    v_add_u32 v5, 131072, v17
    ds_read_b64_tr_b16 a[136:137], v5 offset:0
    v_add_u32 v5, 131072, v17
    ds_read_b64_tr_b16 a[138:139], v5 offset:512
    v_add_u32 v5, 131072, v16
    ds_read_b64_tr_b16 a[68:69], v5 offset:4096
    v_add_u32 v5, 131072, v16
    ds_read_b64_tr_b16 a[70:71], v5 offset:4608
    v_add_u32 v5, 131072, v17
    ds_read_b64_tr_b16 a[140:141], v5 offset:4096
    v_add_u32 v5, 131072, v17
    ds_read_b64_tr_b16 a[142:143], v5 offset:4608
    s_waitcnt lgkmcnt(0)
    s_barrier
    s_mov_b32 s25, 1152
    v_and_b32 v1, 63, v0
    v_and_b32 v2, 15, v1
    v_lshrrev_b32 v3, 4, v1
    v_bfe_u32 v4, v2, 1, 3
    v_xor_b32 v3, v3, v4
    v_lshlrev_b32 v3, 4, v3
    v_lshlrev_b32 v2, 7, v2
    v_add_u32 v8, v2, v3
    v_xor_b32 v9, 64, v8
    v_lshrrev_b32 v2, 3, v1
    v_mul_lo_u32 v2, v2, s25
    v_and_b32 v3, 7, v1
    v_lshrrev_b32 v4, 4, v1
    v_xor_b32 v3, v3, v4
    s_and_b32 s37, s17, 1
    s_lshl_b32 s34, s37, 2
    v_xor_b32 v3, s34, v3
    v_lshlrev_b32 v3, 4, v3
    v_add_u32 v12, v2, v3
    s_load_dwordx2 s[12:13], s[0:1], 88
    s_waitcnt lgkmcnt(0)
    s_mov_b32 s14, 256
    s_mov_b32 s15, 0x20000
    s_cmp_lg_u32 s17, 0
    s_cbranch_scc1 Llw1q2
    s_mov_b32 s19, 0
    v_and_b32 v1, 63, v0
    v_lshlrev_b32 v2, 2, v1
Llw0q2:
    buffer_load_dword v3, v2, s[12:15], 0 offen sc1
    s_waitcnt vmcnt(0)
    s_mov_b32 s20, 0
    s_mov_b32 s21, 0
    v_readlane_b32 s22, v3, 2
    s_nop 2
    s_add_u32 s20, s20, s22
    v_readlane_b32 s22, v3, 3
    s_nop 2
    s_add_u32 s21, s21, s22
    v_readlane_b32 s22, v3, 18
    s_nop 2
    s_add_u32 s20, s20, s22
    v_readlane_b32 s22, v3, 19
    s_nop 2
    s_add_u32 s21, s21, s22
    v_readlane_b32 s22, v3, 34
    s_nop 2
    s_add_u32 s20, s20, s22
    v_readlane_b32 s22, v3, 35
    s_nop 2
    s_add_u32 s21, s21, s22
    v_readlane_b32 s22, v3, 50
    s_nop 2
    s_add_u32 s20, s20, s22
    v_readlane_b32 s22, v3, 51
    s_nop 2
    s_add_u32 s21, s21, s22
    s_cmp_ge_u32 s20, s90
    s_cselect_b32 s22, s21, 0
    s_cmp_eq_u32 s89, 1
    s_cselect_b32 s20, s20, s22
    s_cmp_ge_u32 s20, 224
    s_cbranch_scc1 Llw1q2
    s_sleep 12
    s_add_u32 s19, s19, 1
    s_cmp_lt_u32 s19, 524288
    s_cbranch_scc1 Llw0q2
    s_branch Lfail
Llw1q2:
    s_barrier
    s_cmp_lg_u32 s17, 0
    s_cbranch_scc1 Linv_53
    buffer_inv sc1
    s_waitcnt vmcnt(0)
Linv_53:
    s_barrier
    s_mov_b32 s8, s4
    s_mov_b32 s9, s5
    s_mov_b32 s10, s6
    s_mov_b32 s11, s7
    s_and_b32 s53, s64, 31
    s_mov_b32 s40, 0
    s_mov_b32 s42, -1
    s_mul_i32 s24, s65, 73728
    s_add_u32 s24, s24, 2097152
    s_lshl_b32 s36, s17, 3
    s_mul_i32 s36, s36, s25
    s_add_u32 s36, s36, s24
    s_lshl_b32 s37, s25, 5
    s_lshl_b32 s39, s17, 10
    s_add_u32 s39, s39, s40
    s_add_u32 s38, s36, 0
    s_add_u32 s34, s39, 0
    s_mov_b32 m0, s34
    s_nop 0
    buffer_load_dwordx4 v12, s[8:11], s38 offen lds
    s_add_u32 s38, s38, s37
    s_add_u32 s34, s34, 4096
    s_mov_b32 m0, s34
    s_nop 0
    buffer_load_dwordx4 v12, s[8:11], s38 offen lds
    s_add_u32 s38, s36, 128
    s_add_u32 s34, s39, 8192
    s_mov_b32 m0, s34
    s_nop 0
    buffer_load_dwordx4 v12, s[8:11], s38 offen lds
    s_add_u32 s38, s38, s37
    s_add_u32 s34, s34, 4096
    s_mov_b32 m0, s34
    s_nop 0
    buffer_load_dwordx4 v12, s[8:11], s38 offen lds
    s_add_u32 s38, s36, 256
    s_add_u32 s34, s39, 16384
    s_mov_b32 m0, s34
    s_nop 0
    buffer_load_dwordx4 v12, s[8:11], s38 offen lds
    s_add_u32 s38, s38, s37
    s_add_u32 s34, s34, 4096
    s_mov_b32 m0, s34
    s_nop 0
    buffer_load_dwordx4 v12, s[8:11], s38 offen lds
    s_add_u32 s38, s36, 384
    s_add_u32 s34, s39, 24576
    s_mov_b32 m0, s34
    s_nop 0
    buffer_load_dwordx4 v12, s[8:11], s38 offen lds
    s_add_u32 s38, s38, s37
    s_add_u32 s34, s34, 4096
    s_mov_b32 m0, s34
    s_nop 0
    buffer_load_dwordx4 v12, s[8:11], s38 offen lds
    s_add_u32 s38, s36, 512
    s_add_u32 s34, s39, 32768
    s_mov_b32 m0, s34
    s_nop 0
    buffer_load_dwordx4 v12, s[8:11], s38 offen lds
    s_add_u32 s38, s38, s37
    s_add_u32 s34, s34, 4096
    s_mov_b32 m0, s34
    s_nop 0
    buffer_load_dwordx4 v12, s[8:11], s38 offen lds
    s_add_u32 s38, s36, 640
    s_add_u32 s34, s39, 40960
    s_mov_b32 m0, s34
    s_nop 0
    buffer_load_dwordx4 v12, s[8:11], s38 offen lds
    s_add_u32 s38, s38, s37
    s_add_u32 s34, s34, 4096
    s_mov_b32 m0, s34
    s_nop 0
    buffer_load_dwordx4 v12, s[8:11], s38 offen lds
    s_add_u32 s38, s36, 768
    s_add_u32 s34, s39, 49152
    s_mov_b32 m0, s34
    s_nop 0
    buffer_load_dwordx4 v12, s[8:11], s38 offen lds
    s_add_u32 s38, s38, s37
    s_add_u32 s34, s34, 4096
    s_mov_b32 m0, s34
    s_nop 0
    buffer_load_dwordx4 v12, s[8:11], s38 offen lds
    s_add_u32 s38, s36, 896
    s_add_u32 s34, s39, 57344
    s_mov_b32 m0, s34
    s_nop 0
    buffer_load_dwordx4 v12, s[8:11], s38 offen lds
    s_add_u32 s38, s38, s37
    s_add_u32 s34, s34, 4096
    s_mov_b32 m0, s34
    s_nop 0
    buffer_load_dwordx4 v12, s[8:11], s38 offen lds
    s_add_u32 s38, s36, 1024
    s_add_u32 s34, s39, 65536
    s_mov_b32 m0, s34
    s_nop 0
    buffer_load_dwordx4 v12, s[8:11], s38 offen lds
    s_add_u32 s38, s38, s37
    s_add_u32 s34, s34, 4096
    s_mov_b32 m0, s34
    s_nop 0
    buffer_load_dwordx4 v12, s[8:11], s38 offen lds
Lql_m2:
    s_add_u32 s41, s65, 2
    s_add_u32 s20, s65, 1
    s_cmp_lt_u32 s65, 7
    s_cselect_b32 s41, s20, s41
    s_cmp_eq_u32 s65, 3
    s_cselect_b32 s41, 8, s41
    s_xor_b32 s43, s40, 73728
    s_mul_i32 s24, s41, 73728
    s_add_u32 s24, s24, 2097152
    s_cmp_ge_u32 s41, 32
    s_cselect_b32 s24, 0x40000000, s24
    s_cmp_eq_u32 s42, -1
    s_cbranch_scc1 Lqw2_m2
    s_waitcnt vmcnt(5)
    s_branch Lqw1_m2x
Lqw2_m2:
    s_waitcnt vmcnt(0)
Lqw1_m2x:
    s_barrier
    v_add_u32 v10, s40, v8
    v_add_u32 v11, s40, v9
    v_add_u32 v13, 65536, v10
    v_add_u32 v14, 65536, v11
    ds_read_b128 v[32:35], v10 offset:0
    ds_read_b128 v[36:39], v10 offset:2048
    ds_read_b128 v[40:43], v10 offset:4096
    ds_read_b128 v[44:47], v10 offset:6144
    v_mov_b64 v[128:129], 0
    v_mov_b64 v[130:131], 0
    v_mov_b64 v[132:133], 0
    v_mov_b64 v[134:135], 0
    v_mov_b64 v[136:137], 0
    v_mov_b64 v[138:139], 0
    v_mov_b64 v[140:141], 0
    v_mov_b64 v[142:143], 0
    v_mov_b64 v[144:145], 0
    v_mov_b64 v[146:147], 0
    v_mov_b64 v[148:149], 0
    v_mov_b64 v[150:151], 0
    v_mov_b64 v[152:153], 0
    v_mov_b64 v[154:155], 0
    v_mov_b64 v[156:157], 0
    v_mov_b64 v[158:159], 0
    s_waitcnt lgkmcnt(0)
    v_mfma_f32_16x16x32_bf16 v[128:131], a[0:3], v[32:35], v[128:131]
    ds_read_b128 v[64:67], v11 offset:0
    v_mfma_f32_16x16x32_bf16 v[132:135], a[72:75], v[32:35], v[132:135]
    ds_read_b128 v[68:71], v11 offset:2048
    v_mfma_f32_16x16x32_bf16 v[136:139], a[0:3], v[36:39], v[136:139]
    ds_read_b128 v[72:75], v11 offset:4096
    v_mfma_f32_16x16x32_bf16 v[140:143], a[72:75], v[36:39], v[140:143]
    ds_read_b128 v[76:79], v11 offset:6144
    v_mfma_f32_16x16x32_bf16 v[144:147], a[0:3], v[40:43], v[144:147]
    v_mfma_f32_16x16x32_bf16 v[148:151], a[72:75], v[40:43], v[148:151]
    s_lshl_b32 s36, s17, 3
    s_mul_i32 s36, s36, s25
    s_add_u32 s36, s36, s24
    s_lshl_b32 s37, s25, 5
    s_lshl_b32 s39, s17, 10
    s_add_u32 s39, s39, s43
    s_add_u32 s38, s36, 0
    s_add_u32 s34, s39, 0
    s_mov_b32 m0, s34
    s_nop 0
    buffer_load_dwordx4 v12, s[8:11], s38 offen lds
    v_mfma_f32_16x16x32_bf16 v[152:155], a[0:3], v[44:47], v[152:155]
    v_mfma_f32_16x16x32_bf16 v[156:159], a[72:75], v[44:47], v[156:159]
    s_add_u32 s38, s38, s37
    s_add_u32 s34, s34, 4096
    s_mov_b32 m0, s34
    s_nop 0
    buffer_load_dwordx4 v12, s[8:11], s38 offen lds
    s_waitcnt lgkmcnt(0)
    v_mfma_f32_16x16x32_bf16 v[128:131], a[4:7], v[64:67], v[128:131]
    ds_read_b128 v[32:35], v10 offset:8192
    v_mfma_f32_16x16x32_bf16 v[132:135], a[76:79], v[64:67], v[132:135]
    ds_read_b128 v[36:39], v10 offset:10240
    v_mfma_f32_16x16x32_bf16 v[136:139], a[4:7], v[68:71], v[136:139]
    ds_read_b128 v[40:43], v10 offset:12288
    v_mfma_f32_16x16x32_bf16 v[140:143], a[76:79], v[68:71], v[140:143]
    ds_read_b128 v[44:47], v10 offset:14336
    v_mfma_f32_16x16x32_bf16 v[144:147], a[4:7], v[72:75], v[144:147]
    v_mfma_f32_16x16x32_bf16 v[148:151], a[76:79], v[72:75], v[148:151]
    s_add_u32 s38, s36, 128
    s_add_u32 s34, s39, 8192
    s_mov_b32 m0, s34
    s_nop 0
    buffer_load_dwordx4 v12, s[8:11], s38 offen lds
    v_mfma_f32_16x16x32_bf16 v[152:155], a[4:7], v[76:79], v[152:155]
    v_mfma_f32_16x16x32_bf16 v[156:159], a[76:79], v[76:79], v[156:159]
    s_add_u32 s38, s38, s37
    s_add_u32 s34, s34, 4096
    s_mov_b32 m0, s34
    s_nop 0
    buffer_load_dwordx4 v12, s[8:11], s38 offen lds
    s_waitcnt lgkmcnt(0)
    v_mfma_f32_16x16x32_bf16 v[128:131], a[8:11], v[32:35], v[128:131]
    ds_read_b128 v[64:67], v11 offset:8192
    v_mfma_f32_16x16x32_bf16 v[132:135], a[80:83], v[32:35], v[132:135]
    ds_read_b128 v[68:71], v11 offset:10240
    v_mfma_f32_16x16x32_bf16 v[136:139], a[8:11], v[36:39], v[136:139]
    ds_read_b128 v[72:75], v11 offset:12288
    v_mfma_f32_16x16x32_bf16 v[140:143], a[80:83], v[36:39], v[140:143]
    ds_read_b128 v[76:79], v11 offset:14336
    v_mfma_f32_16x16x32_bf16 v[144:147], a[8:11], v[40:43], v[144:147]
    v_mfma_f32_16x16x32_bf16 v[148:151], a[80:83], v[40:43], v[148:151]
    s_add_u32 s38, s36, 256
    s_add_u32 s34, s39, 16384
    s_mov_b32 m0, s34
    s_nop 0
    buffer_load_dwordx4 v12, s[8:11], s38 offen lds
    v_mfma_f32_16x16x32_bf16 v[152:155], a[8:11], v[44:47], v[152:155]
    v_mfma_f32_16x16x32_bf16 v[156:159], a[80:83], v[44:47], v[156:159]
    s_add_u32 s38, s38, s37
    s_add_u32 s34, s34, 4096
    s_mov_b32 m0, s34
    s_nop 0
    buffer_load_dwordx4 v12, s[8:11], s38 offen lds
    s_waitcnt lgkmcnt(0)
    v_mfma_f32_16x16x32_bf16 v[128:131], a[12:15], v[64:67], v[128:131]
    ds_read_b128 v[32:35], v10 offset:16384
    v_mfma_f32_16x16x32_bf16 v[132:135], a[84:87], v[64:67], v[132:135]
    ds_read_b128 v[36:39], v10 offset:18432
    v_mfma_f32_16x16x32_bf16 v[136:139], a[12:15], v[68:71], v[136:139]
    ds_read_b128 v[40:43], v10 offset:20480
    v_mfma_f32_16x16x32_bf16 v[140:143], a[84:87], v[68:71], v[140:143]
    ds_read_b128 v[44:47], v10 offset:22528
    v_mfma_f32_16x16x32_bf16 v[144:147], a[12:15], v[72:75], v[144:147]
    v_mfma_f32_16x16x32_bf16 v[148:151], a[84:87], v[72:75], v[148:151]
    s_add_u32 s38, s36, 384
    s_add_u32 s34, s39, 24576
    s_mov_b32 m0, s34
    s_nop 0
    buffer_load_dwordx4 v12, s[8:11], s38 offen lds
    v_mfma_f32_16x16x32_bf16 v[152:155], a[12:15], v[76:79], v[152:155]
    v_mfma_f32_16x16x32_bf16 v[156:159], a[84:87], v[76:79], v[156:159]
    s_add_u32 s38, s38, s37
    s_add_u32 s34, s34, 4096
    s_mov_b32 m0, s34
    s_nop 0
    buffer_load_dwordx4 v12, s[8:11], s38 offen lds
    s_waitcnt lgkmcnt(0)
    v_mfma_f32_16x16x32_bf16 v[128:131], a[16:19], v[32:35], v[128:131]
    ds_read_b128 v[64:67], v11 offset:16384
    v_mfma_f32_16x16x32_bf16 v[132:135], a[88:91], v[32:35], v[132:135]
    ds_read_b128 v[68:71], v11 offset:18432
    v_mfma_f32_16x16x32_bf16 v[136:139], a[16:19], v[36:39], v[136:139]
    ds_read_b128 v[72:75], v11 offset:20480
    v_mfma_f32_16x16x32_bf16 v[140:143], a[88:91], v[36:39], v[140:143]
    ds_read_b128 v[76:79], v11 offset:22528
    v_mfma_f32_16x16x32_bf16 v[144:147], a[16:19], v[40:43], v[144:147]
    v_mfma_f32_16x16x32_bf16 v[148:151], a[88:91], v[40:43], v[148:151]
    s_add_u32 s38, s36, 512
    s_add_u32 s34, s39, 32768
    s_mov_b32 m0, s34
    s_nop 0
    buffer_load_dwordx4 v12, s[8:11], s38 offen lds
    v_mfma_f32_16x16x32_bf16 v[152:155], a[16:19], v[44:47], v[152:155]
    v_mfma_f32_16x16x32_bf16 v[156:159], a[88:91], v[44:47], v[156:159]
    s_add_u32 s38, s38, s37
    s_add_u32 s34, s34, 4096
    s_mov_b32 m0, s34
    s_nop 0
    buffer_load_dwordx4 v12, s[8:11], s38 offen lds
    s_waitcnt lgkmcnt(0)
    v_mfma_f32_16x16x32_bf16 v[128:131], a[20:23], v[64:67], v[128:131]
    ds_read_b128 v[32:35], v10 offset:24576
    v_mfma_f32_16x16x32_bf16 v[132:135], a[92:95], v[64:67], v[132:135]
    ds_read_b128 v[36:39], v10 offset:26624
    v_mfma_f32_16x16x32_bf16 v[136:139], a[20:23], v[68:71], v[136:139]
    ds_read_b128 v[40:43], v10 offset:28672
    v_mfma_f32_16x16x32_bf16 v[140:143], a[92:95], v[68:71], v[140:143]
    ds_read_b128 v[44:47], v10 offset:30720
    v_mfma_f32_16x16x32_bf16 v[144:147], a[20:23], v[72:75], v[144:147]
    v_mfma_f32_16x16x32_bf16 v[148:151], a[92:95], v[72:75], v[148:151]
    s_add_u32 s38, s36, 640
    s_add_u32 s34, s39, 40960
    s_mov_b32 m0, s34
    s_nop 0
    buffer_load_dwordx4 v12, s[8:11], s38 offen lds
    v_mfma_f32_16x16x32_bf16 v[152:155], a[20:23], v[76:79], v[152:155]
    v_mfma_f32_16x16x32_bf16 v[156:159], a[92:95], v[76:79], v[156:159]
    s_add_u32 s38, s38, s37
    s_add_u32 s34, s34, 4096
    s_mov_b32 m0, s34
    s_nop 0
    buffer_load_dwordx4 v12, s[8:11], s38 offen lds
    s_waitcnt lgkmcnt(0)
    v_mfma_f32_16x16x32_bf16 v[128:131], a[24:27], v[32:35], v[128:131]
    ds_read_b128 v[64:67], v11 offset:24576
    v_mfma_f32_16x16x32_bf16 v[132:135], a[96:99], v[32:35], v[132:135]
    ds_read_b128 v[68:71], v11 offset:26624
    v_mfma_f32_16x16x32_bf16 v[136:139], a[24:27], v[36:39], v[136:139]
    ds_read_b128 v[72:75], v11 offset:28672
    v_mfma_f32_16x16x32_bf16 v[140:143], a[96:99], v[36:39], v[140:143]
    ds_read_b128 v[76:79], v11 offset:30720
    v_mfma_f32_16x16x32_bf16 v[144:147], a[24:27], v[40:43], v[144:147]
    v_mfma_f32_16x16x32_bf16 v[148:151], a[96:99], v[40:43], v[148:151]
    s_add_u32 s38, s36, 768
    s_add_u32 s34, s39, 49152
    s_mov_b32 m0, s34
    s_nop 0
    buffer_load_dwordx4 v12, s[8:11], s38 offen lds
    v_mfma_f32_16x16x32_bf16 v[152:155], a[24:27], v[44:47], v[152:155]
    v_mfma_f32_16x16x32_bf16 v[156:159], a[96:99], v[44:47], v[156:159]
    s_add_u32 s38, s38, s37
    s_add_u32 s34, s34, 4096
    s_mov_b32 m0, s34
    s_nop 0
    buffer_load_dwordx4 v12, s[8:11], s38 offen lds
    s_waitcnt lgkmcnt(0)
    v_mfma_f32_16x16x32_bf16 v[128:131], a[28:31], v[64:67], v[128:131]
    ds_read_b128 v[32:35], v10 offset:32768
    v_mfma_f32_16x16x32_bf16 v[132:135], a[100:103], v[64:67], v[132:135]
    ds_read_b128 v[36:39], v10 offset:34816
    v_mfma_f32_16x16x32_bf16 v[136:139], a[28:31], v[68:71], v[136:139]
    ds_read_b128 v[40:43], v10 offset:36864
    v_mfma_f32_16x16x32_bf16 v[140:143], a[100:103], v[68:71], v[140:143]
    ds_read_b128 v[44:47], v10 offset:38912
    v_mfma_f32_16x16x32_bf16 v[144:147], a[28:31], v[72:75], v[144:147]
    v_mfma_f32_16x16x32_bf16 v[148:151], a[100:103], v[72:75], v[148:151]
    s_add_u32 s38, s36, 896
    s_add_u32 s34, s39, 57344
    s_mov_b32 m0, s34
    s_nop 0
    buffer_load_dwordx4 v12, s[8:11], s38 offen lds
    v_mfma_f32_16x16x32_bf16 v[152:155], a[28:31], v[76:79], v[152:155]
    v_mfma_f32_16x16x32_bf16 v[156:159], a[100:103], v[76:79], v[156:159]
    s_add_u32 s38, s38, s37
    s_add_u32 s34, s34, 4096
    s_mov_b32 m0, s34
    s_nop 0
    buffer_load_dwordx4 v12, s[8:11], s38 offen lds
    s_waitcnt lgkmcnt(0)
    v_mfma_f32_16x16x32_bf16 v[128:131], a[32:35], v[32:35], v[128:131]
    ds_read_b128 v[64:67], v11 offset:32768
    v_mfma_f32_16x16x32_bf16 v[132:135], a[104:107], v[32:35], v[132:135]
    ds_read_b128 v[68:71], v11 offset:34816
    v_mfma_f32_16x16x32_bf16 v[136:139], a[32:35], v[36:39], v[136:139]
    ds_read_b128 v[72:75], v11 offset:36864
    v_mfma_f32_16x16x32_bf16 v[140:143], a[104:107], v[36:39], v[140:143]
    ds_read_b128 v[76:79], v11 offset:38912
    v_mfma_f32_16x16x32_bf16 v[144:147], a[32:35], v[40:43], v[144:147]
    v_mfma_f32_16x16x32_bf16 v[148:151], a[104:107], v[40:43], v[148:151]
    s_add_u32 s38, s36, 1024
    s_add_u32 s34, s39, 65536
    s_mov_b32 m0, s34
    s_nop 0
    buffer_load_dwordx4 v12, s[8:11], s38 offen lds
    v_mfma_f32_16x16x32_bf16 v[152:155], a[32:35], v[44:47], v[152:155]
    v_mfma_f32_16x16x32_bf16 v[156:159], a[104:107], v[44:47], v[156:159]
    s_add_u32 s38, s38, s37
    s_add_u32 s34, s34, 4096
    s_mov_b32 m0, s34
    s_nop 0
    buffer_load_dwordx4 v12, s[8:11], s38 offen lds
    s_waitcnt lgkmcnt(0)
    v_mfma_f32_16x16x32_bf16 v[128:131], a[36:39], v[64:67], v[128:131]
    ds_read_b128 v[32:35], v10 offset:40960
    v_mfma_f32_16x16x32_bf16 v[132:135], a[108:111], v[64:67], v[132:135]
    ds_read_b128 v[36:39], v10 offset:43008
    v_mfma_f32_16x16x32_bf16 v[136:139], a[36:39], v[68:71], v[136:139]
    ds_read_b128 v[40:43], v10 offset:45056
    v_mfma_f32_16x16x32_bf16 v[140:143], a[108:111], v[68:71], v[140:143]
    ds_read_b128 v[44:47], v10 offset:47104
    v_mfma_f32_16x16x32_bf16 v[144:147], a[36:39], v[72:75], v[144:147]
    v_mfma_f32_16x16x32_bf16 v[148:151], a[108:111], v[72:75], v[148:151]
    v_mfma_f32_16x16x32_bf16 v[152:155], a[36:39], v[76:79], v[152:155]
    v_mfma_f32_16x16x32_bf16 v[156:159], a[108:111], v[76:79], v[156:159]
    s_waitcnt lgkmcnt(0)
    v_mfma_f32_16x16x32_bf16 v[128:131], a[40:43], v[32:35], v[128:131]
    ds_read_b128 v[64:67], v11 offset:40960
    v_mfma_f32_16x16x32_bf16 v[132:135], a[112:115], v[32:35], v[132:135]
    ds_read_b128 v[68:71], v11 offset:43008
    v_mfma_f32_16x16x32_bf16 v[136:139], a[40:43], v[36:39], v[136:139]
    ds_read_b128 v[72:75], v11 offset:45056
    v_mfma_f32_16x16x32_bf16 v[140:143], a[112:115], v[36:39], v[140:143]
    ds_read_b128 v[76:79], v11 offset:47104
    v_mfma_f32_16x16x32_bf16 v[144:147], a[40:43], v[40:43], v[144:147]
    v_mfma_f32_16x16x32_bf16 v[148:151], a[112:115], v[40:43], v[148:151]
    v_mfma_f32_16x16x32_bf16 v[152:155], a[40:43], v[44:47], v[152:155]
    v_mfma_f32_16x16x32_bf16 v[156:159], a[112:115], v[44:47], v[156:159]
    s_waitcnt lgkmcnt(0)
    v_mfma_f32_16x16x32_bf16 v[128:131], a[44:47], v[64:67], v[128:131]
    ds_read_b128 v[32:35], v10 offset:49152
    v_mfma_f32_16x16x32_bf16 v[132:135], a[116:119], v[64:67], v[132:135]
    ds_read_b128 v[36:39], v10 offset:51200
    v_mfma_f32_16x16x32_bf16 v[136:139], a[44:47], v[68:71], v[136:139]
    ds_read_b128 v[40:43], v10 offset:53248
    v_mfma_f32_16x16x32_bf16 v[140:143], a[116:119], v[68:71], v[140:143]
    ds_read_b128 v[44:47], v10 offset:55296
    v_mfma_f32_16x16x32_bf16 v[144:147], a[44:47], v[72:75], v[144:147]
    v_mfma_f32_16x16x32_bf16 v[148:151], a[116:119], v[72:75], v[148:151]
    v_mfma_f32_16x16x32_bf16 v[152:155], a[44:47], v[76:79], v[152:155]
    v_mfma_f32_16x16x32_bf16 v[156:159], a[116:119], v[76:79], v[156:159]
    s_waitcnt lgkmcnt(0)
    v_mfma_f32_16x16x32_bf16 v[128:131], a[48:51], v[32:35], v[128:131]
    ds_read_b128 v[64:67], v11 offset:49152
    v_mfma_f32_16x16x32_bf16 v[132:135], a[120:123], v[32:35], v[132:135]
    ds_read_b128 v[68:71], v11 offset:51200
    v_mfma_f32_16x16x32_bf16 v[136:139], a[48:51], v[36:39], v[136:139]
    ds_read_b128 v[72:75], v11 offset:53248
    v_mfma_f32_16x16x32_bf16 v[140:143], a[120:123], v[36:39], v[140:143]
    ds_read_b128 v[76:79], v11 offset:55296
    v_mfma_f32_16x16x32_bf16 v[144:147], a[48:51], v[40:43], v[144:147]
    v_mfma_f32_16x16x32_bf16 v[148:151], a[120:123], v[40:43], v[148:151]
    v_mfma_f32_16x16x32_bf16 v[152:155], a[48:51], v[44:47], v[152:155]
    v_mfma_f32_16x16x32_bf16 v[156:159], a[120:123], v[44:47], v[156:159]
    s_waitcnt lgkmcnt(0)
    v_mfma_f32_16x16x32_bf16 v[128:131], a[52:55], v[64:67], v[128:131]
    ds_read_b128 v[32:35], v10 offset:57344
    v_mfma_f32_16x16x32_bf16 v[132:135], a[124:127], v[64:67], v[132:135]
    ds_read_b128 v[36:39], v10 offset:59392
    v_mfma_f32_16x16x32_bf16 v[136:139], a[52:55], v[68:71], v[136:139]
    ds_read_b128 v[40:43], v10 offset:61440
    v_mfma_f32_16x16x32_bf16 v[140:143], a[124:127], v[68:71], v[140:143]
    ds_read_b128 v[44:47], v10 offset:63488
    v_mfma_f32_16x16x32_bf16 v[144:147], a[52:55], v[72:75], v[144:147]
    v_mfma_f32_16x16x32_bf16 v[148:151], a[124:127], v[72:75], v[148:151]
    v_mfma_f32_16x16x32_bf16 v[152:155], a[52:55], v[76:79], v[152:155]
    v_mfma_f32_16x16x32_bf16 v[156:159], a[124:127], v[76:79], v[156:159]
    s_waitcnt lgkmcnt(0)
    v_mfma_f32_16x16x32_bf16 v[128:131], a[56:59], v[32:35], v[128:131]
    ds_read_b128 v[64:67], v11 offset:57344
    v_mfma_f32_16x16x32_bf16 v[132:135], a[128:131], v[32:35], v[132:135]
    ds_read_b128 v[68:71], v11 offset:59392
    v_mfma_f32_16x16x32_bf16 v[136:139], a[56:59], v[36:39], v[136:139]
    ds_read_b128 v[72:75], v11 offset:61440
    v_mfma_f32_16x16x32_bf16 v[140:143], a[128:131], v[36:39], v[140:143]
    ds_read_b128 v[76:79], v11 offset:63488
    v_mfma_f32_16x16x32_bf16 v[144:147], a[56:59], v[40:43], v[144:147]
    v_mfma_f32_16x16x32_bf16 v[148:151], a[128:131], v[40:43], v[148:151]
    v_mfma_f32_16x16x32_bf16 v[152:155], a[56:59], v[44:47], v[152:155]
    v_mfma_f32_16x16x32_bf16 v[156:159], a[128:131], v[44:47], v[156:159]
    s_waitcnt lgkmcnt(0)
    v_mfma_f32_16x16x32_bf16 v[128:131], a[60:63], v[64:67], v[128:131]
    ds_read_b128 v[32:35], v13 offset:0
    v_mfma_f32_16x16x32_bf16 v[132:135], a[132:135], v[64:67], v[132:135]
    ds_read_b128 v[36:39], v13 offset:2048
    v_mfma_f32_16x16x32_bf16 v[136:139], a[60:63], v[68:71], v[136:139]
    ds_read_b128 v[40:43], v13 offset:4096
    v_mfma_f32_16x16x32_bf16 v[140:143], a[132:135], v[68:71], v[140:143]
    ds_read_b128 v[44:47], v13 offset:6144
    v_mfma_f32_16x16x32_bf16 v[144:147], a[60:63], v[72:75], v[144:147]
    v_mfma_f32_16x16x32_bf16 v[148:151], a[132:135], v[72:75], v[148:151]
    v_mfma_f32_16x16x32_bf16 v[152:155], a[60:63], v[76:79], v[152:155]
    v_mfma_f32_16x16x32_bf16 v[156:159], a[132:135], v[76:79], v[156:159]
    s_waitcnt lgkmcnt(0)
    v_mfma_f32_16x16x32_bf16 v[128:131], a[64:67], v[32:35], v[128:131]
    ds_read_b128 v[64:67], v14 offset:0
    v_mfma_f32_16x16x32_bf16 v[132:135], a[136:139], v[32:35], v[132:135]
    ds_read_b128 v[68:71], v14 offset:2048
    v_mfma_f32_16x16x32_bf16 v[136:139], a[64:67], v[36:39], v[136:139]
    ds_read_b128 v[72:75], v14 offset:4096
    v_mfma_f32_16x16x32_bf16 v[140:143], a[136:139], v[36:39], v[140:143]
    ds_read_b128 v[76:79], v14 offset:6144
    v_mfma_f32_16x16x32_bf16 v[144:147], a[64:67], v[40:43], v[144:147]
    v_mfma_f32_16x16x32_bf16 v[148:151], a[136:139], v[40:43], v[148:151]
    v_mfma_f32_16x16x32_bf16 v[152:155], a[64:67], v[44:47], v[152:155]
    v_mfma_f32_16x16x32_bf16 v[156:159], a[136:139], v[44:47], v[156:159]
    s_waitcnt lgkmcnt(0)
    v_mfma_f32_16x16x32_bf16 v[128:131], a[68:71], v[64:67], v[128:131]
    v_mfma_f32_16x16x32_bf16 v[132:135], a[140:143], v[64:67], v[132:135]
    v_mfma_f32_16x16x32_bf16 v[136:139], a[68:71], v[68:71], v[136:139]
    v_mfma_f32_16x16x32_bf16 v[140:143], a[140:143], v[68:71], v[140:143]
    v_mfma_f32_16x16x32_bf16 v[144:147], a[68:71], v[72:75], v[144:147]
    v_mfma_f32_16x16x32_bf16 v[148:151], a[140:143], v[72:75], v[148:151]
    v_mfma_f32_16x16x32_bf16 v[152:155], a[68:71], v[76:79], v[152:155]
    v_mfma_f32_16x16x32_bf16 v[156:159], a[140:143], v[76:79], v[156:159]
    s_waitcnt vmcnt(18)
    s_barrier
    s_mov_b32 s53, 147456
    s_mov_b32 s56, 8192
    s_mul_i32 s57, s65, 524288
    s_lshl_b32 s54, s79, 8
    s_add_u32 s57, s57, s54
    s_add_u32 s57, s57, 8388608
    v_and_b32 v1, 63, v0
    v_and_b32 v2, 31, v1
    v_mul_u32_u24 v2, 256, v2
    v_add_u32 v2, s53, v2
    v_lshrrev_b32 v3, 5, v1
    s_mul_i32 s36, s17, 4
    v_add_u32 v3, s36, v3
    v_and_b32 v4, 7, v1
    v_add_u32 v5, 0, v3
    v_xor_b32 v5, v5, v4
    v_lshlrev_b32 v5, 4, v5
    v_add_u32 v16, v2, v5
    v_add_u32 v5, 2, v3
    v_xor_b32 v5, v5, v4
    v_lshlrev_b32 v5, 4, v5
    v_add_u32 v17, v2, v5
    v_cvt_pk_bf16_f32 v32, v128, v129
    v_cvt_pk_bf16_f32 v33, v130, v131
    v_cvt_pk_bf16_f32 v34, v136, v137
    v_cvt_pk_bf16_f32 v35, v138, v139
    s_nop 0
    v_permlane16_swap_b32 v32, v34
    v_permlane16_swap_b32 v33, v35
    ds_write_b128 v16, v[32:35] offset:0
    v_cvt_pk_bf16_f32 v36, v132, v133
    v_cvt_pk_bf16_f32 v37, v134, v135
    v_cvt_pk_bf16_f32 v38, v140, v141
    v_cvt_pk_bf16_f32 v39, v142, v143
    s_nop 0
    v_permlane16_swap_b32 v36, v38
    v_permlane16_swap_b32 v37, v39
    ds_write_b128 v17, v[36:39] offset:0
    v_cvt_pk_bf16_f32 v40, v144, v145
    v_cvt_pk_bf16_f32 v41, v146, v147
    v_cvt_pk_bf16_f32 v42, v152, v153
    v_cvt_pk_bf16_f32 v43, v154, v155
    s_nop 0
    v_permlane16_swap_b32 v40, v42
    v_permlane16_swap_b32 v41, v43
    ds_write_b128 v16, v[40:43] offset:8192
    v_cvt_pk_bf16_f32 v44, v148, v149
    v_cvt_pk_bf16_f32 v45, v150, v151
    v_cvt_pk_bf16_f32 v46, v156, v157
    v_cvt_pk_bf16_f32 v47, v158, v159
    s_nop 0
    v_permlane16_swap_b32 v44, v46
    v_permlane16_swap_b32 v45, v47
    ds_write_b128 v17, v[44:47] offset:8192
    v_lshrrev_b32 v2, 4, v1
    s_mul_i32 s36, s17, 16
    v_add_u32 v2, s36, v2
    v_and_b32 v3, 15, v1
    v_lshrrev_b32 v4, 4, v1
    v_xor_b32 v4, v4, v3
    v_lshlrev_b32 v4, 4, v4
    v_mul_u32_u24 v5, 256, v2
    v_add_u32 v5, v5, v4
    v_add_u32 v16, s53, v5
    v_xor_b32 v5, 64, v5
    v_add_u32 v17, s53, v5
    v_mul_lo_u32 v2, v2, s56
    v_lshlrev_b32 v3, 4, v3
    v_add_u32 v18, v2, v3
    s_lshl_b32 s37, s56, 2
    s_mov_b32 s39, s57
    s_waitcnt lgkmcnt(0)
    s_barrier
    ds_read_b128 v[32:35], v16 offset:0
    ds_read_b128 v[36:39], v17 offset:1024
    ds_read_b128 v[40:43], v16 offset:2048
    ds_read_b128 v[44:47], v17 offset:3072
    s_waitcnt lgkmcnt(3)
    buffer_store_dwordx4 v[32:35], v18, s[4:7], s39 offen sc1
    s_add_u32 s39, s39, s37
    s_waitcnt lgkmcnt(2)
    buffer_store_dwordx4 v[36:39], v18, s[4:7], s39 offen sc1
    s_add_u32 s39, s39, s37
    s_waitcnt lgkmcnt(1)
    buffer_store_dwordx4 v[40:43], v18, s[4:7], s39 offen sc1
    s_add_u32 s39, s39, s37
    s_waitcnt lgkmcnt(0)
    buffer_store_dwordx4 v[44:47], v18, s[4:7], s39 offen sc1
    s_lshl_b32 s67, s42, 8
    s_lshl_b32 s54, s79, 2
    s_add_u32 s67, s67, s54
    s_add_u32 s67, s67, 1581056
    s_cmp_eq_u32 s42, -1
    s_cselect_b32 s67, 0x40000000, s67
    s_cmp_lg_u32 s17, 0
    s_cselect_b32 s67, 0x40000000, s67
    s_mov_b64 exec, 1
    v_mov_b32 v4, 0
    v_mov_b32 v5, 256
    buffer_atomic_add v5, v4, s[4:7], s67 offen
    s_mov_b64 exec, -1
    s_cmp_ge_u32 s65, 8
    s_cbranch_scc1 Lqeg_m2
    s_waitcnt vmcnt(0)
    s_barrier
    s_lshl_b32 s67, s65, 8
    s_lshl_b32 s54, s79, 2
    s_add_u32 s67, s67, s54
    s_add_u32 s67, s67, 1581056
    s_cmp_eq_u32 s65, -1
    s_cselect_b32 s67, 0x40000000, s67
    s_cmp_lg_u32 s17, 0
    s_cselect_b32 s67, 0x40000000, s67
    s_mov_b64 exec, 1
    v_mov_b32 v4, 0
    v_mov_b32 v5, 256
    buffer_atomic_add v5, v4, s[4:7], s67 offen
    s_mov_b64 exec, -1
    s_mov_b32 s44, 1
    s_mov_b32 s42, -1
    s_mov_b32 s65, s41
    s_mov_b32 s40, s43
    s_branch Lql_m2
Lqeg_m2:
    s_mov_b32 s42, s65
    s_mov_b32 s65, s41
    s_mov_b32 s40, s43
    s_cmp_lt_u32 s65, 32
    s_cbranch_scc1 Lql_m2
    s_waitcnt vmcnt(0)
    s_barrier
    s_lshl_b32 s67, s42, 8
    s_lshl_b32 s54, s79, 2
    s_add_u32 s67, s67, s54
    s_add_u32 s67, s67, 1581056
    s_cmp_eq_u32 s42, -1
    s_cselect_b32 s67, 0x40000000, s67
    s_cmp_lg_u32 s17, 0
    s_cselect_b32 s67, 0x40000000, s67
    s_mov_b64 exec, 1
    v_mov_b32 v4, 0
    v_mov_b32 v5, 256
    buffer_atomic_add v5, v4, s[4:7], s67 offen
    s_mov_b64 exec, -1
    s_branch Lqkv_fin
Lqkv_done:
    s_load_dwordx2 s[12:13], s[0:1], 88
    s_waitcnt lgkmcnt(0)
    s_mov_b32 s14, 256
    s_mov_b32 s15, 0x20000
    s_cmp_lg_u32 s17, 0
    s_cbranch_scc1 Llw1x
    s_mov_b32 s19, 0
    v_and_b32 v1, 63, v0
    v_lshlrev_b32 v2, 2, v1
Llw0x:
    buffer_load_dword v3, v2, s[12:15], 0 offen sc1
    s_waitcnt vmcnt(0)
    s_mov_b32 s20, 0
    s_mov_b32 s21, 0
    v_readlane_b32 s22, v3, 2
    s_nop 2
    s_add_u32 s20, s20, s22
    v_readlane_b32 s22, v3, 3
    s_nop 2
    s_add_u32 s21, s21, s22
    v_readlane_b32 s22, v3, 18
    s_nop 2
    s_add_u32 s20, s20, s22
    v_readlane_b32 s22, v3, 19
    s_nop 2
    s_add_u32 s21, s21, s22
    v_readlane_b32 s22, v3, 34
    s_nop 2
    s_add_u32 s20, s20, s22
    v_readlane_b32 s22, v3, 35
    s_nop 2
    s_add_u32 s21, s21, s22
    v_readlane_b32 s22, v3, 50
    s_nop 2
    s_add_u32 s20, s20, s22
    v_readlane_b32 s22, v3, 51
    s_nop 2
    s_add_u32 s21, s21, s22
    s_cmp_ge_u32 s20, s90
    s_cselect_b32 s22, s21, 0
    s_cmp_eq_u32 s89, 1
    s_cselect_b32 s20, s20, s22
    s_cmp_ge_u32 s20, 224
    s_cbranch_scc1 Llw1x
    s_sleep 12
    s_add_u32 s19, s19, 1
    s_cmp_lt_u32 s19, 524288
    s_cbranch_scc1 Llw0x
    s_branch Lfail
Llw1x:
    s_barrier
Lqkv_fin:
    s_sub_u32 s66, s64, 192
    s_cmp_ge_u32 s64, 192
    s_cbranch_scc1 Lslot
    s_and_b32 s66, s64, 31
    s_mul_i32 s66, s66, 6
    s_lshr_b32 s20, s64, 5
    s_add_u32 s66, s66, s20
    s_add_u32 s66, s66, 32
Lslot:
    s_cmp_ge_u32 s66, 224
    s_cbranch_scc1 Lexit
    s_mov_b32 s65, 0
    s_cmp_ge_u32 s66, 208
    s_cbranch_scc1 Lp_fin
    s_cmp_ge_u32 s66, 160
    s_cbranch_scc1 Lp_f2
    s_cmp_ge_u32 s66, 112
    s_cbranch_scc1 Lp_f1
    s_cmp_ge_u32 s66, 80
    s_cbranch_scc1 Lp_ln2
    s_cmp_ge_u32 s66, 32
    s_cbranch_scc1 Lp_wo
    s_lshr_b32 s65, s66, 4
    s_and_b32 s79, s66, 15
    s_mov_b32 s78, 0
    v_and_b32 v1, 63, v0
    v_and_b32 v2, 31, v1
    v_lshrrev_b32 v3, 5, v1
    v_lshlrev_b32 v4, 13, v2
    v_lshlrev_b32 v5, 4, v3
    v_add_u32 v4, v4, v5
    v_and_b32 v6, 19, v2
    v_bfe_u32 v7, v2, 3, 1
    v_lshlrev_b32 v7, 2, v7
    v_or_b32 v6, v6, v7
    v_bfe_u32 v7, v2, 2, 1
    v_lshlrev_b32 v7, 3, v7
    v_or_b32 v6, v6, v7
    v_lshlrev_b32 v7, 13, v6
    v_add_u32 v7, v7, v5
    v_lshlrev_b32 v8, 4, v1
    v_lshlrev_b32 v10, 6, v2
    v_add_u32 v10, v10, v5
    v_mov_b32 v9, 0x80000000
    v_lshlrev_b32 v11, 4, v2
    v_cmp_eq_u32 vcc, 0, v3
    s_nop 1
    v_cndmask_b32 v11, v9, v11, vcc
    v_lshlrev_b32 v12, 3, v3
    v_bfe_u32 v13, v1, 2, 2
    v_add_u32 v12, v12, v13
    v_lshlrev_b32 v12, 4, v12
    v_bfe_u32 v13, v1, 1, 1
    v_lshlrev_b32 v13, 3, v13
    v_add_u32 v12, v12, v13
    s_lshl_b32 s61, s17, 11
    v_add_u32 v12, s61, v12
    v_mov_b32 v6, 0
    s_mov_b32 s62, 0x3e0293ee
    s_mov_b32 s63, 0x3e0293ee
    s_lshl_b32 s51, s79, 1
    s_lshr_b32 s20, s17, 1
    s_add_u32 s51, s51, s20
    s_lshl_b32 s52, s65, 1
    s_and_b32 s20, s17, 1
    s_add_u32 s52, s52, s20
    s_lshl_b32 s53, s52, 18
    s_lshl_b32 s54, s51, 8
    s_add_u32 s53, s53, s54
    s_add_u32 s55, s53, 8388608
    s_add_u32 s56, s53, 25165824
    s_add_u32 s58, s53, 67108864
    s_lshl_b32 s54, s52, 5
    s_add_u32 s54, s54, s51
    s_lshl_b32 s59, s54, 13
    s_add_u32 s59, s59, 41943040
    s_lshl_b32 s54, s54, 11
    s_add_u32 s57, s54, 58720256
    s_add_u32 s60, s54, 62914560
    s_lshl_b32 s61, s51, 8
    s_add_u32 s61, s61, 1572864
    s_cmp_eq_u32 s78, 1
    s_cbranch_scc1 Lar2a
    s_mov_b32 s19, 0
    s_lshl_b32 s22, s51, 2
    s_add_u32 s21, s22, 1588736
    s_lshl_b32 s23, s65, 8
    s_add_u32 s23, s23, s22
    s_add_u32 s23, s23, 1581056
Lar0a:
    s_mov_b64 exec, 1
    buffer_load_dword v13, v6, s[4:7], s21 offen sc1
    buffer_load_dword v14, v6, s[4:7], s21 offen offset:256 sc1
    buffer_load_dword v5, v6, s[4:7], s23 offen sc1
    s_mov_b64 exec, -1
    s_waitcnt vmcnt(0)
    v_readfirstlane_b32 s20, v13
    v_readfirstlane_b32 s22, v14
    s_nop 2
    s_min_u32 s20, s20, s22
    v_readfirstlane_b32 s22, v5
    s_cmp_ge_u32 s20, 0x102
    s_cselect_b32 s78, 1, 0
    s_nop 0
    s_cmp_ge_u32 s22, 0x102
    s_cbranch_scc1 Lar2a
    s_sleep 24
    s_add_u32 s19, s19, 1
    s_cmp_lt_u32 s19, 524288
    s_cbranch_scc1 Lar0a
    s_branch Lfail
Lar2a:
    buffer_load_dwordx4 v[16:19], v4, s[4:7], s55 offen offset:0 sc1
    buffer_load_dwordx4 v[48:51], v7, s[4:7], s56 offen offset:0 sc1
    buffer_load_dwordx4 v[20:23], v4, s[4:7], s55 offen offset:32 sc1
    buffer_load_dwordx4 v[52:55], v7, s[4:7], s56 offen offset:32 sc1
    buffer_load_dwordx4 v[24:27], v4, s[4:7], s55 offen offset:64 sc1
    buffer_load_dwordx4 v[56:59], v7, s[4:7], s56 offen offset:64 sc1
    buffer_load_dwordx4 v[28:31], v4, s[4:7], s55 offen offset:96 sc1
    buffer_load_dwordx4 v[60:63], v7, s[4:7], s56 offen offset:96 sc1
    buffer_load_dwordx4 v[32:35], v4, s[4:7], s55 offen offset:128 sc1
    buffer_load_dwordx4 v[64:67], v7, s[4:7], s56 offen offset:128 sc1
    buffer_load_dwordx4 v[36:39], v4, s[4:7], s55 offen offset:160 sc1
    buffer_load_dwordx4 v[68:71], v7, s[4:7], s56 offen offset:160 sc1
    buffer_load_dwordx4 v[40:43], v4, s[4:7], s55 offen offset:192 sc1
    buffer_load_dwordx4 v[72:75], v7, s[4:7], s56 offen offset:192 sc1
    buffer_load_dwordx4 v[44:47], v4, s[4:7], s55 offen offset:224 sc1
    buffer_load_dwordx4 v[76:79], v7, s[4:7], s56 offen offset:224 sc1
    s_add_u32 s20, s59, 0
    buffer_load_dwordx4 v[112:115], v10, s[4:7], s20 offen offset:0 sc1
    s_add_u32 s20, s59, 0
    buffer_load_dwordx4 v[116:119], v10, s[4:7], s20 offen offset:32 sc1
    s_add_u32 s20, s59, 2048
    buffer_load_dwordx4 v[120:123], v10, s[4:7], s20 offen offset:0 sc1
    s_add_u32 s20, s59, 2048
    buffer_load_dwordx4 v[124:127], v10, s[4:7], s20 offen offset:32 sc1
    s_add_u32 s20, s59, 4096
    buffer_load_dwordx4 v[128:131], v10, s[4:7], s20 offen offset:0 sc1
    s_add_u32 s20, s59, 4096
    buffer_load_dwordx4 v[132:135], v10, s[4:7], s20 offen offset:32 sc1
    s_add_u32 s20, s59, 6144
    buffer_load_dwordx4 v[136:139], v10, s[4:7], s20 offen offset:0 sc1
    s_add_u32 s20, s59, 6144
    buffer_load_dwordx4 v[140:143], v10, s[4:7], s20 offen offset:32 sc1
Lp_att:
    s_mov_b64 exec, 1
    buffer_load_dword v13, v6, s[4:7], s61 offen sc1
    s_mov_b64 exec, -1
    s_waitcnt vmcnt(0)
    v_readfirstlane_b32 s20, v13
    s_lshl_b32 s68, s65, 1
    s_add_u32 s68, s68, 2
    s_mov_b32 s50, 0
    s_cmp_ge_u32 s20, s68
    s_cbranch_scc0 Latt_nr
    s_lshl_b32 s20, s17, 11
    s_mov_b32 m0, s20
    s_nop 0
    buffer_load_dwordx4 v8, s[4:7], s57 offen sc1 lds
    buffer_load_dwordx4 v8, s[4:7], s57 offen offset:1024 sc1 lds
    buffer_load_dwordx4 v[144:147], v11, s[4:7], s60 offen offset:0 sc1
    buffer_load_dwordx4 v[148:151], v11, s[4:7], s60 offen offset:512 sc1
    buffer_load_dwordx4 v[152:155], v11, s[4:7], s60 offen offset:1024 sc1
    buffer_load_dwordx4 v[156:159], v11, s[4:7], s60 offen offset:1536 sc1
    s_mov_b32 s50, 1
Latt_nr:
    v_mfma_f32_32x32x16_bf16 v[160:175], v[48:51], v[16:19], 0
    v_mfma_f32_32x32x16_bf16 v[160:175], v[52:55], v[20:23], v[160:175]
    v_mfma_f32_32x32x16_bf16 v[160:175], v[56:59], v[24:27], v[160:175]
    v_mfma_f32_32x32x16_bf16 v[160:175], v[60:63], v[28:31], v[160:175]
    v_mfma_f32_32x32x16_bf16 v[160:175], v[64:67], v[32:35], v[160:175]
    v_mfma_f32_32x32x16_bf16 v[160:175], v[68:71], v[36:39], v[160:175]
    v_mfma_f32_32x32x16_bf16 v[160:175], v[72:75], v[40:43], v[160:175]
    v_mfma_f32_32x32x16_bf16 v[160:175], v[76:79], v[44:47], v[160:175]
    v_mov_b32 v5, 0xff800000
    v_lshlrev_b32 v13, 3, v3
    v_add_u32 v14, 0, v13
    v_cmp_le_u32 vcc, v14, v2
    s_nop 7
    v_cndmask_b32 v160, v5, v160, vcc
    v_add_u32 v14, 1, v13
    v_cmp_le_u32 vcc, v14, v2
    s_nop 1
    v_cndmask_b32 v161, v5, v161, vcc
    v_add_u32 v14, 2, v13
    v_cmp_le_u32 vcc, v14, v2
    s_nop 1
    v_cndmask_b32 v162, v5, v162, vcc
    v_add_u32 v14, 3, v13
    v_cmp_le_u32 vcc, v14, v2
    s_nop 1
    v_cndmask_b32 v163, v5, v163, vcc
    v_add_u32 v14, 4, v13
    v_cmp_le_u32 vcc, v14, v2
    s_nop 1
    v_cndmask_b32 v164, v5, v164, vcc
    v_add_u32 v14, 5, v13
    v_cmp_le_u32 vcc, v14, v2
    s_nop 1
    v_cndmask_b32 v165, v5, v165, vcc
    v_add_u32 v14, 6, v13
    v_cmp_le_u32 vcc, v14, v2
    s_nop 1
    v_cndmask_b32 v166, v5, v166, vcc
    v_add_u32 v14, 7, v13
    v_cmp_le_u32 vcc, v14, v2
    s_nop 1
    v_cndmask_b32 v167, v5, v167, vcc
    v_add_u32 v14, 16, v13
    v_cmp_le_u32 vcc, v14, v2
    s_nop 1
    v_cndmask_b32 v168, v5, v168, vcc
    v_add_u32 v14, 17, v13
    v_cmp_le_u32 vcc, v14, v2
    s_nop 1
    v_cndmask_b32 v169, v5, v169, vcc
    v_add_u32 v14, 18, v13
    v_cmp_le_u32 vcc, v14, v2
    s_nop 1
    v_cndmask_b32 v170, v5, v170, vcc
    v_add_u32 v14, 19, v13
    v_cmp_le_u32 vcc, v14, v2
    s_nop 1
    v_cndmask_b32 v171, v5, v171, vcc
    v_add_u32 v14, 20, v13
    v_cmp_le_u32 vcc, v14, v2
    s_nop 1
    v_cndmask_b32 v172, v5, v172, vcc
    v_add_u32 v14, 21, v13
    v_cmp_le_u32 vcc, v14, v2
    s_nop 1
    v_cndmask_b32 v173, v5, v173, vcc
    v_add_u32 v14, 22, v13
    v_cmp_le_u32 vcc, v14, v2
    s_nop 1
    v_cndmask_b32 v174, v5, v174, vcc
    v_add_u32 v14, 23, v13
    v_cmp_le_u32 vcc, v14, v2
    s_nop 1
    v_cndmask_b32 v175, v5, v175, vcc
    v_max3_f32 v14, v160, v161, v162
    v_max3_f32 v14, v14, v163, v164
    v_max3_f32 v14, v14, v165, v166
    v_max3_f32 v14, v14, v167, v168
    v_max3_f32 v14, v14, v169, v170
    v_max3_f32 v14, v14, v171, v172
    v_max3_f32 v14, v14, v173, v174
    v_max_f32 v14, v14, v175
    v_mov_b32 v15, v14
    s_nop 1
    v_permlane32_swap_b32 v15, v14
    v_max_f32 v14, v14, v15
    v_mul_f32 v14, s62, v14
    v_fma_f32 v160, v160, s62, -v14
    v_fma_f32 v161, v161, s62, -v14
    v_fma_f32 v162, v162, s62, -v14
    v_fma_f32 v163, v163, s62, -v14
    v_fma_f32 v164, v164, s62, -v14
    v_fma_f32 v165, v165, s62, -v14
    v_fma_f32 v166, v166, s62, -v14
    v_fma_f32 v167, v167, s62, -v14
    v_fma_f32 v168, v168, s62, -v14
    v_fma_f32 v169, v169, s62, -v14
    v_fma_f32 v170, v170, s62, -v14
    v_fma_f32 v171, v171, s62, -v14
    v_fma_f32 v172, v172, s62, -v14
    v_fma_f32 v173, v173, s62, -v14
    v_fma_f32 v174, v174, s62, -v14
    v_fma_f32 v175, v175, s62, -v14
    v_exp_f32 v160, v160
    v_exp_f32 v161, v161
    v_exp_f32 v162, v162
    v_exp_f32 v163, v163
    v_exp_f32 v164, v164
    v_exp_f32 v165, v165
    v_exp_f32 v166, v166
    v_exp_f32 v167, v167
    v_exp_f32 v168, v168
    v_exp_f32 v169, v169
    v_exp_f32 v170, v170
    v_exp_f32 v171, v171
    v_exp_f32 v172, v172
    v_exp_f32 v173, v173
    v_exp_f32 v174, v174
    v_exp_f32 v175, v175
    v_cvt_pk_bf16_f32 v48, v160, v161
    v_cvt_pk_bf16_f32 v49, v162, v163
    v_cvt_pk_bf16_f32 v50, v164, v165
    v_cvt_pk_bf16_f32 v51, v166, v167
    v_cvt_pk_bf16_f32 v52, v168, v169
    v_cvt_pk_bf16_f32 v53, v170, v171
    v_cvt_pk_bf16_f32 v54, v172, v173
    v_cvt_pk_bf16_f32 v55, v174, v175
    v_mfma_f32_32x32x16_bf16 v[192:207], v[112:115], v[48:51], 0
    s_nop 0
    v_mfma_f32_32x32x16_bf16 v[192:207], v[116:119], v[52:55], v[192:207]
    v_mfma_f32_32x32x16_bf16 v[208:223], v[120:123], v[48:51], 0
    v_mfma_f32_32x32x16_bf16 v[208:223], v[124:127], v[52:55], v[208:223]
    v_mfma_f32_32x32x16_bf16 v[224:239], v[128:131], v[48:51], 0
    v_mfma_f32_32x32x16_bf16 v[224:239], v[132:135], v[52:55], v[224:239]
    v_mfma_f32_32x32x16_bf16 v[240:255], v[136:139], v[48:51], 0
    v_mfma_f32_32x32x16_bf16 v[240:255], v[140:143], v[52:55], v[240:255]
    v_add_f32 v15, v160, v161
    v_add_f32 v15, v15, v162
    v_add_f32 v15, v15, v163
    v_add_f32 v15, v15, v164
    v_add_f32 v15, v15, v165
    v_add_f32 v15, v15, v166
    v_add_f32 v15, v15, v167
    v_add_f32 v15, v15, v168
    v_add_f32 v15, v15, v169
    v_add_f32 v15, v15, v170
    v_add_f32 v15, v15, v171
    v_add_f32 v15, v15, v172
    v_add_f32 v15, v15, v173
    v_add_f32 v15, v15, v174
    v_add_f32 v15, v15, v175
    s_cmp_eq_u32 s50, 1
    s_cbranch_scc1 Latt_go
    s_mov_b32 s19, 0
Latt_pl:
    s_mov_b64 exec, 1
    buffer_load_dword v13, v6, s[4:7], s61 offen sc1
    s_mov_b64 exec, -1
    s_waitcnt vmcnt(0)
    v_readfirstlane_b32 s20, v13
    s_nop 2
    s_cmp_ge_u32 s20, s68
    s_cbranch_scc1 Latt_pd
    s_sleep 3
    s_add_u32 s19, s19, 1
    s_cmp_lt_u32 s19, 2097152
    s_cbranch_scc1 Latt_pl
    s_branch Lfail
Latt_pd:
    s_lshl_b32 s20, s17, 11
    s_mov_b32 m0, s20
    s_nop 0
    buffer_load_dwordx4 v8, s[4:7], s57 offen sc1 lds
    buffer_load_dwordx4 v8, s[4:7], s57 offen offset:1024 sc1 lds
    buffer_load_dwordx4 v[144:147], v11, s[4:7], s60 offen offset:0 sc1
    buffer_load_dwordx4 v[148:151], v11, s[4:7], s60 offen offset:512 sc1
    buffer_load_dwordx4 v[152:155], v11, s[4:7], s60 offen offset:1024 sc1
    buffer_load_dwordx4 v[156:159], v11, s[4:7], s60 offen offset:1536 sc1
Latt_go:
    s_waitcnt vmcnt(0)
    ds_read_b64_tr_b16 v[80:81], v12 offset:0
    ds_read_b64_tr_b16 v[82:83], v12 offset:64
    ds_read_b64_tr_b16 v[84:85], v12 offset:256
    ds_read_b64_tr_b16 v[86:87], v12 offset:320
    ds_read_b64_tr_b16 v[88:89], v12 offset:512
    ds_read_b64_tr_b16 v[90:91], v12 offset:576
    ds_read_b64_tr_b16 v[92:93], v12 offset:768
    ds_read_b64_tr_b16 v[94:95], v12 offset:832
    ds_read_b64_tr_b16 v[96:97], v12 offset:1024
    ds_read_b64_tr_b16 v[98:99], v12 offset:1088
    ds_read_b64_tr_b16 v[100:101], v12 offset:1280
    ds_read_b64_tr_b16 v[102:103], v12 offset:1344
    ds_read_b64_tr_b16 v[104:105], v12 offset:1536
    ds_read_b64_tr_b16 v[106:107], v12 offset:1600
    ds_read_b64_tr_b16 v[108:109], v12 offset:1792
    ds_read_b64_tr_b16 v[110:111], v12 offset:1856
    s_waitcnt lgkmcnt(0)
    v_mfma_f32_32x32x16_bf16 v[176:191], v[80:83], v[16:19], 0
    v_mfma_f32_32x32x16_bf16 v[176:191], v[84:87], v[20:23], v[176:191]
    v_mfma_f32_32x32x16_bf16 v[176:191], v[88:91], v[24:27], v[176:191]
    v_mfma_f32_32x32x16_bf16 v[176:191], v[92:95], v[28:31], v[176:191]
    v_mfma_f32_32x32x16_bf16 v[176:191], v[96:99], v[32:35], v[176:191]
    v_mfma_f32_32x32x16_bf16 v[176:191], v[100:103], v[36:39], v[176:191]
    v_mfma_f32_32x32x16_bf16 v[176:191], v[104:107], v[40:43], v[176:191]
    v_mfma_f32_32x32x16_bf16 v[176:191], v[108:111], v[44:47], v[176:191]
    v_mov_b32 v5, 0xff800000
    v_cmp_eq_u32 vcc, 0, v3
    s_nop 9
    v_cndmask_b32 v176, v5, v176, vcc
    v_cndmask_b32 v177, v5, v177, vcc
    v_cndmask_b32 v178, v5, v178, vcc
    v_cndmask_b32 v179, v5, v179, vcc
    v_cndmask_b32 v180, v5, v180, vcc
    v_cndmask_b32 v181, v5, v181, vcc
    v_cndmask_b32 v182, v5, v182, vcc
    v_cndmask_b32 v183, v5, v183, vcc
    v_max3_f32 v13, v176, v177, v178
    v_max3_f32 v13, v13, v179, v180
    v_max3_f32 v13, v13, v181, v182
    v_max_f32 v13, v13, v183
    v_mov_b32 v5, v13
    s_nop 1
    v_permlane32_swap_b32 v5, v13
    v_max_f32 v13, v13, v5
    v_mul_f32 v13, s62, v13
    v_max_f32 v13, v13, v14
    v_sub_f32 v14, v14, v13
    v_exp_f32 v14, v14
    v_fma_f32 v176, v176, s62, -v13
    v_fma_f32 v177, v177, s62, -v13
    v_fma_f32 v178, v178, s62, -v13
    v_fma_f32 v179, v179, s62, -v13
    v_fma_f32 v180, v180, s62, -v13
    v_fma_f32 v181, v181, s62, -v13
    v_fma_f32 v182, v182, s62, -v13
    v_fma_f32 v183, v183, s62, -v13
    v_exp_f32 v176, v176
    v_exp_f32 v177, v177
    v_exp_f32 v178, v178
    v_exp_f32 v179, v179
    v_exp_f32 v180, v180
    v_exp_f32 v181, v181
    v_exp_f32 v182, v182
    v_exp_f32 v183, v183
    v_mul_f32 v15, v15, v14
    v_add_f32 v15, v15, v176
    v_add_f32 v15, v15, v177
    v_add_f32 v15, v15, v178
    v_add_f32 v15, v15, v179
    v_add_f32 v15, v15, v180
    v_add_f32 v15, v15, v181
    v_add_f32 v15, v15, v182
    v_add_f32 v15, v15, v183
    v_mov_b32 v5, v15
    s_nop 1
    v_permlane32_swap_b32 v5, v15
    v_add_f32 v15, v15, v5
    v_rcp_f32 v15, v15
    s_nop 0
    v_mul_f32 v14, v14, v15
    v_mul_f32 v176, v176, v15
    v_mul_f32 v177, v177, v15
    v_mul_f32 v178, v178, v15
    v_mul_f32 v179, v179, v15
    v_mul_f32 v180, v180, v15
    v_mul_f32 v181, v181, v15
    v_mul_f32 v182, v182, v15
    v_mul_f32 v183, v183, v15
    v_cvt_pk_bf16_f32 v56, v176, v177
    v_cvt_pk_bf16_f32 v57, v178, v179
    v_cvt_pk_bf16_f32 v58, v180, v181
    v_cvt_pk_bf16_f32 v59, v182, v183
    v_pk_mul_f32 v[192:193], v[192:193], v[14:15] op_sel_hi:[1,0]
    v_pk_mul_f32 v[194:195], v[194:195], v[14:15] op_sel_hi:[1,0]
    v_pk_mul_f32 v[196:197], v[196:197], v[14:15] op_sel_hi:[1,0]
    v_pk_mul_f32 v[198:199], v[198:199], v[14:15] op_sel_hi:[1,0]
    v_pk_mul_f32 v[200:201], v[200:201], v[14:15] op_sel_hi:[1,0]
    v_pk_mul_f32 v[202:203], v[202:203], v[14:15] op_sel_hi:[1,0]
    v_pk_mul_f32 v[204:205], v[204:205], v[14:15] op_sel_hi:[1,0]
    v_pk_mul_f32 v[206:207], v[206:207], v[14:15] op_sel_hi:[1,0]
    v_pk_mul_f32 v[208:209], v[208:209], v[14:15] op_sel_hi:[1,0]
    v_pk_mul_f32 v[210:211], v[210:211], v[14:15] op_sel_hi:[1,0]
    v_pk_mul_f32 v[212:213], v[212:213], v[14:15] op_sel_hi:[1,0]
    v_pk_mul_f32 v[214:215], v[214:215], v[14:15] op_sel_hi:[1,0]
    v_pk_mul_f32 v[216:217], v[216:217], v[14:15] op_sel_hi:[1,0]
    v_pk_mul_f32 v[218:219], v[218:219], v[14:15] op_sel_hi:[1,0]
    v_pk_mul_f32 v[220:221], v[220:221], v[14:15] op_sel_hi:[1,0]
    v_pk_mul_f32 v[222:223], v[222:223], v[14:15] op_sel_hi:[1,0]
    v_pk_mul_f32 v[224:225], v[224:225], v[14:15] op_sel_hi:[1,0]
    v_pk_mul_f32 v[226:227], v[226:227], v[14:15] op_sel_hi:[1,0]
    v_pk_mul_f32 v[228:229], v[228:229], v[14:15] op_sel_hi:[1,0]
    v_pk_mul_f32 v[230:231], v[230:231], v[14:15] op_sel_hi:[1,0]
    v_pk_mul_f32 v[232:233], v[232:233], v[14:15] op_sel_hi:[1,0]
    v_pk_mul_f32 v[234:235], v[234:235], v[14:15] op_sel_hi:[1,0]
    v_pk_mul_f32 v[236:237], v[236:237], v[14:15] op_sel_hi:[1,0]
    v_pk_mul_f32 v[238:239], v[238:239], v[14:15] op_sel_hi:[1,0]
    v_pk_mul_f32 v[240:241], v[240:241], v[14:15] op_sel_hi:[1,0]
    v_pk_mul_f32 v[242:243], v[242:243], v[14:15] op_sel_hi:[1,0]
    v_pk_mul_f32 v[244:245], v[244:245], v[14:15] op_sel_hi:[1,0]
    v_pk_mul_f32 v[246:247], v[246:247], v[14:15] op_sel_hi:[1,0]
    v_pk_mul_f32 v[248:249], v[248:249], v[14:15] op_sel_hi:[1,0]
    v_pk_mul_f32 v[250:251], v[250:251], v[14:15] op_sel_hi:[1,0]
    v_pk_mul_f32 v[252:253], v[252:253], v[14:15] op_sel_hi:[1,0]
    v_pk_mul_f32 v[254:255], v[254:255], v[14:15] op_sel_hi:[1,0]
    v_mfma_f32_32x32x16_bf16 v[192:207], v[144:147], v[56:59], v[192:207]
    v_mfma_f32_32x32x16_bf16 v[208:223], v[148:151], v[56:59], v[208:223]
    v_mfma_f32_32x32x16_bf16 v[224:239], v[152:155], v[56:59], v[224:239]
    v_mfma_f32_32x32x16_bf16 v[240:255], v[156:159], v[56:59], v[240:255]
    s_lshl_b32 s20, s17, 13
    s_add_u32 s20, s20, 16384
    v_lshlrev_b32 v5, 8, v2
    v_add_u32 v5, s20, v5
    v_and_b32 v13, 7, v2
    s_nop 3
    v_cvt_pk_bf16_f32 v80, v192, v193
    v_cvt_pk_bf16_f32 v81, v194, v195
    v_cvt_pk_bf16_f32 v82, v196, v197
    v_cvt_pk_bf16_f32 v83, v198, v199
    v_cvt_pk_bf16_f32 v84, v200, v201
    v_cvt_pk_bf16_f32 v85, v202, v203
    v_cvt_pk_bf16_f32 v86, v204, v205
    v_cvt_pk_bf16_f32 v87, v206, v207
    v_permlane32_swap_b32 v80, v82
    v_permlane32_swap_b32 v81, v83
    v_permlane32_swap_b32 v84, v86
    v_permlane32_swap_b32 v85, v87
    v_add_u32 v14, 0, v3
    v_xor_b32 v14, v14, v13
    v_lshlrev_b32 v14, 4, v14
    v_add_u32 v14, v14, v5
    ds_write_b128 v14, v[80:83]
    v_add_u32 v14, 2, v3
    v_xor_b32 v14, v14, v13
    v_lshlrev_b32 v14, 4, v14
    v_add_u32 v14, v14, v5
    ds_write_b128 v14, v[84:87]
    v_cvt_pk_bf16_f32 v88, v208, v209
    v_cvt_pk_bf16_f32 v89, v210, v211
    v_cvt_pk_bf16_f32 v90, v212, v213
    v_cvt_pk_bf16_f32 v91, v214, v215
    v_cvt_pk_bf16_f32 v92, v216, v217
    v_cvt_pk_bf16_f32 v93, v218, v219
    v_cvt_pk_bf16_f32 v94, v220, v221
    v_cvt_pk_bf16_f32 v95, v222, v223
    v_permlane32_swap_b32 v88, v90
    v_permlane32_swap_b32 v89, v91
    v_permlane32_swap_b32 v92, v94
    v_permlane32_swap_b32 v93, v95
    v_add_u32 v14, 4, v3
    v_xor_b32 v14, v14, v13
    v_lshlrev_b32 v14, 4, v14
    v_add_u32 v14, v14, v5
    ds_write_b128 v14, v[88:91]
    v_add_u32 v14, 6, v3
    v_xor_b32 v14, v14, v13
    v_lshlrev_b32 v14, 4, v14
    v_add_u32 v14, v14, v5
    ds_write_b128 v14, v[92:95]
    v_cvt_pk_bf16_f32 v96, v224, v225
    v_cvt_pk_bf16_f32 v97, v226, v227
    v_cvt_pk_bf16_f32 v98, v228, v229
    v_cvt_pk_bf16_f32 v99, v230, v231
    v_cvt_pk_bf16_f32 v100, v232, v233
    v_cvt_pk_bf16_f32 v101, v234, v235
    v_cvt_pk_bf16_f32 v102, v236, v237
    v_cvt_pk_bf16_f32 v103, v238, v239
    v_permlane32_swap_b32 v96, v98
    v_permlane32_swap_b32 v97, v99
    v_permlane32_swap_b32 v100, v102
    v_permlane32_swap_b32 v101, v103
    v_add_u32 v14, 8, v3
    v_xor_b32 v14, v14, v13
    v_lshlrev_b32 v14, 4, v14
    v_add_u32 v14, v14, v5
    ds_write_b128 v14, v[96:99]
    v_add_u32 v14, 10, v3
    v_xor_b32 v14, v14, v13
    v_lshlrev_b32 v14, 4, v14
    v_add_u32 v14, v14, v5
    ds_write_b128 v14, v[100:103]
    v_cvt_pk_bf16_f32 v104, v240, v241
    v_cvt_pk_bf16_f32 v105, v242, v243
    v_cvt_pk_bf16_f32 v106, v244, v245
    v_cvt_pk_bf16_f32 v107, v246, v247
    v_cvt_pk_bf16_f32 v108, v248, v249
    v_cvt_pk_bf16_f32 v109, v250, v251
    v_cvt_pk_bf16_f32 v110, v252, v253
    v_cvt_pk_bf16_f32 v111, v254, v255
    v_permlane32_swap_b32 v104, v106
    v_permlane32_swap_b32 v105, v107
    v_permlane32_swap_b32 v108, v110
    v_permlane32_swap_b32 v109, v111
    v_add_u32 v14, 12, v3
    v_xor_b32 v14, v14, v13
    v_lshlrev_b32 v14, 4, v14
    v_add_u32 v14, v14, v5
    ds_write_b128 v14, v[104:107]
    v_add_u32 v14, 14, v3
    v_xor_b32 v14, v14, v13
    v_lshlrev_b32 v14, 4, v14
    v_add_u32 v14, v14, v5
    ds_write_b128 v14, v[108:111]
    v_lshrrev_b32 v13, 4, v1
    v_and_b32 v14, 15, v1
    v_xor_b32 v15, v14, v13
    v_lshlrev_b32 v15, 4, v15
    v_lshlrev_b32 v5, 8, v13
    v_add_u32 v15, v15, v5
    v_add_u32 v15, s20, v15
    v_xor_b32 v5, 64, v15
    v_lshlrev_b32 v13, 13, v13
    v_lshlrev_b32 v14, 4, v14
    v_add_u32 v13, v13, v14
    s_waitcnt lgkmcnt(0)
    ds_read_b128 v[192:195], v15 offset:0
    ds_read_b128 v[196:199], v5 offset:1024
    ds_read_b128 v[200:203], v15 offset:2048
    ds_read_b128 v[204:207], v5 offset:3072
    ds_read_b128 v[208:211], v15 offset:4096
    ds_read_b128 v[212:215], v5 offset:5120
    ds_read_b128 v[216:219], v15 offset:6144
    ds_read_b128 v[220:223], v5 offset:7168
    s_mov_b32 s20, s58
    s_waitcnt lgkmcnt(7)
    buffer_store_dwordx4 v[192:195], v13, s[4:7], s20 offen sc1
    s_add_u32 s20, s20, 32768
    s_waitcnt lgkmcnt(6)
    buffer_store_dwordx4 v[196:199], v13, s[4:7], s20 offen sc1
    s_add_u32 s20, s20, 32768
    s_waitcnt lgkmcnt(5)
    buffer_store_dwordx4 v[200:203], v13, s[4:7], s20 offen sc1
    s_add_u32 s20, s20, 32768
    s_waitcnt lgkmcnt(4)
    buffer_store_dwordx4 v[204:207], v13, s[4:7], s20 offen sc1
    s_add_u32 s20, s20, 32768
    s_waitcnt lgkmcnt(3)
    buffer_store_dwordx4 v[208:211], v13, s[4:7], s20 offen sc1
    s_add_u32 s20, s20, 32768
    s_waitcnt lgkmcnt(2)
    buffer_store_dwordx4 v[212:215], v13, s[4:7], s20 offen sc1
    s_add_u32 s20, s20, 32768
    s_waitcnt lgkmcnt(1)
    buffer_store_dwordx4 v[216:219], v13, s[4:7], s20 offen sc1
    s_add_u32 s20, s20, 32768
    s_waitcnt lgkmcnt(0)
    buffer_store_dwordx4 v[220:223], v13, s[4:7], s20 offen sc1
    s_mov_b32 s77, s65
    s_add_u32 s65, s65, 2
    s_cmp_ge_u32 s65, 32
    s_cbranch_scc1 Latt_last
    s_cmp_eq_u32 s78, 1
    s_cbranch_scc0 Latt_slow
    s_lshl_b32 s51, s79, 1
    s_lshr_b32 s20, s17, 1
    s_add_u32 s51, s51, s20
    s_lshl_b32 s52, s65, 1
    s_and_b32 s20, s17, 1
    s_add_u32 s52, s52, s20
    s_lshl_b32 s53, s52, 18
    s_lshl_b32 s54, s51, 8
    s_add_u32 s53, s53, s54
    s_add_u32 s55, s53, 8388608
    s_add_u32 s56, s53, 25165824
    s_add_u32 s58, s53, 67108864
    s_lshl_b32 s54, s52, 5
    s_add_u32 s54, s54, s51
    s_lshl_b32 s59, s54, 13
    s_add_u32 s59, s59, 41943040
    s_lshl_b32 s54, s54, 11
    s_add_u32 s57, s54, 58720256
    s_add_u32 s60, s54, 62914560
    s_lshl_b32 s61, s51, 8
    s_add_u32 s61, s61, 1572864
    buffer_load_dwordx4 v[16:19], v4, s[4:7], s55 offen offset:0 sc1
    buffer_load_dwordx4 v[48:51], v7, s[4:7], s56 offen offset:0 sc1
    buffer_load_dwordx4 v[20:23], v4, s[4:7], s55 offen offset:32 sc1
    buffer_load_dwordx4 v[52:55], v7, s[4:7], s56 offen offset:32 sc1
    buffer_load_dwordx4 v[24:27], v4, s[4:7], s55 offen offset:64 sc1
    buffer_load_dwordx4 v[56:59], v7, s[4:7], s56 offen offset:64 sc1
    buffer_load_dwordx4 v[28:31], v4, s[4:7], s55 offen offset:96 sc1
    buffer_load_dwordx4 v[60:63], v7, s[4:7], s56 offen offset:96 sc1
    buffer_load_dwordx4 v[32:35], v4, s[4:7], s55 offen offset:128 sc1
    buffer_load_dwordx4 v[64:67], v7, s[4:7], s56 offen offset:128 sc1
    buffer_load_dwordx4 v[36:39], v4, s[4:7], s55 offen offset:160 sc1
    buffer_load_dwordx4 v[68:71], v7, s[4:7], s56 offen offset:160 sc1
    buffer_load_dwordx4 v[40:43], v4, s[4:7], s55 offen offset:192 sc1
    buffer_load_dwordx4 v[72:75], v7, s[4:7], s56 offen offset:192 sc1
    buffer_load_dwordx4 v[44:47], v4, s[4:7], s55 offen offset:224 sc1
    buffer_load_dwordx4 v[76:79], v7, s[4:7], s56 offen offset:224 sc1
    s_add_u32 s20, s59, 0
    buffer_load_dwordx4 v[112:115], v10, s[4:7], s20 offen offset:0 sc1
    s_add_u32 s20, s59, 0
    buffer_load_dwordx4 v[116:119], v10, s[4:7], s20 offen offset:32 sc1
    s_add_u32 s20, s59, 2048
    buffer_load_dwordx4 v[120:123], v10, s[4:7], s20 offen offset:0 sc1
    s_add_u32 s20, s59, 2048
    buffer_load_dwordx4 v[124:127], v10, s[4:7], s20 offen offset:32 sc1
    s_add_u32 s20, s59, 4096
    buffer_load_dwordx4 v[128:131], v10, s[4:7], s20 offen offset:0 sc1
    s_add_u32 s20, s59, 4096
    buffer_load_dwordx4 v[132:135], v10, s[4:7], s20 offen offset:32 sc1
    s_add_u32 s20, s59, 6144
    buffer_load_dwordx4 v[136:139], v10, s[4:7], s20 offen offset:0 sc1
    s_add_u32 s20, s59, 6144
    buffer_load_dwordx4 v[140:143], v10, s[4:7], s20 offen offset:32 sc1
    s_waitcnt vmcnt(24)
    s_branch Latt_sig
Latt_last:
Latt_slow:
    s_waitcnt vmcnt(0)
Latt_sig:
    s_lshr_b32 s68, s79, 1
    s_mul_i32 s67, s77, 8
    s_add_u32 s67, s67, s68
    s_lshl_b32 s67, s67, 8
    s_add_u32 s67, s67, 1589248
    s_barrier
    s_cmp_lg_u32 s17, 0
    s_cselect_b32 s67, 0x40000000, s67
    s_mov_b64 exec, 1
    v_mov_b32 v5, 1
    buffer_atomic_add v5, v6, s[4:7], s67 offen
    s_mov_b64 exec, -1
    s_cmp_ge_u32 s65, 32
    s_cbranch_scc1 Lexit
    s_cmp_eq_u32 s78, 1
    s_cbranch_scc1 Lp_att
    s_lshl_b32 s51, s79, 1
    s_lshr_b32 s20, s17, 1
    s_add_u32 s51, s51, s20
    s_lshl_b32 s52, s65, 1
    s_and_b32 s20, s17, 1
    s_add_u32 s52, s52, s20
    s_lshl_b32 s53, s52, 18
    s_lshl_b32 s54, s51, 8
    s_add_u32 s53, s53, s54
    s_add_u32 s55, s53, 8388608
    s_add_u32 s56, s53, 25165824
    s_add_u32 s58, s53, 67108864
    s_lshl_b32 s54, s52, 5
    s_add_u32 s54, s54, s51
    s_lshl_b32 s59, s54, 13
    s_add_u32 s59, s59, 41943040
    s_lshl_b32 s54, s54, 11
    s_add_u32 s57, s54, 58720256
    s_add_u32 s60, s54, 62914560
    s_lshl_b32 s61, s51, 8
    s_add_u32 s61, s61, 1572864
    s_cmp_eq_u32 s78, 1
    s_cbranch_scc1 Lar2b
    s_mov_b32 s19, 0
    s_lshl_b32 s22, s51, 2
    s_add_u32 s21, s22, 1588736
    s_lshl_b32 s23, s65, 8
    s_add_u32 s23, s23, s22
    s_add_u32 s23, s23, 1581056
Lar0b:
    s_mov_b64 exec, 1
    buffer_load_dword v13, v6, s[4:7], s21 offen sc1
    buffer_load_dword v14, v6, s[4:7], s21 offen offset:256 sc1
    buffer_load_dword v5, v6, s[4:7], s23 offen sc1
    s_mov_b64 exec, -1
    s_waitcnt vmcnt(0)
    v_readfirstlane_b32 s20, v13
    v_readfirstlane_b32 s22, v14
    s_nop 2
    s_min_u32 s20, s20, s22
    v_readfirstlane_b32 s22, v5
    s_cmp_ge_u32 s20, 0x102
    s_cselect_b32 s78, 1, 0
    s_nop 0
    s_cmp_ge_u32 s22, 0x102
    s_cbranch_scc1 Lar2b
    s_sleep 24
    s_add_u32 s19, s19, 1
    s_cmp_lt_u32 s19, 524288
    s_cbranch_scc1 Lar0b
    s_branch Lfail
Lar2b:
    buffer_load_dwordx4 v[16:19], v4, s[4:7], s55 offen offset:0 sc1
    buffer_load_dwordx4 v[48:51], v7, s[4:7], s56 offen offset:0 sc1
    buffer_load_dwordx4 v[20:23], v4, s[4:7], s55 offen offset:32 sc1
    buffer_load_dwordx4 v[52:55], v7, s[4:7], s56 offen offset:32 sc1
    buffer_load_dwordx4 v[24:27], v4, s[4:7], s55 offen offset:64 sc1
    buffer_load_dwordx4 v[56:59], v7, s[4:7], s56 offen offset:64 sc1
    buffer_load_dwordx4 v[28:31], v4, s[4:7], s55 offen offset:96 sc1
    buffer_load_dwordx4 v[60:63], v7, s[4:7], s56 offen offset:96 sc1
    buffer_load_dwordx4 v[32:35], v4, s[4:7], s55 offen offset:128 sc1
    buffer_load_dwordx4 v[64:67], v7, s[4:7], s56 offen offset:128 sc1
    buffer_load_dwordx4 v[36:39], v4, s[4:7], s55 offen offset:160 sc1
    buffer_load_dwordx4 v[68:71], v7, s[4:7], s56 offen offset:160 sc1
    buffer_load_dwordx4 v[40:43], v4, s[4:7], s55 offen offset:192 sc1
    buffer_load_dwordx4 v[72:75], v7, s[4:7], s56 offen offset:192 sc1
    buffer_load_dwordx4 v[44:47], v4, s[4:7], s55 offen offset:224 sc1
    buffer_load_dwordx4 v[76:79], v7, s[4:7], s56 offen offset:224 sc1
    s_add_u32 s20, s59, 0
    buffer_load_dwordx4 v[112:115], v10, s[4:7], s20 offen offset:0 sc1
    s_add_u32 s20, s59, 0
    buffer_load_dwordx4 v[116:119], v10, s[4:7], s20 offen offset:32 sc1
    s_add_u32 s20, s59, 2048
    buffer_load_dwordx4 v[120:123], v10, s[4:7], s20 offen offset:0 sc1
    s_add_u32 s20, s59, 2048
    buffer_load_dwordx4 v[124:127], v10, s[4:7], s20 offen offset:32 sc1
    s_add_u32 s20, s59, 4096
    buffer_load_dwordx4 v[128:131], v10, s[4:7], s20 offen offset:0 sc1
    s_add_u32 s20, s59, 4096
    buffer_load_dwordx4 v[132:135], v10, s[4:7], s20 offen offset:32 sc1
    s_add_u32 s20, s59, 6144
    buffer_load_dwordx4 v[136:139], v10, s[4:7], s20 offen offset:0 sc1
    s_add_u32 s20, s59, 6144
    buffer_load_dwordx4 v[140:143], v10, s[4:7], s20 offen offset:32 sc1
    s_branch Lp_att
Lp_wo:
    s_sub_u32 s20, s66, 32
    s_cmp_ge_u32 s20, 24
    s_cselect_b32 s65, 1, 0
    s_cselect_b32 s21, 24, 0
    s_sub_u32 s20, s20, s21
    s_mov_b32 s77, s65
    s_mul_hi_u32 s78, s20, s63
    s_mul_i32 s79, s78, 3
    s_sub_u32 s79, s20, s79
    s_load_dwordx2 s[12:13], s[0:1], 40
    s_waitcnt lgkmcnt(0)
    s_mov_b32 s14, 4718592
    s_mov_b32 s15, 0x20000
    s_mul_i32 s26, s78, 589824
    s_mul_i32 s54, s79, 384
    s_add_u32 s26, s26, s54
    s_mov_b32 s27, 1152
    v_and_b32 v1, 63, v0
    v_lshrrev_b32 v2, 3, v1
    v_mul_lo_u32 v2, v2, s27
    v_and_b32 v3, 7, v1
    v_bfe_u32 v4, v1, 4, 1
    v_lshlrev_b32 v4, 2, v4
    v_xor_b32 v3, v3, v4
    v_lshlrev_b32 v3, 4, v3
    v_add_u32 v19, v2, v3
    v_lshrrev_b32 v2, 4, v1
    v_lshlrev_b32 v2, 3, v2
    v_bfe_u32 v3, v1, 2, 2
    v_add_u32 v2, v2, v3
    v_lshlrev_b32 v2, 7, v2
    v_and_b32 v4, 3, v1
    v_lshlrev_b32 v4, 3, v4
    v_add_u32 v2, v2, v4
    v_bfe_u32 v3, v1, 3, 1
    v_lshlrev_b32 v3, 6, v3
    s_mul_i32 s36, s17, 48
    s_add_u32 s36, s36, 0
    s_lshr_b32 s37, s36, 5
    s_and_b32 s37, s37, 1
    s_lshl_b32 s37, s37, 6
    v_xor_b32 v4, s37, v3
    v_add_u32 v4, v4, v2
    s_lshr_b32 s37, s36, 6
    s_lshl_b32 s37, s37, 13
    s_and_b32 s34, s36, 16
    s_lshl_b32 s34, s34, 1
    s_add_u32 s37, s37, s34
    v_add_u32 v16, s37, v4
    s_mul_i32 s36, s17, 48
    s_add_u32 s36, s36, 16
    s_lshr_b32 s37, s36, 5
    s_and_b32 s37, s37, 1
    s_lshl_b32 s37, s37, 6
    v_xor_b32 v4, s37, v3
    v_add_u32 v4, v4, v2
    s_lshr_b32 s37, s36, 6
    s_lshl_b32 s37, s37, 13
    s_and_b32 s34, s36, 16
    s_lshl_b32 s34, s34, 1
    s_add_u32 s37, s37, s34
    v_add_u32 v17, s37, v4
    s_mul_i32 s36, s17, 48
    s_add_u32 s36, s36, 32
    s_lshr_b32 s37, s36, 5
    s_and_b32 s37, s37, 1
    s_lshl_b32 s37, s37, 6
    v_xor_b32 v4, s37, v3
    v_add_u32 v4, v4, v2
    s_lshr_b32 s37, s36, 6
    s_lshl_b32 s37, s37, 13
    s_and_b32 s34, s36, 16
    s_lshl_b32 s34, s34, 1
    s_add_u32 s37, s37, s34
    v_add_u32 v18, s37, v4
    s_lshl_b32 s36, s17, 3
    s_add_u32 s36, s36, 0
    s_mul_i32 s39, s36, s27
    s_add_u32 s39, s39, s26
    s_lshl_b32 s34, s17, 10
    s_add_u32 s34, s34, 0
    s_lshl_b32 s37, s27, 5
    s_mov_b32 m0, s34
    s_nop 0
    buffer_load_dwordx4 v19, s[12:15], s39 offen lds
    s_add_u32 s34, s34, 4096
    s_add_u32 s39, s39, s37
    s_mov_b32 m0, s34
    s_nop 0
    buffer_load_dwordx4 v19, s[12:15], s39 offen lds
    s_add_u32 s34, s34, 4096
    s_sub_u32 s39, s39, s37
    s_add_u32 s39, s39, 128
    s_mov_b32 m0, s34
    s_nop 0
    buffer_load_dwordx4 v19, s[12:15], s39 offen lds
    s_add_u32 s34, s34, 4096
    s_add_u32 s39, s39, s37
    s_mov_b32 m0, s34
    s_nop 0
    buffer_load_dwordx4 v19, s[12:15], s39 offen lds
    s_add_u32 s34, s34, 4096
    s_sub_u32 s39, s39, s37
    s_add_u32 s39, s39, 128
    s_mov_b32 m0, s34
    s_nop 0
    buffer_load_dwordx4 v19, s[12:15], s39 offen lds
    s_add_u32 s34, s34, 4096
    s_add_u32 s39, s39, s37
    s_mov_b32 m0, s34
    s_nop 0
    buffer_load_dwordx4 v19, s[12:15], s39 offen lds
    s_lshl_b32 s36, s17, 3
    s_add_u32 s36, s36, 64
    s_mul_i32 s39, s36, s27
    s_add_u32 s39, s39, s26
    s_lshl_b32 s34, s17, 10
    s_add_u32 s34, s34, 24576
    s_lshl_b32 s37, s27, 5
    s_mov_b32 m0, s34
    s_nop 0
    buffer_load_dwordx4 v19, s[12:15], s39 offen lds
    s_add_u32 s34, s34, 4096
    s_add_u32 s39, s39, s37
    s_mov_b32 m0, s34
    s_nop 0
    buffer_load_dwordx4 v19, s[12:15], s39 offen lds
    s_add_u32 s34, s34, 4096
    s_sub_u32 s39, s39, s37
    s_add_u32 s39, s39, 128
    s_mov_b32 m0, s34
    s_nop 0
    buffer_load_dwordx4 v19, s[12:15], s39 offen lds
    s_add_u32 s34, s34, 4096
    s_add_u32 s39, s39, s37
    s_mov_b32 m0, s34
    s_nop 0
    buffer_load_dwordx4 v19, s[12:15], s39 offen lds
    s_add_u32 s34, s34, 4096
    s_sub_u32 s39, s39, s37
    s_add_u32 s39, s39, 128
    s_mov_b32 m0, s34
    s_nop 0
    buffer_load_dwordx4 v19, s[12:15], s39 offen lds
    s_add_u32 s34, s34, 4096
    s_add_u32 s39, s39, s37
    s_mov_b32 m0, s34
    s_nop 0
    buffer_load_dwordx4 v19, s[12:15], s39 offen lds
    s_lshl_b32 s36, s17, 3
    s_add_u32 s36, s36, 128
    s_mul_i32 s39, s36, s27
    s_add_u32 s39, s39, s26
    s_lshl_b32 s34, s17, 10
    s_add_u32 s34, s34, 49152
    s_lshl_b32 s37, s27, 5
    s_mov_b32 m0, s34
    s_nop 0
    buffer_load_dwordx4 v19, s[12:15], s39 offen lds
    s_add_u32 s34, s34, 4096
    s_add_u32 s39, s39, s37
    s_mov_b32 m0, s34
    s_nop 0
    buffer_load_dwordx4 v19, s[12:15], s39 offen lds
    s_add_u32 s34, s34, 4096
    s_sub_u32 s39, s39, s37
    s_add_u32 s39, s39, 128
    s_mov_b32 m0, s34
    s_nop 0
    buffer_load_dwordx4 v19, s[12:15], s39 offen lds
    s_add_u32 s34, s34, 4096
    s_add_u32 s39, s39, s37
    s_mov_b32 m0, s34
    s_nop 0
    buffer_load_dwordx4 v19, s[12:15], s39 offen lds
    s_add_u32 s34, s34, 4096
    s_sub_u32 s39, s39, s37
    s_add_u32 s39, s39, 128
    s_mov_b32 m0, s34
    s_nop 0
    buffer_load_dwordx4 v19, s[12:15], s39 offen lds
    s_add_u32 s34, s34, 4096
    s_add_u32 s39, s39, s37
    s_mov_b32 m0, s34
    s_nop 0
    buffer_load_dwordx4 v19, s[12:15], s39 offen lds
    s_lshl_b32 s36, s17, 3
    s_add_u32 s36, s36, 192
    s_mul_i32 s39, s36, s27
    s_add_u32 s39, s39, s26
    s_lshl_b32 s34, s17, 10
    s_add_u32 s34, s34, 73728
    s_lshl_b32 s37, s27, 5
    s_mov_b32 m0, s34
    s_nop 0
    buffer_load_dwordx4 v19, s[12:15], s39 offen lds
    s_add_u32 s34, s34, 4096
    s_add_u32 s39, s39, s37
    s_mov_b32 m0, s34
    s_nop 0
    buffer_load_dwordx4 v19, s[12:15], s39 offen lds
    s_add_u32 s34, s34, 4096
    s_sub_u32 s39, s39, s37
    s_add_u32 s39, s39, 128
    s_mov_b32 m0, s34
    s_nop 0
    buffer_load_dwordx4 v19, s[12:15], s39 offen lds
    s_add_u32 s34, s34, 4096
    s_add_u32 s39, s39, s37
    s_mov_b32 m0, s34
    s_nop 0
    buffer_load_dwordx4 v19, s[12:15], s39 offen lds
    s_add_u32 s34, s34, 4096
    s_sub_u32 s39, s39, s37
    s_add_u32 s39, s39, 128
    s_mov_b32 m0, s34
    s_nop 0
    buffer_load_dwordx4 v19, s[12:15], s39 offen lds
    s_add_u32 s34, s34, 4096
    s_add_u32 s39, s39, s37
    s_mov_b32 m0, s34
    s_nop 0
    buffer_load_dwordx4 v19, s[12:15], s39 offen lds
    s_lshl_b32 s36, s17, 3
    s_add_u32 s36, s36, 256
    s_mul_i32 s39, s36, s27
    s_add_u32 s39, s39, s26
    s_lshl_b32 s34, s17, 10
    s_add_u32 s34, s34, 98304
    s_lshl_b32 s37, s27, 5
    s_mov_b32 m0, s34
    s_nop 0
    buffer_load_dwordx4 v19, s[12:15], s39 offen lds
    s_add_u32 s34, s34, 4096
    s_add_u32 s39, s39, s37
    s_mov_b32 m0, s34
    s_nop 0
    buffer_load_dwordx4 v19, s[12:15], s39 offen lds
    s_add_u32 s34, s34, 4096
    s_sub_u32 s39, s39, s37
    s_add_u32 s39, s39, 128
    s_mov_b32 m0, s34
    s_nop 0
    buffer_load_dwordx4 v19, s[12:15], s39 offen lds
    s_add_u32 s34, s34, 4096
    s_add_u32 s39, s39, s37
    s_mov_b32 m0, s34
    s_nop 0
    buffer_load_dwordx4 v19, s[12:15], s39 offen lds
    s_add_u32 s34, s34, 4096
    s_sub_u32 s39, s39, s37
    s_add_u32 s39, s39, 128
    s_mov_b32 m0, s34
    s_nop 0
    buffer_load_dwordx4 v19, s[12:15], s39 offen lds
    s_add_u32 s34, s34, 4096
    s_add_u32 s39, s39, s37
    s_mov_b32 m0, s34
    s_nop 0
    buffer_load_dwordx4 v19, s[12:15], s39 offen lds
    s_lshl_b32 s36, s17, 3
    s_add_u32 s36, s36, 320
    s_mul_i32 s39, s36, s27
    s_add_u32 s39, s39, s26
    s_lshl_b32 s34, s17, 10
    s_add_u32 s34, s34, 122880
    s_lshl_b32 s37, s27, 5
    s_mov_b32 m0, s34
    s_nop 0
    buffer_load_dwordx4 v19, s[12:15], s39 offen lds
    s_add_u32 s34, s34, 4096
    s_add_u32 s39, s39, s37
    s_mov_b32 m0, s34
    s_nop 0
    buffer_load_dwordx4 v19, s[12:15], s39 offen lds
    s_add_u32 s34, s34, 4096
    s_sub_u32 s39, s39, s37
    s_add_u32 s39, s39, 128
    s_mov_b32 m0, s34
    s_nop 0
    buffer_load_dwordx4 v19, s[12:15], s39 offen lds
    s_add_u32 s34, s34, 4096
    s_add_u32 s39, s39, s37
    s_mov_b32 m0, s34
    s_nop 0
    buffer_load_dwordx4 v19, s[12:15], s39 offen lds
    s_add_u32 s34, s34, 4096
    s_sub_u32 s39, s39, s37
    s_add_u32 s39, s39, 128
    s_mov_b32 m0, s34
    s_nop 0
    buffer_load_dwordx4 v19, s[12:15], s39 offen lds
    s_add_u32 s34, s34, 4096
    s_add_u32 s39, s39, s37
    s_mov_b32 m0, s34
    s_nop 0
    buffer_load_dwordx4 v19, s[12:15], s39 offen lds
    s_waitcnt vmcnt(0)
    s_barrier
    ds_read_b64_tr_b16 a[0:1], v16 offset:0
    ds_read_b64_tr_b16 a[2:3], v16 offset:512
    ds_read_b64_tr_b16 a[72:73], v17 offset:0
    ds_read_b64_tr_b16 a[74:75], v17 offset:512
    ds_read_b64_tr_b16 a[144:145], v18 offset:0
    ds_read_b64_tr_b16 a[146:147], v18 offset:512
    ds_read_b64_tr_b16 a[4:5], v16 offset:4096
    ds_read_b64_tr_b16 a[6:7], v16 offset:4608
    ds_read_b64_tr_b16 a[76:77], v17 offset:4096
    ds_read_b64_tr_b16 a[78:79], v17 offset:4608
    ds_read_b64_tr_b16 a[148:149], v18 offset:4096
    ds_read_b64_tr_b16 a[150:151], v18 offset:4608
    s_waitcnt lgkmcnt(0)
    ds_read_b64_tr_b16 a[8:9], v16 offset:24576
    ds_read_b64_tr_b16 a[10:11], v16 offset:25088
    ds_read_b64_tr_b16 a[80:81], v17 offset:24576
    ds_read_b64_tr_b16 a[82:83], v17 offset:25088
    ds_read_b64_tr_b16 a[152:153], v18 offset:24576
    ds_read_b64_tr_b16 a[154:155], v18 offset:25088
    ds_read_b64_tr_b16 a[12:13], v16 offset:28672
    ds_read_b64_tr_b16 a[14:15], v16 offset:29184
    ds_read_b64_tr_b16 a[84:85], v17 offset:28672
    ds_read_b64_tr_b16 a[86:87], v17 offset:29184
    ds_read_b64_tr_b16 a[156:157], v18 offset:28672
    ds_read_b64_tr_b16 a[158:159], v18 offset:29184
    s_waitcnt lgkmcnt(0)
    ds_read_b64_tr_b16 a[16:17], v16 offset:49152
    ds_read_b64_tr_b16 a[18:19], v16 offset:49664
    ds_read_b64_tr_b16 a[88:89], v17 offset:49152
    ds_read_b64_tr_b16 a[90:91], v17 offset:49664
    ds_read_b64_tr_b16 a[160:161], v18 offset:49152
    ds_read_b64_tr_b16 a[162:163], v18 offset:49664
    ds_read_b64_tr_b16 a[20:21], v16 offset:53248
    ds_read_b64_tr_b16 a[22:23], v16 offset:53760
    ds_read_b64_tr_b16 a[92:93], v17 offset:53248
    ds_read_b64_tr_b16 a[94:95], v17 offset:53760
    ds_read_b64_tr_b16 a[164:165], v18 offset:53248
    ds_read_b64_tr_b16 a[166:167], v18 offset:53760
    s_waitcnt lgkmcnt(0)
    v_add_u32 v5, 65536, v16
    ds_read_b64_tr_b16 a[24:25], v5 offset:8192
    v_add_u32 v5, 65536, v16
    ds_read_b64_tr_b16 a[26:27], v5 offset:8704
    v_add_u32 v5, 65536, v17
    ds_read_b64_tr_b16 a[96:97], v5 offset:8192
    v_add_u32 v5, 65536, v17
    ds_read_b64_tr_b16 a[98:99], v5 offset:8704
    v_add_u32 v5, 65536, v18
    ds_read_b64_tr_b16 a[168:169], v5 offset:8192
    v_add_u32 v5, 65536, v18
    ds_read_b64_tr_b16 a[170:171], v5 offset:8704
    v_add_u32 v5, 65536, v16
    ds_read_b64_tr_b16 a[28:29], v5 offset:12288
    v_add_u32 v5, 65536, v16
    ds_read_b64_tr_b16 a[30:31], v5 offset:12800
    v_add_u32 v5, 65536, v17
    ds_read_b64_tr_b16 a[100:101], v5 offset:12288
    v_add_u32 v5, 65536, v17
    ds_read_b64_tr_b16 a[102:103], v5 offset:12800
    v_add_u32 v5, 65536, v18
    ds_read_b64_tr_b16 a[172:173], v5 offset:12288
    v_add_u32 v5, 65536, v18
    ds_read_b64_tr_b16 a[174:175], v5 offset:12800
    s_waitcnt lgkmcnt(0)
    v_add_u32 v5, 65536, v16
    ds_read_b64_tr_b16 a[32:33], v5 offset:32768
    v_add_u32 v5, 65536, v16
    ds_read_b64_tr_b16 a[34:35], v5 offset:33280
    v_add_u32 v5, 65536, v17
    ds_read_b64_tr_b16 a[104:105], v5 offset:32768
    v_add_u32 v5, 65536, v17
    ds_read_b64_tr_b16 a[106:107], v5 offset:33280
    v_add_u32 v5, 65536, v18
    ds_read_b64_tr_b16 a[176:177], v5 offset:32768
    v_add_u32 v5, 65536, v18
    ds_read_b64_tr_b16 a[178:179], v5 offset:33280
    v_add_u32 v5, 65536, v16
    ds_read_b64_tr_b16 a[36:37], v5 offset:36864
    v_add_u32 v5, 65536, v16
    ds_read_b64_tr_b16 a[38:39], v5 offset:37376
    v_add_u32 v5, 65536, v17
    ds_read_b64_tr_b16 a[108:109], v5 offset:36864
    v_add_u32 v5, 65536, v17
    ds_read_b64_tr_b16 a[110:111], v5 offset:37376
    v_add_u32 v5, 65536, v18
    ds_read_b64_tr_b16 a[180:181], v5 offset:36864
    v_add_u32 v5, 65536, v18
    ds_read_b64_tr_b16 a[182:183], v5 offset:37376
    s_waitcnt lgkmcnt(0)
    v_add_u32 v5, 65536, v16
    ds_read_b64_tr_b16 a[40:41], v5 offset:57344
    v_add_u32 v5, 65536, v16
    ds_read_b64_tr_b16 a[42:43], v5 offset:57856
    v_add_u32 v5, 65536, v17
    ds_read_b64_tr_b16 a[112:113], v5 offset:57344
    v_add_u32 v5, 65536, v17
    ds_read_b64_tr_b16 a[114:115], v5 offset:57856
    v_add_u32 v5, 65536, v18
    ds_read_b64_tr_b16 a[184:185], v5 offset:57344
    v_add_u32 v5, 65536, v18
    ds_read_b64_tr_b16 a[186:187], v5 offset:57856
    v_add_u32 v5, 65536, v16
    ds_read_b64_tr_b16 a[44:45], v5 offset:61440
    v_add_u32 v5, 65536, v16
    ds_read_b64_tr_b16 a[46:47], v5 offset:61952
    v_add_u32 v5, 65536, v17
    ds_read_b64_tr_b16 a[116:117], v5 offset:61440
    v_add_u32 v5, 65536, v17
    ds_read_b64_tr_b16 a[118:119], v5 offset:61952
    v_add_u32 v5, 65536, v18
    ds_read_b64_tr_b16 a[188:189], v5 offset:61440
    v_add_u32 v5, 65536, v18
    ds_read_b64_tr_b16 a[190:191], v5 offset:61952
    s_waitcnt lgkmcnt(0)
    s_barrier
    s_lshl_b32 s36, s17, 3
    s_add_u32 s36, s36, 384
    s_mul_i32 s39, s36, s27
    s_add_u32 s39, s39, s26
    s_lshl_b32 s34, s17, 10
    s_add_u32 s34, s34, 0
    s_lshl_b32 s37, s27, 5
    s_mov_b32 m0, s34
    s_nop 0
    buffer_load_dwordx4 v19, s[12:15], s39 offen lds
    s_add_u32 s34, s34, 4096
    s_add_u32 s39, s39, s37
    s_mov_b32 m0, s34
    s_nop 0
    buffer_load_dwordx4 v19, s[12:15], s39 offen lds
    s_add_u32 s34, s34, 4096
    s_sub_u32 s39, s39, s37
    s_add_u32 s39, s39, 128
    s_mov_b32 m0, s34
    s_nop 0
    buffer_load_dwordx4 v19, s[12:15], s39 offen lds
    s_add_u32 s34, s34, 4096
    s_add_u32 s39, s39, s37
    s_mov_b32 m0, s34
    s_nop 0
    buffer_load_dwordx4 v19, s[12:15], s39 offen lds
    s_add_u32 s34, s34, 4096
    s_sub_u32 s39, s39, s37
    s_add_u32 s39, s39, 128
    s_mov_b32 m0, s34
    s_nop 0
    buffer_load_dwordx4 v19, s[12:15], s39 offen lds
    s_add_u32 s34, s34, 4096
    s_add_u32 s39, s39, s37
    s_mov_b32 m0, s34
    s_nop 0
    buffer_load_dwordx4 v19, s[12:15], s39 offen lds
    s_lshl_b32 s36, s17, 3
    s_add_u32 s36, s36, 448
    s_mul_i32 s39, s36, s27
    s_add_u32 s39, s39, s26
    s_lshl_b32 s34, s17, 10
    s_add_u32 s34, s34, 24576
    s_lshl_b32 s37, s27, 5
    s_mov_b32 m0, s34
    s_nop 0
    buffer_load_dwordx4 v19, s[12:15], s39 offen lds
    s_add_u32 s34, s34, 4096
    s_add_u32 s39, s39, s37
    s_mov_b32 m0, s34
    s_nop 0
    buffer_load_dwordx4 v19, s[12:15], s39 offen lds
    s_add_u32 s34, s34, 4096
    s_sub_u32 s39, s39, s37
    s_add_u32 s39, s39, 128
    s_mov_b32 m0, s34
    s_nop 0
    buffer_load_dwordx4 v19, s[12:15], s39 offen lds
    s_add_u32 s34, s34, 4096
    s_add_u32 s39, s39, s37
    s_mov_b32 m0, s34
    s_nop 0
    buffer_load_dwordx4 v19, s[12:15], s39 offen lds
    s_add_u32 s34, s34, 4096
    s_sub_u32 s39, s39, s37
    s_add_u32 s39, s39, 128
    s_mov_b32 m0, s34
    s_nop 0
    buffer_load_dwordx4 v19, s[12:15], s39 offen lds
    s_add_u32 s34, s34, 4096
    s_add_u32 s39, s39, s37
    s_mov_b32 m0, s34
    s_nop 0
    buffer_load_dwordx4 v19, s[12:15], s39 offen lds
    s_waitcnt vmcnt(0)
    s_barrier
    ds_read_b64_tr_b16 a[48:49], v16 offset:0
    ds_read_b64_tr_b16 a[50:51], v16 offset:512
    ds_read_b64_tr_b16 a[120:121], v17 offset:0
    ds_read_b64_tr_b16 a[122:123], v17 offset:512
    ds_read_b64_tr_b16 a[192:193], v18 offset:0
    ds_read_b64_tr_b16 a[194:195], v18 offset:512
    ds_read_b64_tr_b16 a[52:53], v16 offset:4096
    ds_read_b64_tr_b16 a[54:55], v16 offset:4608
    ds_read_b64_tr_b16 a[124:125], v17 offset:4096
    ds_read_b64_tr_b16 a[126:127], v17 offset:4608
    ds_read_b64_tr_b16 a[196:197], v18 offset:4096
    ds_read_b64_tr_b16 a[198:199], v18 offset:4608
    s_waitcnt lgkmcnt(0)
    ds_read_b64_tr_b16 a[56:57], v16 offset:24576
    ds_read_b64_tr_b16 a[58:59], v16 offset:25088
    ds_read_b64_tr_b16 a[128:129], v17 offset:24576
    ds_read_b64_tr_b16 a[130:131], v17 offset:25088
    ds_read_b64_tr_b16 a[200:201], v18 offset:24576
    ds_read_b64_tr_b16 a[202:203], v18 offset:25088
    ds_read_b64_tr_b16 a[60:61], v16 offset:28672
    ds_read_b64_tr_b16 a[62:63], v16 offset:29184
    ds_read_b64_tr_b16 a[132:133], v17 offset:28672
    ds_read_b64_tr_b16 a[134:135], v17 offset:29184
    ds_read_b64_tr_b16 a[204:205], v18 offset:28672
    ds_read_b64_tr_b16 a[206:207], v18 offset:29184
    s_waitcnt lgkmcnt(0)
    s_barrier
    s_mov_b32 s25, 8192
    v_and_b32 v1, 63, v0
    v_and_b32 v2, 15, v1
    v_lshrrev_b32 v3, 4, v1
    v_bfe_u32 v4, v2, 1, 3
    v_xor_b32 v3, v3, v4
    v_lshlrev_b32 v3, 4, v3
    v_lshlrev_b32 v2, 7, v2
    v_add_u32 v8, v2, v3
    v_xor_b32 v9, 64, v8
    v_lshrrev_b32 v2, 3, v1
    v_mul_lo_u32 v2, v2, s25
    v_and_b32 v3, 7, v1
    v_lshrrev_b32 v4, 4, v1
    v_xor_b32 v3, v3, v4
    s_and_b32 s37, s17, 1
    s_lshl_b32 s34, s37, 2
    v_xor_b32 v3, s34, v3
    v_lshlrev_b32 v3, 4, v3
    v_add_u32 v12, v2, v3
Lp_wo_l:
    s_mov_b32 s68, s78
    s_mul_i32 s67, s65, 8
    s_add_u32 s67, s67, s68
    s_lshl_b32 s67, s67, 8
    s_add_u32 s67, s67, 1589248
    s_cmp_lg_u32 s17, 0
    s_cbranch_scc1 Lw_56
    s_mov_b64 exec, 1
    v_mov_b32 v2, 0
    s_mov_b32 s70, 0
Lw_54:
    buffer_load_dword v3, v2, s[4:7], s67 offen sc1
    s_waitcnt vmcnt(0)
    v_readfirstlane_b32 s69, v3
    s_nop 2
    s_cmp_ge_u32 s69, 2
    s_cbranch_scc1 Lw_55
    s_cmp_ge_u32 s70, 2
    s_cbranch_scc1 Lb_57
    s_cmp_ge_u32 s65, 28
    s_cbranch_scc1 Lb_57
    s_sleep 24
Lb_57:
    s_sleep 2
    s_add_u32 s70, s70, 1
    s_cmp_lt_u32 s70, 524288
    s_cbranch_scc1 Lw_54
    s_branch Lfail
Lw_55:
    s_mov_b64 exec, -1
Lw_56:
    s_barrier
    s_mov_b32 s8, s4
    s_mov_b32 s9, s5
    s_mov_b32 s10, s6
    s_mov_b32 s11, s7
    s_lshl_b32 s52, s65, 6
    s_mul_i32 s24, s52, 8192
    s_mul_i32 s54, s78, 1024
    s_add_u32 s24, s24, s54
    s_add_u32 s24, s24, 67108864
    s_lshl_b32 s36, s17, 3
    s_mul_i32 s36, s36, s25
    s_add_u32 s36, s36, s24
    s_lshl_b32 s37, s25, 5
    s_lshl_b32 s39, s17, 10
    s_add_u32 s38, s36, 0
    s_add_u32 s34, s39, 0
    s_mov_b32 m0, s34
    s_nop 0
    buffer_load_dwordx4 v12, s[8:11], s38 offen sc1 lds
    s_add_u32 s38, s38, s37
    s_add_u32 s34, s34, 4096
    s_mov_b32 m0, s34
    s_nop 0
    buffer_load_dwordx4 v12, s[8:11], s38 offen sc1 lds
    s_add_u32 s38, s36, 128
    s_add_u32 s34, s39, 8192
    s_mov_b32 m0, s34
    s_nop 0
    buffer_load_dwordx4 v12, s[8:11], s38 offen sc1 lds
    s_add_u32 s38, s38, s37
    s_add_u32 s34, s34, 4096
    s_mov_b32 m0, s34
    s_nop 0
    buffer_load_dwordx4 v12, s[8:11], s38 offen sc1 lds
    s_add_u32 s38, s36, 256
    s_add_u32 s34, s39, 16384
    s_mov_b32 m0, s34
    s_nop 0
    buffer_load_dwordx4 v12, s[8:11], s38 offen sc1 lds
    s_add_u32 s38, s38, s37
    s_add_u32 s34, s34, 4096
    s_mov_b32 m0, s34
    s_nop 0
    buffer_load_dwordx4 v12, s[8:11], s38 offen sc1 lds
    s_add_u32 s38, s36, 384
    s_add_u32 s34, s39, 24576
    s_mov_b32 m0, s34
    s_nop 0
    buffer_load_dwordx4 v12, s[8:11], s38 offen sc1 lds
    s_add_u32 s38, s38, s37
    s_add_u32 s34, s34, 4096
    s_mov_b32 m0, s34
    s_nop 0
    buffer_load_dwordx4 v12, s[8:11], s38 offen sc1 lds
    s_add_u32 s38, s36, 512
    s_add_u32 s34, s39, 32768
    s_mov_b32 m0, s34
    s_nop 0
    buffer_load_dwordx4 v12, s[8:11], s38 offen sc1 lds
    s_add_u32 s38, s38, s37
    s_add_u32 s34, s34, 4096
    s_mov_b32 m0, s34
    s_nop 0
    buffer_load_dwordx4 v12, s[8:11], s38 offen sc1 lds
    s_add_u32 s38, s36, 640
    s_add_u32 s34, s39, 40960
    s_mov_b32 m0, s34
    s_nop 0
    buffer_load_dwordx4 v12, s[8:11], s38 offen sc1 lds
    s_add_u32 s38, s38, s37
    s_add_u32 s34, s34, 4096
    s_mov_b32 m0, s34
    s_nop 0
    buffer_load_dwordx4 v12, s[8:11], s38 offen sc1 lds
    s_add_u32 s38, s36, 768
    s_add_u32 s34, s39, 49152
    s_mov_b32 m0, s34
    s_nop 0
    buffer_load_dwordx4 v12, s[8:11], s38 offen sc1 lds
    s_add_u32 s38, s38, s37
    s_add_u32 s34, s34, 4096
    s_mov_b32 m0, s34
    s_nop 0
    buffer_load_dwordx4 v12, s[8:11], s38 offen sc1 lds
    s_add_u32 s38, s36, 896
    s_add_u32 s34, s39, 57344
    s_mov_b32 m0, s34
    s_nop 0
    buffer_load_dwordx4 v12, s[8:11], s38 offen sc1 lds
    s_add_u32 s38, s38, s37
    s_add_u32 s34, s34, 4096
    s_mov_b32 m0, s34
    s_nop 0
    buffer_load_dwordx4 v12, s[8:11], s38 offen sc1 lds
    v_mov_b64 v[128:129], 0
    v_mov_b64 v[130:131], 0
    v_mov_b64 v[132:133], 0
    v_mov_b64 v[134:135], 0
    v_mov_b64 v[136:137], 0
    v_mov_b64 v[138:139], 0
    v_mov_b64 v[140:141], 0
    v_mov_b64 v[142:143], 0
    v_mov_b64 v[144:145], 0
    v_mov_b64 v[146:147], 0
    v_mov_b64 v[148:149], 0
    v_mov_b64 v[150:151], 0
    v_mov_b64 v[152:153], 0
    v_mov_b64 v[154:155], 0
    v_mov_b64 v[156:157], 0
    v_mov_b64 v[158:159], 0
    v_mov_b64 v[160:161], 0
    v_mov_b64 v[162:163], 0
    v_mov_b64 v[164:165], 0
    v_mov_b64 v[166:167], 0
    v_mov_b64 v[168:169], 0
    v_mov_b64 v[170:171], 0
    v_mov_b64 v[172:173], 0
    v_mov_b64 v[174:175], 0
    v_add_u32 v10, 65536, v8
    v_add_u32 v11, 65536, v9
    s_waitcnt vmcnt(14)
    s_barrier
    ds_read_b128 v[32:35], v8 offset:0
    ds_read_b128 v[36:39], v8 offset:2048
    ds_read_b128 v[40:43], v8 offset:4096
    ds_read_b128 v[44:47], v8 offset:6144
    s_waitcnt lgkmcnt(0)
    v_mfma_f32_16x16x32_bf16 v[128:131], a[0:3], v[32:35], v[128:131]
    v_mfma_f32_16x16x32_bf16 v[132:135], a[72:75], v[32:35], v[132:135]
    ds_read_b128 v[64:67], v9 offset:0
    v_mfma_f32_16x16x32_bf16 v[136:139], a[144:147], v[32:35], v[136:139]
    v_mfma_f32_16x16x32_bf16 v[140:143], a[0:3], v[36:39], v[140:143]
    ds_read_b128 v[68:71], v9 offset:2048
    v_mfma_f32_16x16x32_bf16 v[144:147], a[72:75], v[36:39], v[144:147]
    v_mfma_f32_16x16x32_bf16 v[148:151], a[144:147], v[36:39], v[148:151]
    ds_read_b128 v[72:75], v9 offset:4096
    v_mfma_f32_16x16x32_bf16 v[152:155], a[0:3], v[40:43], v[152:155]
    v_mfma_f32_16x16x32_bf16 v[156:159], a[72:75], v[40:43], v[156:159]
    ds_read_b128 v[76:79], v9 offset:6144
    v_mfma_f32_16x16x32_bf16 v[160:163], a[144:147], v[40:43], v[160:163]
    v_mfma_f32_16x16x32_bf16 v[164:167], a[0:3], v[44:47], v[164:167]
    v_mfma_f32_16x16x32_bf16 v[168:171], a[72:75], v[44:47], v[168:171]
    v_mfma_f32_16x16x32_bf16 v[172:175], a[144:147], v[44:47], v[172:175]
    s_waitcnt lgkmcnt(0)
    v_mfma_f32_16x16x32_bf16 v[128:131], a[4:7], v[64:67], v[128:131]
    v_mfma_f32_16x16x32_bf16 v[132:135], a[76:79], v[64:67], v[132:135]
    s_waitcnt vmcnt(12)
    v_mfma_f32_16x16x32_bf16 v[136:139], a[148:151], v[64:67], v[136:139]
    v_mfma_f32_16x16x32_bf16 v[140:143], a[4:7], v[68:71], v[140:143]
    s_barrier
    v_mfma_f32_16x16x32_bf16 v[144:147], a[76:79], v[68:71], v[144:147]
    v_mfma_f32_16x16x32_bf16 v[148:151], a[148:151], v[68:71], v[148:151]
    ds_read_b128 v[32:35], v8 offset:8192
    v_mfma_f32_16x16x32_bf16 v[152:155], a[4:7], v[72:75], v[152:155]
    v_mfma_f32_16x16x32_bf16 v[156:159], a[76:79], v[72:75], v[156:159]
    ds_read_b128 v[36:39], v8 offset:10240
    v_mfma_f32_16x16x32_bf16 v[160:163], a[148:151], v[72:75], v[160:163]
    v_mfma_f32_16x16x32_bf16 v[164:167], a[4:7], v[76:79], v[164:167]
    ds_read_b128 v[40:43], v8 offset:12288
    v_mfma_f32_16x16x32_bf16 v[168:171], a[76:79], v[76:79], v[168:171]
    v_mfma_f32_16x16x32_bf16 v[172:175], a[148:151], v[76:79], v[172:175]
    ds_read_b128 v[44:47], v8 offset:14336
    s_waitcnt lgkmcnt(0)
    v_mfma_f32_16x16x32_bf16 v[128:131], a[8:11], v[32:35], v[128:131]
    v_mfma_f32_16x16x32_bf16 v[132:135], a[80:83], v[32:35], v[132:135]
    ds_read_b128 v[64:67], v9 offset:8192
    v_mfma_f32_16x16x32_bf16 v[136:139], a[152:155], v[32:35], v[136:139]
    v_mfma_f32_16x16x32_bf16 v[140:143], a[8:11], v[36:39], v[140:143]
    ds_read_b128 v[68:71], v9 offset:10240
    v_mfma_f32_16x16x32_bf16 v[144:147], a[80:83], v[36:39], v[144:147]
    v_mfma_f32_16x16x32_bf16 v[148:151], a[152:155], v[36:39], v[148:151]
    ds_read_b128 v[72:75], v9 offset:12288
    v_mfma_f32_16x16x32_bf16 v[152:155], a[8:11], v[40:43], v[152:155]
    v_mfma_f32_16x16x32_bf16 v[156:159], a[80:83], v[40:43], v[156:159]
    ds_read_b128 v[76:79], v9 offset:14336
    v_mfma_f32_16x16x32_bf16 v[160:163], a[152:155], v[40:43], v[160:163]
    v_mfma_f32_16x16x32_bf16 v[164:167], a[8:11], v[44:47], v[164:167]
    v_mfma_f32_16x16x32_bf16 v[168:171], a[80:83], v[44:47], v[168:171]
    v_mfma_f32_16x16x32_bf16 v[172:175], a[152:155], v[44:47], v[172:175]
    s_waitcnt lgkmcnt(0)
    v_mfma_f32_16x16x32_bf16 v[128:131], a[12:15], v[64:67], v[128:131]
    v_mfma_f32_16x16x32_bf16 v[132:135], a[84:87], v[64:67], v[132:135]
    s_waitcnt vmcnt(10)
    v_mfma_f32_16x16x32_bf16 v[136:139], a[156:159], v[64:67], v[136:139]
    v_mfma_f32_16x16x32_bf16 v[140:143], a[12:15], v[68:71], v[140:143]
    s_barrier
    v_mfma_f32_16x16x32_bf16 v[144:147], a[84:87], v[68:71], v[144:147]
    v_mfma_f32_16x16x32_bf16 v[148:151], a[156:159], v[68:71], v[148:151]
    ds_read_b128 v[32:35], v8 offset:16384
    v_mfma_f32_16x16x32_bf16 v[152:155], a[12:15], v[72:75], v[152:155]
    v_mfma_f32_16x16x32_bf16 v[156:159], a[84:87], v[72:75], v[156:159]
    ds_read_b128 v[36:39], v8 offset:18432
    v_mfma_f32_16x16x32_bf16 v[160:163], a[156:159], v[72:75], v[160:163]
    v_mfma_f32_16x16x32_bf16 v[164:167], a[12:15], v[76:79], v[164:167]
    ds_read_b128 v[40:43], v8 offset:20480
    v_mfma_f32_16x16x32_bf16 v[168:171], a[84:87], v[76:79], v[168:171]
    v_mfma_f32_16x16x32_bf16 v[172:175], a[156:159], v[76:79], v[172:175]
    ds_read_b128 v[44:47], v8 offset:22528
    s_waitcnt lgkmcnt(0)
    v_mfma_f32_16x16x32_bf16 v[128:131], a[16:19], v[32:35], v[128:131]
    v_mfma_f32_16x16x32_bf16 v[132:135], a[88:91], v[32:35], v[132:135]
    ds_read_b128 v[64:67], v9 offset:16384
    v_mfma_f32_16x16x32_bf16 v[136:139], a[160:163], v[32:35], v[136:139]
    v_mfma_f32_16x16x32_bf16 v[140:143], a[16:19], v[36:39], v[140:143]
    ds_read_b128 v[68:71], v9 offset:18432
    v_mfma_f32_16x16x32_bf16 v[144:147], a[88:91], v[36:39], v[144:147]
    v_mfma_f32_16x16x32_bf16 v[148:151], a[160:163], v[36:39], v[148:151]
    ds_read_b128 v[72:75], v9 offset:20480
    v_mfma_f32_16x16x32_bf16 v[152:155], a[16:19], v[40:43], v[152:155]
    v_mfma_f32_16x16x32_bf16 v[156:159], a[88:91], v[40:43], v[156:159]
    ds_read_b128 v[76:79], v9 offset:22528
    v_mfma_f32_16x16x32_bf16 v[160:163], a[160:163], v[40:43], v[160:163]
    v_mfma_f32_16x16x32_bf16 v[164:167], a[16:19], v[44:47], v[164:167]
    v_mfma_f32_16x16x32_bf16 v[168:171], a[88:91], v[44:47], v[168:171]
    v_mfma_f32_16x16x32_bf16 v[172:175], a[160:163], v[44:47], v[172:175]
    s_waitcnt lgkmcnt(0)
    v_mfma_f32_16x16x32_bf16 v[128:131], a[20:23], v[64:67], v[128:131]
    v_mfma_f32_16x16x32_bf16 v[132:135], a[92:95], v[64:67], v[132:135]
    s_waitcnt vmcnt(8)
    v_mfma_f32_16x16x32_bf16 v[136:139], a[164:167], v[64:67], v[136:139]
    v_mfma_f32_16x16x32_bf16 v[140:143], a[20:23], v[68:71], v[140:143]
    s_barrier
    v_mfma_f32_16x16x32_bf16 v[144:147], a[92:95], v[68:71], v[144:147]
    v_mfma_f32_16x16x32_bf16 v[148:151], a[164:167], v[68:71], v[148:151]
    ds_read_b128 v[32:35], v8 offset:24576
    v_mfma_f32_16x16x32_bf16 v[152:155], a[20:23], v[72:75], v[152:155]
    v_mfma_f32_16x16x32_bf16 v[156:159], a[92:95], v[72:75], v[156:159]
    ds_read_b128 v[36:39], v8 offset:26624
    v_mfma_f32_16x16x32_bf16 v[160:163], a[164:167], v[72:75], v[160:163]
    v_mfma_f32_16x16x32_bf16 v[164:167], a[20:23], v[76:79], v[164:167]
    ds_read_b128 v[40:43], v8 offset:28672
    v_mfma_f32_16x16x32_bf16 v[168:171], a[92:95], v[76:79], v[168:171]
    v_mfma_f32_16x16x32_bf16 v[172:175], a[164:167], v[76:79], v[172:175]
    ds_read_b128 v[44:47], v8 offset:30720
    s_waitcnt lgkmcnt(0)
    v_mfma_f32_16x16x32_bf16 v[128:131], a[24:27], v[32:35], v[128:131]
    v_mfma_f32_16x16x32_bf16 v[132:135], a[96:99], v[32:35], v[132:135]
    ds_read_b128 v[64:67], v9 offset:24576
    v_mfma_f32_16x16x32_bf16 v[136:139], a[168:171], v[32:35], v[136:139]
    v_mfma_f32_16x16x32_bf16 v[140:143], a[24:27], v[36:39], v[140:143]
    ds_read_b128 v[68:71], v9 offset:26624
    v_mfma_f32_16x16x32_bf16 v[144:147], a[96:99], v[36:39], v[144:147]
    v_mfma_f32_16x16x32_bf16 v[148:151], a[168:171], v[36:39], v[148:151]
    ds_read_b128 v[72:75], v9 offset:28672
    v_mfma_f32_16x16x32_bf16 v[152:155], a[24:27], v[40:43], v[152:155]
    v_mfma_f32_16x16x32_bf16 v[156:159], a[96:99], v[40:43], v[156:159]
    ds_read_b128 v[76:79], v9 offset:30720
    v_mfma_f32_16x16x32_bf16 v[160:163], a[168:171], v[40:43], v[160:163]
    v_mfma_f32_16x16x32_bf16 v[164:167], a[24:27], v[44:47], v[164:167]
    v_mfma_f32_16x16x32_bf16 v[168:171], a[96:99], v[44:47], v[168:171]
    v_mfma_f32_16x16x32_bf16 v[172:175], a[168:171], v[44:47], v[172:175]
    s_waitcnt lgkmcnt(0)
    v_mfma_f32_16x16x32_bf16 v[128:131], a[28:31], v[64:67], v[128:131]
    v_mfma_f32_16x16x32_bf16 v[132:135], a[100:103], v[64:67], v[132:135]
    s_waitcnt vmcnt(6)
    v_mfma_f32_16x16x32_bf16 v[136:139], a[172:175], v[64:67], v[136:139]
    v_mfma_f32_16x16x32_bf16 v[140:143], a[28:31], v[68:71], v[140:143]
    s_barrier
    v_mfma_f32_16x16x32_bf16 v[144:147], a[100:103], v[68:71], v[144:147]
    v_mfma_f32_16x16x32_bf16 v[148:151], a[172:175], v[68:71], v[148:151]
    ds_read_b128 v[32:35], v8 offset:32768
    v_mfma_f32_16x16x32_bf16 v[152:155], a[28:31], v[72:75], v[152:155]
    v_mfma_f32_16x16x32_bf16 v[156:159], a[100:103], v[72:75], v[156:159]
    ds_read_b128 v[36:39], v8 offset:34816
    v_mfma_f32_16x16x32_bf16 v[160:163], a[172:175], v[72:75], v[160:163]
    v_mfma_f32_16x16x32_bf16 v[164:167], a[28:31], v[76:79], v[164:167]
    ds_read_b128 v[40:43], v8 offset:36864
    v_mfma_f32_16x16x32_bf16 v[168:171], a[100:103], v[76:79], v[168:171]
    v_mfma_f32_16x16x32_bf16 v[172:175], a[172:175], v[76:79], v[172:175]
    ds_read_b128 v[44:47], v8 offset:38912
    s_waitcnt lgkmcnt(0)
    v_mfma_f32_16x16x32_bf16 v[128:131], a[32:35], v[32:35], v[128:131]
    v_mfma_f32_16x16x32_bf16 v[132:135], a[104:107], v[32:35], v[132:135]
    ds_read_b128 v[64:67], v9 offset:32768
    v_mfma_f32_16x16x32_bf16 v[136:139], a[176:179], v[32:35], v[136:139]
    v_mfma_f32_16x16x32_bf16 v[140:143], a[32:35], v[36:39], v[140:143]
    ds_read_b128 v[68:71], v9 offset:34816
    v_mfma_f32_16x16x32_bf16 v[144:147], a[104:107], v[36:39], v[144:147]
    v_mfma_f32_16x16x32_bf16 v[148:151], a[176:179], v[36:39], v[148:151]
    ds_read_b128 v[72:75], v9 offset:36864
    v_mfma_f32_16x16x32_bf16 v[152:155], a[32:35], v[40:43], v[152:155]
    v_mfma_f32_16x16x32_bf16 v[156:159], a[104:107], v[40:43], v[156:159]
    ds_read_b128 v[76:79], v9 offset:38912
    v_mfma_f32_16x16x32_bf16 v[160:163], a[176:179], v[40:43], v[160:163]
    v_mfma_f32_16x16x32_bf16 v[164:167], a[32:35], v[44:47], v[164:167]
    v_mfma_f32_16x16x32_bf16 v[168:171], a[104:107], v[44:47], v[168:171]
    v_mfma_f32_16x16x32_bf16 v[172:175], a[176:179], v[44:47], v[172:175]
    s_waitcnt lgkmcnt(0)
    v_mfma_f32_16x16x32_bf16 v[128:131], a[36:39], v[64:67], v[128:131]
    v_mfma_f32_16x16x32_bf16 v[132:135], a[108:111], v[64:67], v[132:135]
    s_waitcnt vmcnt(4)
    v_mfma_f32_16x16x32_bf16 v[136:139], a[180:183], v[64:67], v[136:139]
    v_mfma_f32_16x16x32_bf16 v[140:143], a[36:39], v[68:71], v[140:143]
    s_barrier
    v_mfma_f32_16x16x32_bf16 v[144:147], a[108:111], v[68:71], v[144:147]
    v_mfma_f32_16x16x32_bf16 v[148:151], a[180:183], v[68:71], v[148:151]
    ds_read_b128 v[32:35], v8 offset:40960
    v_mfma_f32_16x16x32_bf16 v[152:155], a[36:39], v[72:75], v[152:155]
    v_mfma_f32_16x16x32_bf16 v[156:159], a[108:111], v[72:75], v[156:159]
    ds_read_b128 v[36:39], v8 offset:43008
    v_mfma_f32_16x16x32_bf16 v[160:163], a[180:183], v[72:75], v[160:163]
    v_mfma_f32_16x16x32_bf16 v[164:167], a[36:39], v[76:79], v[164:167]
    ds_read_b128 v[40:43], v8 offset:45056
    v_mfma_f32_16x16x32_bf16 v[168:171], a[108:111], v[76:79], v[168:171]
    v_mfma_f32_16x16x32_bf16 v[172:175], a[180:183], v[76:79], v[172:175]
    ds_read_b128 v[44:47], v8 offset:47104
    s_waitcnt lgkmcnt(0)
    v_mfma_f32_16x16x32_bf16 v[128:131], a[40:43], v[32:35], v[128:131]
    v_mfma_f32_16x16x32_bf16 v[132:135], a[112:115], v[32:35], v[132:135]
    ds_read_b128 v[64:67], v9 offset:40960
    v_mfma_f32_16x16x32_bf16 v[136:139], a[184:187], v[32:35], v[136:139]
    v_mfma_f32_16x16x32_bf16 v[140:143], a[40:43], v[36:39], v[140:143]
    ds_read_b128 v[68:71], v9 offset:43008
    v_mfma_f32_16x16x32_bf16 v[144:147], a[112:115], v[36:39], v[144:147]
    v_mfma_f32_16x16x32_bf16 v[148:151], a[184:187], v[36:39], v[148:151]
    ds_read_b128 v[72:75], v9 offset:45056
    v_mfma_f32_16x16x32_bf16 v[152:155], a[40:43], v[40:43], v[152:155]
    v_mfma_f32_16x16x32_bf16 v[156:159], a[112:115], v[40:43], v[156:159]
    ds_read_b128 v[76:79], v9 offset:47104
    v_mfma_f32_16x16x32_bf16 v[160:163], a[184:187], v[40:43], v[160:163]
    v_mfma_f32_16x16x32_bf16 v[164:167], a[40:43], v[44:47], v[164:167]
    v_mfma_f32_16x16x32_bf16 v[168:171], a[112:115], v[44:47], v[168:171]
    v_mfma_f32_16x16x32_bf16 v[172:175], a[184:187], v[44:47], v[172:175]
    s_waitcnt lgkmcnt(0)
    v_mfma_f32_16x16x32_bf16 v[128:131], a[44:47], v[64:67], v[128:131]
    v_mfma_f32_16x16x32_bf16 v[132:135], a[116:119], v[64:67], v[132:135]
    s_waitcnt vmcnt(2)
    v_mfma_f32_16x16x32_bf16 v[136:139], a[188:191], v[64:67], v[136:139]
    v_mfma_f32_16x16x32_bf16 v[140:143], a[44:47], v[68:71], v[140:143]
    s_barrier
    v_mfma_f32_16x16x32_bf16 v[144:147], a[116:119], v[68:71], v[144:147]
    v_mfma_f32_16x16x32_bf16 v[148:151], a[188:191], v[68:71], v[148:151]
    ds_read_b128 v[32:35], v8 offset:49152
    v_mfma_f32_16x16x32_bf16 v[152:155], a[44:47], v[72:75], v[152:155]
    v_mfma_f32_16x16x32_bf16 v[156:159], a[116:119], v[72:75], v[156:159]
    ds_read_b128 v[36:39], v8 offset:51200
    v_mfma_f32_16x16x32_bf16 v[160:163], a[188:191], v[72:75], v[160:163]
    v_mfma_f32_16x16x32_bf16 v[164:167], a[44:47], v[76:79], v[164:167]
    ds_read_b128 v[40:43], v8 offset:53248
    v_mfma_f32_16x16x32_bf16 v[168:171], a[116:119], v[76:79], v[168:171]
    v_mfma_f32_16x16x32_bf16 v[172:175], a[188:191], v[76:79], v[172:175]
    ds_read_b128 v[44:47], v8 offset:55296
    s_waitcnt lgkmcnt(0)
    v_mfma_f32_16x16x32_bf16 v[128:131], a[48:51], v[32:35], v[128:131]
    v_mfma_f32_16x16x32_bf16 v[132:135], a[120:123], v[32:35], v[132:135]
    ds_read_b128 v[64:67], v9 offset:49152
    v_mfma_f32_16x16x32_bf16 v[136:139], a[192:195], v[32:35], v[136:139]
    v_mfma_f32_16x16x32_bf16 v[140:143], a[48:51], v[36:39], v[140:143]
    ds_read_b128 v[68:71], v9 offset:51200
    v_mfma_f32_16x16x32_bf16 v[144:147], a[120:123], v[36:39], v[144:147]
    v_mfma_f32_16x16x32_bf16 v[148:151], a[192:195], v[36:39], v[148:151]
    ds_read_b128 v[72:75], v9 offset:53248
    v_mfma_f32_16x16x32_bf16 v[152:155], a[48:51], v[40:43], v[152:155]
    v_mfma_f32_16x16x32_bf16 v[156:159], a[120:123], v[40:43], v[156:159]
    ds_read_b128 v[76:79], v9 offset:55296
    v_mfma_f32_16x16x32_bf16 v[160:163], a[192:195], v[40:43], v[160:163]
    v_mfma_f32_16x16x32_bf16 v[164:167], a[48:51], v[44:47], v[164:167]
    v_mfma_f32_16x16x32_bf16 v[168:171], a[120:123], v[44:47], v[168:171]
    v_mfma_f32_16x16x32_bf16 v[172:175], a[192:195], v[44:47], v[172:175]
    s_waitcnt lgkmcnt(0)
    v_mfma_f32_16x16x32_bf16 v[128:131], a[52:55], v[64:67], v[128:131]
    v_mfma_f32_16x16x32_bf16 v[132:135], a[124:127], v[64:67], v[132:135]
    s_waitcnt vmcnt(0)
    v_mfma_f32_16x16x32_bf16 v[136:139], a[196:199], v[64:67], v[136:139]
    v_mfma_f32_16x16x32_bf16 v[140:143], a[52:55], v[68:71], v[140:143]
    s_barrier
    v_mfma_f32_16x16x32_bf16 v[144:147], a[124:127], v[68:71], v[144:147]
    v_mfma_f32_16x16x32_bf16 v[148:151], a[196:199], v[68:71], v[148:151]
    ds_read_b128 v[32:35], v8 offset:57344
    v_mfma_f32_16x16x32_bf16 v[152:155], a[52:55], v[72:75], v[152:155]
    v_mfma_f32_16x16x32_bf16 v[156:159], a[124:127], v[72:75], v[156:159]
    ds_read_b128 v[36:39], v8 offset:59392
    v_mfma_f32_16x16x32_bf16 v[160:163], a[196:199], v[72:75], v[160:163]
    v_mfma_f32_16x16x32_bf16 v[164:167], a[52:55], v[76:79], v[164:167]
    ds_read_b128 v[40:43], v8 offset:61440
    v_mfma_f32_16x16x32_bf16 v[168:171], a[124:127], v[76:79], v[168:171]
    v_mfma_f32_16x16x32_bf16 v[172:175], a[196:199], v[76:79], v[172:175]
    ds_read_b128 v[44:47], v8 offset:63488
    s_waitcnt lgkmcnt(0)
    v_mfma_f32_16x16x32_bf16 v[128:131], a[56:59], v[32:35], v[128:131]
    v_mfma_f32_16x16x32_bf16 v[132:135], a[128:131], v[32:35], v[132:135]
    ds_read_b128 v[64:67], v9 offset:57344
    v_mfma_f32_16x16x32_bf16 v[136:139], a[200:203], v[32:35], v[136:139]
    v_mfma_f32_16x16x32_bf16 v[140:143], a[56:59], v[36:39], v[140:143]
    ds_read_b128 v[68:71], v9 offset:59392
    v_mfma_f32_16x16x32_bf16 v[144:147], a[128:131], v[36:39], v[144:147]
    v_mfma_f32_16x16x32_bf16 v[148:151], a[200:203], v[36:39], v[148:151]
    ds_read_b128 v[72:75], v9 offset:61440
    v_mfma_f32_16x16x32_bf16 v[152:155], a[56:59], v[40:43], v[152:155]
    v_mfma_f32_16x16x32_bf16 v[156:159], a[128:131], v[40:43], v[156:159]
    ds_read_b128 v[76:79], v9 offset:63488
    v_mfma_f32_16x16x32_bf16 v[160:163], a[200:203], v[40:43], v[160:163]
    v_mfma_f32_16x16x32_bf16 v[164:167], a[56:59], v[44:47], v[164:167]
    v_mfma_f32_16x16x32_bf16 v[168:171], a[128:131], v[44:47], v[168:171]
    v_mfma_f32_16x16x32_bf16 v[172:175], a[200:203], v[44:47], v[172:175]
    s_waitcnt lgkmcnt(0)
    v_mfma_f32_16x16x32_bf16 v[128:131], a[60:63], v[64:67], v[128:131]
    v_mfma_f32_16x16x32_bf16 v[132:135], a[132:135], v[64:67], v[132:135]
    v_mfma_f32_16x16x32_bf16 v[136:139], a[204:207], v[64:67], v[136:139]
    v_mfma_f32_16x16x32_bf16 v[140:143], a[60:63], v[68:71], v[140:143]
    v_mfma_f32_16x16x32_bf16 v[144:147], a[132:135], v[68:71], v[144:147]
    v_mfma_f32_16x16x32_bf16 v[148:151], a[204:207], v[68:71], v[148:151]
    v_mfma_f32_16x16x32_bf16 v[152:155], a[60:63], v[72:75], v[152:155]
    v_mfma_f32_16x16x32_bf16 v[156:159], a[132:135], v[72:75], v[156:159]
    v_mfma_f32_16x16x32_bf16 v[160:163], a[204:207], v[72:75], v[160:163]
    v_mfma_f32_16x16x32_bf16 v[164:167], a[60:63], v[76:79], v[164:167]
    v_mfma_f32_16x16x32_bf16 v[168:171], a[132:135], v[76:79], v[168:171]
    v_mfma_f32_16x16x32_bf16 v[172:175], a[204:207], v[76:79], v[172:175]
    s_nop 7
    s_mov_b32 s53, 98304
    s_mov_b32 s56, 1152
    s_mul_i32 s57, s78, 2359296
    s_mul_i32 s54, s52, 1152
    s_add_u32 s57, s57, s54
    s_mul_i32 s54, s79, 384
    s_add_u32 s57, s57, s54
    s_add_u32 s57, s57, 121634816
    v_and_b32 v1, 63, v0
    v_and_b32 v2, 31, v1
    v_mul_u32_u24 v2, 384, v2
    v_add_u32 v2, s53, v2
    v_lshrrev_b32 v3, 5, v1
    s_mul_i32 s36, s17, 6
    v_add_u32 v3, s36, v3
    v_and_b32 v4, 7, v1
    v_add_u32 v5, 0, v3
    v_xor_b32 v5, v5, v4
    v_lshlrev_b32 v5, 4, v5
    v_add_u32 v16, v2, v5
    v_add_u32 v5, 2, v3
    v_xor_b32 v5, v5, v4
    v_lshlrev_b32 v5, 4, v5
    v_add_u32 v17, v2, v5
    v_add_u32 v5, 4, v3
    v_xor_b32 v5, v5, v4
    v_lshlrev_b32 v5, 4, v5
    v_add_u32 v18, v2, v5
    v_cvt_pk_bf16_f32 v32, v128, v129
    v_cvt_pk_bf16_f32 v33, v130, v131
    v_cvt_pk_bf16_f32 v34, v140, v141
    v_cvt_pk_bf16_f32 v35, v142, v143
    s_nop 0
    v_permlane16_swap_b32 v32, v34
    v_permlane16_swap_b32 v33, v35
    ds_write_b128 v16, v[32:35] offset:0
    v_cvt_pk_bf16_f32 v36, v132, v133
    v_cvt_pk_bf16_f32 v37, v134, v135
    v_cvt_pk_bf16_f32 v38, v144, v145
    v_cvt_pk_bf16_f32 v39, v146, v147
    s_nop 0
    v_permlane16_swap_b32 v36, v38
    v_permlane16_swap_b32 v37, v39
    ds_write_b128 v17, v[36:39] offset:0
    v_cvt_pk_bf16_f32 v40, v136, v137
    v_cvt_pk_bf16_f32 v41, v138, v139
    v_cvt_pk_bf16_f32 v42, v148, v149
    v_cvt_pk_bf16_f32 v43, v150, v151
    s_nop 0
    v_permlane16_swap_b32 v40, v42
    v_permlane16_swap_b32 v41, v43
    ds_write_b128 v18, v[40:43] offset:0
    v_cvt_pk_bf16_f32 v44, v152, v153
    v_cvt_pk_bf16_f32 v45, v154, v155
    v_cvt_pk_bf16_f32 v46, v164, v165
    v_cvt_pk_bf16_f32 v47, v166, v167
    s_nop 0
    v_permlane16_swap_b32 v44, v46
    v_permlane16_swap_b32 v45, v47
    ds_write_b128 v16, v[44:47] offset:12288
    v_cvt_pk_bf16_f32 v48, v156, v157
    v_cvt_pk_bf16_f32 v49, v158, v159
    v_cvt_pk_bf16_f32 v50, v168, v169
    v_cvt_pk_bf16_f32 v51, v170, v171
    s_nop 0
    v_permlane16_swap_b32 v48, v50
    v_permlane16_swap_b32 v49, v51
    ds_write_b128 v17, v[48:51] offset:12288
    v_cvt_pk_bf16_f32 v52, v160, v161
    v_cvt_pk_bf16_f32 v53, v162, v163
    v_cvt_pk_bf16_f32 v54, v172, v173
    v_cvt_pk_bf16_f32 v55, v174, v175
    s_nop 0
    v_permlane16_swap_b32 v52, v54
    v_permlane16_swap_b32 v53, v55
    ds_write_b128 v18, v[52:55] offset:12288
    v_cmp_le_u32 vcc, 24, v1
    s_nop 1
    v_cndmask_b32 v2, 0, 1, vcc
    v_mul_u32_u24 v3, 24, v2
    v_sub_u32 v3, v1, v3
    s_mul_i32 s36, s17, 16
    v_xor_b32 v4, v3, v2
    v_lshlrev_b32 v4, 4, v4
    v_add_u32 v2, s36, v2
    v_mul_u32_u24 v5, 384, v2
    v_add_u32 v5, s53, v5
    v_mul_lo_u32 v2, v2, s56
    v_lshlrev_b32 v3, 4, v3
    v_add_u32 v18, v2, v3
    v_mov_b32 v2, 0x40000000
    v_cmp_gt_u32 vcc, 48, v1
    s_nop 1
    v_cndmask_b32 v18, v2, v18, vcc
    s_lshl_b32 s37, s56, 1
    s_mov_b32 s39, s57
    v_xor_b32 v3, 0, v4
    v_add_u32 v20, v5, v3
    v_xor_b32 v3, 32, v4
    v_add_u32 v21, v5, v3
    v_xor_b32 v3, 64, v4
    v_add_u32 v22, v5, v3
    v_xor_b32 v3, 96, v4
    v_add_u32 v23, v5, v3
    s_waitcnt lgkmcnt(0)
    s_barrier
    ds_read_b128 v[32:35], v20 offset:0
    ds_read_b128 v[36:39], v21 offset:768
    ds_read_b128 v[40:43], v22 offset:1536
    ds_read_b128 v[44:47], v23 offset:2304
    ds_read_b128 v[48:51], v20 offset:3072
    ds_read_b128 v[52:55], v21 offset:3840
    ds_read_b128 v[56:59], v22 offset:4608
    ds_read_b128 v[60:63], v23 offset:5376
    s_waitcnt lgkmcnt(7)
    buffer_store_dwordx4 v[32:35], v18, s[4:7], s39 offen sc1
    s_add_u32 s39, s39, s37
    s_waitcnt lgkmcnt(6)
    buffer_store_dwordx4 v[36:39], v18, s[4:7], s39 offen sc1
    s_add_u32 s39, s39, s37
    s_waitcnt lgkmcnt(5)
    buffer_store_dwordx4 v[40:43], v18, s[4:7], s39 offen sc1
    s_add_u32 s39, s39, s37
    s_waitcnt lgkmcnt(4)
    buffer_store_dwordx4 v[44:47], v18, s[4:7], s39 offen sc1
    s_add_u32 s39, s39, s37
    s_waitcnt lgkmcnt(3)
    buffer_store_dwordx4 v[48:51], v18, s[4:7], s39 offen sc1
    s_add_u32 s39, s39, s37
    s_waitcnt lgkmcnt(2)
    buffer_store_dwordx4 v[52:55], v18, s[4:7], s39 offen sc1
    s_add_u32 s39, s39, s37
    s_waitcnt lgkmcnt(1)
    buffer_store_dwordx4 v[56:59], v18, s[4:7], s39 offen sc1
    s_add_u32 s39, s39, s37
    s_waitcnt lgkmcnt(0)
    buffer_store_dwordx4 v[60:63], v18, s[4:7], s39 offen sc1
    s_lshl_b32 s67, s65, 2
    s_and_b32 s20, s66, 3
    s_add_u32 s67, s67, s20
    s_lshl_b32 s67, s67, 8
    s_add_u32 s67, s67, 1654784
    s_waitcnt vmcnt(0)
    s_barrier
    s_cmp_lg_u32 s17, 0
    s_cbranch_scc1 Ls_58
    s_mov_b64 exec, 1
    v_mov_b32 v2, 0
    v_mov_b32 v3, 1
    buffer_atomic_add v3, v2, s[4:7], s67 offen
    s_mov_b64 exec, -1
Ls_58:
    s_add_u32 s65, s65, 2
    s_cmp_lt_u32 s65, 31
    s_cbranch_scc1 Lp_wo_l
    s_mov_b32 s65, 31
    s_mov_b32 s68, s78
    s_mul_i32 s67, s65, 8
    s_add_u32 s67, s67, s68
    s_lshl_b32 s67, s67, 8
    s_add_u32 s67, s67, 1589248
    s_cmp_lg_u32 s17, 0
    s_cbranch_scc1 Lw_61
    s_mov_b64 exec, 1
    v_mov_b32 v2, 0
    s_mov_b32 s70, 0
Lw_59:
    buffer_load_dword v3, v2, s[4:7], s67 offen sc1
    s_waitcnt vmcnt(0)
    v_readfirstlane_b32 s69, v3
    s_nop 2
    s_cmp_ge_u32 s69, 2
    s_cbranch_scc1 Lw_60
    s_sleep 2
    s_add_u32 s70, s70, 1
    s_cmp_lt_u32 s70, 524288
    s_cbranch_scc1 Lw_59
    s_branch Lfail
Lw_60:
    s_mov_b64 exec, -1
Lw_61:
    s_barrier
    s_mov_b32 s8, s4
    s_mov_b32 s9, s5
    s_mov_b32 s10, s6
    s_mov_b32 s11, s7
    s_lshl_b32 s52, s65, 6
    s_lshl_b32 s54, s77, 5
    s_add_u32 s52, s52, s54
    s_mul_i32 s24, s52, 8192
    s_mul_i32 s54, s78, 1024
    s_add_u32 s24, s24, s54
    s_add_u32 s24, s24, 67108864
    s_lshl_b32 s36, s17, 3
    s_mul_i32 s36, s36, s25
    s_add_u32 s36, s36, s24
    s_lshl_b32 s37, s25, 5
    s_lshl_b32 s39, s17, 10
    s_add_u32 s38, s36, 0
    s_add_u32 s34, s39, 0
    s_mov_b32 m0, s34
    s_nop 0
    buffer_load_dwordx4 v12, s[8:11], s38 offen sc1 lds
    s_add_u32 s38, s36, 128
    s_add_u32 s34, s39, 4096
    s_mov_b32 m0, s34
    s_nop 0
    buffer_load_dwordx4 v12, s[8:11], s38 offen sc1 lds
    s_add_u32 s38, s36, 256
    s_add_u32 s34, s39, 8192
    s_mov_b32 m0, s34
    s_nop 0
    buffer_load_dwordx4 v12, s[8:11], s38 offen sc1 lds
    s_add_u32 s38, s36, 384
    s_add_u32 s34, s39, 12288
    s_mov_b32 m0, s34
    s_nop 0
    buffer_load_dwordx4 v12, s[8:11], s38 offen sc1 lds
    s_add_u32 s38, s36, 512
    s_add_u32 s34, s39, 16384
    s_mov_b32 m0, s34
    s_nop 0
    buffer_load_dwordx4 v12, s[8:11], s38 offen sc1 lds
    s_add_u32 s38, s36, 640
    s_add_u32 s34, s39, 20480
    s_mov_b32 m0, s34
    s_nop 0
    buffer_load_dwordx4 v12, s[8:11], s38 offen sc1 lds
    s_add_u32 s38, s36, 768
    s_add_u32 s34, s39, 24576
    s_mov_b32 m0, s34
    s_nop 0
    buffer_load_dwordx4 v12, s[8:11], s38 offen sc1 lds
    s_add_u32 s38, s36, 896
    s_add_u32 s34, s39, 28672
    s_mov_b32 m0, s34
    s_nop 0
    buffer_load_dwordx4 v12, s[8:11], s38 offen sc1 lds
    v_mov_b64 v[128:129], 0
    v_mov_b64 v[130:131], 0
    v_mov_b64 v[132:133], 0
    v_mov_b64 v[134:135], 0
    v_mov_b64 v[136:137], 0
    v_mov_b64 v[138:139], 0
    v_mov_b64 v[140:141], 0
    v_mov_b64 v[142:143], 0
    v_mov_b64 v[144:145], 0
    v_mov_b64 v[146:147], 0
    v_mov_b64 v[148:149], 0
    v_mov_b64 v[150:151], 0
    v_add_u32 v10, 65536, v8
    v_add_u32 v11, 65536, v9
    s_waitcnt vmcnt(7)
    s_barrier
    ds_read_b128 v[32:35], v8 offset:0
    ds_read_b128 v[36:39], v8 offset:2048
    s_waitcnt lgkmcnt(0)
    v_mfma_f32_16x16x32_bf16 v[128:131], a[0:3], v[32:35], v[128:131]
    v_mfma_f32_16x16x32_bf16 v[132:135], a[72:75], v[32:35], v[132:135]
    ds_read_b128 v[64:67], v9 offset:0
    v_mfma_f32_16x16x32_bf16 v[136:139], a[144:147], v[32:35], v[136:139]
    v_mfma_f32_16x16x32_bf16 v[140:143], a[0:3], v[36:39], v[140:143]
    ds_read_b128 v[68:71], v9 offset:2048
    v_mfma_f32_16x16x32_bf16 v[144:147], a[72:75], v[36:39], v[144:147]
    v_mfma_f32_16x16x32_bf16 v[148:151], a[144:147], v[36:39], v[148:151]
    s_waitcnt lgkmcnt(0)
    v_mfma_f32_16x16x32_bf16 v[128:131], a[4:7], v[64:67], v[128:131]
    v_mfma_f32_16x16x32_bf16 v[132:135], a[76:79], v[64:67], v[132:135]
    s_waitcnt vmcnt(6)
    v_mfma_f32_16x16x32_bf16 v[136:139], a[148:151], v[64:67], v[136:139]
    v_mfma_f32_16x16x32_bf16 v[140:143], a[4:7], v[68:71], v[140:143]
    s_barrier
    v_mfma_f32_16x16x32_bf16 v[144:147], a[76:79], v[68:71], v[144:147]
    v_mfma_f32_16x16x32_bf16 v[148:151], a[148:151], v[68:71], v[148:151]
    ds_read_b128 v[32:35], v8 offset:4096
    ds_read_b128 v[36:39], v8 offset:6144
    s_waitcnt lgkmcnt(0)
    v_mfma_f32_16x16x32_bf16 v[128:131], a[8:11], v[32:35], v[128:131]
    v_mfma_f32_16x16x32_bf16 v[132:135], a[80:83], v[32:35], v[132:135]
    ds_read_b128 v[64:67], v9 offset:4096
    v_mfma_f32_16x16x32_bf16 v[136:139], a[152:155], v[32:35], v[136:139]
    v_mfma_f32_16x16x32_bf16 v[140:143], a[8:11], v[36:39], v[140:143]
    ds_read_b128 v[68:71], v9 offset:6144
    v_mfma_f32_16x16x32_bf16 v[144:147], a[80:83], v[36:39], v[144:147]
    v_mfma_f32_16x16x32_bf16 v[148:151], a[152:155], v[36:39], v[148:151]
    s_waitcnt lgkmcnt(0)
    v_mfma_f32_16x16x32_bf16 v[128:131], a[12:15], v[64:67], v[128:131]
    v_mfma_f32_16x16x32_bf16 v[132:135], a[84:87], v[64:67], v[132:135]
    s_waitcnt vmcnt(5)
    v_mfma_f32_16x16x32_bf16 v[136:139], a[156:159], v[64:67], v[136:139]
    v_mfma_f32_16x16x32_bf16 v[140:143], a[12:15], v[68:71], v[140:143]
    s_barrier
    v_mfma_f32_16x16x32_bf16 v[144:147], a[84:87], v[68:71], v[144:147]
    v_mfma_f32_16x16x32_bf16 v[148:151], a[156:159], v[68:71], v[148:151]
    ds_read_b128 v[32:35], v8 offset:8192
    ds_read_b128 v[36:39], v8 offset:10240
    s_waitcnt lgkmcnt(0)
    v_mfma_f32_16x16x32_bf16 v[128:131], a[16:19], v[32:35], v[128:131]
    v_mfma_f32_16x16x32_bf16 v[132:135], a[88:91], v[32:35], v[132:135]
    ds_read_b128 v[64:67], v9 offset:8192
    v_mfma_f32_16x16x32_bf16 v[136:139], a[160:163], v[32:35], v[136:139]
    v_mfma_f32_16x16x32_bf16 v[140:143], a[16:19], v[36:39], v[140:143]
    ds_read_b128 v[68:71], v9 offset:10240
    v_mfma_f32_16x16x32_bf16 v[144:147], a[88:91], v[36:39], v[144:147]
    v_mfma_f32_16x16x32_bf16 v[148:151], a[160:163], v[36:39], v[148:151]
    s_waitcnt lgkmcnt(0)
    v_mfma_f32_16x16x32_bf16 v[128:131], a[20:23], v[64:67], v[128:131]
    v_mfma_f32_16x16x32_bf16 v[132:135], a[92:95], v[64:67], v[132:135]
    s_waitcnt vmcnt(4)
    v_mfma_f32_16x16x32_bf16 v[136:139], a[164:167], v[64:67], v[136:139]
    v_mfma_f32_16x16x32_bf16 v[140:143], a[20:23], v[68:71], v[140:143]
    s_barrier
    v_mfma_f32_16x16x32_bf16 v[144:147], a[92:95], v[68:71], v[144:147]
    v_mfma_f32_16x16x32_bf16 v[148:151], a[164:167], v[68:71], v[148:151]
    ds_read_b128 v[32:35], v8 offset:12288
    ds_read_b128 v[36:39], v8 offset:14336
    s_waitcnt lgkmcnt(0)
    v_mfma_f32_16x16x32_bf16 v[128:131], a[24:27], v[32:35], v[128:131]
    v_mfma_f32_16x16x32_bf16 v[132:135], a[96:99], v[32:35], v[132:135]
    ds_read_b128 v[64:67], v9 offset:12288
    v_mfma_f32_16x16x32_bf16 v[136:139], a[168:171], v[32:35], v[136:139]
    v_mfma_f32_16x16x32_bf16 v[140:143], a[24:27], v[36:39], v[140:143]
    ds_read_b128 v[68:71], v9 offset:14336
    v_mfma_f32_16x16x32_bf16 v[144:147], a[96:99], v[36:39], v[144:147]
    v_mfma_f32_16x16x32_bf16 v[148:151], a[168:171], v[36:39], v[148:151]
    s_waitcnt lgkmcnt(0)
    v_mfma_f32_16x16x32_bf16 v[128:131], a[28:31], v[64:67], v[128:131]
    v_mfma_f32_16x16x32_bf16 v[132:135], a[100:103], v[64:67], v[132:135]
    s_waitcnt vmcnt(3)
    v_mfma_f32_16x16x32_bf16 v[136:139], a[172:175], v[64:67], v[136:139]
    v_mfma_f32_16x16x32_bf16 v[140:143], a[28:31], v[68:71], v[140:143]
    s_barrier
    v_mfma_f32_16x16x32_bf16 v[144:147], a[100:103], v[68:71], v[144:147]
    v_mfma_f32_16x16x32_bf16 v[148:151], a[172:175], v[68:71], v[148:151]
    ds_read_b128 v[32:35], v8 offset:16384
    ds_read_b128 v[36:39], v8 offset:18432
    s_waitcnt lgkmcnt(0)
    v_mfma_f32_16x16x32_bf16 v[128:131], a[32:35], v[32:35], v[128:131]
    v_mfma_f32_16x16x32_bf16 v[132:135], a[104:107], v[32:35], v[132:135]
    ds_read_b128 v[64:67], v9 offset:16384
    v_mfma_f32_16x16x32_bf16 v[136:139], a[176:179], v[32:35], v[136:139]
    v_mfma_f32_16x16x32_bf16 v[140:143], a[32:35], v[36:39], v[140:143]
    ds_read_b128 v[68:71], v9 offset:18432
    v_mfma_f32_16x16x32_bf16 v[144:147], a[104:107], v[36:39], v[144:147]
    v_mfma_f32_16x16x32_bf16 v[148:151], a[176:179], v[36:39], v[148:151]
    s_waitcnt lgkmcnt(0)
    v_mfma_f32_16x16x32_bf16 v[128:131], a[36:39], v[64:67], v[128:131]
    v_mfma_f32_16x16x32_bf16 v[132:135], a[108:111], v[64:67], v[132:135]
    s_waitcnt vmcnt(2)
    v_mfma_f32_16x16x32_bf16 v[136:139], a[180:183], v[64:67], v[136:139]
    v_mfma_f32_16x16x32_bf16 v[140:143], a[36:39], v[68:71], v[140:143]
    s_barrier
    v_mfma_f32_16x16x32_bf16 v[144:147], a[108:111], v[68:71], v[144:147]
    v_mfma_f32_16x16x32_bf16 v[148:151], a[180:183], v[68:71], v[148:151]
    ds_read_b128 v[32:35], v8 offset:20480
    ds_read_b128 v[36:39], v8 offset:22528
    s_waitcnt lgkmcnt(0)
    v_mfma_f32_16x16x32_bf16 v[128:131], a[40:43], v[32:35], v[128:131]
    v_mfma_f32_16x16x32_bf16 v[132:135], a[112:115], v[32:35], v[132:135]
    ds_read_b128 v[64:67], v9 offset:20480
    v_mfma_f32_16x16x32_bf16 v[136:139], a[184:187], v[32:35], v[136:139]
    v_mfma_f32_16x16x32_bf16 v[140:143], a[40:43], v[36:39], v[140:143]
    ds_read_b128 v[68:71], v9 offset:22528
    v_mfma_f32_16x16x32_bf16 v[144:147], a[112:115], v[36:39], v[144:147]
    v_mfma_f32_16x16x32_bf16 v[148:151], a[184:187], v[36:39], v[148:151]
    s_waitcnt lgkmcnt(0)
    v_mfma_f32_16x16x32_bf16 v[128:131], a[44:47], v[64:67], v[128:131]
    v_mfma_f32_16x16x32_bf16 v[132:135], a[116:119], v[64:67], v[132:135]
    s_waitcnt vmcnt(1)
    v_mfma_f32_16x16x32_bf16 v[136:139], a[188:191], v[64:67], v[136:139]
    v_mfma_f32_16x16x32_bf16 v[140:143], a[44:47], v[68:71], v[140:143]
    s_barrier
    v_mfma_f32_16x16x32_bf16 v[144:147], a[116:119], v[68:71], v[144:147]
    v_mfma_f32_16x16x32_bf16 v[148:151], a[188:191], v[68:71], v[148:151]
    ds_read_b128 v[32:35], v8 offset:24576
    ds_read_b128 v[36:39], v8 offset:26624
    s_waitcnt lgkmcnt(0)
    v_mfma_f32_16x16x32_bf16 v[128:131], a[48:51], v[32:35], v[128:131]
    v_mfma_f32_16x16x32_bf16 v[132:135], a[120:123], v[32:35], v[132:135]
    ds_read_b128 v[64:67], v9 offset:24576
    v_mfma_f32_16x16x32_bf16 v[136:139], a[192:195], v[32:35], v[136:139]
    v_mfma_f32_16x16x32_bf16 v[140:143], a[48:51], v[36:39], v[140:143]
    ds_read_b128 v[68:71], v9 offset:26624
    v_mfma_f32_16x16x32_bf16 v[144:147], a[120:123], v[36:39], v[144:147]
    v_mfma_f32_16x16x32_bf16 v[148:151], a[192:195], v[36:39], v[148:151]
    s_waitcnt lgkmcnt(0)
    v_mfma_f32_16x16x32_bf16 v[128:131], a[52:55], v[64:67], v[128:131]
    v_mfma_f32_16x16x32_bf16 v[132:135], a[124:127], v[64:67], v[132:135]
    s_waitcnt vmcnt(0)
    v_mfma_f32_16x16x32_bf16 v[136:139], a[196:199], v[64:67], v[136:139]
    v_mfma_f32_16x16x32_bf16 v[140:143], a[52:55], v[68:71], v[140:143]
    s_barrier
    v_mfma_f32_16x16x32_bf16 v[144:147], a[124:127], v[68:71], v[144:147]
    v_mfma_f32_16x16x32_bf16 v[148:151], a[196:199], v[68:71], v[148:151]
    ds_read_b128 v[32:35], v8 offset:28672
    ds_read_b128 v[36:39], v8 offset:30720
    s_waitcnt lgkmcnt(0)
    v_mfma_f32_16x16x32_bf16 v[128:131], a[56:59], v[32:35], v[128:131]
    v_mfma_f32_16x16x32_bf16 v[132:135], a[128:131], v[32:35], v[132:135]
    ds_read_b128 v[64:67], v9 offset:28672
    v_mfma_f32_16x16x32_bf16 v[136:139], a[200:203], v[32:35], v[136:139]
    v_mfma_f32_16x16x32_bf16 v[140:143], a[56:59], v[36:39], v[140:143]
    ds_read_b128 v[68:71], v9 offset:30720
    v_mfma_f32_16x16x32_bf16 v[144:147], a[128:131], v[36:39], v[144:147]
    v_mfma_f32_16x16x32_bf16 v[148:151], a[200:203], v[36:39], v[148:151]
    s_waitcnt lgkmcnt(0)
    v_mfma_f32_16x16x32_bf16 v[128:131], a[60:63], v[64:67], v[128:131]
    v_mfma_f32_16x16x32_bf16 v[132:135], a[132:135], v[64:67], v[132:135]
    v_mfma_f32_16x16x32_bf16 v[136:139], a[204:207], v[64:67], v[136:139]
    v_mfma_f32_16x16x32_bf16 v[140:143], a[60:63], v[68:71], v[140:143]
    v_mfma_f32_16x16x32_bf16 v[144:147], a[132:135], v[68:71], v[144:147]
    v_mfma_f32_16x16x32_bf16 v[148:151], a[204:207], v[68:71], v[148:151]
    s_nop 7
    s_mov_b32 s53, 98304
    s_mov_b32 s56, 1152
    s_mul_i32 s57, s78, 2359296
    s_mul_i32 s54, s52, 1152
    s_add_u32 s57, s57, s54
    s_mul_i32 s54, s79, 384
    s_add_u32 s57, s57, s54
    s_add_u32 s57, s57, 121634816
    v_and_b32 v1, 63, v0
    v_and_b32 v2, 31, v1
    v_mul_u32_u24 v2, 384, v2
    v_add_u32 v2, s53, v2
    v_lshrrev_b32 v3, 5, v1
    s_mul_i32 s36, s17, 6
    v_add_u32 v3, s36, v3
    v_and_b32 v4, 7, v1
    v_add_u32 v5, 0, v3
    v_xor_b32 v5, v5, v4
    v_lshlrev_b32 v5, 4, v5
    v_add_u32 v16, v2, v5
    v_add_u32 v5, 2, v3
    v_xor_b32 v5, v5, v4
    v_lshlrev_b32 v5, 4, v5
    v_add_u32 v17, v2, v5
    v_add_u32 v5, 4, v3
    v_xor_b32 v5, v5, v4
    v_lshlrev_b32 v5, 4, v5
    v_add_u32 v18, v2, v5
    v_cvt_pk_bf16_f32 v32, v128, v129
    v_cvt_pk_bf16_f32 v33, v130, v131
    v_cvt_pk_bf16_f32 v34, v140, v141
    v_cvt_pk_bf16_f32 v35, v142, v143
    s_nop 0
    v_permlane16_swap_b32 v32, v34
    v_permlane16_swap_b32 v33, v35
    ds_write_b128 v16, v[32:35] offset:0
    v_cvt_pk_bf16_f32 v36, v132, v133
    v_cvt_pk_bf16_f32 v37, v134, v135
    v_cvt_pk_bf16_f32 v38, v144, v145
    v_cvt_pk_bf16_f32 v39, v146, v147
    s_nop 0
    v_permlane16_swap_b32 v36, v38
    v_permlane16_swap_b32 v37, v39
    ds_write_b128 v17, v[36:39] offset:0
    v_cvt_pk_bf16_f32 v40, v136, v137
    v_cvt_pk_bf16_f32 v41, v138, v139
    v_cvt_pk_bf16_f32 v42, v148, v149
    v_cvt_pk_bf16_f32 v43, v150, v151
    s_nop 0
    v_permlane16_swap_b32 v40, v42
    v_permlane16_swap_b32 v41, v43
    ds_write_b128 v18, v[40:43] offset:0
    v_cmp_le_u32 vcc, 24, v1
    s_nop 1
    v_cndmask_b32 v2, 0, 1, vcc
    v_mul_u32_u24 v3, 24, v2
    v_sub_u32 v3, v1, v3
    s_mul_i32 s36, s17, 8
    v_xor_b32 v4, v3, v2
    v_lshlrev_b32 v4, 4, v4
    v_add_u32 v2, s36, v2
    v_mul_u32_u24 v5, 384, v2
    v_add_u32 v5, s53, v5
    v_mul_lo_u32 v2, v2, s56
    v_lshlrev_b32 v3, 4, v3
    v_add_u32 v18, v2, v3
    v_mov_b32 v2, 0x40000000
    v_cmp_gt_u32 vcc, 48, v1
    s_nop 1
    v_cndmask_b32 v18, v2, v18, vcc
    s_lshl_b32 s37, s56, 1
    s_mov_b32 s39, s57
    v_xor_b32 v3, 0, v4
    v_add_u32 v20, v5, v3
    v_xor_b32 v3, 32, v4
    v_add_u32 v21, v5, v3
    v_xor_b32 v3, 64, v4
    v_add_u32 v22, v5, v3
    v_xor_b32 v3, 96, v4
    v_add_u32 v23, v5, v3
    s_waitcnt lgkmcnt(0)
    s_barrier
    ds_read_b128 v[32:35], v20 offset:0
    ds_read_b128 v[36:39], v21 offset:768
    ds_read_b128 v[40:43], v22 offset:1536
    ds_read_b128 v[44:47], v23 offset:2304
    s_waitcnt lgkmcnt(3)
    buffer_store_dwordx4 v[32:35], v18, s[4:7], s39 offen sc1
    s_add_u32 s39, s39, s37
    s_waitcnt lgkmcnt(2)
    buffer_store_dwordx4 v[36:39], v18, s[4:7], s39 offen sc1
    s_add_u32 s39, s39, s37
    s_waitcnt lgkmcnt(1)
    buffer_store_dwordx4 v[40:43], v18, s[4:7], s39 offen sc1
    s_add_u32 s39, s39, s37
    s_waitcnt lgkmcnt(0)
    buffer_store_dwordx4 v[44:47], v18, s[4:7], s39 offen sc1
    s_lshl_b32 s67, s65, 2
    s_and_b32 s20, s66, 3
    s_add_u32 s67, s67, s20
    s_lshl_b32 s67, s67, 8
    s_add_u32 s67, s67, 1654784
    s_waitcnt vmcnt(0)
    s_barrier
    s_cmp_lg_u32 s17, 0
    s_cbranch_scc1 Ls_62
    s_mov_b64 exec, 1
    v_mov_b32 v2, 0
    v_mov_b32 v3, 1
    buffer_atomic_add v3, v2, s[4:7], s67 offen
    s_mov_b64 exec, -1
Ls_62:
    s_branch Lexit
Lp_ln2:
    s_sub_u32 s79, s66, 80
    s_lshr_b32 s65, s79, 4
    s_and_b32 s79, s79, 15
Lp_ln2_l:
    s_cmp_eq_u32 s65, 31
    s_cselect_b32 s68, 48, 24
    s_lshl_b32 s67, s65, 2
    s_lshl_b32 s67, s67, 8
    s_add_u32 s67, s67, 1654784
    s_cmp_lg_u32 s17, 0
    s_cbranch_scc1 Lw_65
    v_and_b32 v2, 63, v0
    v_lshlrev_b32 v2, 8, v2
    s_mov_b64 exec, 0xf
    s_mov_b32 s70, 0
Lw_63:
    buffer_load_dword v3, v2, s[4:7], s67 offen sc1
    s_waitcnt vmcnt(0)
    v_readlane_b32 s69, v3, 0
    v_readlane_b32 s20, v3, 1
    s_nop 2
    s_add_u32 s69, s69, s20
    v_readlane_b32 s20, v3, 2
    s_nop 2
    s_add_u32 s69, s69, s20
    v_readlane_b32 s20, v3, 3
    s_nop 2
    s_add_u32 s69, s69, s20
    s_cmp_ge_u32 s69, s68
    s_cbranch_scc1 Lw_64
    s_cmp_ge_u32 s70, 2
    s_cbranch_scc1 Lb_66
    s_cmp_ge_u32 s65, 28
    s_cbranch_scc1 Lb_66
    s_sleep 24
Lb_66:
    s_sleep 2
    s_add_u32 s70, s70, 1
    s_cmp_lt_u32 s70, 524288
    s_cbranch_scc1 Lw_63
    s_branch Lfail
Lw_64:
    s_mov_b64 exec, -1
Lw_65:
    s_barrier
    s_lshl_b32 s20, s79, 2
    s_lshl_b32 s50, s65, 6
    s_add_u32 s50, s50, s20
    s_mov_b32 s49, 4
    s_load_dwordx2 s[8:9], s[0:1], 0
    s_load_dwordx2 s[12:13], s[0:1], 80
    s_waitcnt lgkmcnt(0)
    s_mov_b32 s10, 2359296
    s_mov_b32 s11, 0x20000
    s_mov_b32 s14, 2359296
    s_mov_b32 s15, 0x20000
    v_and_b32 v1, 63, v0
    v_cmp_gt_u32 vcc, 36, v1
    v_lshlrev_b32 v2, 4, v1
    v_mov_b32 v3, 0x40000000
    v_cndmask_b32 v2, v3, v2, vcc
    v_mov_b32 v4, v2
    s_mov_b64 s[60:61], vcc
    s_add_u32 s51, s17, 0
    s_add_u32 s59, s51, s50
    s_mul_i32 s52, s59, 1152
    s_mul_i32 s55, s59, 2304
    s_cmp_lt_u32 s51, s49
    s_cselect_b32 s52, s52, 0x40000000
    s_cselect_b32 s55, s55, 0x40000000
    buffer_load_dwordx4 v[48:51], v2, s[8:11], s52 offen
    buffer_load_dwordx4 v[52:55], v2, s[8:11], s52 offen offset:576
    s_add_u32 s58, s52, 121634816
    buffer_load_dwordx4 v[112:115], v2, s[4:7], s58 offen sc1
    buffer_load_dwordx4 v[116:119], v2, s[4:7], s58 offen offset:576 sc1
    s_add_u32 s58, s52, 123994112
    buffer_load_dwordx4 v[120:123], v2, s[4:7], s58 offen sc1
    buffer_load_dwordx4 v[124:127], v2, s[4:7], s58 offen offset:576 sc1
    s_add_u32 s58, s52, 126353408
    buffer_load_dwordx4 v[128:131], v2, s[4:7], s58 offen sc1
    buffer_load_dwordx4 v[132:135], v2, s[4:7], s58 offen offset:576 sc1
    s_add_u32 s58, s52, 128712704
    buffer_load_dwordx4 v[136:139], v2, s[4:7], s58 offen sc1
    buffer_load_dwordx4 v[140:143], v2, s[4:7], s58 offen offset:576 sc1
    s_add_u32 s58, s52, 131072000
    buffer_load_dwordx4 v[144:147], v2, s[4:7], s58 offen sc1
    buffer_load_dwordx4 v[148:151], v2, s[4:7], s58 offen offset:576 sc1
    s_add_u32 s58, s52, 133431296
    buffer_load_dwordx4 v[152:155], v2, s[4:7], s58 offen sc1
    buffer_load_dwordx4 v[156:159], v2, s[4:7], s58 offen offset:576 sc1
    s_add_u32 s58, s52, 135790592
    buffer_load_dwordx4 v[160:163], v2, s[4:7], s58 offen sc1
    buffer_load_dwordx4 v[164:167], v2, s[4:7], s58 offen offset:576 sc1
    s_add_u32 s58, s52, 138149888
    buffer_load_dwordx4 v[168:171], v2, s[4:7], s58 offen sc1
    buffer_load_dwordx4 v[172:175], v2, s[4:7], s58 offen offset:576 sc1
    s_waitcnt vmcnt(0)
    v_lshlrev_b32 v16, 16, v48
    v_and_b32 v17, 0xffff0000, v48
    v_lshlrev_b32 v18, 16, v49
    v_and_b32 v19, 0xffff0000, v49
    v_lshlrev_b32 v20, 16, v50
    v_and_b32 v21, 0xffff0000, v50
    v_lshlrev_b32 v22, 16, v51
    v_and_b32 v23, 0xffff0000, v51
    v_lshlrev_b32 v24, 16, v52
    v_and_b32 v25, 0xffff0000, v52
    v_lshlrev_b32 v26, 16, v53
    v_and_b32 v27, 0xffff0000, v53
    v_lshlrev_b32 v28, 16, v54
    v_and_b32 v29, 0xffff0000, v54
    v_lshlrev_b32 v30, 16, v55
    v_and_b32 v31, 0xffff0000, v55
    v_lshlrev_b32 v5, 16, v112
    v_and_b32 v6, 0xffff0000, v112
    v_add_f32 v16, v16, v5
    v_add_f32 v17, v17, v6
    v_lshlrev_b32 v5, 16, v113
    v_and_b32 v6, 0xffff0000, v113
    v_add_f32 v18, v18, v5
    v_add_f32 v19, v19, v6
    v_lshlrev_b32 v5, 16, v114
    v_and_b32 v6, 0xffff0000, v114
    v_add_f32 v20, v20, v5
    v_add_f32 v21, v21, v6
    v_lshlrev_b32 v5, 16, v115
    v_and_b32 v6, 0xffff0000, v115
    v_add_f32 v22, v22, v5
    v_add_f32 v23, v23, v6
    v_lshlrev_b32 v5, 16, v116
    v_and_b32 v6, 0xffff0000, v116
    v_add_f32 v24, v24, v5
    v_add_f32 v25, v25, v6
    v_lshlrev_b32 v5, 16, v117
    v_and_b32 v6, 0xffff0000, v117
    v_add_f32 v26, v26, v5
    v_add_f32 v27, v27, v6
    v_lshlrev_b32 v5, 16, v118
    v_and_b32 v6, 0xffff0000, v118
    v_add_f32 v28, v28, v5
    v_add_f32 v29, v29, v6
    v_lshlrev_b32 v5, 16, v119
    v_and_b32 v6, 0xffff0000, v119
    v_add_f32 v30, v30, v5
    v_add_f32 v31, v31, v6
    v_lshlrev_b32 v5, 16, v120
    v_and_b32 v6, 0xffff0000, v120
    v_add_f32 v16, v16, v5
    v_add_f32 v17, v17, v6
    v_lshlrev_b32 v5, 16, v121
    v_and_b32 v6, 0xffff0000, v121
    v_add_f32 v18, v18, v5
    v_add_f32 v19, v19, v6
    v_lshlrev_b32 v5, 16, v122
    v_and_b32 v6, 0xffff0000, v122
    v_add_f32 v20, v20, v5
    v_add_f32 v21, v21, v6
    v_lshlrev_b32 v5, 16, v123
    v_and_b32 v6, 0xffff0000, v123
    v_add_f32 v22, v22, v5
    v_add_f32 v23, v23, v6
    v_lshlrev_b32 v5, 16, v124
    v_and_b32 v6, 0xffff0000, v124
    v_add_f32 v24, v24, v5
    v_add_f32 v25, v25, v6
    v_lshlrev_b32 v5, 16, v125
    v_and_b32 v6, 0xffff0000, v125
    v_add_f32 v26, v26, v5
    v_add_f32 v27, v27, v6
    v_lshlrev_b32 v5, 16, v126
    v_and_b32 v6, 0xffff0000, v126
    v_add_f32 v28, v28, v5
    v_add_f32 v29, v29, v6
    v_lshlrev_b32 v5, 16, v127
    v_and_b32 v6, 0xffff0000, v127
    v_add_f32 v30, v30, v5
    v_add_f32 v31, v31, v6
    v_lshlrev_b32 v5, 16, v128
    v_and_b32 v6, 0xffff0000, v128
    v_add_f32 v16, v16, v5
    v_add_f32 v17, v17, v6
    v_lshlrev_b32 v5, 16, v129
    v_and_b32 v6, 0xffff0000, v129
    v_add_f32 v18, v18, v5
    v_add_f32 v19, v19, v6
    v_lshlrev_b32 v5, 16, v130
    v_and_b32 v6, 0xffff0000, v130
    v_add_f32 v20, v20, v5
    v_add_f32 v21, v21, v6
    v_lshlrev_b32 v5, 16, v131
    v_and_b32 v6, 0xffff0000, v131
    v_add_f32 v22, v22, v5
    v_add_f32 v23, v23, v6
    v_lshlrev_b32 v5, 16, v132
    v_and_b32 v6, 0xffff0000, v132
    v_add_f32 v24, v24, v5
    v_add_f32 v25, v25, v6
    v_lshlrev_b32 v5, 16, v133
    v_and_b32 v6, 0xffff0000, v133
    v_add_f32 v26, v26, v5
    v_add_f32 v27, v27, v6
    v_lshlrev_b32 v5, 16, v134
    v_and_b32 v6, 0xffff0000, v134
    v_add_f32 v28, v28, v5
    v_add_f32 v29, v29, v6
    v_lshlrev_b32 v5, 16, v135
    v_and_b32 v6, 0xffff0000, v135
    v_add_f32 v30, v30, v5
    v_add_f32 v31, v31, v6
    v_lshlrev_b32 v5, 16, v136
    v_and_b32 v6, 0xffff0000, v136
    v_add_f32 v16, v16, v5
    v_add_f32 v17, v17, v6
    v_lshlrev_b32 v5, 16, v137
    v_and_b32 v6, 0xffff0000, v137
    v_add_f32 v18, v18, v5
    v_add_f32 v19, v19, v6
    v_lshlrev_b32 v5, 16, v138
    v_and_b32 v6, 0xffff0000, v138
    v_add_f32 v20, v20, v5
    v_add_f32 v21, v21, v6
    v_lshlrev_b32 v5, 16, v139
    v_and_b32 v6, 0xffff0000, v139
    v_add_f32 v22, v22, v5
    v_add_f32 v23, v23, v6
    v_lshlrev_b32 v5, 16, v140
    v_and_b32 v6, 0xffff0000, v140
    v_add_f32 v24, v24, v5
    v_add_f32 v25, v25, v6
    v_lshlrev_b32 v5, 16, v141
    v_and_b32 v6, 0xffff0000, v141
    v_add_f32 v26, v26, v5
    v_add_f32 v27, v27, v6
    v_lshlrev_b32 v5, 16, v142
    v_and_b32 v6, 0xffff0000, v142
    v_add_f32 v28, v28, v5
    v_add_f32 v29, v29, v6
    v_lshlrev_b32 v5, 16, v143
    v_and_b32 v6, 0xffff0000, v143
    v_add_f32 v30, v30, v5
    v_add_f32 v31, v31, v6
    v_lshlrev_b32 v5, 16, v144
    v_and_b32 v6, 0xffff0000, v144
    v_add_f32 v16, v16, v5
    v_add_f32 v17, v17, v6
    v_lshlrev_b32 v5, 16, v145
    v_and_b32 v6, 0xffff0000, v145
    v_add_f32 v18, v18, v5
    v_add_f32 v19, v19, v6
    v_lshlrev_b32 v5, 16, v146
    v_and_b32 v6, 0xffff0000, v146
    v_add_f32 v20, v20, v5
    v_add_f32 v21, v21, v6
    v_lshlrev_b32 v5, 16, v147
    v_and_b32 v6, 0xffff0000, v147
    v_add_f32 v22, v22, v5
    v_add_f32 v23, v23, v6
    v_lshlrev_b32 v5, 16, v148
    v_and_b32 v6, 0xffff0000, v148
    v_add_f32 v24, v24, v5
    v_add_f32 v25, v25, v6
    v_lshlrev_b32 v5, 16, v149
    v_and_b32 v6, 0xffff0000, v149
    v_add_f32 v26, v26, v5
    v_add_f32 v27, v27, v6
    v_lshlrev_b32 v5, 16, v150
    v_and_b32 v6, 0xffff0000, v150
    v_add_f32 v28, v28, v5
    v_add_f32 v29, v29, v6
    v_lshlrev_b32 v5, 16, v151
    v_and_b32 v6, 0xffff0000, v151
    v_add_f32 v30, v30, v5
    v_add_f32 v31, v31, v6
    v_lshlrev_b32 v5, 16, v152
    v_and_b32 v6, 0xffff0000, v152
    v_add_f32 v16, v16, v5
    v_add_f32 v17, v17, v6
    v_lshlrev_b32 v5, 16, v153
    v_and_b32 v6, 0xffff0000, v153
    v_add_f32 v18, v18, v5
    v_add_f32 v19, v19, v6
    v_lshlrev_b32 v5, 16, v154
    v_and_b32 v6, 0xffff0000, v154
    v_add_f32 v20, v20, v5
    v_add_f32 v21, v21, v6
    v_lshlrev_b32 v5, 16, v155
    v_and_b32 v6, 0xffff0000, v155
    v_add_f32 v22, v22, v5
    v_add_f32 v23, v23, v6
    v_lshlrev_b32 v5, 16, v156
    v_and_b32 v6, 0xffff0000, v156
    v_add_f32 v24, v24, v5
    v_add_f32 v25, v25, v6
    v_lshlrev_b32 v5, 16, v157
    v_and_b32 v6, 0xffff0000, v157
    v_add_f32 v26, v26, v5
    v_add_f32 v27, v27, v6
    v_lshlrev_b32 v5, 16, v158
    v_and_b32 v6, 0xffff0000, v158
    v_add_f32 v28, v28, v5
    v_add_f32 v29, v29, v6
    v_lshlrev_b32 v5, 16, v159
    v_and_b32 v6, 0xffff0000, v159
    v_add_f32 v30, v30, v5
    v_add_f32 v31, v31, v6
    v_lshlrev_b32 v5, 16, v160
    v_and_b32 v6, 0xffff0000, v160
    v_add_f32 v16, v16, v5
    v_add_f32 v17, v17, v6
    v_lshlrev_b32 v5, 16, v161
    v_and_b32 v6, 0xffff0000, v161
    v_add_f32 v18, v18, v5
    v_add_f32 v19, v19, v6
    v_lshlrev_b32 v5, 16, v162
    v_and_b32 v6, 0xffff0000, v162
    v_add_f32 v20, v20, v5
    v_add_f32 v21, v21, v6
    v_lshlrev_b32 v5, 16, v163
    v_and_b32 v6, 0xffff0000, v163
    v_add_f32 v22, v22, v5
    v_add_f32 v23, v23, v6
    v_lshlrev_b32 v5, 16, v164
    v_and_b32 v6, 0xffff0000, v164
    v_add_f32 v24, v24, v5
    v_add_f32 v25, v25, v6
    v_lshlrev_b32 v5, 16, v165
    v_and_b32 v6, 0xffff0000, v165
    v_add_f32 v26, v26, v5
    v_add_f32 v27, v27, v6
    v_lshlrev_b32 v5, 16, v166
    v_and_b32 v6, 0xffff0000, v166
    v_add_f32 v28, v28, v5
    v_add_f32 v29, v29, v6
    v_lshlrev_b32 v5, 16, v167
    v_and_b32 v6, 0xffff0000, v167
    v_add_f32 v30, v30, v5
    v_add_f32 v31, v31, v6
    v_lshlrev_b32 v5, 16, v168
    v_and_b32 v6, 0xffff0000, v168
    v_add_f32 v16, v16, v5
    v_add_f32 v17, v17, v6
    v_lshlrev_b32 v5, 16, v169
    v_and_b32 v6, 0xffff0000, v169
    v_add_f32 v18, v18, v5
    v_add_f32 v19, v19, v6
    v_lshlrev_b32 v5, 16, v170
    v_and_b32 v6, 0xffff0000, v170
    v_add_f32 v20, v20, v5
    v_add_f32 v21, v21, v6
    v_lshlrev_b32 v5, 16, v171
    v_and_b32 v6, 0xffff0000, v171
    v_add_f32 v22, v22, v5
    v_add_f32 v23, v23, v6
    v_lshlrev_b32 v5, 16, v172
    v_and_b32 v6, 0xffff0000, v172
    v_add_f32 v24, v24, v5
    v_add_f32 v25, v25, v6
    v_lshlrev_b32 v5, 16, v173
    v_and_b32 v6, 0xffff0000, v173
    v_add_f32 v26, v26, v5
    v_add_f32 v27, v27, v6
    v_lshlrev_b32 v5, 16, v174
    v_and_b32 v6, 0xffff0000, v174
    v_add_f32 v28, v28, v5
    v_add_f32 v29, v29, v6
    v_lshlrev_b32 v5, 16, v175
    v_and_b32 v6, 0xffff0000, v175
    v_add_f32 v30, v30, v5
    v_add_f32 v31, v31, v6
    s_add_u32 s58, s55, 83886080
    buffer_store_dwordx4 v[16:19], v4, s[4:7], s58 offen offset:0 sc1
    buffer_store_dwordx4 v[20:23], v4, s[4:7], s58 offen offset:576 sc1
    buffer_store_dwordx4 v[24:27], v4, s[4:7], s58 offen offset:1152 sc1
    buffer_store_dwordx4 v[28:31], v4, s[4:7], s58 offen offset:1728 sc1
    v_add_f32 v5, v16, v17
    v_add_f32 v5, v5, v18
    v_add_f32 v5, v5, v19
    v_add_f32 v5, v5, v20
    v_add_f32 v5, v5, v21
    v_add_f32 v5, v5, v22
    v_add_f32 v5, v5, v23
    v_add_f32 v5, v5, v24
    v_add_f32 v5, v5, v25
    v_add_f32 v5, v5, v26
    v_add_f32 v5, v5, v27
    v_add_f32 v5, v5, v28
    v_add_f32 v5, v5, v29
    v_add_f32 v5, v5, v30
    v_add_f32 v5, v5, v31
    s_nop 1
    v_add_f32_dpp v5, v5, v5 row_ror:1 row_mask:0xf bank_mask:0xf
    s_nop 1
    v_add_f32_dpp v5, v5, v5 row_ror:2 row_mask:0xf bank_mask:0xf
    s_nop 1
    v_add_f32_dpp v5, v5, v5 row_ror:4 row_mask:0xf bank_mask:0xf
    s_nop 1
    v_add_f32_dpp v5, v5, v5 row_ror:8 row_mask:0xf bank_mask:0xf
    v_mov_b32 v6, v5
    s_nop 1
    v_permlane16_swap_b32 v6, v5
    v_add_f32 v5, v5, v6
    v_mov_b32 v6, v5
    s_nop 1
    v_permlane32_swap_b32 v6, v5
    v_add_f32 v5, v5, v6
    v_mul_f32 v5, 0x3ae38e39, v5
    v_sub_f32 v32, v16, v5
    v_sub_f32 v33, v17, v5
    v_sub_f32 v34, v18, v5
    v_sub_f32 v35, v19, v5
    v_sub_f32 v36, v20, v5
    v_sub_f32 v37, v21, v5
    v_sub_f32 v38, v22, v5
    v_sub_f32 v39, v23, v5
    v_sub_f32 v40, v24, v5
    v_sub_f32 v41, v25, v5
    v_sub_f32 v42, v26, v5
    v_sub_f32 v43, v27, v5
    v_sub_f32 v44, v28, v5
    v_sub_f32 v45, v29, v5
    v_sub_f32 v46, v30, v5
    v_sub_f32 v47, v31, v5
    v_mul_f32 v6, v32, v32
    v_fmac_f32 v6, v33, v33
    v_fmac_f32 v6, v34, v34
    v_fmac_f32 v6, v35, v35
    v_fmac_f32 v6, v36, v36
    v_fmac_f32 v6, v37, v37
    v_fmac_f32 v6, v38, v38
    v_fmac_f32 v6, v39, v39
    v_fmac_f32 v6, v40, v40
    v_fmac_f32 v6, v41, v41
    v_fmac_f32 v6, v42, v42
    v_fmac_f32 v6, v43, v43
    v_fmac_f32 v6, v44, v44
    v_fmac_f32 v6, v45, v45
    v_fmac_f32 v6, v46, v46
    v_fmac_f32 v6, v47, v47
    v_cndmask_b32 v6, 0, v6, s[60:61]
    s_nop 1
    v_add_f32_dpp v6, v6, v6 row_ror:1 row_mask:0xf bank_mask:0xf
    s_nop 1
    v_add_f32_dpp v6, v6, v6 row_ror:2 row_mask:0xf bank_mask:0xf
    s_nop 1
    v_add_f32_dpp v6, v6, v6 row_ror:4 row_mask:0xf bank_mask:0xf
    s_nop 1
    v_add_f32_dpp v6, v6, v6 row_ror:8 row_mask:0xf bank_mask:0xf
    v_mov_b32 v7, v6
    s_nop 1
    v_permlane16_swap_b32 v7, v6
    v_add_f32 v6, v6, v7
    v_mov_b32 v7, v6
    s_nop 1
    v_permlane32_swap_b32 v7, v6
    v_add_f32 v6, v6, v7
    v_mov_b32 v7, 0x3727c5ac
    v_fmac_f32 v7, 0x3ae38e39, v6
    v_rsq_f32 v7, v7
    s_nop 0
    v_mul_f32 v32, v32, v7
    v_mul_f32 v33, v33, v7
    v_mul_f32 v34, v34, v7
    v_mul_f32 v35, v35, v7
    v_mul_f32 v36, v36, v7
    v_mul_f32 v37, v37, v7
    v_mul_f32 v38, v38, v7
    v_mul_f32 v39, v39, v7
    v_mul_f32 v40, v40, v7
    v_mul_f32 v41, v41, v7
    v_mul_f32 v42, v42, v7
    v_mul_f32 v43, v43, v7
    v_mul_f32 v44, v44, v7
    v_mul_f32 v45, v45, v7
    v_mul_f32 v46, v46, v7
    v_mul_f32 v47, v47, v7
    v_cvt_pk_bf16_f32 v48, v32, v33
    v_cvt_pk_bf16_f32 v49, v34, v35
    v_cvt_pk_bf16_f32 v50, v36, v37
    v_cvt_pk_bf16_f32 v51, v38, v39
    v_cvt_pk_bf16_f32 v52, v40, v41
    v_cvt_pk_bf16_f32 v53, v42, v43
    v_cvt_pk_bf16_f32 v54, v44, v45
    v_cvt_pk_bf16_f32 v55, v46, v47
    s_add_u32 s58, s52, 92274688
    buffer_store_dwordx4 v[48:51], v2, s[4:7], s58 offen sc1
    buffer_store_dwordx4 v[52:55], v2, s[4:7], s58 offen offset:576 sc1
    s_lshl_b32 s67, s65, 2
    s_and_b32 s20, s66, 3
    s_add_u32 s67, s67, s20
    s_lshl_b32 s67, s67, 8
    s_add_u32 s67, s67, 1687552
    s_waitcnt vmcnt(0)
    s_barrier
    s_cmp_lg_u32 s17, 0
    s_cbranch_scc1 Ls_67
    s_mov_b64 exec, 1
    v_mov_b32 v2, 0
    v_mov_b32 v3, 1
    buffer_atomic_add v3, v2, s[4:7], s67 offen
    s_mov_b64 exec, -1
Ls_67:
    s_add_u32 s65, s65, 2
    s_cmp_lt_u32 s65, 32
    s_cbranch_scc1 Lp_ln2_l
    s_branch Lexit
Lp_f1:
    s_sub_u32 s20, s66, 112
    s_cmp_ge_u32 s20, 24
    s_cselect_b32 s65, 1, 0
    s_cselect_b32 s21, 24, 0
    s_sub_u32 s20, s20, s21
    s_mov_b32 s77, s65
    s_mov_b32 s78, 0
    s_mov_b32 s79, s20
    s_load_dwordx2 s[12:13], s[0:1], 64
    s_waitcnt lgkmcnt(0)
    s_mov_b32 s14, 5308416
    s_mov_b32 s15, 0x20000
    s_mul_i32 s26, s78, 5308416
    s_mul_i32 s54, s79, 384
    s_add_u32 s26, s26, s54
    s_mov_b32 s27, 9216
    v_and_b32 v1, 63, v0
    v_lshrrev_b32 v2, 3, v1
    v_mul_lo_u32 v2, v2, s27
    v_and_b32 v3, 7, v1
    v_bfe_u32 v4, v1, 4, 1
    v_lshlrev_b32 v4, 2, v4
    v_xor_b32 v3, v3, v4
    v_lshlrev_b32 v3, 4, v3
    v_add_u32 v19, v2, v3
    v_lshrrev_b32 v2, 4, v1
    v_lshlrev_b32 v2, 3, v2
    v_bfe_u32 v3, v1, 2, 2
    v_add_u32 v2, v2, v3
    v_lshlrev_b32 v2, 7, v2
    v_and_b32 v4, 3, v1
    v_lshlrev_b32 v4, 3, v4
    v_add_u32 v2, v2, v4
    v_bfe_u32 v3, v1, 3, 1
    v_lshlrev_b32 v3, 6, v3
    s_mul_i32 s36, s17, 48
    s_add_u32 s36, s36, 0
    s_lshr_b32 s37, s36, 5
    s_and_b32 s37, s37, 1
    s_lshl_b32 s37, s37, 6
    v_xor_b32 v4, s37, v3
    v_add_u32 v4, v4, v2
    s_lshr_b32 s37, s36, 6
    s_lshl_b32 s37, s37, 13
    s_and_b32 s34, s36, 16
    s_lshl_b32 s34, s34, 1
    s_add_u32 s37, s37, s34
    v_add_u32 v16, s37, v4
    s_mul_i32 s36, s17, 48
    s_add_u32 s36, s36, 16
    s_lshr_b32 s37, s36, 5
    s_and_b32 s37, s37, 1
    s_lshl_b32 s37, s37, 6
    v_xor_b32 v4, s37, v3
    v_add_u32 v4, v4, v2
    s_lshr_b32 s37, s36, 6
    s_lshl_b32 s37, s37, 13
    s_and_b32 s34, s36, 16
    s_lshl_b32 s34, s34, 1
    s_add_u32 s37, s37, s34
    v_add_u32 v17, s37, v4
    s_mul_i32 s36, s17, 48
    s_add_u32 s36, s36, 32
    s_lshr_b32 s37, s36, 5
    s_and_b32 s37, s37, 1
    s_lshl_b32 s37, s37, 6
    v_xor_b32 v4, s37, v3
    v_add_u32 v4, v4, v2
    s_lshr_b32 s37, s36, 6
    s_lshl_b32 s37, s37, 13
    s_and_b32 s34, s36, 16
    s_lshl_b32 s34, s34, 1
    s_add_u32 s37, s37, s34
    v_add_u32 v18, s37, v4
    s_lshl_b32 s36, s17, 3
    s_add_u32 s36, s36, 0
    s_mul_i32 s39, s36, s27
    s_add_u32 s39, s39, s26
    s_lshl_b32 s34, s17, 10
    s_add_u32 s34, s34, 0
    s_lshl_b32 s37, s27, 5
    s_mov_b32 m0, s34
    s_nop 0
    buffer_load_dwordx4 v19, s[12:15], s39 offen lds
    s_add_u32 s34, s34, 4096
    s_add_u32 s39, s39, s37
    s_mov_b32 m0, s34
    s_nop 0
    buffer_load_dwordx4 v19, s[12:15], s39 offen lds
    s_add_u32 s34, s34, 4096
    s_sub_u32 s39, s39, s37
    s_add_u32 s39, s39, 128
    s_mov_b32 m0, s34
    s_nop 0
    buffer_load_dwordx4 v19, s[12:15], s39 offen lds
    s_add_u32 s34, s34, 4096
    s_add_u32 s39, s39, s37
    s_mov_b32 m0, s34
    s_nop 0
    buffer_load_dwordx4 v19, s[12:15], s39 offen lds
    s_add_u32 s34, s34, 4096
    s_sub_u32 s39, s39, s37
    s_add_u32 s39, s39, 128
    s_mov_b32 m0, s34
    s_nop 0
    buffer_load_dwordx4 v19, s[12:15], s39 offen lds
    s_add_u32 s34, s34, 4096
    s_add_u32 s39, s39, s37
    s_mov_b32 m0, s34
    s_nop 0
    buffer_load_dwordx4 v19, s[12:15], s39 offen lds
    s_lshl_b32 s36, s17, 3
    s_add_u32 s36, s36, 64
    s_mul_i32 s39, s36, s27
    s_add_u32 s39, s39, s26
    s_lshl_b32 s34, s17, 10
    s_add_u32 s34, s34, 24576
    s_lshl_b32 s37, s27, 5
    s_mov_b32 m0, s34
    s_nop 0
    buffer_load_dwordx4 v19, s[12:15], s39 offen lds
    s_add_u32 s34, s34, 4096
    s_add_u32 s39, s39, s37
    s_mov_b32 m0, s34
    s_nop 0
    buffer_load_dwordx4 v19, s[12:15], s39 offen lds
    s_add_u32 s34, s34, 4096
    s_sub_u32 s39, s39, s37
    s_add_u32 s39, s39, 128
    s_mov_b32 m0, s34
    s_nop 0
    buffer_load_dwordx4 v19, s[12:15], s39 offen lds
    s_add_u32 s34, s34, 4096
    s_add_u32 s39, s39, s37
    s_mov_b32 m0, s34
    s_nop 0
    buffer_load_dwordx4 v19, s[12:15], s39 offen lds
    s_add_u32 s34, s34, 4096
    s_sub_u32 s39, s39, s37
    s_add_u32 s39, s39, 128
    s_mov_b32 m0, s34
    s_nop 0
    buffer_load_dwordx4 v19, s[12:15], s39 offen lds
    s_add_u32 s34, s34, 4096
    s_add_u32 s39, s39, s37
    s_mov_b32 m0, s34
    s_nop 0
    buffer_load_dwordx4 v19, s[12:15], s39 offen lds
    s_lshl_b32 s36, s17, 3
    s_add_u32 s36, s36, 128
    s_mul_i32 s39, s36, s27
    s_add_u32 s39, s39, s26
    s_lshl_b32 s34, s17, 10
    s_add_u32 s34, s34, 49152
    s_lshl_b32 s37, s27, 5
    s_mov_b32 m0, s34
    s_nop 0
    buffer_load_dwordx4 v19, s[12:15], s39 offen lds
    s_add_u32 s34, s34, 4096
    s_add_u32 s39, s39, s37
    s_mov_b32 m0, s34
    s_nop 0
    buffer_load_dwordx4 v19, s[12:15], s39 offen lds
    s_add_u32 s34, s34, 4096
    s_sub_u32 s39, s39, s37
    s_add_u32 s39, s39, 128
    s_mov_b32 m0, s34
    s_nop 0
    buffer_load_dwordx4 v19, s[12:15], s39 offen lds
    s_add_u32 s34, s34, 4096
    s_add_u32 s39, s39, s37
    s_mov_b32 m0, s34
    s_nop 0
    buffer_load_dwordx4 v19, s[12:15], s39 offen lds
    s_add_u32 s34, s34, 4096
    s_sub_u32 s39, s39, s37
    s_add_u32 s39, s39, 128
    s_mov_b32 m0, s34
    s_nop 0
    buffer_load_dwordx4 v19, s[12:15], s39 offen lds
    s_add_u32 s34, s34, 4096
    s_add_u32 s39, s39, s37
    s_mov_b32 m0, s34
    s_nop 0
    buffer_load_dwordx4 v19, s[12:15], s39 offen lds
    s_lshl_b32 s36, s17, 3
    s_add_u32 s36, s36, 192
    s_mul_i32 s39, s36, s27
    s_add_u32 s39, s39, s26
    s_lshl_b32 s34, s17, 10
    s_add_u32 s34, s34, 73728
    s_lshl_b32 s37, s27, 5
    s_mov_b32 m0, s34
    s_nop 0
    buffer_load_dwordx4 v19, s[12:15], s39 offen lds
    s_add_u32 s34, s34, 4096
    s_add_u32 s39, s39, s37
    s_mov_b32 m0, s34
    s_nop 0
    buffer_load_dwordx4 v19, s[12:15], s39 offen lds
    s_add_u32 s34, s34, 4096
    s_sub_u32 s39, s39, s37
    s_add_u32 s39, s39, 128
    s_mov_b32 m0, s34
    s_nop 0
    buffer_load_dwordx4 v19, s[12:15], s39 offen lds
    s_add_u32 s34, s34, 4096
    s_add_u32 s39, s39, s37
    s_mov_b32 m0, s34
    s_nop 0
    buffer_load_dwordx4 v19, s[12:15], s39 offen lds
    s_add_u32 s34, s34, 4096
    s_sub_u32 s39, s39, s37
    s_add_u32 s39, s39, 128
    s_mov_b32 m0, s34
    s_nop 0
    buffer_load_dwordx4 v19, s[12:15], s39 offen lds
    s_add_u32 s34, s34, 4096
    s_add_u32 s39, s39, s37
    s_mov_b32 m0, s34
    s_nop 0
    buffer_load_dwordx4 v19, s[12:15], s39 offen lds
    s_lshl_b32 s36, s17, 3
    s_add_u32 s36, s36, 256
    s_mul_i32 s39, s36, s27
    s_add_u32 s39, s39, s26
    s_lshl_b32 s34, s17, 10
    s_add_u32 s34, s34, 98304
    s_lshl_b32 s37, s27, 5
    s_mov_b32 m0, s34
    s_nop 0
    buffer_load_dwordx4 v19, s[12:15], s39 offen lds
    s_add_u32 s34, s34, 4096
    s_add_u32 s39, s39, s37
    s_mov_b32 m0, s34
    s_nop 0
    buffer_load_dwordx4 v19, s[12:15], s39 offen lds
    s_add_u32 s34, s34, 4096
    s_sub_u32 s39, s39, s37
    s_add_u32 s39, s39, 128
    s_mov_b32 m0, s34
    s_nop 0
    buffer_load_dwordx4 v19, s[12:15], s39 offen lds
    s_add_u32 s34, s34, 4096
    s_add_u32 s39, s39, s37
    s_mov_b32 m0, s34
    s_nop 0
    buffer_load_dwordx4 v19, s[12:15], s39 offen lds
    s_add_u32 s34, s34, 4096
    s_sub_u32 s39, s39, s37
    s_add_u32 s39, s39, 128
    s_mov_b32 m0, s34
    s_nop 0
    buffer_load_dwordx4 v19, s[12:15], s39 offen lds
    s_add_u32 s34, s34, 4096
    s_add_u32 s39, s39, s37
    s_mov_b32 m0, s34
    s_nop 0
    buffer_load_dwordx4 v19, s[12:15], s39 offen lds
    s_lshl_b32 s36, s17, 3
    s_add_u32 s36, s36, 320
    s_mul_i32 s39, s36, s27
    s_add_u32 s39, s39, s26
    s_lshl_b32 s34, s17, 10
    s_add_u32 s34, s34, 122880
    s_lshl_b32 s37, s27, 5
    s_mov_b32 m0, s34
    s_nop 0
    buffer_load_dwordx4 v19, s[12:15], s39 offen lds
    s_add_u32 s34, s34, 4096
    s_add_u32 s39, s39, s37
    s_mov_b32 m0, s34
    s_nop 0
    buffer_load_dwordx4 v19, s[12:15], s39 offen lds
    s_add_u32 s34, s34, 4096
    s_sub_u32 s39, s39, s37
    s_add_u32 s39, s39, 128
    s_mov_b32 m0, s34
    s_nop 0
    buffer_load_dwordx4 v19, s[12:15], s39 offen lds
    s_add_u32 s34, s34, 4096
    s_add_u32 s39, s39, s37
    s_mov_b32 m0, s34
    s_nop 0
    buffer_load_dwordx4 v19, s[12:15], s39 offen lds
    s_add_u32 s34, s34, 4096
    s_sub_u32 s39, s39, s37
    s_add_u32 s39, s39, 128
    s_mov_b32 m0, s34
    s_nop 0
    buffer_load_dwordx4 v19, s[12:15], s39 offen lds
    s_add_u32 s34, s34, 4096
    s_add_u32 s39, s39, s37
    s_mov_b32 m0, s34
    s_nop 0
    buffer_load_dwordx4 v19, s[12:15], s39 offen lds
    s_waitcnt vmcnt(0)
    s_barrier
    ds_read_b64_tr_b16 a[0:1], v16 offset:0
    ds_read_b64_tr_b16 a[2:3], v16 offset:512
    ds_read_b64_tr_b16 a[72:73], v17 offset:0
    ds_read_b64_tr_b16 a[74:75], v17 offset:512
    ds_read_b64_tr_b16 a[144:145], v18 offset:0
    ds_read_b64_tr_b16 a[146:147], v18 offset:512
    ds_read_b64_tr_b16 a[4:5], v16 offset:4096
    ds_read_b64_tr_b16 a[6:7], v16 offset:4608
    ds_read_b64_tr_b16 a[76:77], v17 offset:4096
    ds_read_b64_tr_b16 a[78:79], v17 offset:4608
    ds_read_b64_tr_b16 a[148:149], v18 offset:4096
    ds_read_b64_tr_b16 a[150:151], v18 offset:4608
    s_waitcnt lgkmcnt(0)
    ds_read_b64_tr_b16 a[8:9], v16 offset:24576
    ds_read_b64_tr_b16 a[10:11], v16 offset:25088
    ds_read_b64_tr_b16 a[80:81], v17 offset:24576
    ds_read_b64_tr_b16 a[82:83], v17 offset:25088
    ds_read_b64_tr_b16 a[152:153], v18 offset:24576
    ds_read_b64_tr_b16 a[154:155], v18 offset:25088
    ds_read_b64_tr_b16 a[12:13], v16 offset:28672
    ds_read_b64_tr_b16 a[14:15], v16 offset:29184
    ds_read_b64_tr_b16 a[84:85], v17 offset:28672
    ds_read_b64_tr_b16 a[86:87], v17 offset:29184
    ds_read_b64_tr_b16 a[156:157], v18 offset:28672
    ds_read_b64_tr_b16 a[158:159], v18 offset:29184
    s_waitcnt lgkmcnt(0)
    ds_read_b64_tr_b16 a[16:17], v16 offset:49152
    ds_read_b64_tr_b16 a[18:19], v16 offset:49664
    ds_read_b64_tr_b16 a[88:89], v17 offset:49152
    ds_read_b64_tr_b16 a[90:91], v17 offset:49664
    ds_read_b64_tr_b16 a[160:161], v18 offset:49152
    ds_read_b64_tr_b16 a[162:163], v18 offset:49664
    ds_read_b64_tr_b16 a[20:21], v16 offset:53248
    ds_read_b64_tr_b16 a[22:23], v16 offset:53760
    ds_read_b64_tr_b16 a[92:93], v17 offset:53248
    ds_read_b64_tr_b16 a[94:95], v17 offset:53760
    ds_read_b64_tr_b16 a[164:165], v18 offset:53248
    ds_read_b64_tr_b16 a[166:167], v18 offset:53760
    s_waitcnt lgkmcnt(0)
    v_add_u32 v5, 65536, v16
    ds_read_b64_tr_b16 a[24:25], v5 offset:8192
    v_add_u32 v5, 65536, v16
    ds_read_b64_tr_b16 a[26:27], v5 offset:8704
    v_add_u32 v5, 65536, v17
    ds_read_b64_tr_b16 a[96:97], v5 offset:8192
    v_add_u32 v5, 65536, v17
    ds_read_b64_tr_b16 a[98:99], v5 offset:8704
    v_add_u32 v5, 65536, v18
    ds_read_b64_tr_b16 a[168:169], v5 offset:8192
    v_add_u32 v5, 65536, v18
    ds_read_b64_tr_b16 a[170:171], v5 offset:8704
    v_add_u32 v5, 65536, v16
    ds_read_b64_tr_b16 a[28:29], v5 offset:12288
    v_add_u32 v5, 65536, v16
    ds_read_b64_tr_b16 a[30:31], v5 offset:12800
    v_add_u32 v5, 65536, v17
    ds_read_b64_tr_b16 a[100:101], v5 offset:12288
    v_add_u32 v5, 65536, v17
    ds_read_b64_tr_b16 a[102:103], v5 offset:12800
    v_add_u32 v5, 65536, v18
    ds_read_b64_tr_b16 a[172:173], v5 offset:12288
    v_add_u32 v5, 65536, v18
    ds_read_b64_tr_b16 a[174:175], v5 offset:12800
    s_waitcnt lgkmcnt(0)
    v_add_u32 v5, 65536, v16
    ds_read_b64_tr_b16 a[32:33], v5 offset:32768
    v_add_u32 v5, 65536, v16
    ds_read_b64_tr_b16 a[34:35], v5 offset:33280
    v_add_u32 v5, 65536, v17
    ds_read_b64_tr_b16 a[104:105], v5 offset:32768
    v_add_u32 v5, 65536, v17
    ds_read_b64_tr_b16 a[106:107], v5 offset:33280
    v_add_u32 v5, 65536, v18
    ds_read_b64_tr_b16 a[176:177], v5 offset:32768
    v_add_u32 v5, 65536, v18
    ds_read_b64_tr_b16 a[178:179], v5 offset:33280
    v_add_u32 v5, 65536, v16
    ds_read_b64_tr_b16 a[36:37], v5 offset:36864
    v_add_u32 v5, 65536, v16
    ds_read_b64_tr_b16 a[38:39], v5 offset:37376
    v_add_u32 v5, 65536, v17
    ds_read_b64_tr_b16 a[108:109], v5 offset:36864
    v_add_u32 v5, 65536, v17
    ds_read_b64_tr_b16 a[110:111], v5 offset:37376
    v_add_u32 v5, 65536, v18
    ds_read_b64_tr_b16 a[180:181], v5 offset:36864
    v_add_u32 v5, 65536, v18
    ds_read_b64_tr_b16 a[182:183], v5 offset:37376
    s_waitcnt lgkmcnt(0)
    v_add_u32 v5, 65536, v16
    ds_read_b64_tr_b16 a[40:41], v5 offset:57344
    v_add_u32 v5, 65536, v16
    ds_read_b64_tr_b16 a[42:43], v5 offset:57856
    v_add_u32 v5, 65536, v17
    ds_read_b64_tr_b16 a[112:113], v5 offset:57344
    v_add_u32 v5, 65536, v17
    ds_read_b64_tr_b16 a[114:115], v5 offset:57856
    v_add_u32 v5, 65536, v18
    ds_read_b64_tr_b16 a[184:185], v5 offset:57344
    v_add_u32 v5, 65536, v18
    ds_read_b64_tr_b16 a[186:187], v5 offset:57856
    v_add_u32 v5, 65536, v16
    ds_read_b64_tr_b16 a[44:45], v5 offset:61440
    v_add_u32 v5, 65536, v16
    ds_read_b64_tr_b16 a[46:47], v5 offset:61952
    v_add_u32 v5, 65536, v17
    ds_read_b64_tr_b16 a[116:117], v5 offset:61440
    v_add_u32 v5, 65536, v17
    ds_read_b64_tr_b16 a[118:119], v5 offset:61952
    v_add_u32 v5, 65536, v18
    ds_read_b64_tr_b16 a[188:189], v5 offset:61440
    v_add_u32 v5, 65536, v18
    ds_read_b64_tr_b16 a[190:191], v5 offset:61952
    s_waitcnt lgkmcnt(0)
    s_barrier
    s_lshl_b32 s36, s17, 3
    s_add_u32 s36, s36, 384
    s_mul_i32 s39, s36, s27
    s_add_u32 s39, s39, s26
    s_lshl_b32 s34, s17, 10
    s_add_u32 s34, s34, 0
    s_lshl_b32 s37, s27, 5
    s_mov_b32 m0, s34
    s_nop 0
    buffer_load_dwordx4 v19, s[12:15], s39 offen lds
    s_add_u32 s34, s34, 4096
    s_add_u32 s39, s39, s37
    s_mov_b32 m0, s34
    s_nop 0
    buffer_load_dwordx4 v19, s[12:15], s39 offen lds
    s_add_u32 s34, s34, 4096
    s_sub_u32 s39, s39, s37
    s_add_u32 s39, s39, 128
    s_mov_b32 m0, s34
    s_nop 0
    buffer_load_dwordx4 v19, s[12:15], s39 offen lds
    s_add_u32 s34, s34, 4096
    s_add_u32 s39, s39, s37
    s_mov_b32 m0, s34
    s_nop 0
    buffer_load_dwordx4 v19, s[12:15], s39 offen lds
    s_add_u32 s34, s34, 4096
    s_sub_u32 s39, s39, s37
    s_add_u32 s39, s39, 128
    s_mov_b32 m0, s34
    s_nop 0
    buffer_load_dwordx4 v19, s[12:15], s39 offen lds
    s_add_u32 s34, s34, 4096
    s_add_u32 s39, s39, s37
    s_mov_b32 m0, s34
    s_nop 0
    buffer_load_dwordx4 v19, s[12:15], s39 offen lds
    s_lshl_b32 s36, s17, 3
    s_add_u32 s36, s36, 448
    s_mul_i32 s39, s36, s27
    s_add_u32 s39, s39, s26
    s_lshl_b32 s34, s17, 10
    s_add_u32 s34, s34, 24576
    s_lshl_b32 s37, s27, 5
    s_mov_b32 m0, s34
    s_nop 0
    buffer_load_dwordx4 v19, s[12:15], s39 offen lds
    s_add_u32 s34, s34, 4096
    s_add_u32 s39, s39, s37
    s_mov_b32 m0, s34
    s_nop 0
    buffer_load_dwordx4 v19, s[12:15], s39 offen lds
    s_add_u32 s34, s34, 4096
    s_sub_u32 s39, s39, s37
    s_add_u32 s39, s39, 128
    s_mov_b32 m0, s34
    s_nop 0
    buffer_load_dwordx4 v19, s[12:15], s39 offen lds
    s_add_u32 s34, s34, 4096
    s_add_u32 s39, s39, s37
    s_mov_b32 m0, s34
    s_nop 0
    buffer_load_dwordx4 v19, s[12:15], s39 offen lds
    s_add_u32 s34, s34, 4096
    s_sub_u32 s39, s39, s37
    s_add_u32 s39, s39, 128
    s_mov_b32 m0, s34
    s_nop 0
    buffer_load_dwordx4 v19, s[12:15], s39 offen lds
    s_add_u32 s34, s34, 4096
    s_add_u32 s39, s39, s37
    s_mov_b32 m0, s34
    s_nop 0
    buffer_load_dwordx4 v19, s[12:15], s39 offen lds
    s_lshl_b32 s36, s17, 3
    s_add_u32 s36, s36, 512
    s_mul_i32 s39, s36, s27
    s_add_u32 s39, s39, s26
    s_lshl_b32 s34, s17, 10
    s_add_u32 s34, s34, 49152
    s_lshl_b32 s37, s27, 5
    s_mov_b32 m0, s34
    s_nop 0
    buffer_load_dwordx4 v19, s[12:15], s39 offen lds
    s_add_u32 s34, s34, 4096
    s_add_u32 s39, s39, s37
    s_mov_b32 m0, s34
    s_nop 0
    buffer_load_dwordx4 v19, s[12:15], s39 offen lds
    s_add_u32 s34, s34, 4096
    s_sub_u32 s39, s39, s37
    s_add_u32 s39, s39, 128
    s_mov_b32 m0, s34
    s_nop 0
    buffer_load_dwordx4 v19, s[12:15], s39 offen lds
    s_add_u32 s34, s34, 4096
    s_add_u32 s39, s39, s37
    s_mov_b32 m0, s34
    s_nop 0
    buffer_load_dwordx4 v19, s[12:15], s39 offen lds
    s_add_u32 s34, s34, 4096
    s_sub_u32 s39, s39, s37
    s_add_u32 s39, s39, 128
    s_mov_b32 m0, s34
    s_nop 0
    buffer_load_dwordx4 v19, s[12:15], s39 offen lds
    s_add_u32 s34, s34, 4096
    s_add_u32 s39, s39, s37
    s_mov_b32 m0, s34
    s_nop 0
    buffer_load_dwordx4 v19, s[12:15], s39 offen lds
    s_waitcnt vmcnt(0)
    s_barrier
    ds_read_b64_tr_b16 a[48:49], v16 offset:0
    ds_read_b64_tr_b16 a[50:51], v16 offset:512
    ds_read_b64_tr_b16 a[120:121], v17 offset:0
    ds_read_b64_tr_b16 a[122:123], v17 offset:512
    ds_read_b64_tr_b16 a[192:193], v18 offset:0
    ds_read_b64_tr_b16 a[194:195], v18 offset:512
    ds_read_b64_tr_b16 a[52:53], v16 offset:4096
    ds_read_b64_tr_b16 a[54:55], v16 offset:4608
    ds_read_b64_tr_b16 a[124:125], v17 offset:4096
    ds_read_b64_tr_b16 a[126:127], v17 offset:4608
    ds_read_b64_tr_b16 a[196:197], v18 offset:4096
    ds_read_b64_tr_b16 a[198:199], v18 offset:4608
    s_waitcnt lgkmcnt(0)
    ds_read_b64_tr_b16 a[56:57], v16 offset:24576
    ds_read_b64_tr_b16 a[58:59], v16 offset:25088
    ds_read_b64_tr_b16 a[128:129], v17 offset:24576
    ds_read_b64_tr_b16 a[130:131], v17 offset:25088
    ds_read_b64_tr_b16 a[200:201], v18 offset:24576
    ds_read_b64_tr_b16 a[202:203], v18 offset:25088
    ds_read_b64_tr_b16 a[60:61], v16 offset:28672
    ds_read_b64_tr_b16 a[62:63], v16 offset:29184
    ds_read_b64_tr_b16 a[132:133], v17 offset:28672
    ds_read_b64_tr_b16 a[134:135], v17 offset:29184
    ds_read_b64_tr_b16 a[204:205], v18 offset:28672
    ds_read_b64_tr_b16 a[206:207], v18 offset:29184
    s_waitcnt lgkmcnt(0)
    ds_read_b64_tr_b16 a[64:65], v16 offset:49152
    ds_read_b64_tr_b16 a[66:67], v16 offset:49664
    ds_read_b64_tr_b16 a[136:137], v17 offset:49152
    ds_read_b64_tr_b16 a[138:139], v17 offset:49664
    ds_read_b64_tr_b16 a[208:209], v18 offset:49152
    ds_read_b64_tr_b16 a[210:211], v18 offset:49664
    ds_read_b64_tr_b16 a[68:69], v16 offset:53248
    ds_read_b64_tr_b16 a[70:71], v16 offset:53760
    ds_read_b64_tr_b16 a[140:141], v17 offset:53248
    ds_read_b64_tr_b16 a[142:143], v17 offset:53760
    ds_read_b64_tr_b16 a[212:213], v18 offset:53248
    ds_read_b64_tr_b16 a[214:215], v18 offset:53760
    s_waitcnt lgkmcnt(0)
    s_barrier
    s_mov_b32 s25, 1152
    v_and_b32 v1, 63, v0
    v_and_b32 v2, 15, v1
    v_lshrrev_b32 v3, 4, v1
    v_bfe_u32 v4, v2, 1, 3
    v_xor_b32 v3, v3, v4
    v_lshlrev_b32 v3, 4, v3
    v_lshlrev_b32 v2, 7, v2
    v_add_u32 v8, v2, v3
    v_xor_b32 v9, 64, v8
    v_lshrrev_b32 v2, 3, v1
    v_mul_lo_u32 v2, v2, s25
    v_and_b32 v3, 7, v1
    v_lshrrev_b32 v4, 4, v1
    v_xor_b32 v3, v3, v4
    s_and_b32 s37, s17, 1
    s_lshl_b32 s34, s37, 2
    v_xor_b32 v3, s34, v3
    v_lshlrev_b32 v3, 4, v3
    v_add_u32 v12, v2, v3
Lp_f1_l:
    s_lshl_b32 s67, s65, 2
    s_lshl_b32 s67, s67, 8
    s_add_u32 s67, s67, 1687552
    s_cmp_lg_u32 s17, 0
    s_cbranch_scc1 Lw_70
    v_and_b32 v2, 63, v0
    v_lshlrev_b32 v2, 8, v2
    s_mov_b64 exec, 0xf
    s_mov_b32 s70, 0
Lw_68:
    buffer_load_dword v3, v2, s[4:7], s67 offen sc1
    s_waitcnt vmcnt(0)
    v_readlane_b32 s69, v3, 0
    v_readlane_b32 s20, v3, 1
    s_nop 2
    s_add_u32 s69, s69, s20
    v_readlane_b32 s20, v3, 2
    s_nop 2
    s_add_u32 s69, s69, s20
    v_readlane_b32 s20, v3, 3
    s_nop 2
    s_add_u32 s69, s69, s20
    s_cmp_ge_u32 s69, 16
    s_cbranch_scc1 Lw_69
    s_cmp_ge_u32 s70, 2
    s_cbranch_scc1 Lb_71
    s_cmp_ge_u32 s65, 28
    s_cbranch_scc1 Lb_71
    s_sleep 24
Lb_71:
    s_sleep 2
    s_add_u32 s70, s70, 1
    s_cmp_lt_u32 s70, 524288
    s_cbranch_scc1 Lw_68
    s_branch Lfail
Lw_69:
    s_mov_b64 exec, -1
Lw_70:
    s_barrier
    s_mov_b32 s8, s4
    s_mov_b32 s9, s5
    s_mov_b32 s10, s6
    s_mov_b32 s11, s7
    s_lshl_b32 s52, s65, 6
    s_mul_i32 s24, s52, 1152
    s_mul_i32 s54, s78, 1152
    s_add_u32 s24, s24, s54
    s_add_u32 s24, s24, 92274688
    s_lshl_b32 s36, s17, 3
    s_mul_i32 s36, s36, s25
    s_add_u32 s36, s36, s24
    s_lshl_b32 s37, s25, 5
    s_lshl_b32 s39, s17, 10
    s_add_u32 s38, s36, 0
    s_add_u32 s34, s39, 0
    s_mov_b32 m0, s34
    s_nop 0
    buffer_load_dwordx4 v12, s[8:11], s38 offen sc1 lds
    s_add_u32 s38, s38, s37
    s_add_u32 s34, s34, 4096
    s_mov_b32 m0, s34
    s_nop 0
    buffer_load_dwordx4 v12, s[8:11], s38 offen sc1 lds
    s_add_u32 s38, s36, 128
    s_add_u32 s34, s39, 8192
    s_mov_b32 m0, s34
    s_nop 0
    buffer_load_dwordx4 v12, s[8:11], s38 offen sc1 lds
    s_add_u32 s38, s38, s37
    s_add_u32 s34, s34, 4096
    s_mov_b32 m0, s34
    s_nop 0
    buffer_load_dwordx4 v12, s[8:11], s38 offen sc1 lds
    s_add_u32 s38, s36, 256
    s_add_u32 s34, s39, 16384
    s_mov_b32 m0, s34
    s_nop 0
    buffer_load_dwordx4 v12, s[8:11], s38 offen sc1 lds
    s_add_u32 s38, s38, s37
    s_add_u32 s34, s34, 4096
    s_mov_b32 m0, s34
    s_nop 0
    buffer_load_dwordx4 v12, s[8:11], s38 offen sc1 lds
    s_add_u32 s38, s36, 384
    s_add_u32 s34, s39, 24576
    s_mov_b32 m0, s34
    s_nop 0
    buffer_load_dwordx4 v12, s[8:11], s38 offen sc1 lds
    s_add_u32 s38, s38, s37
    s_add_u32 s34, s34, 4096
    s_mov_b32 m0, s34
    s_nop 0
    buffer_load_dwordx4 v12, s[8:11], s38 offen sc1 lds
    s_add_u32 s38, s36, 512
    s_add_u32 s34, s39, 32768
    s_mov_b32 m0, s34
    s_nop 0
    buffer_load_dwordx4 v12, s[8:11], s38 offen sc1 lds
    s_add_u32 s38, s38, s37
    s_add_u32 s34, s34, 4096
    s_mov_b32 m0, s34
    s_nop 0
    buffer_load_dwordx4 v12, s[8:11], s38 offen sc1 lds
    s_add_u32 s38, s36, 640
    s_add_u32 s34, s39, 40960
    s_mov_b32 m0, s34
    s_nop 0
    buffer_load_dwordx4 v12, s[8:11], s38 offen sc1 lds
    s_add_u32 s38, s38, s37
    s_add_u32 s34, s34, 4096
    s_mov_b32 m0, s34
    s_nop 0
    buffer_load_dwordx4 v12, s[8:11], s38 offen sc1 lds
    s_add_u32 s38, s36, 768
    s_add_u32 s34, s39, 49152
    s_mov_b32 m0, s34
    s_nop 0
    buffer_load_dwordx4 v12, s[8:11], s38 offen sc1 lds
    s_add_u32 s38, s38, s37
    s_add_u32 s34, s34, 4096
    s_mov_b32 m0, s34
    s_nop 0
    buffer_load_dwordx4 v12, s[8:11], s38 offen sc1 lds
    s_add_u32 s38, s36, 896
    s_add_u32 s34, s39, 57344
    s_mov_b32 m0, s34
    s_nop 0
    buffer_load_dwordx4 v12, s[8:11], s38 offen sc1 lds
    s_add_u32 s38, s38, s37
    s_add_u32 s34, s34, 4096
    s_mov_b32 m0, s34
    s_nop 0
    buffer_load_dwordx4 v12, s[8:11], s38 offen sc1 lds
    s_add_u32 s38, s36, 1024
    s_add_u32 s34, s39, 65536
    s_mov_b32 m0, s34
    s_nop 0
    buffer_load_dwordx4 v12, s[8:11], s38 offen sc1 lds
    s_add_u32 s38, s38, s37
    s_add_u32 s34, s34, 4096
    s_mov_b32 m0, s34
    s_nop 0
    buffer_load_dwordx4 v12, s[8:11], s38 offen sc1 lds
    v_mov_b64 v[128:129], 0
    v_mov_b64 v[130:131], 0
    v_mov_b64 v[132:133], 0
    v_mov_b64 v[134:135], 0
    v_mov_b64 v[136:137], 0
    v_mov_b64 v[138:139], 0
    v_mov_b64 v[140:141], 0
    v_mov_b64 v[142:143], 0
    v_mov_b64 v[144:145], 0
    v_mov_b64 v[146:147], 0
    v_mov_b64 v[148:149], 0
    v_mov_b64 v[150:151], 0
    v_mov_b64 v[152:153], 0
    v_mov_b64 v[154:155], 0
    v_mov_b64 v[156:157], 0
    v_mov_b64 v[158:159], 0
    v_mov_b64 v[160:161], 0
    v_mov_b64 v[162:163], 0
    v_mov_b64 v[164:165], 0
    v_mov_b64 v[166:167], 0
    v_mov_b64 v[168:169], 0
    v_mov_b64 v[170:171], 0
    v_mov_b64 v[172:173], 0
    v_mov_b64 v[174:175], 0
    v_add_u32 v10, 65536, v8
    v_add_u32 v11, 65536, v9
    s_waitcnt vmcnt(16)
    s_barrier
    ds_read_b128 v[32:35], v8 offset:0
    ds_read_b128 v[36:39], v8 offset:2048
    ds_read_b128 v[40:43], v8 offset:4096
    ds_read_b128 v[44:47], v8 offset:6144
    s_waitcnt lgkmcnt(0)
    v_mfma_f32_16x16x32_bf16 v[128:131], a[0:3], v[32:35], v[128:131]
    v_mfma_f32_16x16x32_bf16 v[132:135], a[72:75], v[32:35], v[132:135]
    ds_read_b128 v[64:67], v9 offset:0
    v_mfma_f32_16x16x32_bf16 v[136:139], a[144:147], v[32:35], v[136:139]
    v_mfma_f32_16x16x32_bf16 v[140:143], a[0:3], v[36:39], v[140:143]
    ds_read_b128 v[68:71], v9 offset:2048
    v_mfma_f32_16x16x32_bf16 v[144:147], a[72:75], v[36:39], v[144:147]
    v_mfma_f32_16x16x32_bf16 v[148:151], a[144:147], v[36:39], v[148:151]
    ds_read_b128 v[72:75], v9 offset:4096
    v_mfma_f32_16x16x32_bf16 v[152:155], a[0:3], v[40:43], v[152:155]
    v_mfma_f32_16x16x32_bf16 v[156:159], a[72:75], v[40:43], v[156:159]
    ds_read_b128 v[76:79], v9 offset:6144
    v_mfma_f32_16x16x32_bf16 v[160:163], a[144:147], v[40:43], v[160:163]
    v_mfma_f32_16x16x32_bf16 v[164:167], a[0:3], v[44:47], v[164:167]
    v_mfma_f32_16x16x32_bf16 v[168:171], a[72:75], v[44:47], v[168:171]
    v_mfma_f32_16x16x32_bf16 v[172:175], a[144:147], v[44:47], v[172:175]
    s_waitcnt lgkmcnt(0)
    v_mfma_f32_16x16x32_bf16 v[128:131], a[4:7], v[64:67], v[128:131]
    v_mfma_f32_16x16x32_bf16 v[132:135], a[76:79], v[64:67], v[132:135]
    s_waitcnt vmcnt(14)
    v_mfma_f32_16x16x32_bf16 v[136:139], a[148:151], v[64:67], v[136:139]
    v_mfma_f32_16x16x32_bf16 v[140:143], a[4:7], v[68:71], v[140:143]
    s_barrier
    v_mfma_f32_16x16x32_bf16 v[144:147], a[76:79], v[68:71], v[144:147]
    v_mfma_f32_16x16x32_bf16 v[148:151], a[148:151], v[68:71], v[148:151]
    ds_read_b128 v[32:35], v8 offset:8192
    v_mfma_f32_16x16x32_bf16 v[152:155], a[4:7], v[72:75], v[152:155]
    v_mfma_f32_16x16x32_bf16 v[156:159], a[76:79], v[72:75], v[156:159]
    ds_read_b128 v[36:39], v8 offset:10240
    v_mfma_f32_16x16x32_bf16 v[160:163], a[148:151], v[72:75], v[160:163]
    v_mfma_f32_16x16x32_bf16 v[164:167], a[4:7], v[76:79], v[164:167]
    ds_read_b128 v[40:43], v8 offset:12288
    v_mfma_f32_16x16x32_bf16 v[168:171], a[76:79], v[76:79], v[168:171]
    v_mfma_f32_16x16x32_bf16 v[172:175], a[148:151], v[76:79], v[172:175]
    ds_read_b128 v[44:47], v8 offset:14336
    s_waitcnt lgkmcnt(0)
    v_mfma_f32_16x16x32_bf16 v[128:131], a[8:11], v[32:35], v[128:131]
    v_mfma_f32_16x16x32_bf16 v[132:135], a[80:83], v[32:35], v[132:135]
    ds_read_b128 v[64:67], v9 offset:8192
    v_mfma_f32_16x16x32_bf16 v[136:139], a[152:155], v[32:35], v[136:139]
    v_mfma_f32_16x16x32_bf16 v[140:143], a[8:11], v[36:39], v[140:143]
    ds_read_b128 v[68:71], v9 offset:10240
    v_mfma_f32_16x16x32_bf16 v[144:147], a[80:83], v[36:39], v[144:147]
    v_mfma_f32_16x16x32_bf16 v[148:151], a[152:155], v[36:39], v[148:151]
    ds_read_b128 v[72:75], v9 offset:12288
    v_mfma_f32_16x16x32_bf16 v[152:155], a[8:11], v[40:43], v[152:155]
    v_mfma_f32_16x16x32_bf16 v[156:159], a[80:83], v[40:43], v[156:159]
    ds_read_b128 v[76:79], v9 offset:14336
    v_mfma_f32_16x16x32_bf16 v[160:163], a[152:155], v[40:43], v[160:163]
    v_mfma_f32_16x16x32_bf16 v[164:167], a[8:11], v[44:47], v[164:167]
    v_mfma_f32_16x16x32_bf16 v[168:171], a[80:83], v[44:47], v[168:171]
    v_mfma_f32_16x16x32_bf16 v[172:175], a[152:155], v[44:47], v[172:175]
    s_waitcnt lgkmcnt(0)
    v_mfma_f32_16x16x32_bf16 v[128:131], a[12:15], v[64:67], v[128:131]
    v_mfma_f32_16x16x32_bf16 v[132:135], a[84:87], v[64:67], v[132:135]
    s_waitcnt vmcnt(12)
    v_mfma_f32_16x16x32_bf16 v[136:139], a[156:159], v[64:67], v[136:139]
    v_mfma_f32_16x16x32_bf16 v[140:143], a[12:15], v[68:71], v[140:143]
    s_barrier
    v_mfma_f32_16x16x32_bf16 v[144:147], a[84:87], v[68:71], v[144:147]
    v_mfma_f32_16x16x32_bf16 v[148:151], a[156:159], v[68:71], v[148:151]
    ds_read_b128 v[32:35], v8 offset:16384
    v_mfma_f32_16x16x32_bf16 v[152:155], a[12:15], v[72:75], v[152:155]
    v_mfma_f32_16x16x32_bf16 v[156:159], a[84:87], v[72:75], v[156:159]
    ds_read_b128 v[36:39], v8 offset:18432
    v_mfma_f32_16x16x32_bf16 v[160:163], a[156:159], v[72:75], v[160:163]
    v_mfma_f32_16x16x32_bf16 v[164:167], a[12:15], v[76:79], v[164:167]
    ds_read_b128 v[40:43], v8 offset:20480
    v_mfma_f32_16x16x32_bf16 v[168:171], a[84:87], v[76:79], v[168:171]
    v_mfma_f32_16x16x32_bf16 v[172:175], a[156:159], v[76:79], v[172:175]
    ds_read_b128 v[44:47], v8 offset:22528
    s_waitcnt lgkmcnt(0)
    v_mfma_f32_16x16x32_bf16 v[128:131], a[16:19], v[32:35], v[128:131]
    v_mfma_f32_16x16x32_bf16 v[132:135], a[88:91], v[32:35], v[132:135]
    ds_read_b128 v[64:67], v9 offset:16384
    v_mfma_f32_16x16x32_bf16 v[136:139], a[160:163], v[32:35], v[136:139]
    v_mfma_f32_16x16x32_bf16 v[140:143], a[16:19], v[36:39], v[140:143]
    ds_read_b128 v[68:71], v9 offset:18432
    v_mfma_f32_16x16x32_bf16 v[144:147], a[88:91], v[36:39], v[144:147]
    v_mfma_f32_16x16x32_bf16 v[148:151], a[160:163], v[36:39], v[148:151]
    ds_read_b128 v[72:75], v9 offset:20480
    v_mfma_f32_16x16x32_bf16 v[152:155], a[16:19], v[40:43], v[152:155]
    v_mfma_f32_16x16x32_bf16 v[156:159], a[88:91], v[40:43], v[156:159]
    ds_read_b128 v[76:79], v9 offset:22528
    v_mfma_f32_16x16x32_bf16 v[160:163], a[160:163], v[40:43], v[160:163]
    v_mfma_f32_16x16x32_bf16 v[164:167], a[16:19], v[44:47], v[164:167]
    v_mfma_f32_16x16x32_bf16 v[168:171], a[88:91], v[44:47], v[168:171]
    v_mfma_f32_16x16x32_bf16 v[172:175], a[160:163], v[44:47], v[172:175]
    s_waitcnt lgkmcnt(0)
    v_mfma_f32_16x16x32_bf16 v[128:131], a[20:23], v[64:67], v[128:131]
    v_mfma_f32_16x16x32_bf16 v[132:135], a[92:95], v[64:67], v[132:135]
    s_waitcnt vmcnt(10)
    v_mfma_f32_16x16x32_bf16 v[136:139], a[164:167], v[64:67], v[136:139]
    v_mfma_f32_16x16x32_bf16 v[140:143], a[20:23], v[68:71], v[140:143]
    s_barrier
    v_mfma_f32_16x16x32_bf16 v[144:147], a[92:95], v[68:71], v[144:147]
    v_mfma_f32_16x16x32_bf16 v[148:151], a[164:167], v[68:71], v[148:151]
    ds_read_b128 v[32:35], v8 offset:24576
    v_mfma_f32_16x16x32_bf16 v[152:155], a[20:23], v[72:75], v[152:155]
    v_mfma_f32_16x16x32_bf16 v[156:159], a[92:95], v[72:75], v[156:159]
    ds_read_b128 v[36:39], v8 offset:26624
    v_mfma_f32_16x16x32_bf16 v[160:163], a[164:167], v[72:75], v[160:163]
    v_mfma_f32_16x16x32_bf16 v[164:167], a[20:23], v[76:79], v[164:167]
    ds_read_b128 v[40:43], v8 offset:28672
    v_mfma_f32_16x16x32_bf16 v[168:171], a[92:95], v[76:79], v[168:171]
    v_mfma_f32_16x16x32_bf16 v[172:175], a[164:167], v[76:79], v[172:175]
    ds_read_b128 v[44:47], v8 offset:30720
    s_waitcnt lgkmcnt(0)
    v_mfma_f32_16x16x32_bf16 v[128:131], a[24:27], v[32:35], v[128:131]
    v_mfma_f32_16x16x32_bf16 v[132:135], a[96:99], v[32:35], v[132:135]
    ds_read_b128 v[64:67], v9 offset:24576
    v_mfma_f32_16x16x32_bf16 v[136:139], a[168:171], v[32:35], v[136:139]
    v_mfma_f32_16x16x32_bf16 v[140:143], a[24:27], v[36:39], v[140:143]
    ds_read_b128 v[68:71], v9 offset:26624
    v_mfma_f32_16x16x32_bf16 v[144:147], a[96:99], v[36:39], v[144:147]
    v_mfma_f32_16x16x32_bf16 v[148:151], a[168:171], v[36:39], v[148:151]
    ds_read_b128 v[72:75], v9 offset:28672
    v_mfma_f32_16x16x32_bf16 v[152:155], a[24:27], v[40:43], v[152:155]
    v_mfma_f32_16x16x32_bf16 v[156:159], a[96:99], v[40:43], v[156:159]
    ds_read_b128 v[76:79], v9 offset:30720
    v_mfma_f32_16x16x32_bf16 v[160:163], a[168:171], v[40:43], v[160:163]
    v_mfma_f32_16x16x32_bf16 v[164:167], a[24:27], v[44:47], v[164:167]
    v_mfma_f32_16x16x32_bf16 v[168:171], a[96:99], v[44:47], v[168:171]
    v_mfma_f32_16x16x32_bf16 v[172:175], a[168:171], v[44:47], v[172:175]
    s_waitcnt lgkmcnt(0)
    v_mfma_f32_16x16x32_bf16 v[128:131], a[28:31], v[64:67], v[128:131]
    v_mfma_f32_16x16x32_bf16 v[132:135], a[100:103], v[64:67], v[132:135]
    s_waitcnt vmcnt(8)
    v_mfma_f32_16x16x32_bf16 v[136:139], a[172:175], v[64:67], v[136:139]
    v_mfma_f32_16x16x32_bf16 v[140:143], a[28:31], v[68:71], v[140:143]
    s_barrier
    v_mfma_f32_16x16x32_bf16 v[144:147], a[100:103], v[68:71], v[144:147]
    v_mfma_f32_16x16x32_bf16 v[148:151], a[172:175], v[68:71], v[148:151]
    ds_read_b128 v[32:35], v8 offset:32768
    v_mfma_f32_16x16x32_bf16 v[152:155], a[28:31], v[72:75], v[152:155]
    v_mfma_f32_16x16x32_bf16 v[156:159], a[100:103], v[72:75], v[156:159]
    ds_read_b128 v[36:39], v8 offset:34816
    v_mfma_f32_16x16x32_bf16 v[160:163], a[172:175], v[72:75], v[160:163]
    v_mfma_f32_16x16x32_bf16 v[164:167], a[28:31], v[76:79], v[164:167]
    ds_read_b128 v[40:43], v8 offset:36864
    v_mfma_f32_16x16x32_bf16 v[168:171], a[100:103], v[76:79], v[168:171]
    v_mfma_f32_16x16x32_bf16 v[172:175], a[172:175], v[76:79], v[172:175]
    ds_read_b128 v[44:47], v8 offset:38912
    s_waitcnt lgkmcnt(0)
    v_mfma_f32_16x16x32_bf16 v[128:131], a[32:35], v[32:35], v[128:131]
    v_mfma_f32_16x16x32_bf16 v[132:135], a[104:107], v[32:35], v[132:135]
    ds_read_b128 v[64:67], v9 offset:32768
    v_mfma_f32_16x16x32_bf16 v[136:139], a[176:179], v[32:35], v[136:139]
    v_mfma_f32_16x16x32_bf16 v[140:143], a[32:35], v[36:39], v[140:143]
    ds_read_b128 v[68:71], v9 offset:34816
    v_mfma_f32_16x16x32_bf16 v[144:147], a[104:107], v[36:39], v[144:147]
    v_mfma_f32_16x16x32_bf16 v[148:151], a[176:179], v[36:39], v[148:151]
    ds_read_b128 v[72:75], v9 offset:36864
    v_mfma_f32_16x16x32_bf16 v[152:155], a[32:35], v[40:43], v[152:155]
    v_mfma_f32_16x16x32_bf16 v[156:159], a[104:107], v[40:43], v[156:159]
    ds_read_b128 v[76:79], v9 offset:38912
    v_mfma_f32_16x16x32_bf16 v[160:163], a[176:179], v[40:43], v[160:163]
    v_mfma_f32_16x16x32_bf16 v[164:167], a[32:35], v[44:47], v[164:167]
    v_mfma_f32_16x16x32_bf16 v[168:171], a[104:107], v[44:47], v[168:171]
    v_mfma_f32_16x16x32_bf16 v[172:175], a[176:179], v[44:47], v[172:175]
    s_waitcnt lgkmcnt(0)
    v_mfma_f32_16x16x32_bf16 v[128:131], a[36:39], v[64:67], v[128:131]
    v_mfma_f32_16x16x32_bf16 v[132:135], a[108:111], v[64:67], v[132:135]
    s_waitcnt vmcnt(6)
    v_mfma_f32_16x16x32_bf16 v[136:139], a[180:183], v[64:67], v[136:139]
    v_mfma_f32_16x16x32_bf16 v[140:143], a[36:39], v[68:71], v[140:143]
    s_barrier
    v_mfma_f32_16x16x32_bf16 v[144:147], a[108:111], v[68:71], v[144:147]
    v_mfma_f32_16x16x32_bf16 v[148:151], a[180:183], v[68:71], v[148:151]
    ds_read_b128 v[32:35], v8 offset:40960
    v_mfma_f32_16x16x32_bf16 v[152:155], a[36:39], v[72:75], v[152:155]
    v_mfma_f32_16x16x32_bf16 v[156:159], a[108:111], v[72:75], v[156:159]
    ds_read_b128 v[36:39], v8 offset:43008
    v_mfma_f32_16x16x32_bf16 v[160:163], a[180:183], v[72:75], v[160:163]
    v_mfma_f32_16x16x32_bf16 v[164:167], a[36:39], v[76:79], v[164:167]
    ds_read_b128 v[40:43], v8 offset:45056
    v_mfma_f32_16x16x32_bf16 v[168:171], a[108:111], v[76:79], v[168:171]
    v_mfma_f32_16x16x32_bf16 v[172:175], a[180:183], v[76:79], v[172:175]
    ds_read_b128 v[44:47], v8 offset:47104
    s_waitcnt lgkmcnt(0)
    v_mfma_f32_16x16x32_bf16 v[128:131], a[40:43], v[32:35], v[128:131]
    v_mfma_f32_16x16x32_bf16 v[132:135], a[112:115], v[32:35], v[132:135]
    ds_read_b128 v[64:67], v9 offset:40960
    v_mfma_f32_16x16x32_bf16 v[136:139], a[184:187], v[32:35], v[136:139]
    v_mfma_f32_16x16x32_bf16 v[140:143], a[40:43], v[36:39], v[140:143]
    ds_read_b128 v[68:71], v9 offset:43008
    v_mfma_f32_16x16x32_bf16 v[144:147], a[112:115], v[36:39], v[144:147]
    v_mfma_f32_16x16x32_bf16 v[148:151], a[184:187], v[36:39], v[148:151]
    ds_read_b128 v[72:75], v9 offset:45056
    v_mfma_f32_16x16x32_bf16 v[152:155], a[40:43], v[40:43], v[152:155]
    v_mfma_f32_16x16x32_bf16 v[156:159], a[112:115], v[40:43], v[156:159]
    ds_read_b128 v[76:79], v9 offset:47104
    v_mfma_f32_16x16x32_bf16 v[160:163], a[184:187], v[40:43], v[160:163]
    v_mfma_f32_16x16x32_bf16 v[164:167], a[40:43], v[44:47], v[164:167]
    v_mfma_f32_16x16x32_bf16 v[168:171], a[112:115], v[44:47], v[168:171]
    v_mfma_f32_16x16x32_bf16 v[172:175], a[184:187], v[44:47], v[172:175]
    s_waitcnt lgkmcnt(0)
    v_mfma_f32_16x16x32_bf16 v[128:131], a[44:47], v[64:67], v[128:131]
    v_mfma_f32_16x16x32_bf16 v[132:135], a[116:119], v[64:67], v[132:135]
    s_waitcnt vmcnt(4)
    v_mfma_f32_16x16x32_bf16 v[136:139], a[188:191], v[64:67], v[136:139]
    v_mfma_f32_16x16x32_bf16 v[140:143], a[44:47], v[68:71], v[140:143]
    s_barrier
    v_mfma_f32_16x16x32_bf16 v[144:147], a[116:119], v[68:71], v[144:147]
    v_mfma_f32_16x16x32_bf16 v[148:151], a[188:191], v[68:71], v[148:151]
    ds_read_b128 v[32:35], v8 offset:49152
    v_mfma_f32_16x16x32_bf16 v[152:155], a[44:47], v[72:75], v[152:155]
    v_mfma_f32_16x16x32_bf16 v[156:159], a[116:119], v[72:75], v[156:159]
    ds_read_b128 v[36:39], v8 offset:51200
    v_mfma_f32_16x16x32_bf16 v[160:163], a[188:191], v[72:75], v[160:163]
    v_mfma_f32_16x16x32_bf16 v[164:167], a[44:47], v[76:79], v[164:167]
    ds_read_b128 v[40:43], v8 offset:53248
    v_mfma_f32_16x16x32_bf16 v[168:171], a[116:119], v[76:79], v[168:171]
    v_mfma_f32_16x16x32_bf16 v[172:175], a[188:191], v[76:79], v[172:175]
    ds_read_b128 v[44:47], v8 offset:55296
    s_waitcnt lgkmcnt(0)
    v_mfma_f32_16x16x32_bf16 v[128:131], a[48:51], v[32:35], v[128:131]
    v_mfma_f32_16x16x32_bf16 v[132:135], a[120:123], v[32:35], v[132:135]
    ds_read_b128 v[64:67], v9 offset:49152
    v_mfma_f32_16x16x32_bf16 v[136:139], a[192:195], v[32:35], v[136:139]
    v_mfma_f32_16x16x32_bf16 v[140:143], a[48:51], v[36:39], v[140:143]
    ds_read_b128 v[68:71], v9 offset:51200
    v_mfma_f32_16x16x32_bf16 v[144:147], a[120:123], v[36:39], v[144:147]
    v_mfma_f32_16x16x32_bf16 v[148:151], a[192:195], v[36:39], v[148:151]
    ds_read_b128 v[72:75], v9 offset:53248
    v_mfma_f32_16x16x32_bf16 v[152:155], a[48:51], v[40:43], v[152:155]
    v_mfma_f32_16x16x32_bf16 v[156:159], a[120:123], v[40:43], v[156:159]
    ds_read_b128 v[76:79], v9 offset:55296
    v_mfma_f32_16x16x32_bf16 v[160:163], a[192:195], v[40:43], v[160:163]
    v_mfma_f32_16x16x32_bf16 v[164:167], a[48:51], v[44:47], v[164:167]
    v_mfma_f32_16x16x32_bf16 v[168:171], a[120:123], v[44:47], v[168:171]
    v_mfma_f32_16x16x32_bf16 v[172:175], a[192:195], v[44:47], v[172:175]
    s_waitcnt lgkmcnt(0)
    v_mfma_f32_16x16x32_bf16 v[128:131], a[52:55], v[64:67], v[128:131]
    v_mfma_f32_16x16x32_bf16 v[132:135], a[124:127], v[64:67], v[132:135]
    s_waitcnt vmcnt(2)
    v_mfma_f32_16x16x32_bf16 v[136:139], a[196:199], v[64:67], v[136:139]
    v_mfma_f32_16x16x32_bf16 v[140:143], a[52:55], v[68:71], v[140:143]
    s_barrier
    v_mfma_f32_16x16x32_bf16 v[144:147], a[124:127], v[68:71], v[144:147]
    v_mfma_f32_16x16x32_bf16 v[148:151], a[196:199], v[68:71], v[148:151]
    ds_read_b128 v[32:35], v8 offset:57344
    v_mfma_f32_16x16x32_bf16 v[152:155], a[52:55], v[72:75], v[152:155]
    v_mfma_f32_16x16x32_bf16 v[156:159], a[124:127], v[72:75], v[156:159]
    ds_read_b128 v[36:39], v8 offset:59392
    v_mfma_f32_16x16x32_bf16 v[160:163], a[196:199], v[72:75], v[160:163]
    v_mfma_f32_16x16x32_bf16 v[164:167], a[52:55], v[76:79], v[164:167]
    ds_read_b128 v[40:43], v8 offset:61440
    v_mfma_f32_16x16x32_bf16 v[168:171], a[124:127], v[76:79], v[168:171]
    v_mfma_f32_16x16x32_bf16 v[172:175], a[196:199], v[76:79], v[172:175]
    ds_read_b128 v[44:47], v8 offset:63488
    s_waitcnt lgkmcnt(0)
    v_mfma_f32_16x16x32_bf16 v[128:131], a[56:59], v[32:35], v[128:131]
    v_mfma_f32_16x16x32_bf16 v[132:135], a[128:131], v[32:35], v[132:135]
    ds_read_b128 v[64:67], v9 offset:57344
    v_mfma_f32_16x16x32_bf16 v[136:139], a[200:203], v[32:35], v[136:139]
    v_mfma_f32_16x16x32_bf16 v[140:143], a[56:59], v[36:39], v[140:143]
    ds_read_b128 v[68:71], v9 offset:59392
    v_mfma_f32_16x16x32_bf16 v[144:147], a[128:131], v[36:39], v[144:147]
    v_mfma_f32_16x16x32_bf16 v[148:151], a[200:203], v[36:39], v[148:151]
    ds_read_b128 v[72:75], v9 offset:61440
    v_mfma_f32_16x16x32_bf16 v[152:155], a[56:59], v[40:43], v[152:155]
    v_mfma_f32_16x16x32_bf16 v[156:159], a[128:131], v[40:43], v[156:159]
    ds_read_b128 v[76:79], v9 offset:63488
    v_mfma_f32_16x16x32_bf16 v[160:163], a[200:203], v[40:43], v[160:163]
    v_mfma_f32_16x16x32_bf16 v[164:167], a[56:59], v[44:47], v[164:167]
    v_mfma_f32_16x16x32_bf16 v[168:171], a[128:131], v[44:47], v[168:171]
    v_mfma_f32_16x16x32_bf16 v[172:175], a[200:203], v[44:47], v[172:175]
    s_waitcnt lgkmcnt(0)
    v_mfma_f32_16x16x32_bf16 v[128:131], a[60:63], v[64:67], v[128:131]
    v_mfma_f32_16x16x32_bf16 v[132:135], a[132:135], v[64:67], v[132:135]
    s_waitcnt vmcnt(0)
    v_mfma_f32_16x16x32_bf16 v[136:139], a[204:207], v[64:67], v[136:139]
    v_mfma_f32_16x16x32_bf16 v[140:143], a[60:63], v[68:71], v[140:143]
    s_barrier
    v_mfma_f32_16x16x32_bf16 v[144:147], a[132:135], v[68:71], v[144:147]
    v_mfma_f32_16x16x32_bf16 v[148:151], a[204:207], v[68:71], v[148:151]
    ds_read_b128 v[32:35], v10 offset:0
    v_mfma_f32_16x16x32_bf16 v[152:155], a[60:63], v[72:75], v[152:155]
    v_mfma_f32_16x16x32_bf16 v[156:159], a[132:135], v[72:75], v[156:159]
    ds_read_b128 v[36:39], v10 offset:2048
    v_mfma_f32_16x16x32_bf16 v[160:163], a[204:207], v[72:75], v[160:163]
    v_mfma_f32_16x16x32_bf16 v[164:167], a[60:63], v[76:79], v[164:167]
    ds_read_b128 v[40:43], v10 offset:4096
    v_mfma_f32_16x16x32_bf16 v[168:171], a[132:135], v[76:79], v[168:171]
    v_mfma_f32_16x16x32_bf16 v[172:175], a[204:207], v[76:79], v[172:175]
    ds_read_b128 v[44:47], v10 offset:6144
    s_waitcnt lgkmcnt(0)
    v_mfma_f32_16x16x32_bf16 v[128:131], a[64:67], v[32:35], v[128:131]
    v_mfma_f32_16x16x32_bf16 v[132:135], a[136:139], v[32:35], v[132:135]
    ds_read_b128 v[64:67], v11 offset:0
    v_mfma_f32_16x16x32_bf16 v[136:139], a[208:211], v[32:35], v[136:139]
    v_mfma_f32_16x16x32_bf16 v[140:143], a[64:67], v[36:39], v[140:143]
    ds_read_b128 v[68:71], v11 offset:2048
    v_mfma_f32_16x16x32_bf16 v[144:147], a[136:139], v[36:39], v[144:147]
    v_mfma_f32_16x16x32_bf16 v[148:151], a[208:211], v[36:39], v[148:151]
    ds_read_b128 v[72:75], v11 offset:4096
    v_mfma_f32_16x16x32_bf16 v[152:155], a[64:67], v[40:43], v[152:155]
    v_mfma_f32_16x16x32_bf16 v[156:159], a[136:139], v[40:43], v[156:159]
    ds_read_b128 v[76:79], v11 offset:6144
    v_mfma_f32_16x16x32_bf16 v[160:163], a[208:211], v[40:43], v[160:163]
    v_mfma_f32_16x16x32_bf16 v[164:167], a[64:67], v[44:47], v[164:167]
    v_mfma_f32_16x16x32_bf16 v[168:171], a[136:139], v[44:47], v[168:171]
    v_mfma_f32_16x16x32_bf16 v[172:175], a[208:211], v[44:47], v[172:175]
    s_waitcnt lgkmcnt(0)
    v_mfma_f32_16x16x32_bf16 v[128:131], a[68:71], v[64:67], v[128:131]
    v_mfma_f32_16x16x32_bf16 v[132:135], a[140:143], v[64:67], v[132:135]
    v_mfma_f32_16x16x32_bf16 v[136:139], a[212:215], v[64:67], v[136:139]
    v_mfma_f32_16x16x32_bf16 v[140:143], a[68:71], v[68:71], v[140:143]
    v_mfma_f32_16x16x32_bf16 v[144:147], a[140:143], v[68:71], v[144:147]
    v_mfma_f32_16x16x32_bf16 v[148:151], a[212:215], v[68:71], v[148:151]
    v_mfma_f32_16x16x32_bf16 v[152:155], a[68:71], v[72:75], v[152:155]
    v_mfma_f32_16x16x32_bf16 v[156:159], a[140:143], v[72:75], v[156:159]
    v_mfma_f32_16x16x32_bf16 v[160:163], a[212:215], v[72:75], v[160:163]
    v_mfma_f32_16x16x32_bf16 v[164:167], a[68:71], v[76:79], v[164:167]
    v_mfma_f32_16x16x32_bf16 v[168:171], a[140:143], v[76:79], v[168:171]
    v_mfma_f32_16x16x32_bf16 v[172:175], a[212:215], v[76:79], v[172:175]
    s_nop 7
    s_mov_b32 s53, 98304
    s_mov_b32 s56, 9216
    s_mul_i32 s57, s52, 9216
    s_mul_i32 s54, s79, 384
    s_add_u32 s57, s57, s54
    s_add_u32 s57, s57, 100663296
    v_and_b32 v1, 63, v0
    v_and_b32 v2, 31, v1
    v_mul_u32_u24 v2, 384, v2
    v_add_u32 v2, s53, v2
    v_lshrrev_b32 v3, 5, v1
    s_mul_i32 s36, s17, 6
    v_add_u32 v3, s36, v3
    v_and_b32 v4, 7, v1
    v_add_u32 v5, 0, v3
    v_xor_b32 v5, v5, v4
    v_lshlrev_b32 v5, 4, v5
    v_add_u32 v16, v2, v5
    v_add_u32 v5, 2, v3
    v_xor_b32 v5, v5, v4
    v_lshlrev_b32 v5, 4, v5
    v_add_u32 v17, v2, v5
    v_add_u32 v5, 4, v3
    v_xor_b32 v5, v5, v4
    v_lshlrev_b32 v5, 4, v5
    v_add_u32 v18, v2, v5
    v_max_f32 v128, 0, v128
    v_max_f32 v140, 0, v140
    v_max_f32 v129, 0, v129
    v_max_f32 v141, 0, v141
    v_max_f32 v130, 0, v130
    v_max_f32 v142, 0, v142
    v_max_f32 v131, 0, v131
    v_max_f32 v143, 0, v143
    v_cvt_pk_bf16_f32 v32, v128, v129
    v_cvt_pk_bf16_f32 v33, v130, v131
    v_cvt_pk_bf16_f32 v34, v140, v141
    v_cvt_pk_bf16_f32 v35, v142, v143
    s_nop 0
    v_permlane16_swap_b32 v32, v34
    v_permlane16_swap_b32 v33, v35
    ds_write_b128 v16, v[32:35] offset:0
    v_max_f32 v132, 0, v132
    v_max_f32 v144, 0, v144
    v_max_f32 v133, 0, v133
    v_max_f32 v145, 0, v145
    v_max_f32 v134, 0, v134
    v_max_f32 v146, 0, v146
    v_max_f32 v135, 0, v135
    v_max_f32 v147, 0, v147
    v_cvt_pk_bf16_f32 v36, v132, v133
    v_cvt_pk_bf16_f32 v37, v134, v135
    v_cvt_pk_bf16_f32 v38, v144, v145
    v_cvt_pk_bf16_f32 v39, v146, v147
    s_nop 0
    v_permlane16_swap_b32 v36, v38
    v_permlane16_swap_b32 v37, v39
    ds_write_b128 v17, v[36:39] offset:0
    v_max_f32 v136, 0, v136
    v_max_f32 v148, 0, v148
    v_max_f32 v137, 0, v137
    v_max_f32 v149, 0, v149
    v_max_f32 v138, 0, v138
    v_max_f32 v150, 0, v150
    v_max_f32 v139, 0, v139
    v_max_f32 v151, 0, v151
    v_cvt_pk_bf16_f32 v40, v136, v137
    v_cvt_pk_bf16_f32 v41, v138, v139
    v_cvt_pk_bf16_f32 v42, v148, v149
    v_cvt_pk_bf16_f32 v43, v150, v151
    s_nop 0
    v_permlane16_swap_b32 v40, v42
    v_permlane16_swap_b32 v41, v43
    ds_write_b128 v18, v[40:43] offset:0
    v_max_f32 v152, 0, v152
    v_max_f32 v164, 0, v164
    v_max_f32 v153, 0, v153
    v_max_f32 v165, 0, v165
    v_max_f32 v154, 0, v154
    v_max_f32 v166, 0, v166
    v_max_f32 v155, 0, v155
    v_max_f32 v167, 0, v167
    v_cvt_pk_bf16_f32 v44, v152, v153
    v_cvt_pk_bf16_f32 v45, v154, v155
    v_cvt_pk_bf16_f32 v46, v164, v165
    v_cvt_pk_bf16_f32 v47, v166, v167
    s_nop 0
    v_permlane16_swap_b32 v44, v46
    v_permlane16_swap_b32 v45, v47
    ds_write_b128 v16, v[44:47] offset:12288
    v_max_f32 v156, 0, v156
    v_max_f32 v168, 0, v168
    v_max_f32 v157, 0, v157
    v_max_f32 v169, 0, v169
    v_max_f32 v158, 0, v158
    v_max_f32 v170, 0, v170
    v_max_f32 v159, 0, v159
    v_max_f32 v171, 0, v171
    v_cvt_pk_bf16_f32 v48, v156, v157
    v_cvt_pk_bf16_f32 v49, v158, v159
    v_cvt_pk_bf16_f32 v50, v168, v169
    v_cvt_pk_bf16_f32 v51, v170, v171
    s_nop 0
    v_permlane16_swap_b32 v48, v50
    v_permlane16_swap_b32 v49, v51
    ds_write_b128 v17, v[48:51] offset:12288
    v_max_f32 v160, 0, v160
    v_max_f32 v172, 0, v172
    v_max_f32 v161, 0, v161
    v_max_f32 v173, 0, v173
    v_max_f32 v162, 0, v162
    v_max_f32 v174, 0, v174
    v_max_f32 v163, 0, v163
    v_max_f32 v175, 0, v175
    v_cvt_pk_bf16_f32 v52, v160, v161
    v_cvt_pk_bf16_f32 v53, v162, v163
    v_cvt_pk_bf16_f32 v54, v172, v173
    v_cvt_pk_bf16_f32 v55, v174, v175
    s_nop 0
    v_permlane16_swap_b32 v52, v54
    v_permlane16_swap_b32 v53, v55
    ds_write_b128 v18, v[52:55] offset:12288
    v_cmp_le_u32 vcc, 24, v1
    s_nop 1
    v_cndmask_b32 v2, 0, 1, vcc
    v_mul_u32_u24 v3, 24, v2
    v_sub_u32 v3, v1, v3
    s_mul_i32 s36, s17, 16
    v_xor_b32 v4, v3, v2
    v_lshlrev_b32 v4, 4, v4
    v_add_u32 v2, s36, v2
    v_mul_u32_u24 v5, 384, v2
    v_add_u32 v5, s53, v5
    v_mul_lo_u32 v2, v2, s56
    v_lshlrev_b32 v3, 4, v3
    v_add_u32 v18, v2, v3
    v_mov_b32 v2, 0x40000000
    v_cmp_gt_u32 vcc, 48, v1
    s_nop 1
    v_cndmask_b32 v18, v2, v18, vcc
    s_lshl_b32 s37, s56, 1
    s_mov_b32 s39, s57
    v_xor_b32 v3, 0, v4
    v_add_u32 v20, v5, v3
    v_xor_b32 v3, 32, v4
    v_add_u32 v21, v5, v3
    v_xor_b32 v3, 64, v4
    v_add_u32 v22, v5, v3
    v_xor_b32 v3, 96, v4
    v_add_u32 v23, v5, v3
    s_waitcnt lgkmcnt(0)
    s_barrier
    ds_read_b128 v[32:35], v20 offset:0
    ds_read_b128 v[36:39], v21 offset:768
    ds_read_b128 v[40:43], v22 offset:1536
    ds_read_b128 v[44:47], v23 offset:2304
    ds_read_b128 v[48:51], v20 offset:3072
    ds_read_b128 v[52:55], v21 offset:3840
    ds_read_b128 v[56:59], v22 offset:4608
    ds_read_b128 v[60:63], v23 offset:5376
    s_waitcnt lgkmcnt(7)
    buffer_store_dwordx4 v[32:35], v18, s[4:7], s39 offen sc1
    s_add_u32 s39, s39, s37
    s_waitcnt lgkmcnt(6)
    buffer_store_dwordx4 v[36:39], v18, s[4:7], s39 offen sc1
    s_add_u32 s39, s39, s37
    s_waitcnt lgkmcnt(5)
    buffer_store_dwordx4 v[40:43], v18, s[4:7], s39 offen sc1
    s_add_u32 s39, s39, s37
    s_waitcnt lgkmcnt(4)
    buffer_store_dwordx4 v[44:47], v18, s[4:7], s39 offen sc1
    s_add_u32 s39, s39, s37
    s_waitcnt lgkmcnt(3)
    buffer_store_dwordx4 v[48:51], v18, s[4:7], s39 offen sc1
    s_add_u32 s39, s39, s37
    s_waitcnt lgkmcnt(2)
    buffer_store_dwordx4 v[52:55], v18, s[4:7], s39 offen sc1
    s_add_u32 s39, s39, s37
    s_waitcnt lgkmcnt(1)
    buffer_store_dwordx4 v[56:59], v18, s[4:7], s39 offen sc1
    s_add_u32 s39, s39, s37
    s_waitcnt lgkmcnt(0)
    buffer_store_dwordx4 v[60:63], v18, s[4:7], s39 offen sc1
    s_mov_b32 s20, s79
    s_mul_hi_u32 s68, s20, s63
    s_mul_i32 s21, s68, 3
    s_sub_u32 s21, s20, s21
    s_mul_i32 s67, s65, 8
    s_add_u32 s67, s67, s68
    s_lshl_b32 s67, s67, 8
    s_add_u32 s67, s67, 1720320
    s_waitcnt vmcnt(0)
    s_barrier
    s_cmp_lg_u32 s17, 0
    s_cbranch_scc1 Ls_72
    s_mov_b64 exec, 1
    v_mov_b32 v2, 0
    v_mov_b32 v3, 1
    buffer_atomic_add v3, v2, s[4:7], s67 offen
    s_mov_b64 exec, -1
Ls_72:
    s_add_u32 s65, s65, 2
    s_cmp_lt_u32 s65, 31
    s_cbranch_scc1 Lp_f1_l
    s_mov_b32 s65, 31
    s_lshl_b32 s67, s65, 2
    s_lshl_b32 s67, s67, 8
    s_add_u32 s67, s67, 1687552
    s_cmp_lg_u32 s17, 0
    s_cbranch_scc1 Lw_75
    v_and_b32 v2, 63, v0
    v_lshlrev_b32 v2, 8, v2
    s_mov_b64 exec, 0xf
    s_mov_b32 s70, 0
Lw_73:
    buffer_load_dword v3, v2, s[4:7], s67 offen sc1
    s_waitcnt vmcnt(0)
    v_readlane_b32 s69, v3, 0
    v_readlane_b32 s20, v3, 1
    s_nop 2
    s_add_u32 s69, s69, s20
    v_readlane_b32 s20, v3, 2
    s_nop 2
    s_add_u32 s69, s69, s20
    v_readlane_b32 s20, v3, 3
    s_nop 2
    s_add_u32 s69, s69, s20
    s_cmp_ge_u32 s69, 16
    s_cbranch_scc1 Lw_74
    s_sleep 2
    s_add_u32 s70, s70, 1
    s_cmp_lt_u32 s70, 524288
    s_cbranch_scc1 Lw_73
    s_branch Lfail
Lw_74:
    s_mov_b64 exec, -1
Lw_75:
    s_barrier
    s_mov_b32 s8, s4
    s_mov_b32 s9, s5
    s_mov_b32 s10, s6
    s_mov_b32 s11, s7
    s_lshl_b32 s52, s65, 6
    s_lshl_b32 s54, s77, 5
    s_add_u32 s52, s52, s54
    s_mul_i32 s24, s52, 1152
    s_mul_i32 s54, s78, 1152
    s_add_u32 s24, s24, s54
    s_add_u32 s24, s24, 92274688
    s_lshl_b32 s36, s17, 3
    s_mul_i32 s36, s36, s25
    s_add_u32 s36, s36, s24
    s_lshl_b32 s37, s25, 5
    s_lshl_b32 s39, s17, 10
    s_add_u32 s38, s36, 0
    s_add_u32 s34, s39, 0
    s_mov_b32 m0, s34
    s_nop 0
    buffer_load_dwordx4 v12, s[8:11], s38 offen sc1 lds
    s_add_u32 s38, s36, 128
    s_add_u32 s34, s39, 4096
    s_mov_b32 m0, s34
    s_nop 0
    buffer_load_dwordx4 v12, s[8:11], s38 offen sc1 lds
    s_add_u32 s38, s36, 256
    s_add_u32 s34, s39, 8192
    s_mov_b32 m0, s34
    s_nop 0
    buffer_load_dwordx4 v12, s[8:11], s38 offen sc1 lds
    s_add_u32 s38, s36, 384
    s_add_u32 s34, s39, 12288
    s_mov_b32 m0, s34
    s_nop 0
    buffer_load_dwordx4 v12, s[8:11], s38 offen sc1 lds
    s_add_u32 s38, s36, 512
    s_add_u32 s34, s39, 16384
    s_mov_b32 m0, s34
    s_nop 0
    buffer_load_dwordx4 v12, s[8:11], s38 offen sc1 lds
    s_add_u32 s38, s36, 640
    s_add_u32 s34, s39, 20480
    s_mov_b32 m0, s34
    s_nop 0
    buffer_load_dwordx4 v12, s[8:11], s38 offen sc1 lds
    s_add_u32 s38, s36, 768
    s_add_u32 s34, s39, 24576
    s_mov_b32 m0, s34
    s_nop 0
    buffer_load_dwordx4 v12, s[8:11], s38 offen sc1 lds
    s_add_u32 s38, s36, 896
    s_add_u32 s34, s39, 28672
    s_mov_b32 m0, s34
    s_nop 0
    buffer_load_dwordx4 v12, s[8:11], s38 offen sc1 lds
    s_add_u32 s38, s36, 1024
    s_add_u32 s34, s39, 32768
    s_mov_b32 m0, s34
    s_nop 0
    buffer_load_dwordx4 v12, s[8:11], s38 offen sc1 lds
    v_mov_b64 v[128:129], 0
    v_mov_b64 v[130:131], 0
    v_mov_b64 v[132:133], 0
    v_mov_b64 v[134:135], 0
    v_mov_b64 v[136:137], 0
    v_mov_b64 v[138:139], 0
    v_mov_b64 v[140:141], 0
    v_mov_b64 v[142:143], 0
    v_mov_b64 v[144:145], 0
    v_mov_b64 v[146:147], 0
    v_mov_b64 v[148:149], 0
    v_mov_b64 v[150:151], 0
    v_add_u32 v10, 65536, v8
    v_add_u32 v11, 65536, v9
    s_waitcnt vmcnt(8)
    s_barrier
    ds_read_b128 v[32:35], v8 offset:0
    ds_read_b128 v[36:39], v8 offset:2048
    s_waitcnt lgkmcnt(0)
    v_mfma_f32_16x16x32_bf16 v[128:131], a[0:3], v[32:35], v[128:131]
    v_mfma_f32_16x16x32_bf16 v[132:135], a[72:75], v[32:35], v[132:135]
    ds_read_b128 v[64:67], v9 offset:0
    v_mfma_f32_16x16x32_bf16 v[136:139], a[144:147], v[32:35], v[136:139]
    v_mfma_f32_16x16x32_bf16 v[140:143], a[0:3], v[36:39], v[140:143]
    ds_read_b128 v[68:71], v9 offset:2048
    v_mfma_f32_16x16x32_bf16 v[144:147], a[72:75], v[36:39], v[144:147]
    v_mfma_f32_16x16x32_bf16 v[148:151], a[144:147], v[36:39], v[148:151]
    s_waitcnt lgkmcnt(0)
    v_mfma_f32_16x16x32_bf16 v[128:131], a[4:7], v[64:67], v[128:131]
    v_mfma_f32_16x16x32_bf16 v[132:135], a[76:79], v[64:67], v[132:135]
    s_waitcnt vmcnt(7)
    v_mfma_f32_16x16x32_bf16 v[136:139], a[148:151], v[64:67], v[136:139]
    v_mfma_f32_16x16x32_bf16 v[140:143], a[4:7], v[68:71], v[140:143]
    s_barrier
    v_mfma_f32_16x16x32_bf16 v[144:147], a[76:79], v[68:71], v[144:147]
    v_mfma_f32_16x16x32_bf16 v[148:151], a[148:151], v[68:71], v[148:151]
    ds_read_b128 v[32:35], v8 offset:4096
    ds_read_b128 v[36:39], v8 offset:6144
    s_waitcnt lgkmcnt(0)
    v_mfma_f32_16x16x32_bf16 v[128:131], a[8:11], v[32:35], v[128:131]
    v_mfma_f32_16x16x32_bf16 v[132:135], a[80:83], v[32:35], v[132:135]
    ds_read_b128 v[64:67], v9 offset:4096
    v_mfma_f32_16x16x32_bf16 v[136:139], a[152:155], v[32:35], v[136:139]
    v_mfma_f32_16x16x32_bf16 v[140:143], a[8:11], v[36:39], v[140:143]
    ds_read_b128 v[68:71], v9 offset:6144
    v_mfma_f32_16x16x32_bf16 v[144:147], a[80:83], v[36:39], v[144:147]
    v_mfma_f32_16x16x32_bf16 v[148:151], a[152:155], v[36:39], v[148:151]
    s_waitcnt lgkmcnt(0)
    v_mfma_f32_16x16x32_bf16 v[128:131], a[12:15], v[64:67], v[128:131]
    v_mfma_f32_16x16x32_bf16 v[132:135], a[84:87], v[64:67], v[132:135]
    s_waitcnt vmcnt(6)
    v_mfma_f32_16x16x32_bf16 v[136:139], a[156:159], v[64:67], v[136:139]
    v_mfma_f32_16x16x32_bf16 v[140:143], a[12:15], v[68:71], v[140:143]
    s_barrier
    v_mfma_f32_16x16x32_bf16 v[144:147], a[84:87], v[68:71], v[144:147]
    v_mfma_f32_16x16x32_bf16 v[148:151], a[156:159], v[68:71], v[148:151]
    ds_read_b128 v[32:35], v8 offset:8192
    ds_read_b128 v[36:39], v8 offset:10240
    s_waitcnt lgkmcnt(0)
    v_mfma_f32_16x16x32_bf16 v[128:131], a[16:19], v[32:35], v[128:131]
    v_mfma_f32_16x16x32_bf16 v[132:135], a[88:91], v[32:35], v[132:135]
    ds_read_b128 v[64:67], v9 offset:8192
    v_mfma_f32_16x16x32_bf16 v[136:139], a[160:163], v[32:35], v[136:139]
    v_mfma_f32_16x16x32_bf16 v[140:143], a[16:19], v[36:39], v[140:143]
    ds_read_b128 v[68:71], v9 offset:10240
    v_mfma_f32_16x16x32_bf16 v[144:147], a[88:91], v[36:39], v[144:147]
    v_mfma_f32_16x16x32_bf16 v[148:151], a[160:163], v[36:39], v[148:151]
    s_waitcnt lgkmcnt(0)
    v_mfma_f32_16x16x32_bf16 v[128:131], a[20:23], v[64:67], v[128:131]
    v_mfma_f32_16x16x32_bf16 v[132:135], a[92:95], v[64:67], v[132:135]
    s_waitcnt vmcnt(5)
    v_mfma_f32_16x16x32_bf16 v[136:139], a[164:167], v[64:67], v[136:139]
    v_mfma_f32_16x16x32_bf16 v[140:143], a[20:23], v[68:71], v[140:143]
    s_barrier
    v_mfma_f32_16x16x32_bf16 v[144:147], a[92:95], v[68:71], v[144:147]
    v_mfma_f32_16x16x32_bf16 v[148:151], a[164:167], v[68:71], v[148:151]
    ds_read_b128 v[32:35], v8 offset:12288
    ds_read_b128 v[36:39], v8 offset:14336
    s_waitcnt lgkmcnt(0)
    v_mfma_f32_16x16x32_bf16 v[128:131], a[24:27], v[32:35], v[128:131]
    v_mfma_f32_16x16x32_bf16 v[132:135], a[96:99], v[32:35], v[132:135]
    ds_read_b128 v[64:67], v9 offset:12288
    v_mfma_f32_16x16x32_bf16 v[136:139], a[168:171], v[32:35], v[136:139]
    v_mfma_f32_16x16x32_bf16 v[140:143], a[24:27], v[36:39], v[140:143]
    ds_read_b128 v[68:71], v9 offset:14336
    v_mfma_f32_16x16x32_bf16 v[144:147], a[96:99], v[36:39], v[144:147]
    v_mfma_f32_16x16x32_bf16 v[148:151], a[168:171], v[36:39], v[148:151]
    s_waitcnt lgkmcnt(0)
    v_mfma_f32_16x16x32_bf16 v[128:131], a[28:31], v[64:67], v[128:131]
    v_mfma_f32_16x16x32_bf16 v[132:135], a[100:103], v[64:67], v[132:135]
    s_waitcnt vmcnt(4)
    v_mfma_f32_16x16x32_bf16 v[136:139], a[172:175], v[64:67], v[136:139]
    v_mfma_f32_16x16x32_bf16 v[140:143], a[28:31], v[68:71], v[140:143]
    s_barrier
    v_mfma_f32_16x16x32_bf16 v[144:147], a[100:103], v[68:71], v[144:147]
    v_mfma_f32_16x16x32_bf16 v[148:151], a[172:175], v[68:71], v[148:151]
    ds_read_b128 v[32:35], v8 offset:16384
    ds_read_b128 v[36:39], v8 offset:18432
    s_waitcnt lgkmcnt(0)
    v_mfma_f32_16x16x32_bf16 v[128:131], a[32:35], v[32:35], v[128:131]
    v_mfma_f32_16x16x32_bf16 v[132:135], a[104:107], v[32:35], v[132:135]
    ds_read_b128 v[64:67], v9 offset:16384
    v_mfma_f32_16x16x32_bf16 v[136:139], a[176:179], v[32:35], v[136:139]
    v_mfma_f32_16x16x32_bf16 v[140:143], a[32:35], v[36:39], v[140:143]
    ds_read_b128 v[68:71], v9 offset:18432
    v_mfma_f32_16x16x32_bf16 v[144:147], a[104:107], v[36:39], v[144:147]
    v_mfma_f32_16x16x32_bf16 v[148:151], a[176:179], v[36:39], v[148:151]
    s_waitcnt lgkmcnt(0)
    v_mfma_f32_16x16x32_bf16 v[128:131], a[36:39], v[64:67], v[128:131]
    v_mfma_f32_16x16x32_bf16 v[132:135], a[108:111], v[64:67], v[132:135]
    s_waitcnt vmcnt(3)
    v_mfma_f32_16x16x32_bf16 v[136:139], a[180:183], v[64:67], v[136:139]
    v_mfma_f32_16x16x32_bf16 v[140:143], a[36:39], v[68:71], v[140:143]
    s_barrier
    v_mfma_f32_16x16x32_bf16 v[144:147], a[108:111], v[68:71], v[144:147]
    v_mfma_f32_16x16x32_bf16 v[148:151], a[180:183], v[68:71], v[148:151]
    ds_read_b128 v[32:35], v8 offset:20480
    ds_read_b128 v[36:39], v8 offset:22528
    s_waitcnt lgkmcnt(0)
    v_mfma_f32_16x16x32_bf16 v[128:131], a[40:43], v[32:35], v[128:131]
    v_mfma_f32_16x16x32_bf16 v[132:135], a[112:115], v[32:35], v[132:135]
    ds_read_b128 v[64:67], v9 offset:20480
    v_mfma_f32_16x16x32_bf16 v[136:139], a[184:187], v[32:35], v[136:139]
    v_mfma_f32_16x16x32_bf16 v[140:143], a[40:43], v[36:39], v[140:143]
    ds_read_b128 v[68:71], v9 offset:22528
    v_mfma_f32_16x16x32_bf16 v[144:147], a[112:115], v[36:39], v[144:147]
    v_mfma_f32_16x16x32_bf16 v[148:151], a[184:187], v[36:39], v[148:151]
    s_waitcnt lgkmcnt(0)
    v_mfma_f32_16x16x32_bf16 v[128:131], a[44:47], v[64:67], v[128:131]
    v_mfma_f32_16x16x32_bf16 v[132:135], a[116:119], v[64:67], v[132:135]
    s_waitcnt vmcnt(2)
    v_mfma_f32_16x16x32_bf16 v[136:139], a[188:191], v[64:67], v[136:139]
    v_mfma_f32_16x16x32_bf16 v[140:143], a[44:47], v[68:71], v[140:143]
    s_barrier
    v_mfma_f32_16x16x32_bf16 v[144:147], a[116:119], v[68:71], v[144:147]
    v_mfma_f32_16x16x32_bf16 v[148:151], a[188:191], v[68:71], v[148:151]
    ds_read_b128 v[32:35], v8 offset:24576
    ds_read_b128 v[36:39], v8 offset:26624
    s_waitcnt lgkmcnt(0)
    v_mfma_f32_16x16x32_bf16 v[128:131], a[48:51], v[32:35], v[128:131]
    v_mfma_f32_16x16x32_bf16 v[132:135], a[120:123], v[32:35], v[132:135]
    ds_read_b128 v[64:67], v9 offset:24576
    v_mfma_f32_16x16x32_bf16 v[136:139], a[192:195], v[32:35], v[136:139]
    v_mfma_f32_16x16x32_bf16 v[140:143], a[48:51], v[36:39], v[140:143]
    ds_read_b128 v[68:71], v9 offset:26624
    v_mfma_f32_16x16x32_bf16 v[144:147], a[120:123], v[36:39], v[144:147]
    v_mfma_f32_16x16x32_bf16 v[148:151], a[192:195], v[36:39], v[148:151]
    s_waitcnt lgkmcnt(0)
    v_mfma_f32_16x16x32_bf16 v[128:131], a[52:55], v[64:67], v[128:131]
    v_mfma_f32_16x16x32_bf16 v[132:135], a[124:127], v[64:67], v[132:135]
    s_waitcnt vmcnt(1)
    v_mfma_f32_16x16x32_bf16 v[136:139], a[196:199], v[64:67], v[136:139]
    v_mfma_f32_16x16x32_bf16 v[140:143], a[52:55], v[68:71], v[140:143]
    s_barrier
    v_mfma_f32_16x16x32_bf16 v[144:147], a[124:127], v[68:71], v[144:147]
    v_mfma_f32_16x16x32_bf16 v[148:151], a[196:199], v[68:71], v[148:151]
    ds_read_b128 v[32:35], v8 offset:28672
    ds_read_b128 v[36:39], v8 offset:30720
    s_waitcnt lgkmcnt(0)
    v_mfma_f32_16x16x32_bf16 v[128:131], a[56:59], v[32:35], v[128:131]
    v_mfma_f32_16x16x32_bf16 v[132:135], a[128:131], v[32:35], v[132:135]
    ds_read_b128 v[64:67], v9 offset:28672
    v_mfma_f32_16x16x32_bf16 v[136:139], a[200:203], v[32:35], v[136:139]
    v_mfma_f32_16x16x32_bf16 v[140:143], a[56:59], v[36:39], v[140:143]
    ds_read_b128 v[68:71], v9 offset:30720
    v_mfma_f32_16x16x32_bf16 v[144:147], a[128:131], v[36:39], v[144:147]
    v_mfma_f32_16x16x32_bf16 v[148:151], a[200:203], v[36:39], v[148:151]
    s_waitcnt lgkmcnt(0)
    v_mfma_f32_16x16x32_bf16 v[128:131], a[60:63], v[64:67], v[128:131]
    v_mfma_f32_16x16x32_bf16 v[132:135], a[132:135], v[64:67], v[132:135]
    s_waitcnt vmcnt(0)
    v_mfma_f32_16x16x32_bf16 v[136:139], a[204:207], v[64:67], v[136:139]
    v_mfma_f32_16x16x32_bf16 v[140:143], a[60:63], v[68:71], v[140:143]
    s_barrier
    v_mfma_f32_16x16x32_bf16 v[144:147], a[132:135], v[68:71], v[144:147]
    v_mfma_f32_16x16x32_bf16 v[148:151], a[204:207], v[68:71], v[148:151]
    ds_read_b128 v[32:35], v8 offset:32768
    ds_read_b128 v[36:39], v8 offset:34816
    s_waitcnt lgkmcnt(0)
    v_mfma_f32_16x16x32_bf16 v[128:131], a[64:67], v[32:35], v[128:131]
    v_mfma_f32_16x16x32_bf16 v[132:135], a[136:139], v[32:35], v[132:135]
    ds_read_b128 v[64:67], v9 offset:32768
    v_mfma_f32_16x16x32_bf16 v[136:139], a[208:211], v[32:35], v[136:139]
    v_mfma_f32_16x16x32_bf16 v[140:143], a[64:67], v[36:39], v[140:143]
    ds_read_b128 v[68:71], v9 offset:34816
    v_mfma_f32_16x16x32_bf16 v[144:147], a[136:139], v[36:39], v[144:147]
    v_mfma_f32_16x16x32_bf16 v[148:151], a[208:211], v[36:39], v[148:151]
    s_waitcnt lgkmcnt(0)
    v_mfma_f32_16x16x32_bf16 v[128:131], a[68:71], v[64:67], v[128:131]
    v_mfma_f32_16x16x32_bf16 v[132:135], a[140:143], v[64:67], v[132:135]
    v_mfma_f32_16x16x32_bf16 v[136:139], a[212:215], v[64:67], v[136:139]
    v_mfma_f32_16x16x32_bf16 v[140:143], a[68:71], v[68:71], v[140:143]
    v_mfma_f32_16x16x32_bf16 v[144:147], a[140:143], v[68:71], v[144:147]
    v_mfma_f32_16x16x32_bf16 v[148:151], a[212:215], v[68:71], v[148:151]
    s_nop 7
    s_mov_b32 s53, 98304
    s_mov_b32 s56, 9216
    s_mul_i32 s57, s52, 9216
    s_mul_i32 s54, s79, 384
    s_add_u32 s57, s57, s54
    s_add_u32 s57, s57, 100663296
    v_and_b32 v1, 63, v0
    v_and_b32 v2, 31, v1
    v_mul_u32_u24 v2, 384, v2
    v_add_u32 v2, s53, v2
    v_lshrrev_b32 v3, 5, v1
    s_mul_i32 s36, s17, 6
    v_add_u32 v3, s36, v3
    v_and_b32 v4, 7, v1
    v_add_u32 v5, 0, v3
    v_xor_b32 v5, v5, v4
    v_lshlrev_b32 v5, 4, v5
    v_add_u32 v16, v2, v5
    v_add_u32 v5, 2, v3
    v_xor_b32 v5, v5, v4
    v_lshlrev_b32 v5, 4, v5
    v_add_u32 v17, v2, v5
    v_add_u32 v5, 4, v3
    v_xor_b32 v5, v5, v4
    v_lshlrev_b32 v5, 4, v5
    v_add_u32 v18, v2, v5
    v_max_f32 v128, 0, v128
    v_max_f32 v140, 0, v140
    v_max_f32 v129, 0, v129
    v_max_f32 v141, 0, v141
    v_max_f32 v130, 0, v130
    v_max_f32 v142, 0, v142
    v_max_f32 v131, 0, v131
    v_max_f32 v143, 0, v143
    v_cvt_pk_bf16_f32 v32, v128, v129
    v_cvt_pk_bf16_f32 v33, v130, v131
    v_cvt_pk_bf16_f32 v34, v140, v141
    v_cvt_pk_bf16_f32 v35, v142, v143
    s_nop 0
    v_permlane16_swap_b32 v32, v34
    v_permlane16_swap_b32 v33, v35
    ds_write_b128 v16, v[32:35] offset:0
    v_max_f32 v132, 0, v132
    v_max_f32 v144, 0, v144
    v_max_f32 v133, 0, v133
    v_max_f32 v145, 0, v145
    v_max_f32 v134, 0, v134
    v_max_f32 v146, 0, v146
    v_max_f32 v135, 0, v135
    v_max_f32 v147, 0, v147
    v_cvt_pk_bf16_f32 v36, v132, v133
    v_cvt_pk_bf16_f32 v37, v134, v135
    v_cvt_pk_bf16_f32 v38, v144, v145
    v_cvt_pk_bf16_f32 v39, v146, v147
    s_nop 0
    v_permlane16_swap_b32 v36, v38
    v_permlane16_swap_b32 v37, v39
    ds_write_b128 v17, v[36:39] offset:0
    v_max_f32 v136, 0, v136
    v_max_f32 v148, 0, v148
    v_max_f32 v137, 0, v137
    v_max_f32 v149, 0, v149
    v_max_f32 v138, 0, v138
    v_max_f32 v150, 0, v150
    v_max_f32 v139, 0, v139
    v_max_f32 v151, 0, v151
    v_cvt_pk_bf16_f32 v40, v136, v137
    v_cvt_pk_bf16_f32 v41, v138, v139
    v_cvt_pk_bf16_f32 v42, v148, v149
    v_cvt_pk_bf16_f32 v43, v150, v151
    s_nop 0
    v_permlane16_swap_b32 v40, v42
    v_permlane16_swap_b32 v41, v43
    ds_write_b128 v18, v[40:43] offset:0
    v_cmp_le_u32 vcc, 24, v1
    s_nop 1
    v_cndmask_b32 v2, 0, 1, vcc
    v_mul_u32_u24 v3, 24, v2
    v_sub_u32 v3, v1, v3
    s_mul_i32 s36, s17, 8
    v_xor_b32 v4, v3, v2
    v_lshlrev_b32 v4, 4, v4
    v_add_u32 v2, s36, v2
    v_mul_u32_u24 v5, 384, v2
    v_add_u32 v5, s53, v5
    v_mul_lo_u32 v2, v2, s56
    v_lshlrev_b32 v3, 4, v3
    v_add_u32 v18, v2, v3
    v_mov_b32 v2, 0x40000000
    v_cmp_gt_u32 vcc, 48, v1
    s_nop 1
    v_cndmask_b32 v18, v2, v18, vcc
    s_lshl_b32 s37, s56, 1
    s_mov_b32 s39, s57
    v_xor_b32 v3, 0, v4
    v_add_u32 v20, v5, v3
    v_xor_b32 v3, 32, v4
    v_add_u32 v21, v5, v3
    v_xor_b32 v3, 64, v4
    v_add_u32 v22, v5, v3
    v_xor_b32 v3, 96, v4
    v_add_u32 v23, v5, v3
    s_waitcnt lgkmcnt(0)
    s_barrier
    ds_read_b128 v[32:35], v20 offset:0
    ds_read_b128 v[36:39], v21 offset:768
    ds_read_b128 v[40:43], v22 offset:1536
    ds_read_b128 v[44:47], v23 offset:2304
    s_waitcnt lgkmcnt(3)
    buffer_store_dwordx4 v[32:35], v18, s[4:7], s39 offen sc1
    s_add_u32 s39, s39, s37
    s_waitcnt lgkmcnt(2)
    buffer_store_dwordx4 v[36:39], v18, s[4:7], s39 offen sc1
    s_add_u32 s39, s39, s37
    s_waitcnt lgkmcnt(1)
    buffer_store_dwordx4 v[40:43], v18, s[4:7], s39 offen sc1
    s_add_u32 s39, s39, s37
    s_waitcnt lgkmcnt(0)
    buffer_store_dwordx4 v[44:47], v18, s[4:7], s39 offen sc1
    s_mov_b32 s20, s79
    s_mul_hi_u32 s68, s20, s63
    s_mul_i32 s21, s68, 3
    s_sub_u32 s21, s20, s21
    s_mul_i32 s67, s65, 8
    s_add_u32 s67, s67, s68
    s_lshl_b32 s67, s67, 8
    s_add_u32 s67, s67, 1720320
    s_waitcnt vmcnt(0)
    s_barrier
    s_cmp_lg_u32 s17, 0
    s_cbranch_scc1 Ls_76
    s_mov_b64 exec, 1
    v_mov_b32 v2, 0
    v_mov_b32 v3, 1
    buffer_atomic_add v3, v2, s[4:7], s67 offen
    s_mov_b64 exec, -1
Ls_76:
    s_branch Lexit
Lp_f2:
    s_sub_u32 s20, s66, 160
    s_cmp_ge_u32 s20, 24
    s_cselect_b32 s65, 1, 0
    s_cselect_b32 s21, 24, 0
    s_sub_u32 s20, s20, s21
    s_mov_b32 s77, s65
    s_mul_hi_u32 s78, s20, s63
    s_mul_i32 s79, s78, 3
    s_sub_u32 s79, s20, s79
    s_load_dwordx2 s[12:13], s[0:1], 72
    s_waitcnt lgkmcnt(0)
    s_mov_b32 s14, 5308416
    s_mov_b32 s15, 0x20000
    s_mul_i32 s26, s78, 663552
    s_mul_i32 s54, s79, 384
    s_add_u32 s26, s26, s54
    s_mov_b32 s27, 1152
    v_and_b32 v1, 63, v0
    v_lshrrev_b32 v2, 3, v1
    v_mul_lo_u32 v2, v2, s27
    v_and_b32 v3, 7, v1
    v_bfe_u32 v4, v1, 4, 1
    v_lshlrev_b32 v4, 2, v4
    v_xor_b32 v3, v3, v4
    v_lshlrev_b32 v3, 4, v3
    v_add_u32 v19, v2, v3
    v_lshrrev_b32 v2, 4, v1
    v_lshlrev_b32 v2, 3, v2
    v_bfe_u32 v3, v1, 2, 2
    v_add_u32 v2, v2, v3
    v_lshlrev_b32 v2, 7, v2
    v_and_b32 v4, 3, v1
    v_lshlrev_b32 v4, 3, v4
    v_add_u32 v2, v2, v4
    v_bfe_u32 v3, v1, 3, 1
    v_lshlrev_b32 v3, 6, v3
    s_mul_i32 s36, s17, 48
    s_add_u32 s36, s36, 0
    s_lshr_b32 s37, s36, 5
    s_and_b32 s37, s37, 1
    s_lshl_b32 s37, s37, 6
    v_xor_b32 v4, s37, v3
    v_add_u32 v4, v4, v2
    s_lshr_b32 s37, s36, 6
    s_lshl_b32 s37, s37, 13
    s_and_b32 s34, s36, 16
    s_lshl_b32 s34, s34, 1
    s_add_u32 s37, s37, s34
    v_add_u32 v16, s37, v4
    s_mul_i32 s36, s17, 48
    s_add_u32 s36, s36, 16
    s_lshr_b32 s37, s36, 5
    s_and_b32 s37, s37, 1
    s_lshl_b32 s37, s37, 6
    v_xor_b32 v4, s37, v3
    v_add_u32 v4, v4, v2
    s_lshr_b32 s37, s36, 6
    s_lshl_b32 s37, s37, 13
    s_and_b32 s34, s36, 16
    s_lshl_b32 s34, s34, 1
    s_add_u32 s37, s37, s34
    v_add_u32 v17, s37, v4
    s_mul_i32 s36, s17, 48
    s_add_u32 s36, s36, 32
    s_lshr_b32 s37, s36, 5
    s_and_b32 s37, s37, 1
    s_lshl_b32 s37, s37, 6
    v_xor_b32 v4, s37, v3
    v_add_u32 v4, v4, v2
    s_lshr_b32 s37, s36, 6
    s_lshl_b32 s37, s37, 13
    s_and_b32 s34, s36, 16
    s_lshl_b32 s34, s34, 1
    s_add_u32 s37, s37, s34
    v_add_u32 v18, s37, v4
    s_lshl_b32 s36, s17, 3
    s_add_u32 s36, s36, 0
    s_mul_i32 s39, s36, s27
    s_add_u32 s39, s39, s26
    s_lshl_b32 s34, s17, 10
    s_add_u32 s34, s34, 0
    s_lshl_b32 s37, s27, 5
    s_mov_b32 m0, s34
    s_nop 0
    buffer_load_dwordx4 v19, s[12:15], s39 offen lds
    s_add_u32 s34, s34, 4096
    s_add_u32 s39, s39, s37
    s_mov_b32 m0, s34
    s_nop 0
    buffer_load_dwordx4 v19, s[12:15], s39 offen lds
    s_add_u32 s34, s34, 4096
    s_sub_u32 s39, s39, s37
    s_add_u32 s39, s39, 128
    s_mov_b32 m0, s34
    s_nop 0
    buffer_load_dwordx4 v19, s[12:15], s39 offen lds
    s_add_u32 s34, s34, 4096
    s_add_u32 s39, s39, s37
    s_mov_b32 m0, s34
    s_nop 0
    buffer_load_dwordx4 v19, s[12:15], s39 offen lds
    s_add_u32 s34, s34, 4096
    s_sub_u32 s39, s39, s37
    s_add_u32 s39, s39, 128
    s_mov_b32 m0, s34
    s_nop 0
    buffer_load_dwordx4 v19, s[12:15], s39 offen lds
    s_add_u32 s34, s34, 4096
    s_add_u32 s39, s39, s37
    s_mov_b32 m0, s34
    s_nop 0
    buffer_load_dwordx4 v19, s[12:15], s39 offen lds
    s_lshl_b32 s36, s17, 3
    s_add_u32 s36, s36, 64
    s_mul_i32 s39, s36, s27
    s_add_u32 s39, s39, s26
    s_lshl_b32 s34, s17, 10
    s_add_u32 s34, s34, 24576
    s_lshl_b32 s37, s27, 5
    s_mov_b32 m0, s34
    s_nop 0
    buffer_load_dwordx4 v19, s[12:15], s39 offen lds
    s_add_u32 s34, s34, 4096
    s_add_u32 s39, s39, s37
    s_mov_b32 m0, s34
    s_nop 0
    buffer_load_dwordx4 v19, s[12:15], s39 offen lds
    s_add_u32 s34, s34, 4096
    s_sub_u32 s39, s39, s37
    s_add_u32 s39, s39, 128
    s_mov_b32 m0, s34
    s_nop 0
    buffer_load_dwordx4 v19, s[12:15], s39 offen lds
    s_add_u32 s34, s34, 4096
    s_add_u32 s39, s39, s37
    s_mov_b32 m0, s34
    s_nop 0
    buffer_load_dwordx4 v19, s[12:15], s39 offen lds
    s_add_u32 s34, s34, 4096
    s_sub_u32 s39, s39, s37
    s_add_u32 s39, s39, 128
    s_mov_b32 m0, s34
    s_nop 0
    buffer_load_dwordx4 v19, s[12:15], s39 offen lds
    s_add_u32 s34, s34, 4096
    s_add_u32 s39, s39, s37
    s_mov_b32 m0, s34
    s_nop 0
    buffer_load_dwordx4 v19, s[12:15], s39 offen lds
    s_lshl_b32 s36, s17, 3
    s_add_u32 s36, s36, 128
    s_mul_i32 s39, s36, s27
    s_add_u32 s39, s39, s26
    s_lshl_b32 s34, s17, 10
    s_add_u32 s34, s34, 49152
    s_lshl_b32 s37, s27, 5
    s_mov_b32 m0, s34
    s_nop 0
    buffer_load_dwordx4 v19, s[12:15], s39 offen lds
    s_add_u32 s34, s34, 4096
    s_add_u32 s39, s39, s37
    s_mov_b32 m0, s34
    s_nop 0
    buffer_load_dwordx4 v19, s[12:15], s39 offen lds
    s_add_u32 s34, s34, 4096
    s_sub_u32 s39, s39, s37
    s_add_u32 s39, s39, 128
    s_mov_b32 m0, s34
    s_nop 0
    buffer_load_dwordx4 v19, s[12:15], s39 offen lds
    s_add_u32 s34, s34, 4096
    s_add_u32 s39, s39, s37
    s_mov_b32 m0, s34
    s_nop 0
    buffer_load_dwordx4 v19, s[12:15], s39 offen lds
    s_add_u32 s34, s34, 4096
    s_sub_u32 s39, s39, s37
    s_add_u32 s39, s39, 128
    s_mov_b32 m0, s34
    s_nop 0
    buffer_load_dwordx4 v19, s[12:15], s39 offen lds
    s_add_u32 s34, s34, 4096
    s_add_u32 s39, s39, s37
    s_mov_b32 m0, s34
    s_nop 0
    buffer_load_dwordx4 v19, s[12:15], s39 offen lds
    s_lshl_b32 s36, s17, 3
    s_add_u32 s36, s36, 192
    s_mul_i32 s39, s36, s27
    s_add_u32 s39, s39, s26
    s_lshl_b32 s34, s17, 10
    s_add_u32 s34, s34, 73728
    s_lshl_b32 s37, s27, 5
    s_mov_b32 m0, s34
    s_nop 0
    buffer_load_dwordx4 v19, s[12:15], s39 offen lds
    s_add_u32 s34, s34, 4096
    s_add_u32 s39, s39, s37
    s_mov_b32 m0, s34
    s_nop 0
    buffer_load_dwordx4 v19, s[12:15], s39 offen lds
    s_add_u32 s34, s34, 4096
    s_sub_u32 s39, s39, s37
    s_add_u32 s39, s39, 128
    s_mov_b32 m0, s34
    s_nop 0
    buffer_load_dwordx4 v19, s[12:15], s39 offen lds
    s_add_u32 s34, s34, 4096
    s_add_u32 s39, s39, s37
    s_mov_b32 m0, s34
    s_nop 0
    buffer_load_dwordx4 v19, s[12:15], s39 offen lds
    s_add_u32 s34, s34, 4096
    s_sub_u32 s39, s39, s37
    s_add_u32 s39, s39, 128
    s_mov_b32 m0, s34
    s_nop 0
    buffer_load_dwordx4 v19, s[12:15], s39 offen lds
    s_add_u32 s34, s34, 4096
    s_add_u32 s39, s39, s37
    s_mov_b32 m0, s34
    s_nop 0
    buffer_load_dwordx4 v19, s[12:15], s39 offen lds
    s_lshl_b32 s36, s17, 3
    s_add_u32 s36, s36, 256
    s_mul_i32 s39, s36, s27
    s_add_u32 s39, s39, s26
    s_lshl_b32 s34, s17, 10
    s_add_u32 s34, s34, 98304
    s_lshl_b32 s37, s27, 5
    s_mov_b32 m0, s34
    s_nop 0
    buffer_load_dwordx4 v19, s[12:15], s39 offen lds
    s_add_u32 s34, s34, 4096
    s_add_u32 s39, s39, s37
    s_mov_b32 m0, s34
    s_nop 0
    buffer_load_dwordx4 v19, s[12:15], s39 offen lds
    s_add_u32 s34, s34, 4096
    s_sub_u32 s39, s39, s37
    s_add_u32 s39, s39, 128
    s_mov_b32 m0, s34
    s_nop 0
    buffer_load_dwordx4 v19, s[12:15], s39 offen lds
    s_add_u32 s34, s34, 4096
    s_add_u32 s39, s39, s37
    s_mov_b32 m0, s34
    s_nop 0
    buffer_load_dwordx4 v19, s[12:15], s39 offen lds
    s_add_u32 s34, s34, 4096
    s_sub_u32 s39, s39, s37
    s_add_u32 s39, s39, 128
    s_mov_b32 m0, s34
    s_nop 0
    buffer_load_dwordx4 v19, s[12:15], s39 offen lds
    s_add_u32 s34, s34, 4096
    s_add_u32 s39, s39, s37
    s_mov_b32 m0, s34
    s_nop 0
    buffer_load_dwordx4 v19, s[12:15], s39 offen lds
    s_lshl_b32 s36, s17, 3
    s_add_u32 s36, s36, 320
    s_mul_i32 s39, s36, s27
    s_add_u32 s39, s39, s26
    s_lshl_b32 s34, s17, 10
    s_add_u32 s34, s34, 122880
    s_lshl_b32 s37, s27, 5
    s_mov_b32 m0, s34
    s_nop 0
    buffer_load_dwordx4 v19, s[12:15], s39 offen lds
    s_add_u32 s34, s34, 4096
    s_add_u32 s39, s39, s37
    s_mov_b32 m0, s34
    s_nop 0
    buffer_load_dwordx4 v19, s[12:15], s39 offen lds
    s_add_u32 s34, s34, 4096
    s_sub_u32 s39, s39, s37
    s_add_u32 s39, s39, 128
    s_mov_b32 m0, s34
    s_nop 0
    buffer_load_dwordx4 v19, s[12:15], s39 offen lds
    s_add_u32 s34, s34, 4096
    s_add_u32 s39, s39, s37
    s_mov_b32 m0, s34
    s_nop 0
    buffer_load_dwordx4 v19, s[12:15], s39 offen lds
    s_add_u32 s34, s34, 4096
    s_sub_u32 s39, s39, s37
    s_add_u32 s39, s39, 128
    s_mov_b32 m0, s34
    s_nop 0
    buffer_load_dwordx4 v19, s[12:15], s39 offen lds
    s_add_u32 s34, s34, 4096
    s_add_u32 s39, s39, s37
    s_mov_b32 m0, s34
    s_nop 0
    buffer_load_dwordx4 v19, s[12:15], s39 offen lds
    s_waitcnt vmcnt(0)
    s_barrier
    ds_read_b64_tr_b16 a[0:1], v16 offset:0
    ds_read_b64_tr_b16 a[2:3], v16 offset:512
    ds_read_b64_tr_b16 a[72:73], v17 offset:0
    ds_read_b64_tr_b16 a[74:75], v17 offset:512
    ds_read_b64_tr_b16 a[144:145], v18 offset:0
    ds_read_b64_tr_b16 a[146:147], v18 offset:512
    ds_read_b64_tr_b16 a[4:5], v16 offset:4096
    ds_read_b64_tr_b16 a[6:7], v16 offset:4608
    ds_read_b64_tr_b16 a[76:77], v17 offset:4096
    ds_read_b64_tr_b16 a[78:79], v17 offset:4608
    ds_read_b64_tr_b16 a[148:149], v18 offset:4096
    ds_read_b64_tr_b16 a[150:151], v18 offset:4608
    s_waitcnt lgkmcnt(0)
    ds_read_b64_tr_b16 a[8:9], v16 offset:24576
    ds_read_b64_tr_b16 a[10:11], v16 offset:25088
    ds_read_b64_tr_b16 a[80:81], v17 offset:24576
    ds_read_b64_tr_b16 a[82:83], v17 offset:25088
    ds_read_b64_tr_b16 a[152:153], v18 offset:24576
    ds_read_b64_tr_b16 a[154:155], v18 offset:25088
    ds_read_b64_tr_b16 a[12:13], v16 offset:28672
    ds_read_b64_tr_b16 a[14:15], v16 offset:29184
    ds_read_b64_tr_b16 a[84:85], v17 offset:28672
    ds_read_b64_tr_b16 a[86:87], v17 offset:29184
    ds_read_b64_tr_b16 a[156:157], v18 offset:28672
    ds_read_b64_tr_b16 a[158:159], v18 offset:29184
    s_waitcnt lgkmcnt(0)
    ds_read_b64_tr_b16 a[16:17], v16 offset:49152
    ds_read_b64_tr_b16 a[18:19], v16 offset:49664
    ds_read_b64_tr_b16 a[88:89], v17 offset:49152
    ds_read_b64_tr_b16 a[90:91], v17 offset:49664
    ds_read_b64_tr_b16 a[160:161], v18 offset:49152
    ds_read_b64_tr_b16 a[162:163], v18 offset:49664
    ds_read_b64_tr_b16 a[20:21], v16 offset:53248
    ds_read_b64_tr_b16 a[22:23], v16 offset:53760
    ds_read_b64_tr_b16 a[92:93], v17 offset:53248
    ds_read_b64_tr_b16 a[94:95], v17 offset:53760
    ds_read_b64_tr_b16 a[164:165], v18 offset:53248
    ds_read_b64_tr_b16 a[166:167], v18 offset:53760
    s_waitcnt lgkmcnt(0)
    v_add_u32 v5, 65536, v16
    ds_read_b64_tr_b16 a[24:25], v5 offset:8192
    v_add_u32 v5, 65536, v16
    ds_read_b64_tr_b16 a[26:27], v5 offset:8704
    v_add_u32 v5, 65536, v17
    ds_read_b64_tr_b16 a[96:97], v5 offset:8192
    v_add_u32 v5, 65536, v17
    ds_read_b64_tr_b16 a[98:99], v5 offset:8704
    v_add_u32 v5, 65536, v18
    ds_read_b64_tr_b16 a[168:169], v5 offset:8192
    v_add_u32 v5, 65536, v18
    ds_read_b64_tr_b16 a[170:171], v5 offset:8704
    v_add_u32 v5, 65536, v16
    ds_read_b64_tr_b16 a[28:29], v5 offset:12288
    v_add_u32 v5, 65536, v16
    ds_read_b64_tr_b16 a[30:31], v5 offset:12800
    v_add_u32 v5, 65536, v17
    ds_read_b64_tr_b16 a[100:101], v5 offset:12288
    v_add_u32 v5, 65536, v17
    ds_read_b64_tr_b16 a[102:103], v5 offset:12800
    v_add_u32 v5, 65536, v18
    ds_read_b64_tr_b16 a[172:173], v5 offset:12288
    v_add_u32 v5, 65536, v18
    ds_read_b64_tr_b16 a[174:175], v5 offset:12800
    s_waitcnt lgkmcnt(0)
    v_add_u32 v5, 65536, v16
    ds_read_b64_tr_b16 a[32:33], v5 offset:32768
    v_add_u32 v5, 65536, v16
    ds_read_b64_tr_b16 a[34:35], v5 offset:33280
    v_add_u32 v5, 65536, v17
    ds_read_b64_tr_b16 a[104:105], v5 offset:32768
    v_add_u32 v5, 65536, v17
    ds_read_b64_tr_b16 a[106:107], v5 offset:33280
    v_add_u32 v5, 65536, v18
    ds_read_b64_tr_b16 a[176:177], v5 offset:32768
    v_add_u32 v5, 65536, v18
    ds_read_b64_tr_b16 a[178:179], v5 offset:33280
    v_add_u32 v5, 65536, v16
    ds_read_b64_tr_b16 a[36:37], v5 offset:36864
    v_add_u32 v5, 65536, v16
    ds_read_b64_tr_b16 a[38:39], v5 offset:37376
    v_add_u32 v5, 65536, v17
    ds_read_b64_tr_b16 a[108:109], v5 offset:36864
    v_add_u32 v5, 65536, v17
    ds_read_b64_tr_b16 a[110:111], v5 offset:37376
    v_add_u32 v5, 65536, v18
    ds_read_b64_tr_b16 a[180:181], v5 offset:36864
    v_add_u32 v5, 65536, v18
    ds_read_b64_tr_b16 a[182:183], v5 offset:37376
    s_waitcnt lgkmcnt(0)
    v_add_u32 v5, 65536, v16
    ds_read_b64_tr_b16 a[40:41], v5 offset:57344
    v_add_u32 v5, 65536, v16
    ds_read_b64_tr_b16 a[42:43], v5 offset:57856
    v_add_u32 v5, 65536, v17
    ds_read_b64_tr_b16 a[112:113], v5 offset:57344
    v_add_u32 v5, 65536, v17
    ds_read_b64_tr_b16 a[114:115], v5 offset:57856
    v_add_u32 v5, 65536, v18
    ds_read_b64_tr_b16 a[184:185], v5 offset:57344
    v_add_u32 v5, 65536, v18
    ds_read_b64_tr_b16 a[186:187], v5 offset:57856
    v_add_u32 v5, 65536, v16
    ds_read_b64_tr_b16 a[44:45], v5 offset:61440
    v_add_u32 v5, 65536, v16
    ds_read_b64_tr_b16 a[46:47], v5 offset:61952
    v_add_u32 v5, 65536, v17
    ds_read_b64_tr_b16 a[116:117], v5 offset:61440
    v_add_u32 v5, 65536, v17
    ds_read_b64_tr_b16 a[118:119], v5 offset:61952
    v_add_u32 v5, 65536, v18
    ds_read_b64_tr_b16 a[188:189], v5 offset:61440
    v_add_u32 v5, 65536, v18
    ds_read_b64_tr_b16 a[190:191], v5 offset:61952
    s_waitcnt lgkmcnt(0)
    s_barrier
    s_lshl_b32 s36, s17, 3
    s_add_u32 s36, s36, 384
    s_mul_i32 s39, s36, s27
    s_add_u32 s39, s39, s26
    s_lshl_b32 s34, s17, 10
    s_add_u32 s34, s34, 0
    s_lshl_b32 s37, s27, 5
    s_mov_b32 m0, s34
    s_nop 0
    buffer_load_dwordx4 v19, s[12:15], s39 offen lds
    s_add_u32 s34, s34, 4096
    s_add_u32 s39, s39, s37
    s_mov_b32 m0, s34
    s_nop 0
    buffer_load_dwordx4 v19, s[12:15], s39 offen lds
    s_add_u32 s34, s34, 4096
    s_sub_u32 s39, s39, s37
    s_add_u32 s39, s39, 128
    s_mov_b32 m0, s34
    s_nop 0
    buffer_load_dwordx4 v19, s[12:15], s39 offen lds
    s_add_u32 s34, s34, 4096
    s_add_u32 s39, s39, s37
    s_mov_b32 m0, s34
    s_nop 0
    buffer_load_dwordx4 v19, s[12:15], s39 offen lds
    s_add_u32 s34, s34, 4096
    s_sub_u32 s39, s39, s37
    s_add_u32 s39, s39, 128
    s_mov_b32 m0, s34
    s_nop 0
    buffer_load_dwordx4 v19, s[12:15], s39 offen lds
    s_add_u32 s34, s34, 4096
    s_add_u32 s39, s39, s37
    s_mov_b32 m0, s34
    s_nop 0
    buffer_load_dwordx4 v19, s[12:15], s39 offen lds
    s_lshl_b32 s36, s17, 3
    s_add_u32 s36, s36, 448
    s_mul_i32 s39, s36, s27
    s_add_u32 s39, s39, s26
    s_lshl_b32 s34, s17, 10
    s_add_u32 s34, s34, 24576
    s_lshl_b32 s37, s27, 5
    s_mov_b32 m0, s34
    s_nop 0
    buffer_load_dwordx4 v19, s[12:15], s39 offen lds
    s_add_u32 s34, s34, 4096
    s_add_u32 s39, s39, s37
    s_mov_b32 m0, s34
    s_nop 0
    buffer_load_dwordx4 v19, s[12:15], s39 offen lds
    s_add_u32 s34, s34, 4096
    s_sub_u32 s39, s39, s37
    s_add_u32 s39, s39, 128
    s_mov_b32 m0, s34
    s_nop 0
    buffer_load_dwordx4 v19, s[12:15], s39 offen lds
    s_add_u32 s34, s34, 4096
    s_add_u32 s39, s39, s37
    s_mov_b32 m0, s34
    s_nop 0
    buffer_load_dwordx4 v19, s[12:15], s39 offen lds
    s_add_u32 s34, s34, 4096
    s_sub_u32 s39, s39, s37
    s_add_u32 s39, s39, 128
    s_mov_b32 m0, s34
    s_nop 0
    buffer_load_dwordx4 v19, s[12:15], s39 offen lds
    s_add_u32 s34, s34, 4096
    s_add_u32 s39, s39, s37
    s_mov_b32 m0, s34
    s_nop 0
    buffer_load_dwordx4 v19, s[12:15], s39 offen lds
    s_lshl_b32 s36, s17, 3
    s_add_u32 s36, s36, 512
    s_mul_i32 s39, s36, s27
    s_add_u32 s39, s39, s26
    s_lshl_b32 s34, s17, 10
    s_add_u32 s34, s34, 49152
    s_lshl_b32 s37, s27, 5
    s_mov_b32 m0, s34
    s_nop 0
    buffer_load_dwordx4 v19, s[12:15], s39 offen lds
    s_add_u32 s34, s34, 4096
    s_add_u32 s39, s39, s37
    s_mov_b32 m0, s34
    s_nop 0
    buffer_load_dwordx4 v19, s[12:15], s39 offen lds
    s_add_u32 s34, s34, 4096
    s_sub_u32 s39, s39, s37
    s_add_u32 s39, s39, 128
    s_mov_b32 m0, s34
    s_nop 0
    buffer_load_dwordx4 v19, s[12:15], s39 offen lds
    s_add_u32 s34, s34, 4096
    s_add_u32 s39, s39, s37
    s_mov_b32 m0, s34
    s_nop 0
    buffer_load_dwordx4 v19, s[12:15], s39 offen lds
    s_add_u32 s34, s34, 4096
    s_sub_u32 s39, s39, s37
    s_add_u32 s39, s39, 128
    s_mov_b32 m0, s34
    s_nop 0
    buffer_load_dwordx4 v19, s[12:15], s39 offen lds
    s_add_u32 s34, s34, 4096
    s_add_u32 s39, s39, s37
    s_mov_b32 m0, s34
    s_nop 0
    buffer_load_dwordx4 v19, s[12:15], s39 offen lds
    s_waitcnt vmcnt(0)
    s_barrier
    ds_read_b64_tr_b16 a[48:49], v16 offset:0
    ds_read_b64_tr_b16 a[50:51], v16 offset:512
    ds_read_b64_tr_b16 a[120:121], v17 offset:0
    ds_read_b64_tr_b16 a[122:123], v17 offset:512
    ds_read_b64_tr_b16 a[192:193], v18 offset:0
    ds_read_b64_tr_b16 a[194:195], v18 offset:512
    ds_read_b64_tr_b16 a[52:53], v16 offset:4096
    ds_read_b64_tr_b16 a[54:55], v16 offset:4608
    ds_read_b64_tr_b16 a[124:125], v17 offset:4096
    ds_read_b64_tr_b16 a[126:127], v17 offset:4608
    ds_read_b64_tr_b16 a[196:197], v18 offset:4096
    ds_read_b64_tr_b16 a[198:199], v18 offset:4608
    s_waitcnt lgkmcnt(0)
    ds_read_b64_tr_b16 a[56:57], v16 offset:24576
    ds_read_b64_tr_b16 a[58:59], v16 offset:25088
    ds_read_b64_tr_b16 a[128:129], v17 offset:24576
    ds_read_b64_tr_b16 a[130:131], v17 offset:25088
    ds_read_b64_tr_b16 a[200:201], v18 offset:24576
    ds_read_b64_tr_b16 a[202:203], v18 offset:25088
    ds_read_b64_tr_b16 a[60:61], v16 offset:28672
    ds_read_b64_tr_b16 a[62:63], v16 offset:29184
    ds_read_b64_tr_b16 a[132:133], v17 offset:28672
    ds_read_b64_tr_b16 a[134:135], v17 offset:29184
    ds_read_b64_tr_b16 a[204:205], v18 offset:28672
    ds_read_b64_tr_b16 a[206:207], v18 offset:29184
    s_waitcnt lgkmcnt(0)
    ds_read_b64_tr_b16 a[64:65], v16 offset:49152
    ds_read_b64_tr_b16 a[66:67], v16 offset:49664
    ds_read_b64_tr_b16 a[136:137], v17 offset:49152
    ds_read_b64_tr_b16 a[138:139], v17 offset:49664
    ds_read_b64_tr_b16 a[208:209], v18 offset:49152
    ds_read_b64_tr_b16 a[210:211], v18 offset:49664
    ds_read_b64_tr_b16 a[68:69], v16 offset:53248
    ds_read_b64_tr_b16 a[70:71], v16 offset:53760
    ds_read_b64_tr_b16 a[140:141], v17 offset:53248
    ds_read_b64_tr_b16 a[142:143], v17 offset:53760
    ds_read_b64_tr_b16 a[212:213], v18 offset:53248
    ds_read_b64_tr_b16 a[214:215], v18 offset:53760
    s_waitcnt lgkmcnt(0)
    s_barrier
    s_mov_b32 s25, 9216
    v_and_b32 v1, 63, v0
    v_and_b32 v2, 15, v1
    v_lshrrev_b32 v3, 4, v1
    v_bfe_u32 v4, v2, 1, 3
    v_xor_b32 v3, v3, v4
    v_lshlrev_b32 v3, 4, v3
    v_lshlrev_b32 v2, 7, v2
    v_add_u32 v8, v2, v3
    v_xor_b32 v9, 64, v8
    v_lshrrev_b32 v2, 3, v1
    v_mul_lo_u32 v2, v2, s25
    v_and_b32 v3, 7, v1
    v_lshrrev_b32 v4, 4, v1
    v_xor_b32 v3, v3, v4
    s_and_b32 s37, s17, 1
    s_lshl_b32 s34, s37, 2
    v_xor_b32 v3, s34, v3
    v_lshlrev_b32 v3, 4, v3
    v_add_u32 v12, v2, v3
Lp_f2_l:
    s_mov_b32 s68, s78
    s_mul_i32 s67, s65, 8
    s_add_u32 s67, s67, s68
    s_lshl_b32 s67, s67, 8
    s_add_u32 s67, s67, 1720320
    s_cmp_lg_u32 s17, 0
    s_cbranch_scc1 Lw_79
    s_mov_b64 exec, 1
    v_mov_b32 v2, 0
    s_mov_b32 s70, 0
Lw_77:
    buffer_load_dword v3, v2, s[4:7], s67 offen sc1
    s_waitcnt vmcnt(0)
    v_readfirstlane_b32 s69, v3
    s_nop 2
    s_cmp_ge_u32 s69, 3
    s_cbranch_scc1 Lw_78
    s_cmp_ge_u32 s70, 2
    s_cbranch_scc1 Lb_80
    s_cmp_ge_u32 s65, 28
    s_cbranch_scc1 Lb_80
    s_sleep 24
Lb_80:
    s_sleep 2
    s_add_u32 s70, s70, 1
    s_cmp_lt_u32 s70, 524288
    s_cbranch_scc1 Lw_77
    s_branch Lfail
Lw_78:
    s_mov_b64 exec, -1
Lw_79:
    s_barrier
    s_mov_b32 s8, s4
    s_mov_b32 s9, s5
    s_mov_b32 s10, s6
    s_mov_b32 s11, s7
    s_lshl_b32 s52, s65, 6
    s_mul_i32 s24, s52, 9216
    s_mul_i32 s54, s78, 1152
    s_add_u32 s24, s24, s54
    s_add_u32 s24, s24, 100663296
    s_lshl_b32 s36, s17, 3
    s_mul_i32 s36, s36, s25
    s_add_u32 s36, s36, s24
    s_lshl_b32 s37, s25, 5
    s_lshl_b32 s39, s17, 10
    s_add_u32 s38, s36, 0
    s_add_u32 s34, s39, 0
    s_mov_b32 m0, s34
    s_nop 0
    buffer_load_dwordx4 v12, s[8:11], s38 offen sc1 lds
    s_add_u32 s38, s38, s37
    s_add_u32 s34, s34, 4096
    s_mov_b32 m0, s34
    s_nop 0
    buffer_load_dwordx4 v12, s[8:11], s38 offen sc1 lds
    s_add_u32 s38, s36, 128
    s_add_u32 s34, s39, 8192
    s_mov_b32 m0, s34
    s_nop 0
    buffer_load_dwordx4 v12, s[8:11], s38 offen sc1 lds
    s_add_u32 s38, s38, s37
    s_add_u32 s34, s34, 4096
    s_mov_b32 m0, s34
    s_nop 0
    buffer_load_dwordx4 v12, s[8:11], s38 offen sc1 lds
    s_add_u32 s38, s36, 256
    s_add_u32 s34, s39, 16384
    s_mov_b32 m0, s34
    s_nop 0
    buffer_load_dwordx4 v12, s[8:11], s38 offen sc1 lds
    s_add_u32 s38, s38, s37
    s_add_u32 s34, s34, 4096
    s_mov_b32 m0, s34
    s_nop 0
    buffer_load_dwordx4 v12, s[8:11], s38 offen sc1 lds
    s_add_u32 s38, s36, 384
    s_add_u32 s34, s39, 24576
    s_mov_b32 m0, s34
    s_nop 0
    buffer_load_dwordx4 v12, s[8:11], s38 offen sc1 lds
    s_add_u32 s38, s38, s37
    s_add_u32 s34, s34, 4096
    s_mov_b32 m0, s34
    s_nop 0
    buffer_load_dwordx4 v12, s[8:11], s38 offen sc1 lds
    s_add_u32 s38, s36, 512
    s_add_u32 s34, s39, 32768
    s_mov_b32 m0, s34
    s_nop 0
    buffer_load_dwordx4 v12, s[8:11], s38 offen sc1 lds
    s_add_u32 s38, s38, s37
    s_add_u32 s34, s34, 4096
    s_mov_b32 m0, s34
    s_nop 0
    buffer_load_dwordx4 v12, s[8:11], s38 offen sc1 lds
    s_add_u32 s38, s36, 640
    s_add_u32 s34, s39, 40960
    s_mov_b32 m0, s34
    s_nop 0
    buffer_load_dwordx4 v12, s[8:11], s38 offen sc1 lds
    s_add_u32 s38, s38, s37
    s_add_u32 s34, s34, 4096
    s_mov_b32 m0, s34
    s_nop 0
    buffer_load_dwordx4 v12, s[8:11], s38 offen sc1 lds
    s_add_u32 s38, s36, 768
    s_add_u32 s34, s39, 49152
    s_mov_b32 m0, s34
    s_nop 0
    buffer_load_dwordx4 v12, s[8:11], s38 offen sc1 lds
    s_add_u32 s38, s38, s37
    s_add_u32 s34, s34, 4096
    s_mov_b32 m0, s34
    s_nop 0
    buffer_load_dwordx4 v12, s[8:11], s38 offen sc1 lds
    s_add_u32 s38, s36, 896
    s_add_u32 s34, s39, 57344
    s_mov_b32 m0, s34
    s_nop 0
    buffer_load_dwordx4 v12, s[8:11], s38 offen sc1 lds
    s_add_u32 s38, s38, s37
    s_add_u32 s34, s34, 4096
    s_mov_b32 m0, s34
    s_nop 0
    buffer_load_dwordx4 v12, s[8:11], s38 offen sc1 lds
    s_add_u32 s38, s36, 1024
    s_add_u32 s34, s39, 65536
    s_mov_b32 m0, s34
    s_nop 0
    buffer_load_dwordx4 v12, s[8:11], s38 offen sc1 lds
    s_add_u32 s38, s38, s37
    s_add_u32 s34, s34, 4096
    s_mov_b32 m0, s34
    s_nop 0
    buffer_load_dwordx4 v12, s[8:11], s38 offen sc1 lds
    v_mov_b64 v[128:129], 0
    v_mov_b64 v[130:131], 0
    v_mov_b64 v[132:133], 0
    v_mov_b64 v[134:135], 0
    v_mov_b64 v[136:137], 0
    v_mov_b64 v[138:139], 0
    v_mov_b64 v[140:141], 0
    v_mov_b64 v[142:143], 0
    v_mov_b64 v[144:145], 0
    v_mov_b64 v[146:147], 0
    v_mov_b64 v[148:149], 0
    v_mov_b64 v[150:151], 0
    v_mov_b64 v[152:153], 0
    v_mov_b64 v[154:155], 0
    v_mov_b64 v[156:157], 0
    v_mov_b64 v[158:159], 0
    v_mov_b64 v[160:161], 0
    v_mov_b64 v[162:163], 0
    v_mov_b64 v[164:165], 0
    v_mov_b64 v[166:167], 0
    v_mov_b64 v[168:169], 0
    v_mov_b64 v[170:171], 0
    v_mov_b64 v[172:173], 0
    v_mov_b64 v[174:175], 0
    v_add_u32 v10, 65536, v8
    v_add_u32 v11, 65536, v9
    s_waitcnt vmcnt(16)
    s_barrier
    ds_read_b128 v[32:35], v8 offset:0
    ds_read_b128 v[36:39], v8 offset:2048
    ds_read_b128 v[40:43], v8 offset:4096
    ds_read_b128 v[44:47], v8 offset:6144
    s_waitcnt lgkmcnt(0)
    v_mfma_f32_16x16x32_bf16 v[128:131], a[0:3], v[32:35], v[128:131]
    v_mfma_f32_16x16x32_bf16 v[132:135], a[72:75], v[32:35], v[132:135]
    ds_read_b128 v[64:67], v9 offset:0
    v_mfma_f32_16x16x32_bf16 v[136:139], a[144:147], v[32:35], v[136:139]
    v_mfma_f32_16x16x32_bf16 v[140:143], a[0:3], v[36:39], v[140:143]
    ds_read_b128 v[68:71], v9 offset:2048
    v_mfma_f32_16x16x32_bf16 v[144:147], a[72:75], v[36:39], v[144:147]
    v_mfma_f32_16x16x32_bf16 v[148:151], a[144:147], v[36:39], v[148:151]
    ds_read_b128 v[72:75], v9 offset:4096
    v_mfma_f32_16x16x32_bf16 v[152:155], a[0:3], v[40:43], v[152:155]
    v_mfma_f32_16x16x32_bf16 v[156:159], a[72:75], v[40:43], v[156:159]
    ds_read_b128 v[76:79], v9 offset:6144
    v_mfma_f32_16x16x32_bf16 v[160:163], a[144:147], v[40:43], v[160:163]
    v_mfma_f32_16x16x32_bf16 v[164:167], a[0:3], v[44:47], v[164:167]
    v_mfma_f32_16x16x32_bf16 v[168:171], a[72:75], v[44:47], v[168:171]
    v_mfma_f32_16x16x32_bf16 v[172:175], a[144:147], v[44:47], v[172:175]
    s_waitcnt lgkmcnt(0)
    v_mfma_f32_16x16x32_bf16 v[128:131], a[4:7], v[64:67], v[128:131]
    v_mfma_f32_16x16x32_bf16 v[132:135], a[76:79], v[64:67], v[132:135]
    s_waitcnt vmcnt(14)
    v_mfma_f32_16x16x32_bf16 v[136:139], a[148:151], v[64:67], v[136:139]
    v_mfma_f32_16x16x32_bf16 v[140:143], a[4:7], v[68:71], v[140:143]
    s_barrier
    v_mfma_f32_16x16x32_bf16 v[144:147], a[76:79], v[68:71], v[144:147]
    v_mfma_f32_16x16x32_bf16 v[148:151], a[148:151], v[68:71], v[148:151]
    ds_read_b128 v[32:35], v8 offset:8192
    v_mfma_f32_16x16x32_bf16 v[152:155], a[4:7], v[72:75], v[152:155]
    v_mfma_f32_16x16x32_bf16 v[156:159], a[76:79], v[72:75], v[156:159]
    ds_read_b128 v[36:39], v8 offset:10240
    v_mfma_f32_16x16x32_bf16 v[160:163], a[148:151], v[72:75], v[160:163]
    v_mfma_f32_16x16x32_bf16 v[164:167], a[4:7], v[76:79], v[164:167]
    ds_read_b128 v[40:43], v8 offset:12288
    v_mfma_f32_16x16x32_bf16 v[168:171], a[76:79], v[76:79], v[168:171]
    v_mfma_f32_16x16x32_bf16 v[172:175], a[148:151], v[76:79], v[172:175]
    ds_read_b128 v[44:47], v8 offset:14336
    s_waitcnt lgkmcnt(0)
    v_mfma_f32_16x16x32_bf16 v[128:131], a[8:11], v[32:35], v[128:131]
    v_mfma_f32_16x16x32_bf16 v[132:135], a[80:83], v[32:35], v[132:135]
    ds_read_b128 v[64:67], v9 offset:8192
    v_mfma_f32_16x16x32_bf16 v[136:139], a[152:155], v[32:35], v[136:139]
    v_mfma_f32_16x16x32_bf16 v[140:143], a[8:11], v[36:39], v[140:143]
    ds_read_b128 v[68:71], v9 offset:10240
    v_mfma_f32_16x16x32_bf16 v[144:147], a[80:83], v[36:39], v[144:147]
    v_mfma_f32_16x16x32_bf16 v[148:151], a[152:155], v[36:39], v[148:151]
    ds_read_b128 v[72:75], v9 offset:12288
    v_mfma_f32_16x16x32_bf16 v[152:155], a[8:11], v[40:43], v[152:155]
    v_mfma_f32_16x16x32_bf16 v[156:159], a[80:83], v[40:43], v[156:159]
    ds_read_b128 v[76:79], v9 offset:14336
    v_mfma_f32_16x16x32_bf16 v[160:163], a[152:155], v[40:43], v[160:163]
    v_mfma_f32_16x16x32_bf16 v[164:167], a[8:11], v[44:47], v[164:167]
    v_mfma_f32_16x16x32_bf16 v[168:171], a[80:83], v[44:47], v[168:171]
    v_mfma_f32_16x16x32_bf16 v[172:175], a[152:155], v[44:47], v[172:175]
    s_waitcnt lgkmcnt(0)
    v_mfma_f32_16x16x32_bf16 v[128:131], a[12:15], v[64:67], v[128:131]
    v_mfma_f32_16x16x32_bf16 v[132:135], a[84:87], v[64:67], v[132:135]
    s_waitcnt vmcnt(12)
    v_mfma_f32_16x16x32_bf16 v[136:139], a[156:159], v[64:67], v[136:139]
    v_mfma_f32_16x16x32_bf16 v[140:143], a[12:15], v[68:71], v[140:143]
    s_barrier
    v_mfma_f32_16x16x32_bf16 v[144:147], a[84:87], v[68:71], v[144:147]
    v_mfma_f32_16x16x32_bf16 v[148:151], a[156:159], v[68:71], v[148:151]
    ds_read_b128 v[32:35], v8 offset:16384
    v_mfma_f32_16x16x32_bf16 v[152:155], a[12:15], v[72:75], v[152:155]
    v_mfma_f32_16x16x32_bf16 v[156:159], a[84:87], v[72:75], v[156:159]
    ds_read_b128 v[36:39], v8 offset:18432
    v_mfma_f32_16x16x32_bf16 v[160:163], a[156:159], v[72:75], v[160:163]
    v_mfma_f32_16x16x32_bf16 v[164:167], a[12:15], v[76:79], v[164:167]
    ds_read_b128 v[40:43], v8 offset:20480
    v_mfma_f32_16x16x32_bf16 v[168:171], a[84:87], v[76:79], v[168:171]
    v_mfma_f32_16x16x32_bf16 v[172:175], a[156:159], v[76:79], v[172:175]
    ds_read_b128 v[44:47], v8 offset:22528
    s_waitcnt lgkmcnt(0)
    v_mfma_f32_16x16x32_bf16 v[128:131], a[16:19], v[32:35], v[128:131]
    v_mfma_f32_16x16x32_bf16 v[132:135], a[88:91], v[32:35], v[132:135]
    ds_read_b128 v[64:67], v9 offset:16384
    v_mfma_f32_16x16x32_bf16 v[136:139], a[160:163], v[32:35], v[136:139]
    v_mfma_f32_16x16x32_bf16 v[140:143], a[16:19], v[36:39], v[140:143]
    ds_read_b128 v[68:71], v9 offset:18432
    v_mfma_f32_16x16x32_bf16 v[144:147], a[88:91], v[36:39], v[144:147]
    v_mfma_f32_16x16x32_bf16 v[148:151], a[160:163], v[36:39], v[148:151]
    ds_read_b128 v[72:75], v9 offset:20480
    v_mfma_f32_16x16x32_bf16 v[152:155], a[16:19], v[40:43], v[152:155]
    v_mfma_f32_16x16x32_bf16 v[156:159], a[88:91], v[40:43], v[156:159]
    ds_read_b128 v[76:79], v9 offset:22528
    v_mfma_f32_16x16x32_bf16 v[160:163], a[160:163], v[40:43], v[160:163]
    v_mfma_f32_16x16x32_bf16 v[164:167], a[16:19], v[44:47], v[164:167]
    v_mfma_f32_16x16x32_bf16 v[168:171], a[88:91], v[44:47], v[168:171]
    v_mfma_f32_16x16x32_bf16 v[172:175], a[160:163], v[44:47], v[172:175]
    s_waitcnt lgkmcnt(0)
    v_mfma_f32_16x16x32_bf16 v[128:131], a[20:23], v[64:67], v[128:131]
    v_mfma_f32_16x16x32_bf16 v[132:135], a[92:95], v[64:67], v[132:135]
    s_waitcnt vmcnt(10)
    v_mfma_f32_16x16x32_bf16 v[136:139], a[164:167], v[64:67], v[136:139]
    v_mfma_f32_16x16x32_bf16 v[140:143], a[20:23], v[68:71], v[140:143]
    s_barrier
    v_mfma_f32_16x16x32_bf16 v[144:147], a[92:95], v[68:71], v[144:147]
    v_mfma_f32_16x16x32_bf16 v[148:151], a[164:167], v[68:71], v[148:151]
    ds_read_b128 v[32:35], v8 offset:24576
    v_mfma_f32_16x16x32_bf16 v[152:155], a[20:23], v[72:75], v[152:155]
    v_mfma_f32_16x16x32_bf16 v[156:159], a[92:95], v[72:75], v[156:159]
    ds_read_b128 v[36:39], v8 offset:26624
    v_mfma_f32_16x16x32_bf16 v[160:163], a[164:167], v[72:75], v[160:163]
    v_mfma_f32_16x16x32_bf16 v[164:167], a[20:23], v[76:79], v[164:167]
    ds_read_b128 v[40:43], v8 offset:28672
    v_mfma_f32_16x16x32_bf16 v[168:171], a[92:95], v[76:79], v[168:171]
    v_mfma_f32_16x16x32_bf16 v[172:175], a[164:167], v[76:79], v[172:175]
    ds_read_b128 v[44:47], v8 offset:30720
    s_waitcnt lgkmcnt(0)
    v_mfma_f32_16x16x32_bf16 v[128:131], a[24:27], v[32:35], v[128:131]
    v_mfma_f32_16x16x32_bf16 v[132:135], a[96:99], v[32:35], v[132:135]
    ds_read_b128 v[64:67], v9 offset:24576
    v_mfma_f32_16x16x32_bf16 v[136:139], a[168:171], v[32:35], v[136:139]
    v_mfma_f32_16x16x32_bf16 v[140:143], a[24:27], v[36:39], v[140:143]
    ds_read_b128 v[68:71], v9 offset:26624
    v_mfma_f32_16x16x32_bf16 v[144:147], a[96:99], v[36:39], v[144:147]
    v_mfma_f32_16x16x32_bf16 v[148:151], a[168:171], v[36:39], v[148:151]
    ds_read_b128 v[72:75], v9 offset:28672
    v_mfma_f32_16x16x32_bf16 v[152:155], a[24:27], v[40:43], v[152:155]
    v_mfma_f32_16x16x32_bf16 v[156:159], a[96:99], v[40:43], v[156:159]
    ds_read_b128 v[76:79], v9 offset:30720
    v_mfma_f32_16x16x32_bf16 v[160:163], a[168:171], v[40:43], v[160:163]
    v_mfma_f32_16x16x32_bf16 v[164:167], a[24:27], v[44:47], v[164:167]
    v_mfma_f32_16x16x32_bf16 v[168:171], a[96:99], v[44:47], v[168:171]
    v_mfma_f32_16x16x32_bf16 v[172:175], a[168:171], v[44:47], v[172:175]
    s_waitcnt lgkmcnt(0)
    v_mfma_f32_16x16x32_bf16 v[128:131], a[28:31], v[64:67], v[128:131]
    v_mfma_f32_16x16x32_bf16 v[132:135], a[100:103], v[64:67], v[132:135]
    s_waitcnt vmcnt(8)
    v_mfma_f32_16x16x32_bf16 v[136:139], a[172:175], v[64:67], v[136:139]
    v_mfma_f32_16x16x32_bf16 v[140:143], a[28:31], v[68:71], v[140:143]
    s_barrier
    v_mfma_f32_16x16x32_bf16 v[144:147], a[100:103], v[68:71], v[144:147]
    v_mfma_f32_16x16x32_bf16 v[148:151], a[172:175], v[68:71], v[148:151]
    ds_read_b128 v[32:35], v8 offset:32768
    v_mfma_f32_16x16x32_bf16 v[152:155], a[28:31], v[72:75], v[152:155]
    v_mfma_f32_16x16x32_bf16 v[156:159], a[100:103], v[72:75], v[156:159]
    ds_read_b128 v[36:39], v8 offset:34816
    v_mfma_f32_16x16x32_bf16 v[160:163], a[172:175], v[72:75], v[160:163]
    v_mfma_f32_16x16x32_bf16 v[164:167], a[28:31], v[76:79], v[164:167]
    ds_read_b128 v[40:43], v8 offset:36864
    v_mfma_f32_16x16x32_bf16 v[168:171], a[100:103], v[76:79], v[168:171]
    v_mfma_f32_16x16x32_bf16 v[172:175], a[172:175], v[76:79], v[172:175]
    ds_read_b128 v[44:47], v8 offset:38912
    s_waitcnt lgkmcnt(0)
    v_mfma_f32_16x16x32_bf16 v[128:131], a[32:35], v[32:35], v[128:131]
    v_mfma_f32_16x16x32_bf16 v[132:135], a[104:107], v[32:35], v[132:135]
    ds_read_b128 v[64:67], v9 offset:32768
    v_mfma_f32_16x16x32_bf16 v[136:139], a[176:179], v[32:35], v[136:139]
    v_mfma_f32_16x16x32_bf16 v[140:143], a[32:35], v[36:39], v[140:143]
    ds_read_b128 v[68:71], v9 offset:34816
    v_mfma_f32_16x16x32_bf16 v[144:147], a[104:107], v[36:39], v[144:147]
    v_mfma_f32_16x16x32_bf16 v[148:151], a[176:179], v[36:39], v[148:151]
    ds_read_b128 v[72:75], v9 offset:36864
    v_mfma_f32_16x16x32_bf16 v[152:155], a[32:35], v[40:43], v[152:155]
    v_mfma_f32_16x16x32_bf16 v[156:159], a[104:107], v[40:43], v[156:159]
    ds_read_b128 v[76:79], v9 offset:38912
    v_mfma_f32_16x16x32_bf16 v[160:163], a[176:179], v[40:43], v[160:163]
    v_mfma_f32_16x16x32_bf16 v[164:167], a[32:35], v[44:47], v[164:167]
    v_mfma_f32_16x16x32_bf16 v[168:171], a[104:107], v[44:47], v[168:171]
    v_mfma_f32_16x16x32_bf16 v[172:175], a[176:179], v[44:47], v[172:175]
    s_waitcnt lgkmcnt(0)
    v_mfma_f32_16x16x32_bf16 v[128:131], a[36:39], v[64:67], v[128:131]
    v_mfma_f32_16x16x32_bf16 v[132:135], a[108:111], v[64:67], v[132:135]
    s_waitcnt vmcnt(6)
    v_mfma_f32_16x16x32_bf16 v[136:139], a[180:183], v[64:67], v[136:139]
    v_mfma_f32_16x16x32_bf16 v[140:143], a[36:39], v[68:71], v[140:143]
    s_barrier
    v_mfma_f32_16x16x32_bf16 v[144:147], a[108:111], v[68:71], v[144:147]
    v_mfma_f32_16x16x32_bf16 v[148:151], a[180:183], v[68:71], v[148:151]
    ds_read_b128 v[32:35], v8 offset:40960
    v_mfma_f32_16x16x32_bf16 v[152:155], a[36:39], v[72:75], v[152:155]
    v_mfma_f32_16x16x32_bf16 v[156:159], a[108:111], v[72:75], v[156:159]
    ds_read_b128 v[36:39], v8 offset:43008
    v_mfma_f32_16x16x32_bf16 v[160:163], a[180:183], v[72:75], v[160:163]
    v_mfma_f32_16x16x32_bf16 v[164:167], a[36:39], v[76:79], v[164:167]
    ds_read_b128 v[40:43], v8 offset:45056
    v_mfma_f32_16x16x32_bf16 v[168:171], a[108:111], v[76:79], v[168:171]
    v_mfma_f32_16x16x32_bf16 v[172:175], a[180:183], v[76:79], v[172:175]
    ds_read_b128 v[44:47], v8 offset:47104
    s_waitcnt lgkmcnt(0)
    v_mfma_f32_16x16x32_bf16 v[128:131], a[40:43], v[32:35], v[128:131]
    v_mfma_f32_16x16x32_bf16 v[132:135], a[112:115], v[32:35], v[132:135]
    ds_read_b128 v[64:67], v9 offset:40960
    v_mfma_f32_16x16x32_bf16 v[136:139], a[184:187], v[32:35], v[136:139]
    v_mfma_f32_16x16x32_bf16 v[140:143], a[40:43], v[36:39], v[140:143]
    ds_read_b128 v[68:71], v9 offset:43008
    v_mfma_f32_16x16x32_bf16 v[144:147], a[112:115], v[36:39], v[144:147]
    v_mfma_f32_16x16x32_bf16 v[148:151], a[184:187], v[36:39], v[148:151]
    ds_read_b128 v[72:75], v9 offset:45056
    v_mfma_f32_16x16x32_bf16 v[152:155], a[40:43], v[40:43], v[152:155]
    v_mfma_f32_16x16x32_bf16 v[156:159], a[112:115], v[40:43], v[156:159]
    ds_read_b128 v[76:79], v9 offset:47104
    v_mfma_f32_16x16x32_bf16 v[160:163], a[184:187], v[40:43], v[160:163]
    v_mfma_f32_16x16x32_bf16 v[164:167], a[40:43], v[44:47], v[164:167]
    v_mfma_f32_16x16x32_bf16 v[168:171], a[112:115], v[44:47], v[168:171]
    v_mfma_f32_16x16x32_bf16 v[172:175], a[184:187], v[44:47], v[172:175]
    s_waitcnt lgkmcnt(0)
    v_mfma_f32_16x16x32_bf16 v[128:131], a[44:47], v[64:67], v[128:131]
    v_mfma_f32_16x16x32_bf16 v[132:135], a[116:119], v[64:67], v[132:135]
    s_waitcnt vmcnt(4)
    v_mfma_f32_16x16x32_bf16 v[136:139], a[188:191], v[64:67], v[136:139]
    v_mfma_f32_16x16x32_bf16 v[140:143], a[44:47], v[68:71], v[140:143]
    s_barrier
    v_mfma_f32_16x16x32_bf16 v[144:147], a[116:119], v[68:71], v[144:147]
    v_mfma_f32_16x16x32_bf16 v[148:151], a[188:191], v[68:71], v[148:151]
    ds_read_b128 v[32:35], v8 offset:49152
    v_mfma_f32_16x16x32_bf16 v[152:155], a[44:47], v[72:75], v[152:155]
    v_mfma_f32_16x16x32_bf16 v[156:159], a[116:119], v[72:75], v[156:159]
    ds_read_b128 v[36:39], v8 offset:51200
    v_mfma_f32_16x16x32_bf16 v[160:163], a[188:191], v[72:75], v[160:163]
    v_mfma_f32_16x16x32_bf16 v[164:167], a[44:47], v[76:79], v[164:167]
    ds_read_b128 v[40:43], v8 offset:53248
    v_mfma_f32_16x16x32_bf16 v[168:171], a[116:119], v[76:79], v[168:171]
    v_mfma_f32_16x16x32_bf16 v[172:175], a[188:191], v[76:79], v[172:175]
    ds_read_b128 v[44:47], v8 offset:55296
    s_waitcnt lgkmcnt(0)
    v_mfma_f32_16x16x32_bf16 v[128:131], a[48:51], v[32:35], v[128:131]
    v_mfma_f32_16x16x32_bf16 v[132:135], a[120:123], v[32:35], v[132:135]
    ds_read_b128 v[64:67], v9 offset:49152
    v_mfma_f32_16x16x32_bf16 v[136:139], a[192:195], v[32:35], v[136:139]
    v_mfma_f32_16x16x32_bf16 v[140:143], a[48:51], v[36:39], v[140:143]
    ds_read_b128 v[68:71], v9 offset:51200
    v_mfma_f32_16x16x32_bf16 v[144:147], a[120:123], v[36:39], v[144:147]
    v_mfma_f32_16x16x32_bf16 v[148:151], a[192:195], v[36:39], v[148:151]
    ds_read_b128 v[72:75], v9 offset:53248
    v_mfma_f32_16x16x32_bf16 v[152:155], a[48:51], v[40:43], v[152:155]
    v_mfma_f32_16x16x32_bf16 v[156:159], a[120:123], v[40:43], v[156:159]
    ds_read_b128 v[76:79], v9 offset:55296
    v_mfma_f32_16x16x32_bf16 v[160:163], a[192:195], v[40:43], v[160:163]
    v_mfma_f32_16x16x32_bf16 v[164:167], a[48:51], v[44:47], v[164:167]
    v_mfma_f32_16x16x32_bf16 v[168:171], a[120:123], v[44:47], v[168:171]
    v_mfma_f32_16x16x32_bf16 v[172:175], a[192:195], v[44:47], v[172:175]
    s_waitcnt lgkmcnt(0)
    v_mfma_f32_16x16x32_bf16 v[128:131], a[52:55], v[64:67], v[128:131]
    v_mfma_f32_16x16x32_bf16 v[132:135], a[124:127], v[64:67], v[132:135]
    s_waitcnt vmcnt(2)
    v_mfma_f32_16x16x32_bf16 v[136:139], a[196:199], v[64:67], v[136:139]
    v_mfma_f32_16x16x32_bf16 v[140:143], a[52:55], v[68:71], v[140:143]
    s_barrier
    v_mfma_f32_16x16x32_bf16 v[144:147], a[124:127], v[68:71], v[144:147]
    v_mfma_f32_16x16x32_bf16 v[148:151], a[196:199], v[68:71], v[148:151]
    ds_read_b128 v[32:35], v8 offset:57344
    v_mfma_f32_16x16x32_bf16 v[152:155], a[52:55], v[72:75], v[152:155]
    v_mfma_f32_16x16x32_bf16 v[156:159], a[124:127], v[72:75], v[156:159]
    ds_read_b128 v[36:39], v8 offset:59392
    v_mfma_f32_16x16x32_bf16 v[160:163], a[196:199], v[72:75], v[160:163]
    v_mfma_f32_16x16x32_bf16 v[164:167], a[52:55], v[76:79], v[164:167]
    ds_read_b128 v[40:43], v8 offset:61440
    v_mfma_f32_16x16x32_bf16 v[168:171], a[124:127], v[76:79], v[168:171]
    v_mfma_f32_16x16x32_bf16 v[172:175], a[196:199], v[76:79], v[172:175]
    ds_read_b128 v[44:47], v8 offset:63488
    s_waitcnt lgkmcnt(0)
    v_mfma_f32_16x16x32_bf16 v[128:131], a[56:59], v[32:35], v[128:131]
    v_mfma_f32_16x16x32_bf16 v[132:135], a[128:131], v[32:35], v[132:135]
    ds_read_b128 v[64:67], v9 offset:57344
    v_mfma_f32_16x16x32_bf16 v[136:139], a[200:203], v[32:35], v[136:139]
    v_mfma_f32_16x16x32_bf16 v[140:143], a[56:59], v[36:39], v[140:143]
    ds_read_b128 v[68:71], v9 offset:59392
    v_mfma_f32_16x16x32_bf16 v[144:147], a[128:131], v[36:39], v[144:147]
    v_mfma_f32_16x16x32_bf16 v[148:151], a[200:203], v[36:39], v[148:151]
    ds_read_b128 v[72:75], v9 offset:61440
    v_mfma_f32_16x16x32_bf16 v[152:155], a[56:59], v[40:43], v[152:155]
    v_mfma_f32_16x16x32_bf16 v[156:159], a[128:131], v[40:43], v[156:159]
    ds_read_b128 v[76:79], v9 offset:63488
    v_mfma_f32_16x16x32_bf16 v[160:163], a[200:203], v[40:43], v[160:163]
    v_mfma_f32_16x16x32_bf16 v[164:167], a[56:59], v[44:47], v[164:167]
    v_mfma_f32_16x16x32_bf16 v[168:171], a[128:131], v[44:47], v[168:171]
    v_mfma_f32_16x16x32_bf16 v[172:175], a[200:203], v[44:47], v[172:175]
    s_waitcnt lgkmcnt(0)
    v_mfma_f32_16x16x32_bf16 v[128:131], a[60:63], v[64:67], v[128:131]
    v_mfma_f32_16x16x32_bf16 v[132:135], a[132:135], v[64:67], v[132:135]
    s_waitcnt vmcnt(0)
    v_mfma_f32_16x16x32_bf16 v[136:139], a[204:207], v[64:67], v[136:139]
    v_mfma_f32_16x16x32_bf16 v[140:143], a[60:63], v[68:71], v[140:143]
    s_barrier
    v_mfma_f32_16x16x32_bf16 v[144:147], a[132:135], v[68:71], v[144:147]
    v_mfma_f32_16x16x32_bf16 v[148:151], a[204:207], v[68:71], v[148:151]
    ds_read_b128 v[32:35], v10 offset:0
    v_mfma_f32_16x16x32_bf16 v[152:155], a[60:63], v[72:75], v[152:155]
    v_mfma_f32_16x16x32_bf16 v[156:159], a[132:135], v[72:75], v[156:159]
    ds_read_b128 v[36:39], v10 offset:2048
    v_mfma_f32_16x16x32_bf16 v[160:163], a[204:207], v[72:75], v[160:163]
    v_mfma_f32_16x16x32_bf16 v[164:167], a[60:63], v[76:79], v[164:167]
    ds_read_b128 v[40:43], v10 offset:4096
    v_mfma_f32_16x16x32_bf16 v[168:171], a[132:135], v[76:79], v[168:171]
    v_mfma_f32_16x16x32_bf16 v[172:175], a[204:207], v[76:79], v[172:175]
    ds_read_b128 v[44:47], v10 offset:6144
    s_waitcnt lgkmcnt(0)
    v_mfma_f32_16x16x32_bf16 v[128:131], a[64:67], v[32:35], v[128:131]
    v_mfma_f32_16x16x32_bf16 v[132:135], a[136:139], v[32:35], v[132:135]
    ds_read_b128 v[64:67], v11 offset:0
    v_mfma_f32_16x16x32_bf16 v[136:139], a[208:211], v[32:35], v[136:139]
    v_mfma_f32_16x16x32_bf16 v[140:143], a[64:67], v[36:39], v[140:143]
    ds_read_b128 v[68:71], v11 offset:2048
    v_mfma_f32_16x16x32_bf16 v[144:147], a[136:139], v[36:39], v[144:147]
    v_mfma_f32_16x16x32_bf16 v[148:151], a[208:211], v[36:39], v[148:151]
    ds_read_b128 v[72:75], v11 offset:4096
    v_mfma_f32_16x16x32_bf16 v[152:155], a[64:67], v[40:43], v[152:155]
    v_mfma_f32_16x16x32_bf16 v[156:159], a[136:139], v[40:43], v[156:159]
    ds_read_b128 v[76:79], v11 offset:6144
    v_mfma_f32_16x16x32_bf16 v[160:163], a[208:211], v[40:43], v[160:163]
    v_mfma_f32_16x16x32_bf16 v[164:167], a[64:67], v[44:47], v[164:167]
    v_mfma_f32_16x16x32_bf16 v[168:171], a[136:139], v[44:47], v[168:171]
    v_mfma_f32_16x16x32_bf16 v[172:175], a[208:211], v[44:47], v[172:175]
    s_waitcnt lgkmcnt(0)
    v_mfma_f32_16x16x32_bf16 v[128:131], a[68:71], v[64:67], v[128:131]
    v_mfma_f32_16x16x32_bf16 v[132:135], a[140:143], v[64:67], v[132:135]
    v_mfma_f32_16x16x32_bf16 v[136:139], a[212:215], v[64:67], v[136:139]
    v_mfma_f32_16x16x32_bf16 v[140:143], a[68:71], v[68:71], v[140:143]
    v_mfma_f32_16x16x32_bf16 v[144:147], a[140:143], v[68:71], v[144:147]
    v_mfma_f32_16x16x32_bf16 v[148:151], a[212:215], v[68:71], v[148:151]
    v_mfma_f32_16x16x32_bf16 v[152:155], a[68:71], v[72:75], v[152:155]
    v_mfma_f32_16x16x32_bf16 v[156:159], a[140:143], v[72:75], v[156:159]
    v_mfma_f32_16x16x32_bf16 v[160:163], a[212:215], v[72:75], v[160:163]
    v_mfma_f32_16x16x32_bf16 v[164:167], a[68:71], v[76:79], v[164:167]
    v_mfma_f32_16x16x32_bf16 v[168:171], a[140:143], v[76:79], v[168:171]
    v_mfma_f32_16x16x32_bf16 v[172:175], a[212:215], v[76:79], v[172:175]
    s_nop 7
    s_mov_b32 s53, 98304
    s_mov_b32 s56, 1152
    s_mul_i32 s57, s78, 2359296
    s_mul_i32 s54, s52, 1152
    s_add_u32 s57, s57, s54
    s_mul_i32 s54, s79, 384
    s_add_u32 s57, s57, s54
    s_add_u32 s57, s57, 167772160
    v_and_b32 v1, 63, v0
    v_and_b32 v2, 31, v1
    v_mul_u32_u24 v2, 384, v2
    v_add_u32 v2, s53, v2
    v_lshrrev_b32 v3, 5, v1
    s_mul_i32 s36, s17, 6
    v_add_u32 v3, s36, v3
    v_and_b32 v4, 7, v1
    v_add_u32 v5, 0, v3
    v_xor_b32 v5, v5, v4
    v_lshlrev_b32 v5, 4, v5
    v_add_u32 v16, v2, v5
    v_add_u32 v5, 2, v3
    v_xor_b32 v5, v5, v4
    v_lshlrev_b32 v5, 4, v5
    v_add_u32 v17, v2, v5
    v_add_u32 v5, 4, v3
    v_xor_b32 v5, v5, v4
    v_lshlrev_b32 v5, 4, v5
    v_add_u32 v18, v2, v5
    v_cvt_pk_bf16_f32 v32, v128, v129
    v_cvt_pk_bf16_f32 v33, v130, v131
    v_cvt_pk_bf16_f32 v34, v140, v141
    v_cvt_pk_bf16_f32 v35, v142, v143
    s_nop 0
    v_permlane16_swap_b32 v32, v34
    v_permlane16_swap_b32 v33, v35
    ds_write_b128 v16, v[32:35] offset:0
    v_cvt_pk_bf16_f32 v36, v132, v133
    v_cvt_pk_bf16_f32 v37, v134, v135
    v_cvt_pk_bf16_f32 v38, v144, v145
    v_cvt_pk_bf16_f32 v39, v146, v147
    s_nop 0
    v_permlane16_swap_b32 v36, v38
    v_permlane16_swap_b32 v37, v39
    ds_write_b128 v17, v[36:39] offset:0
    v_cvt_pk_bf16_f32 v40, v136, v137
    v_cvt_pk_bf16_f32 v41, v138, v139
    v_cvt_pk_bf16_f32 v42, v148, v149
    v_cvt_pk_bf16_f32 v43, v150, v151
    s_nop 0
    v_permlane16_swap_b32 v40, v42
    v_permlane16_swap_b32 v41, v43
    ds_write_b128 v18, v[40:43] offset:0
    v_cvt_pk_bf16_f32 v44, v152, v153
    v_cvt_pk_bf16_f32 v45, v154, v155
    v_cvt_pk_bf16_f32 v46, v164, v165
    v_cvt_pk_bf16_f32 v47, v166, v167
    s_nop 0
    v_permlane16_swap_b32 v44, v46
    v_permlane16_swap_b32 v45, v47
    ds_write_b128 v16, v[44:47] offset:12288
    v_cvt_pk_bf16_f32 v48, v156, v157
    v_cvt_pk_bf16_f32 v49, v158, v159
    v_cvt_pk_bf16_f32 v50, v168, v169
    v_cvt_pk_bf16_f32 v51, v170, v171
    s_nop 0
    v_permlane16_swap_b32 v48, v50
    v_permlane16_swap_b32 v49, v51
    ds_write_b128 v17, v[48:51] offset:12288
    v_cvt_pk_bf16_f32 v52, v160, v161
    v_cvt_pk_bf16_f32 v53, v162, v163
    v_cvt_pk_bf16_f32 v54, v172, v173
    v_cvt_pk_bf16_f32 v55, v174, v175
    s_nop 0
    v_permlane16_swap_b32 v52, v54
    v_permlane16_swap_b32 v53, v55
    ds_write_b128 v18, v[52:55] offset:12288
    v_cmp_le_u32 vcc, 24, v1
    s_nop 1
    v_cndmask_b32 v2, 0, 1, vcc
    v_mul_u32_u24 v3, 24, v2
    v_sub_u32 v3, v1, v3
    s_mul_i32 s36, s17, 16
    v_xor_b32 v4, v3, v2
    v_lshlrev_b32 v4, 4, v4
    v_add_u32 v2, s36, v2
    v_mul_u32_u24 v5, 384, v2
    v_add_u32 v5, s53, v5
    v_mul_lo_u32 v2, v2, s56
    v_lshlrev_b32 v3, 4, v3
    v_add_u32 v18, v2, v3
    v_mov_b32 v2, 0x40000000
    v_cmp_gt_u32 vcc, 48, v1
    s_nop 1
    v_cndmask_b32 v18, v2, v18, vcc
    s_lshl_b32 s37, s56, 1
    s_mov_b32 s39, s57
    v_xor_b32 v3, 0, v4
    v_add_u32 v20, v5, v3
    v_xor_b32 v3, 32, v4
    v_add_u32 v21, v5, v3
    v_xor_b32 v3, 64, v4
    v_add_u32 v22, v5, v3
    v_xor_b32 v3, 96, v4
    v_add_u32 v23, v5, v3
    s_waitcnt lgkmcnt(0)
    s_barrier
    ds_read_b128 v[32:35], v20 offset:0
    ds_read_b128 v[36:39], v21 offset:768
    ds_read_b128 v[40:43], v22 offset:1536
    ds_read_b128 v[44:47], v23 offset:2304
    ds_read_b128 v[48:51], v20 offset:3072
    ds_read_b128 v[52:55], v21 offset:3840
    ds_read_b128 v[56:59], v22 offset:4608
    ds_read_b128 v[60:63], v23 offset:5376
    s_waitcnt lgkmcnt(7)
    buffer_store_dwordx4 v[32:35], v18, s[4:7], s39 offen sc1
    s_add_u32 s39, s39, s37
    s_waitcnt lgkmcnt(6)
    buffer_store_dwordx4 v[36:39], v18, s[4:7], s39 offen sc1
    s_add_u32 s39, s39, s37
    s_waitcnt lgkmcnt(5)
    buffer_store_dwordx4 v[40:43], v18, s[4:7], s39 offen sc1
    s_add_u32 s39, s39, s37
    s_waitcnt lgkmcnt(4)
    buffer_store_dwordx4 v[44:47], v18, s[4:7], s39 offen sc1
    s_add_u32 s39, s39, s37
    s_waitcnt lgkmcnt(3)
    buffer_store_dwordx4 v[48:51], v18, s[4:7], s39 offen sc1
    s_add_u32 s39, s39, s37
    s_waitcnt lgkmcnt(2)
    buffer_store_dwordx4 v[52:55], v18, s[4:7], s39 offen sc1
    s_add_u32 s39, s39, s37
    s_waitcnt lgkmcnt(1)
    buffer_store_dwordx4 v[56:59], v18, s[4:7], s39 offen sc1
    s_add_u32 s39, s39, s37
    s_waitcnt lgkmcnt(0)
    buffer_store_dwordx4 v[60:63], v18, s[4:7], s39 offen sc1
    s_lshl_b32 s67, s65, 2
    s_and_b32 s20, s66, 3
    s_add_u32 s67, s67, s20
    s_lshl_b32 s67, s67, 8
    s_add_u32 s67, s67, 1785856
    s_waitcnt vmcnt(0)
    s_barrier
    s_cmp_lg_u32 s17, 0
    s_cbranch_scc1 Ls_81
    s_mov_b64 exec, 1
    v_mov_b32 v2, 0
    v_mov_b32 v3, 1
    buffer_atomic_add v3, v2, s[4:7], s67 offen
    s_mov_b64 exec, -1
Ls_81:
    s_add_u32 s65, s65, 2
    s_cmp_lt_u32 s65, 31
    s_cbranch_scc1 Lp_f2_l
    s_mov_b32 s65, 31
    s_mov_b32 s68, s78
    s_mul_i32 s67, s65, 8
    s_add_u32 s67, s67, s68
    s_lshl_b32 s67, s67, 8
    s_add_u32 s67, s67, 1720320
    s_cmp_lg_u32 s17, 0
    s_cbranch_scc1 Lw_84
    s_mov_b64 exec, 1
    v_mov_b32 v2, 0
    s_mov_b32 s70, 0
Lw_82:
    buffer_load_dword v3, v2, s[4:7], s67 offen sc1
    s_waitcnt vmcnt(0)
    v_readfirstlane_b32 s69, v3
    s_nop 2
    s_cmp_ge_u32 s69, 6
    s_cbranch_scc1 Lw_83
    s_sleep 2
    s_add_u32 s70, s70, 1
    s_cmp_lt_u32 s70, 524288
    s_cbranch_scc1 Lw_82
    s_branch Lfail
Lw_83:
    s_mov_b64 exec, -1
Lw_84:
    s_barrier
    s_mov_b32 s8, s4
    s_mov_b32 s9, s5
    s_mov_b32 s10, s6
    s_mov_b32 s11, s7
    s_lshl_b32 s52, s65, 6
    s_lshl_b32 s54, s77, 5
    s_add_u32 s52, s52, s54
    s_mul_i32 s24, s52, 9216
    s_mul_i32 s54, s78, 1152
    s_add_u32 s24, s24, s54
    s_add_u32 s24, s24, 100663296
    s_lshl_b32 s36, s17, 3
    s_mul_i32 s36, s36, s25
    s_add_u32 s36, s36, s24
    s_lshl_b32 s37, s25, 5
    s_lshl_b32 s39, s17, 10
    s_add_u32 s38, s36, 0
    s_add_u32 s34, s39, 0
    s_mov_b32 m0, s34
    s_nop 0
    buffer_load_dwordx4 v12, s[8:11], s38 offen sc1 lds
    s_add_u32 s38, s36, 128
    s_add_u32 s34, s39, 4096
    s_mov_b32 m0, s34
    s_nop 0
    buffer_load_dwordx4 v12, s[8:11], s38 offen sc1 lds
    s_add_u32 s38, s36, 256
    s_add_u32 s34, s39, 8192
    s_mov_b32 m0, s34
    s_nop 0
    buffer_load_dwordx4 v12, s[8:11], s38 offen sc1 lds
    s_add_u32 s38, s36, 384
    s_add_u32 s34, s39, 12288
    s_mov_b32 m0, s34
    s_nop 0
    buffer_load_dwordx4 v12, s[8:11], s38 offen sc1 lds
    s_add_u32 s38, s36, 512
    s_add_u32 s34, s39, 16384
    s_mov_b32 m0, s34
    s_nop 0
    buffer_load_dwordx4 v12, s[8:11], s38 offen sc1 lds
    s_add_u32 s38, s36, 640
    s_add_u32 s34, s39, 20480
    s_mov_b32 m0, s34
    s_nop 0
    buffer_load_dwordx4 v12, s[8:11], s38 offen sc1 lds
    s_add_u32 s38, s36, 768
    s_add_u32 s34, s39, 24576
    s_mov_b32 m0, s34
    s_nop 0
    buffer_load_dwordx4 v12, s[8:11], s38 offen sc1 lds
    s_add_u32 s38, s36, 896
    s_add_u32 s34, s39, 28672
    s_mov_b32 m0, s34
    s_nop 0
    buffer_load_dwordx4 v12, s[8:11], s38 offen sc1 lds
    s_add_u32 s38, s36, 1024
    s_add_u32 s34, s39, 32768
    s_mov_b32 m0, s34
    s_nop 0
    buffer_load_dwordx4 v12, s[8:11], s38 offen sc1 lds
    v_mov_b64 v[128:129], 0
    v_mov_b64 v[130:131], 0
    v_mov_b64 v[132:133], 0
    v_mov_b64 v[134:135], 0
    v_mov_b64 v[136:137], 0
    v_mov_b64 v[138:139], 0
    v_mov_b64 v[140:141], 0
    v_mov_b64 v[142:143], 0
    v_mov_b64 v[144:145], 0
    v_mov_b64 v[146:147], 0
    v_mov_b64 v[148:149], 0
    v_mov_b64 v[150:151], 0
    v_add_u32 v10, 65536, v8
    v_add_u32 v11, 65536, v9
    s_waitcnt vmcnt(8)
    s_barrier
    ds_read_b128 v[32:35], v8 offset:0
    ds_read_b128 v[36:39], v8 offset:2048
    s_waitcnt lgkmcnt(0)
    v_mfma_f32_16x16x32_bf16 v[128:131], a[0:3], v[32:35], v[128:131]
    v_mfma_f32_16x16x32_bf16 v[132:135], a[72:75], v[32:35], v[132:135]
    ds_read_b128 v[64:67], v9 offset:0
    v_mfma_f32_16x16x32_bf16 v[136:139], a[144:147], v[32:35], v[136:139]
    v_mfma_f32_16x16x32_bf16 v[140:143], a[0:3], v[36:39], v[140:143]
    ds_read_b128 v[68:71], v9 offset:2048
    v_mfma_f32_16x16x32_bf16 v[144:147], a[72:75], v[36:39], v[144:147]
    v_mfma_f32_16x16x32_bf16 v[148:151], a[144:147], v[36:39], v[148:151]
    s_waitcnt lgkmcnt(0)
    v_mfma_f32_16x16x32_bf16 v[128:131], a[4:7], v[64:67], v[128:131]
    v_mfma_f32_16x16x32_bf16 v[132:135], a[76:79], v[64:67], v[132:135]
    s_waitcnt vmcnt(7)
    v_mfma_f32_16x16x32_bf16 v[136:139], a[148:151], v[64:67], v[136:139]
    v_mfma_f32_16x16x32_bf16 v[140:143], a[4:7], v[68:71], v[140:143]
    s_barrier
    v_mfma_f32_16x16x32_bf16 v[144:147], a[76:79], v[68:71], v[144:147]
    v_mfma_f32_16x16x32_bf16 v[148:151], a[148:151], v[68:71], v[148:151]
    ds_read_b128 v[32:35], v8 offset:4096
    ds_read_b128 v[36:39], v8 offset:6144
    s_waitcnt lgkmcnt(0)
    v_mfma_f32_16x16x32_bf16 v[128:131], a[8:11], v[32:35], v[128:131]
    v_mfma_f32_16x16x32_bf16 v[132:135], a[80:83], v[32:35], v[132:135]
    ds_read_b128 v[64:67], v9 offset:4096
    v_mfma_f32_16x16x32_bf16 v[136:139], a[152:155], v[32:35], v[136:139]
    v_mfma_f32_16x16x32_bf16 v[140:143], a[8:11], v[36:39], v[140:143]
    ds_read_b128 v[68:71], v9 offset:6144
    v_mfma_f32_16x16x32_bf16 v[144:147], a[80:83], v[36:39], v[144:147]
    v_mfma_f32_16x16x32_bf16 v[148:151], a[152:155], v[36:39], v[148:151]
    s_waitcnt lgkmcnt(0)
    v_mfma_f32_16x16x32_bf16 v[128:131], a[12:15], v[64:67], v[128:131]
    v_mfma_f32_16x16x32_bf16 v[132:135], a[84:87], v[64:67], v[132:135]
    s_waitcnt vmcnt(6)
    v_mfma_f32_16x16x32_bf16 v[136:139], a[156:159], v[64:67], v[136:139]
    v_mfma_f32_16x16x32_bf16 v[140:143], a[12:15], v[68:71], v[140:143]
    s_barrier
    v_mfma_f32_16x16x32_bf16 v[144:147], a[84:87], v[68:71], v[144:147]
    v_mfma_f32_16x16x32_bf16 v[148:151], a[156:159], v[68:71], v[148:151]
    ds_read_b128 v[32:35], v8 offset:8192
    ds_read_b128 v[36:39], v8 offset:10240
    s_waitcnt lgkmcnt(0)
    v_mfma_f32_16x16x32_bf16 v[128:131], a[16:19], v[32:35], v[128:131]
    v_mfma_f32_16x16x32_bf16 v[132:135], a[88:91], v[32:35], v[132:135]
    ds_read_b128 v[64:67], v9 offset:8192
    v_mfma_f32_16x16x32_bf16 v[136:139], a[160:163], v[32:35], v[136:139]
    v_mfma_f32_16x16x32_bf16 v[140:143], a[16:19], v[36:39], v[140:143]
    ds_read_b128 v[68:71], v9 offset:10240
    v_mfma_f32_16x16x32_bf16 v[144:147], a[88:91], v[36:39], v[144:147]
    v_mfma_f32_16x16x32_bf16 v[148:151], a[160:163], v[36:39], v[148:151]
    s_waitcnt lgkmcnt(0)
    v_mfma_f32_16x16x32_bf16 v[128:131], a[20:23], v[64:67], v[128:131]
    v_mfma_f32_16x16x32_bf16 v[132:135], a[92:95], v[64:67], v[132:135]
    s_waitcnt vmcnt(5)
    v_mfma_f32_16x16x32_bf16 v[136:139], a[164:167], v[64:67], v[136:139]
    v_mfma_f32_16x16x32_bf16 v[140:143], a[20:23], v[68:71], v[140:143]
    s_barrier
    v_mfma_f32_16x16x32_bf16 v[144:147], a[92:95], v[68:71], v[144:147]
    v_mfma_f32_16x16x32_bf16 v[148:151], a[164:167], v[68:71], v[148:151]
    ds_read_b128 v[32:35], v8 offset:12288
    ds_read_b128 v[36:39], v8 offset:14336
    s_waitcnt lgkmcnt(0)
    v_mfma_f32_16x16x32_bf16 v[128:131], a[24:27], v[32:35], v[128:131]
    v_mfma_f32_16x16x32_bf16 v[132:135], a[96:99], v[32:35], v[132:135]
    ds_read_b128 v[64:67], v9 offset:12288
    v_mfma_f32_16x16x32_bf16 v[136:139], a[168:171], v[32:35], v[136:139]
    v_mfma_f32_16x16x32_bf16 v[140:143], a[24:27], v[36:39], v[140:143]
    ds_read_b128 v[68:71], v9 offset:14336
    v_mfma_f32_16x16x32_bf16 v[144:147], a[96:99], v[36:39], v[144:147]
    v_mfma_f32_16x16x32_bf16 v[148:151], a[168:171], v[36:39], v[148:151]
    s_waitcnt lgkmcnt(0)
    v_mfma_f32_16x16x32_bf16 v[128:131], a[28:31], v[64:67], v[128:131]
    v_mfma_f32_16x16x32_bf16 v[132:135], a[100:103], v[64:67], v[132:135]
    s_waitcnt vmcnt(4)
    v_mfma_f32_16x16x32_bf16 v[136:139], a[172:175], v[64:67], v[136:139]
    v_mfma_f32_16x16x32_bf16 v[140:143], a[28:31], v[68:71], v[140:143]
    s_barrier
    v_mfma_f32_16x16x32_bf16 v[144:147], a[100:103], v[68:71], v[144:147]
    v_mfma_f32_16x16x32_bf16 v[148:151], a[172:175], v[68:71], v[148:151]
    ds_read_b128 v[32:35], v8 offset:16384
    ds_read_b128 v[36:39], v8 offset:18432
    s_waitcnt lgkmcnt(0)
    v_mfma_f32_16x16x32_bf16 v[128:131], a[32:35], v[32:35], v[128:131]
    v_mfma_f32_16x16x32_bf16 v[132:135], a[104:107], v[32:35], v[132:135]
    ds_read_b128 v[64:67], v9 offset:16384
    v_mfma_f32_16x16x32_bf16 v[136:139], a[176:179], v[32:35], v[136:139]
    v_mfma_f32_16x16x32_bf16 v[140:143], a[32:35], v[36:39], v[140:143]
    ds_read_b128 v[68:71], v9 offset:18432
    v_mfma_f32_16x16x32_bf16 v[144:147], a[104:107], v[36:39], v[144:147]
    v_mfma_f32_16x16x32_bf16 v[148:151], a[176:179], v[36:39], v[148:151]
    s_waitcnt lgkmcnt(0)
    v_mfma_f32_16x16x32_bf16 v[128:131], a[36:39], v[64:67], v[128:131]
    v_mfma_f32_16x16x32_bf16 v[132:135], a[108:111], v[64:67], v[132:135]
    s_waitcnt vmcnt(3)
    v_mfma_f32_16x16x32_bf16 v[136:139], a[180:183], v[64:67], v[136:139]
    v_mfma_f32_16x16x32_bf16 v[140:143], a[36:39], v[68:71], v[140:143]
    s_barrier
    v_mfma_f32_16x16x32_bf16 v[144:147], a[108:111], v[68:71], v[144:147]
    v_mfma_f32_16x16x32_bf16 v[148:151], a[180:183], v[68:71], v[148:151]
    ds_read_b128 v[32:35], v8 offset:20480
    ds_read_b128 v[36:39], v8 offset:22528
    s_waitcnt lgkmcnt(0)
    v_mfma_f32_16x16x32_bf16 v[128:131], a[40:43], v[32:35], v[128:131]
    v_mfma_f32_16x16x32_bf16 v[132:135], a[112:115], v[32:35], v[132:135]
    ds_read_b128 v[64:67], v9 offset:20480
    v_mfma_f32_16x16x32_bf16 v[136:139], a[184:187], v[32:35], v[136:139]
    v_mfma_f32_16x16x32_bf16 v[140:143], a[40:43], v[36:39], v[140:143]
    ds_read_b128 v[68:71], v9 offset:22528
    v_mfma_f32_16x16x32_bf16 v[144:147], a[112:115], v[36:39], v[144:147]
    v_mfma_f32_16x16x32_bf16 v[148:151], a[184:187], v[36:39], v[148:151]
    s_waitcnt lgkmcnt(0)
    v_mfma_f32_16x16x32_bf16 v[128:131], a[44:47], v[64:67], v[128:131]
    v_mfma_f32_16x16x32_bf16 v[132:135], a[116:119], v[64:67], v[132:135]
    s_waitcnt vmcnt(2)
    v_mfma_f32_16x16x32_bf16 v[136:139], a[188:191], v[64:67], v[136:139]
    v_mfma_f32_16x16x32_bf16 v[140:143], a[44:47], v[68:71], v[140:143]
    s_barrier
    v_mfma_f32_16x16x32_bf16 v[144:147], a[116:119], v[68:71], v[144:147]
    v_mfma_f32_16x16x32_bf16 v[148:151], a[188:191], v[68:71], v[148:151]
    ds_read_b128 v[32:35], v8 offset:24576
    ds_read_b128 v[36:39], v8 offset:26624
    s_waitcnt lgkmcnt(0)
    v_mfma_f32_16x16x32_bf16 v[128:131], a[48:51], v[32:35], v[128:131]
    v_mfma_f32_16x16x32_bf16 v[132:135], a[120:123], v[32:35], v[132:135]
    ds_read_b128 v[64:67], v9 offset:24576
    v_mfma_f32_16x16x32_bf16 v[136:139], a[192:195], v[32:35], v[136:139]
    v_mfma_f32_16x16x32_bf16 v[140:143], a[48:51], v[36:39], v[140:143]
    ds_read_b128 v[68:71], v9 offset:26624
    v_mfma_f32_16x16x32_bf16 v[144:147], a[120:123], v[36:39], v[144:147]
    v_mfma_f32_16x16x32_bf16 v[148:151], a[192:195], v[36:39], v[148:151]
    s_waitcnt lgkmcnt(0)
    v_mfma_f32_16x16x32_bf16 v[128:131], a[52:55], v[64:67], v[128:131]
    v_mfma_f32_16x16x32_bf16 v[132:135], a[124:127], v[64:67], v[132:135]
    s_waitcnt vmcnt(1)
    v_mfma_f32_16x16x32_bf16 v[136:139], a[196:199], v[64:67], v[136:139]
    v_mfma_f32_16x16x32_bf16 v[140:143], a[52:55], v[68:71], v[140:143]
    s_barrier
    v_mfma_f32_16x16x32_bf16 v[144:147], a[124:127], v[68:71], v[144:147]
    v_mfma_f32_16x16x32_bf16 v[148:151], a[196:199], v[68:71], v[148:151]
    ds_read_b128 v[32:35], v8 offset:28672
    ds_read_b128 v[36:39], v8 offset:30720
    s_waitcnt lgkmcnt(0)
    v_mfma_f32_16x16x32_bf16 v[128:131], a[56:59], v[32:35], v[128:131]
    v_mfma_f32_16x16x32_bf16 v[132:135], a[128:131], v[32:35], v[132:135]
    ds_read_b128 v[64:67], v9 offset:28672
    v_mfma_f32_16x16x32_bf16 v[136:139], a[200:203], v[32:35], v[136:139]
    v_mfma_f32_16x16x32_bf16 v[140:143], a[56:59], v[36:39], v[140:143]
    ds_read_b128 v[68:71], v9 offset:30720
    v_mfma_f32_16x16x32_bf16 v[144:147], a[128:131], v[36:39], v[144:147]
    v_mfma_f32_16x16x32_bf16 v[148:151], a[200:203], v[36:39], v[148:151]
    s_waitcnt lgkmcnt(0)
    v_mfma_f32_16x16x32_bf16 v[128:131], a[60:63], v[64:67], v[128:131]
    v_mfma_f32_16x16x32_bf16 v[132:135], a[132:135], v[64:67], v[132:135]
    s_waitcnt vmcnt(0)
    v_mfma_f32_16x16x32_bf16 v[136:139], a[204:207], v[64:67], v[136:139]
    v_mfma_f32_16x16x32_bf16 v[140:143], a[60:63], v[68:71], v[140:143]
    s_barrier
    v_mfma_f32_16x16x32_bf16 v[144:147], a[132:135], v[68:71], v[144:147]
    v_mfma_f32_16x16x32_bf16 v[148:151], a[204:207], v[68:71], v[148:151]
    ds_read_b128 v[32:35], v8 offset:32768
    ds_read_b128 v[36:39], v8 offset:34816
    s_waitcnt lgkmcnt(0)
    v_mfma_f32_16x16x32_bf16 v[128:131], a[64:67], v[32:35], v[128:131]
    v_mfma_f32_16x16x32_bf16 v[132:135], a[136:139], v[32:35], v[132:135]
    ds_read_b128 v[64:67], v9 offset:32768
    v_mfma_f32_16x16x32_bf16 v[136:139], a[208:211], v[32:35], v[136:139]
    v_mfma_f32_16x16x32_bf16 v[140:143], a[64:67], v[36:39], v[140:143]
    ds_read_b128 v[68:71], v9 offset:34816
    v_mfma_f32_16x16x32_bf16 v[144:147], a[136:139], v[36:39], v[144:147]
    v_mfma_f32_16x16x32_bf16 v[148:151], a[208:211], v[36:39], v[148:151]
    s_waitcnt lgkmcnt(0)
    v_mfma_f32_16x16x32_bf16 v[128:131], a[68:71], v[64:67], v[128:131]
    v_mfma_f32_16x16x32_bf16 v[132:135], a[140:143], v[64:67], v[132:135]
    v_mfma_f32_16x16x32_bf16 v[136:139], a[212:215], v[64:67], v[136:139]
    v_mfma_f32_16x16x32_bf16 v[140:143], a[68:71], v[68:71], v[140:143]
    v_mfma_f32_16x16x32_bf16 v[144:147], a[140:143], v[68:71], v[144:147]
    v_mfma_f32_16x16x32_bf16 v[148:151], a[212:215], v[68:71], v[148:151]
    s_nop 7
    s_mov_b32 s53, 98304
    s_mov_b32 s56, 1152
    s_mul_i32 s57, s78, 2359296
    s_mul_i32 s54, s52, 1152
    s_add_u32 s57, s57, s54
    s_mul_i32 s54, s79, 384
    s_add_u32 s57, s57, s54
    s_add_u32 s57, s57, 167772160
    v_and_b32 v1, 63, v0
    v_and_b32 v2, 31, v1
    v_mul_u32_u24 v2, 384, v2
    v_add_u32 v2, s53, v2
    v_lshrrev_b32 v3, 5, v1
    s_mul_i32 s36, s17, 6
    v_add_u32 v3, s36, v3
    v_and_b32 v4, 7, v1
    v_add_u32 v5, 0, v3
    v_xor_b32 v5, v5, v4
    v_lshlrev_b32 v5, 4, v5
    v_add_u32 v16, v2, v5
    v_add_u32 v5, 2, v3
    v_xor_b32 v5, v5, v4
    v_lshlrev_b32 v5, 4, v5
    v_add_u32 v17, v2, v5
    v_add_u32 v5, 4, v3
    v_xor_b32 v5, v5, v4
    v_lshlrev_b32 v5, 4, v5
    v_add_u32 v18, v2, v5
    v_cvt_pk_bf16_f32 v32, v128, v129
    v_cvt_pk_bf16_f32 v33, v130, v131
    v_cvt_pk_bf16_f32 v34, v140, v141
    v_cvt_pk_bf16_f32 v35, v142, v143
    s_nop 0
    v_permlane16_swap_b32 v32, v34
    v_permlane16_swap_b32 v33, v35
    ds_write_b128 v16, v[32:35] offset:0
    v_cvt_pk_bf16_f32 v36, v132, v133
    v_cvt_pk_bf16_f32 v37, v134, v135
    v_cvt_pk_bf16_f32 v38, v144, v145
    v_cvt_pk_bf16_f32 v39, v146, v147
    s_nop 0
    v_permlane16_swap_b32 v36, v38
    v_permlane16_swap_b32 v37, v39
    ds_write_b128 v17, v[36:39] offset:0
    v_cvt_pk_bf16_f32 v40, v136, v137
    v_cvt_pk_bf16_f32 v41, v138, v139
    v_cvt_pk_bf16_f32 v42, v148, v149
    v_cvt_pk_bf16_f32 v43, v150, v151
    s_nop 0
    v_permlane16_swap_b32 v40, v42
    v_permlane16_swap_b32 v41, v43
    ds_write_b128 v18, v[40:43] offset:0
    v_cmp_le_u32 vcc, 24, v1
    s_nop 1
    v_cndmask_b32 v2, 0, 1, vcc
    v_mul_u32_u24 v3, 24, v2
    v_sub_u32 v3, v1, v3
    s_mul_i32 s36, s17, 8
    v_xor_b32 v4, v3, v2
    v_lshlrev_b32 v4, 4, v4
    v_add_u32 v2, s36, v2
    v_mul_u32_u24 v5, 384, v2
    v_add_u32 v5, s53, v5
    v_mul_lo_u32 v2, v2, s56
    v_lshlrev_b32 v3, 4, v3
    v_add_u32 v18, v2, v3
    v_mov_b32 v2, 0x40000000
    v_cmp_gt_u32 vcc, 48, v1
    s_nop 1
    v_cndmask_b32 v18, v2, v18, vcc
    s_lshl_b32 s37, s56, 1
    s_mov_b32 s39, s57
    v_xor_b32 v3, 0, v4
    v_add_u32 v20, v5, v3
    v_xor_b32 v3, 32, v4
    v_add_u32 v21, v5, v3
    v_xor_b32 v3, 64, v4
    v_add_u32 v22, v5, v3
    v_xor_b32 v3, 96, v4
    v_add_u32 v23, v5, v3
    s_waitcnt lgkmcnt(0)
    s_barrier
    ds_read_b128 v[32:35], v20 offset:0
    ds_read_b128 v[36:39], v21 offset:768
    ds_read_b128 v[40:43], v22 offset:1536
    ds_read_b128 v[44:47], v23 offset:2304
    s_waitcnt lgkmcnt(3)
    buffer_store_dwordx4 v[32:35], v18, s[4:7], s39 offen sc1
    s_add_u32 s39, s39, s37
    s_waitcnt lgkmcnt(2)
    buffer_store_dwordx4 v[36:39], v18, s[4:7], s39 offen sc1
    s_add_u32 s39, s39, s37
    s_waitcnt lgkmcnt(1)
    buffer_store_dwordx4 v[40:43], v18, s[4:7], s39 offen sc1
    s_add_u32 s39, s39, s37
    s_waitcnt lgkmcnt(0)
    buffer_store_dwordx4 v[44:47], v18, s[4:7], s39 offen sc1
    s_lshl_b32 s67, s65, 2
    s_and_b32 s20, s66, 3
    s_add_u32 s67, s67, s20
    s_lshl_b32 s67, s67, 8
    s_add_u32 s67, s67, 1785856
    s_waitcnt vmcnt(0)
    s_barrier
    s_cmp_lg_u32 s17, 0
    s_cbranch_scc1 Ls_85
    s_mov_b64 exec, 1
    v_mov_b32 v2, 0
    v_mov_b32 v3, 1
    buffer_atomic_add v3, v2, s[4:7], s67 offen
    s_mov_b64 exec, -1
Ls_85:
    s_branch Lexit
Lp_fin:
    s_cmp_eq_u32 s65, 31
    s_cselect_b32 s68, 48, 24
    s_lshl_b32 s67, s65, 2
    s_lshl_b32 s67, s67, 8
    s_add_u32 s67, s67, 1785856
    s_cmp_lg_u32 s17, 0
    s_cbranch_scc1 Lw_88
    v_and_b32 v2, 63, v0
    v_lshlrev_b32 v2, 8, v2
    s_mov_b64 exec, 0xf
    s_mov_b32 s70, 0
Lw_86:
    buffer_load_dword v3, v2, s[4:7], s67 offen sc1
    s_waitcnt vmcnt(0)
    v_readlane_b32 s69, v3, 0
    v_readlane_b32 s20, v3, 1
    s_nop 2
    s_add_u32 s69, s69, s20
    v_readlane_b32 s20, v3, 2
    s_nop 2
    s_add_u32 s69, s69, s20
    v_readlane_b32 s20, v3, 3
    s_nop 2
    s_add_u32 s69, s69, s20
    s_cmp_ge_u32 s69, s68
    s_cbranch_scc1 Lw_87
    s_cmp_ge_u32 s70, 2
    s_cbranch_scc1 Lb_89
    s_cmp_ge_u32 s65, 28
    s_cbranch_scc1 Lb_89
    s_sleep 24
Lb_89:
    s_sleep 2
    s_add_u32 s70, s70, 1
    s_cmp_lt_u32 s70, 524288
    s_cbranch_scc1 Lw_86
    s_branch Lfail
Lw_87:
    s_mov_b64 exec, -1
Lw_88:
    s_barrier
    s_sub_u32 s20, s66, 208
    s_lshl_b32 s20, s20, 2
    s_lshl_b32 s50, s65, 6
    s_add_u32 s50, s50, s20
    s_mov_b32 s49, 4
    s_load_dwordx2 s[8:9], s[0:1], 0
    s_load_dwordx2 s[12:13], s[0:1], 80
    s_waitcnt lgkmcnt(0)
    s_mov_b32 s10, 2359296
    s_mov_b32 s11, 0x20000
    s_mov_b32 s14, 2359296
    s_mov_b32 s15, 0x20000
    v_and_b32 v1, 63, v0
    v_cmp_gt_u32 vcc, 36, v1
    v_lshlrev_b32 v2, 4, v1
    v_mov_b32 v3, 0x40000000
    v_cndmask_b32 v2, v3, v2, vcc
    v_mov_b32 v4, v2
    s_mov_b64 s[60:61], vcc
    s_add_u32 s51, s17, 0
    s_add_u32 s59, s51, s50
    s_mul_i32 s52, s59, 1152
    s_mul_i32 s55, s59, 2304
    s_cmp_lt_u32 s51, s49
    s_cselect_b32 s52, s52, 0x40000000
    s_cselect_b32 s55, s55, 0x40000000
    s_add_u32 s58, s55, 83886080
    buffer_load_dwordx4 v[16:19], v4, s[4:7], s58 offen offset:0 sc1
    buffer_load_dwordx4 v[20:23], v4, s[4:7], s58 offen offset:576 sc1
    buffer_load_dwordx4 v[24:27], v4, s[4:7], s58 offen offset:1152 sc1
    buffer_load_dwordx4 v[28:31], v4, s[4:7], s58 offen offset:1728 sc1
    s_add_u32 s58, s52, 167772160
    buffer_load_dwordx4 v[112:115], v2, s[4:7], s58 offen sc1
    buffer_load_dwordx4 v[116:119], v2, s[4:7], s58 offen offset:576 sc1
    s_add_u32 s58, s52, 170131456
    buffer_load_dwordx4 v[120:123], v2, s[4:7], s58 offen sc1
    buffer_load_dwordx4 v[124:127], v2, s[4:7], s58 offen offset:576 sc1
    s_add_u32 s58, s52, 172490752
    buffer_load_dwordx4 v[128:131], v2, s[4:7], s58 offen sc1
    buffer_load_dwordx4 v[132:135], v2, s[4:7], s58 offen offset:576 sc1
    s_add_u32 s58, s52, 174850048
    buffer_load_dwordx4 v[136:139], v2, s[4:7], s58 offen sc1
    buffer_load_dwordx4 v[140:143], v2, s[4:7], s58 offen offset:576 sc1
    s_add_u32 s58, s52, 177209344
    buffer_load_dwordx4 v[144:147], v2, s[4:7], s58 offen sc1
    buffer_load_dwordx4 v[148:151], v2, s[4:7], s58 offen offset:576 sc1
    s_add_u32 s58, s52, 179568640
    buffer_load_dwordx4 v[152:155], v2, s[4:7], s58 offen sc1
    buffer_load_dwordx4 v[156:159], v2, s[4:7], s58 offen offset:576 sc1
    s_add_u32 s58, s52, 181927936
    buffer_load_dwordx4 v[160:163], v2, s[4:7], s58 offen sc1
    buffer_load_dwordx4 v[164:167], v2, s[4:7], s58 offen offset:576 sc1
    s_add_u32 s58, s52, 184287232
    buffer_load_dwordx4 v[168:171], v2, s[4:7], s58 offen sc1
    buffer_load_dwordx4 v[172:175], v2, s[4:7], s58 offen offset:576 sc1
    s_waitcnt vmcnt(0)
    v_lshlrev_b32 v5, 16, v112
    v_and_b32 v6, 0xffff0000, v112
    v_add_f32 v16, v16, v5
    v_add_f32 v17, v17, v6
    v_lshlrev_b32 v5, 16, v113
    v_and_b32 v6, 0xffff0000, v113
    v_add_f32 v18, v18, v5
    v_add_f32 v19, v19, v6
    v_lshlrev_b32 v5, 16, v114
    v_and_b32 v6, 0xffff0000, v114
    v_add_f32 v20, v20, v5
    v_add_f32 v21, v21, v6
    v_lshlrev_b32 v5, 16, v115
    v_and_b32 v6, 0xffff0000, v115
    v_add_f32 v22, v22, v5
    v_add_f32 v23, v23, v6
    v_lshlrev_b32 v5, 16, v116
    v_and_b32 v6, 0xffff0000, v116
    v_add_f32 v24, v24, v5
    v_add_f32 v25, v25, v6
    v_lshlrev_b32 v5, 16, v117
    v_and_b32 v6, 0xffff0000, v117
    v_add_f32 v26, v26, v5
    v_add_f32 v27, v27, v6
    v_lshlrev_b32 v5, 16, v118
    v_and_b32 v6, 0xffff0000, v118
    v_add_f32 v28, v28, v5
    v_add_f32 v29, v29, v6
    v_lshlrev_b32 v5, 16, v119
    v_and_b32 v6, 0xffff0000, v119
    v_add_f32 v30, v30, v5
    v_add_f32 v31, v31, v6
    v_lshlrev_b32 v5, 16, v120
    v_and_b32 v6, 0xffff0000, v120
    v_add_f32 v16, v16, v5
    v_add_f32 v17, v17, v6
    v_lshlrev_b32 v5, 16, v121
    v_and_b32 v6, 0xffff0000, v121
    v_add_f32 v18, v18, v5
    v_add_f32 v19, v19, v6
    v_lshlrev_b32 v5, 16, v122
    v_and_b32 v6, 0xffff0000, v122
    v_add_f32 v20, v20, v5
    v_add_f32 v21, v21, v6
    v_lshlrev_b32 v5, 16, v123
    v_and_b32 v6, 0xffff0000, v123
    v_add_f32 v22, v22, v5
    v_add_f32 v23, v23, v6
    v_lshlrev_b32 v5, 16, v124
    v_and_b32 v6, 0xffff0000, v124
    v_add_f32 v24, v24, v5
    v_add_f32 v25, v25, v6
    v_lshlrev_b32 v5, 16, v125
    v_and_b32 v6, 0xffff0000, v125
    v_add_f32 v26, v26, v5
    v_add_f32 v27, v27, v6
    v_lshlrev_b32 v5, 16, v126
    v_and_b32 v6, 0xffff0000, v126
    v_add_f32 v28, v28, v5
    v_add_f32 v29, v29, v6
    v_lshlrev_b32 v5, 16, v127
    v_and_b32 v6, 0xffff0000, v127
    v_add_f32 v30, v30, v5
    v_add_f32 v31, v31, v6
    v_lshlrev_b32 v5, 16, v128
    v_and_b32 v6, 0xffff0000, v128
    v_add_f32 v16, v16, v5
    v_add_f32 v17, v17, v6
    v_lshlrev_b32 v5, 16, v129
    v_and_b32 v6, 0xffff0000, v129
    v_add_f32 v18, v18, v5
    v_add_f32 v19, v19, v6
    v_lshlrev_b32 v5, 16, v130
    v_and_b32 v6, 0xffff0000, v130
    v_add_f32 v20, v20, v5
    v_add_f32 v21, v21, v6
    v_lshlrev_b32 v5, 16, v131
    v_and_b32 v6, 0xffff0000, v131
    v_add_f32 v22, v22, v5
    v_add_f32 v23, v23, v6
    v_lshlrev_b32 v5, 16, v132
    v_and_b32 v6, 0xffff0000, v132
    v_add_f32 v24, v24, v5
    v_add_f32 v25, v25, v6
    v_lshlrev_b32 v5, 16, v133
    v_and_b32 v6, 0xffff0000, v133
    v_add_f32 v26, v26, v5
    v_add_f32 v27, v27, v6
    v_lshlrev_b32 v5, 16, v134
    v_and_b32 v6, 0xffff0000, v134
    v_add_f32 v28, v28, v5
    v_add_f32 v29, v29, v6
    v_lshlrev_b32 v5, 16, v135
    v_and_b32 v6, 0xffff0000, v135
    v_add_f32 v30, v30, v5
    v_add_f32 v31, v31, v6
    v_lshlrev_b32 v5, 16, v136
    v_and_b32 v6, 0xffff0000, v136
    v_add_f32 v16, v16, v5
    v_add_f32 v17, v17, v6
    v_lshlrev_b32 v5, 16, v137
    v_and_b32 v6, 0xffff0000, v137
    v_add_f32 v18, v18, v5
    v_add_f32 v19, v19, v6
    v_lshlrev_b32 v5, 16, v138
    v_and_b32 v6, 0xffff0000, v138
    v_add_f32 v20, v20, v5
    v_add_f32 v21, v21, v6
    v_lshlrev_b32 v5, 16, v139
    v_and_b32 v6, 0xffff0000, v139
    v_add_f32 v22, v22, v5
    v_add_f32 v23, v23, v6
    v_lshlrev_b32 v5, 16, v140
    v_and_b32 v6, 0xffff0000, v140
    v_add_f32 v24, v24, v5
    v_add_f32 v25, v25, v6
    v_lshlrev_b32 v5, 16, v141
    v_and_b32 v6, 0xffff0000, v141
    v_add_f32 v26, v26, v5
    v_add_f32 v27, v27, v6
    v_lshlrev_b32 v5, 16, v142
    v_and_b32 v6, 0xffff0000, v142
    v_add_f32 v28, v28, v5
    v_add_f32 v29, v29, v6
    v_lshlrev_b32 v5, 16, v143
    v_and_b32 v6, 0xffff0000, v143
    v_add_f32 v30, v30, v5
    v_add_f32 v31, v31, v6
    v_lshlrev_b32 v5, 16, v144
    v_and_b32 v6, 0xffff0000, v144
    v_add_f32 v16, v16, v5
    v_add_f32 v17, v17, v6
    v_lshlrev_b32 v5, 16, v145
    v_and_b32 v6, 0xffff0000, v145
    v_add_f32 v18, v18, v5
    v_add_f32 v19, v19, v6
    v_lshlrev_b32 v5, 16, v146
    v_and_b32 v6, 0xffff0000, v146
    v_add_f32 v20, v20, v5
    v_add_f32 v21, v21, v6
    v_lshlrev_b32 v5, 16, v147
    v_and_b32 v6, 0xffff0000, v147
    v_add_f32 v22, v22, v5
    v_add_f32 v23, v23, v6
    v_lshlrev_b32 v5, 16, v148
    v_and_b32 v6, 0xffff0000, v148
    v_add_f32 v24, v24, v5
    v_add_f32 v25, v25, v6
    v_lshlrev_b32 v5, 16, v149
    v_and_b32 v6, 0xffff0000, v149
    v_add_f32 v26, v26, v5
    v_add_f32 v27, v27, v6
    v_lshlrev_b32 v5, 16, v150
    v_and_b32 v6, 0xffff0000, v150
    v_add_f32 v28, v28, v5
    v_add_f32 v29, v29, v6
    v_lshlrev_b32 v5, 16, v151
    v_and_b32 v6, 0xffff0000, v151
    v_add_f32 v30, v30, v5
    v_add_f32 v31, v31, v6
    v_lshlrev_b32 v5, 16, v152
    v_and_b32 v6, 0xffff0000, v152
    v_add_f32 v16, v16, v5
    v_add_f32 v17, v17, v6
    v_lshlrev_b32 v5, 16, v153
    v_and_b32 v6, 0xffff0000, v153
    v_add_f32 v18, v18, v5
    v_add_f32 v19, v19, v6
    v_lshlrev_b32 v5, 16, v154
    v_and_b32 v6, 0xffff0000, v154
    v_add_f32 v20, v20, v5
    v_add_f32 v21, v21, v6
    v_lshlrev_b32 v5, 16, v155
    v_and_b32 v6, 0xffff0000, v155
    v_add_f32 v22, v22, v5
    v_add_f32 v23, v23, v6
    v_lshlrev_b32 v5, 16, v156
    v_and_b32 v6, 0xffff0000, v156
    v_add_f32 v24, v24, v5
    v_add_f32 v25, v25, v6
    v_lshlrev_b32 v5, 16, v157
    v_and_b32 v6, 0xffff0000, v157
    v_add_f32 v26, v26, v5
    v_add_f32 v27, v27, v6
    v_lshlrev_b32 v5, 16, v158
    v_and_b32 v6, 0xffff0000, v158
    v_add_f32 v28, v28, v5
    v_add_f32 v29, v29, v6
    v_lshlrev_b32 v5, 16, v159
    v_and_b32 v6, 0xffff0000, v159
    v_add_f32 v30, v30, v5
    v_add_f32 v31, v31, v6
    v_lshlrev_b32 v5, 16, v160
    v_and_b32 v6, 0xffff0000, v160
    v_add_f32 v16, v16, v5
    v_add_f32 v17, v17, v6
    v_lshlrev_b32 v5, 16, v161
    v_and_b32 v6, 0xffff0000, v161
    v_add_f32 v18, v18, v5
    v_add_f32 v19, v19, v6
    v_lshlrev_b32 v5, 16, v162
    v_and_b32 v6, 0xffff0000, v162
    v_add_f32 v20, v20, v5
    v_add_f32 v21, v21, v6
    v_lshlrev_b32 v5, 16, v163
    v_and_b32 v6, 0xffff0000, v163
    v_add_f32 v22, v22, v5
    v_add_f32 v23, v23, v6
    v_lshlrev_b32 v5, 16, v164
    v_and_b32 v6, 0xffff0000, v164
    v_add_f32 v24, v24, v5
    v_add_f32 v25, v25, v6
    v_lshlrev_b32 v5, 16, v165
    v_and_b32 v6, 0xffff0000, v165
    v_add_f32 v26, v26, v5
    v_add_f32 v27, v27, v6
    v_lshlrev_b32 v5, 16, v166
    v_and_b32 v6, 0xffff0000, v166
    v_add_f32 v28, v28, v5
    v_add_f32 v29, v29, v6
    v_lshlrev_b32 v5, 16, v167
    v_and_b32 v6, 0xffff0000, v167
    v_add_f32 v30, v30, v5
    v_add_f32 v31, v31, v6
    v_lshlrev_b32 v5, 16, v168
    v_and_b32 v6, 0xffff0000, v168
    v_add_f32 v16, v16, v5
    v_add_f32 v17, v17, v6
    v_lshlrev_b32 v5, 16, v169
    v_and_b32 v6, 0xffff0000, v169
    v_add_f32 v18, v18, v5
    v_add_f32 v19, v19, v6
    v_lshlrev_b32 v5, 16, v170
    v_and_b32 v6, 0xffff0000, v170
    v_add_f32 v20, v20, v5
    v_add_f32 v21, v21, v6
    v_lshlrev_b32 v5, 16, v171
    v_and_b32 v6, 0xffff0000, v171
    v_add_f32 v22, v22, v5
    v_add_f32 v23, v23, v6
    v_lshlrev_b32 v5, 16, v172
    v_and_b32 v6, 0xffff0000, v172
    v_add_f32 v24, v24, v5
    v_add_f32 v25, v25, v6
    v_lshlrev_b32 v5, 16, v173
    v_and_b32 v6, 0xffff0000, v173
    v_add_f32 v26, v26, v5
    v_add_f32 v27, v27, v6
    v_lshlrev_b32 v5, 16, v174
    v_and_b32 v6, 0xffff0000, v174
    v_add_f32 v28, v28, v5
    v_add_f32 v29, v29, v6
    v_lshlrev_b32 v5, 16, v175
    v_and_b32 v6, 0xffff0000, v175
    v_add_f32 v30, v30, v5
    v_add_f32 v31, v31, v6
    v_cvt_pk_bf16_f32 v48, v16, v17
    v_cvt_pk_bf16_f32 v49, v18, v19
    v_cvt_pk_bf16_f32 v50, v20, v21
    v_cvt_pk_bf16_f32 v51, v22, v23
    v_cvt_pk_bf16_f32 v52, v24, v25
    v_cvt_pk_bf16_f32 v53, v26, v27
    v_cvt_pk_bf16_f32 v54, v28, v29
    v_cvt_pk_bf16_f32 v55, v30, v31
    buffer_store_dwordx4 v[48:51], v2, s[12:15], s52 offen sc1
    buffer_store_dwordx4 v[52:55], v2, s[12:15], s52 offen offset:576 sc1
    s_waitcnt vmcnt(0)
    s_add_u32 s65, s65, 1
    s_cmp_lt_u32 s65, 32
    s_cbranch_scc1 Lp_fin
    s_branch Lexit
Lchain_fail:
Lfail:
    s_load_dwordx2 s[12:13], s[0:1], 88
    s_waitcnt lgkmcnt(0)
    s_mov_b32 s14, 256
    s_mov_b32 s15, 0x20000
    s_mov_b64 exec, 1
    v_mov_b32 v2, 0xdead
    v_mov_b32 v3, 20
    buffer_store_dword v2, v3, s[12:15], 0 offen
    v_mov_b32 v2, s2
    v_mov_b32 v3, 24
    buffer_store_dword v2, v3, s[12:15], 0 offen
    s_waitcnt vmcnt(0)
Lexit:
Lexit2:
    s_endpgm
.section .rodata,"a"
.p2align 6
.amdhsa_kernel sequential_preLN__memory_aug_recurrent_mem_tr__dense_activation_relu__prompt_kernel
  .amdhsa_next_free_vgpr 512
  .amdhsa_next_free_sgpr 102
  .amdhsa_accum_offset 256
  .amdhsa_group_segment_fixed_size 0
  .amdhsa_kernarg_size 104
  .amdhsa_user_sgpr_count 2
  .amdhsa_user_sgpr_kernarg_segment_ptr 1
  .amdhsa_system_sgpr_workgroup_id_x 1
  .amdhsa_float_denorm_mode_32 3
  .amdhsa_float_denorm_mode_16_64 3
.end_amdhsa_kernel
.text
```
